```python
import torch

def _softmax(x, axis=-1):
    return torch.softmax(x, dim=axis)
def _gelu(x):
    return torch.nn.functional.gelu(x, approximate="tanh")
def _silu(x):
    return torch.nn.functional.silu(x)
def _sigmoid(x):
    return torch.sigmoid(x)
def _layernorm(x, axis=-1, eps=1e-5):
    m = x.mean(dim=axis, keepdim=True)
    v = x.var(dim=axis, keepdim=True, unbiased=False)
    return (x - m) / torch.sqrt(v + eps)
def _scatter_add(tgt, idx, src, axis=0):
    return tgt.clone().index_add_(axis, idx, src)
def _segment_sum(src, seg, n):
    out = torch.zeros((n,) + src.shape[1:], dtype=src.dtype)
    return out.index_add_(0, seg, src)
def _pad(x, pw):
    flat = tuple(v for pair in reversed(pw) for v in pair)
    return torch.nn.functional.pad(x, flat)

kernel_name = 'parallel_sum__linear_kernel_hedgehog__glu_gated_glu__prompt'

def setup_inputs():

    _w = (lambda a: (lambda t: t.to(torch.bfloat16) if t.is_floating_point() else t)(torch.as_tensor(a)))
    def _A_setup():
        B, S, D, H = 1, 2048, 512, 32
        Dh = D // H
        return {
            "x": _w((lambda *s: torch.randn(*s, dtype=torch.bfloat16) * 0.05)(B, S, D)),
            "wqkv": _w((lambda *s: torch.randn(*s, dtype=torch.bfloat16) * 0.4)(D, 3 * D)),
            "w_phi": _w((lambda *s: torch.randn(*s, dtype=torch.bfloat16) * 0.4)(H, Dh, Dh) * (Dh ** -0.5)),
            "wo": _w((lambda *s: torch.randn(*s, dtype=torch.bfloat16) * 0.1)(D, D)),
        }
    _A_in = _A_setup()

    def _B_setup():
        B, S, D, F = 1, 2048, 512, 1792
        return {
            "x": _w((lambda *s: torch.randn(*s, dtype=torch.bfloat16) * 0.05)(B, S, D)),
            "w_gate": _w((lambda *s: torch.randn(*s, dtype=torch.bfloat16) * 0.05)(D, F)),
            "w_up": _w((lambda *s: torch.randn(*s, dtype=torch.bfloat16) * 0.05)(D, F)),
            "w_down": _w((lambda *s: torch.randn(*s, dtype=torch.bfloat16) * 0.05)(F, D)),
        }
    _B_in = _B_setup()

    return {
        "A_x": _A_in["x"],
        "A_wqkv": _A_in["wqkv"],
        "A_w_phi": _A_in["w_phi"],
        "A_wo": _A_in["wo"],
        "B_x": _B_in["x"],
        "B_w_gate": _B_in["w_gate"],
        "B_w_up": _B_in["w_up"],
        "B_w_down": _B_in["w_down"],
    }

def reference(A_x, A_wqkv, A_w_phi, A_wo, B_x, B_w_gate, B_w_up, B_w_down):
    def _A_ref(x, wqkv, w_phi, wo):
        B, S, D = x.shape
        H = 32; Dh = D // H
        qkv = (lambda x, *d: x.permute(*d))((x @ wqkv).reshape(B, S, 3, H, Dh), 2, 0, 3, 1, 4)
        q, k, v = qkv[0], qkv[1], qkv[2]
        pq = torch.einsum("bhsd,hdf->bhsf", q, w_phi)
        pk = torch.einsum("bhsd,hdf->bhsf", k, w_phi)
        phi_q = torch.concatenate([_softmax(pq, axis=-1), _softmax(-pq, axis=-1)], axis=-1)
        phi_k = torch.concatenate([_softmax(pk, axis=-1), _softmax(-pk, axis=-1)], axis=-1)
        kv = torch.einsum("bhsf,bhsd->bhfd", phi_k, v)
        z  = torch.einsum("bhsf->bhf", phi_k)
        num = torch.einsum("bhqf,bhfd->bhqd", phi_q, kv)
        den = torch.einsum("bhqf,bhf->bhq", phi_q, z)[..., None] + 1e-6
        o = num / den
        return (lambda x, *d: x.permute(*d))(o, 0, 2, 1, 3).reshape(B, S, D) @ wo

    def _B_ref(x, w_gate, w_up, w_down):
        g = torch.einsum("bsd,df->bsf", x, w_gate)
        u = torch.einsum("bsd,df->bsf", x, w_up)
        h = _sigmoid(g) * u
        return torch.einsum("bsf,fd->bsd", h, w_down)

    x = A_x
    xn = _layernorm(x, axis=-1)
    return x + _A_ref(xn, A_wqkv, A_w_phi, A_wo) + _B_ref(xn, B_w_gate, B_w_up, B_w_down)
```

```asm
; @launch grid=(256,1,1) block=(512,1,1) lds=163840
.amdgcn_target "amdgcn-amd-amdhsa--gfx950"
.text
.globl parallel_sum__linear_kernel_hedgehog__glu_gated_glu__prompt_kernel
.p2align 8
.type parallel_sum__linear_kernel_hedgehog__glu_gated_glu__prompt_kernel,@function
parallel_sum__linear_kernel_hedgehog__glu_gated_glu__prompt_kernel:
  s_cmp_ge_u32 s2, 256
  s_cbranch_scc1 L_end
  s_load_dwordx16 s[4:19], s[0:1], 0
  s_load_dwordx4 s[20:23], s[0:1], 64
  s_load_dwordx2 s[24:25], s[0:1], 80
  s_getpc_b64 s[100:101]
L_pcref:
  s_lshr_b32 s76, s2, 3
  s_lshl_b32 s76, s76, 12
  s_min_u32 s76, s76, L_codeend-L_pcref-4096
  s_add_u32 s100, s100, s76
  s_addc_u32 s101, s101, 0
  v_lshlrev_b32 v1, 3, v0
  global_load_dword v252, v1, s[100:101]
  v_lshrrev_b32 v1, 6, v0
  v_and_b32 v0, 63, v0
  v_readfirstlane_b32 s80, v1
  s_and_b32 s76, s2, 7
  s_lshr_b32 s77, s2, 3
  s_and_b32 s69, s76, 1
  s_lshl_b32 s69, s69, 3
  s_lshr_b32 s78, s77, 2
  s_add_u32 s69, s69, s78
  s_bfe_u32 s71, s77, 0x10001
  s_and_b32 s70, s76, 6
  s_and_b32 s78, s77, 1
  s_add_u32 s70, s70, s78
  s_and_b32 s78, s77, 1
  s_lshl_b32 s78, s78, 2
  s_add_u32 s72, s69, s78
  s_and_b32 s72, s72, 7
  s_lshl_b32 s73, s76, 2
  s_lshr_b32 s78, s77, 3
  s_add_u32 s73, s73, s78
  s_and_b32 s74, s77, 7
  s_and_b32 s68, s80, 3
  v_lshlrev_b32 v1, 4, v0
  s_mov_b32 s87, 0xffff0000
  s_cmp_ge_u32 s80, 4
  s_cbranch_scc1 L_p2
  v_lshrrev_b32 v36, 3, v0
  v_lshlrev_b32 v36, 10, v36
  v_lshrrev_b32 v37, 4, v0
  v_and_b32 v38, 7, v0
  v_xor_b32 v38, v38, v37
  v_lshl_add_u32 v32, v38, 4, v36
  v_xor_b32 v33, 64, v32
  v_add_u32 v33, 7168, v33
  v_add_u32 v34, 14336, v32
  v_add_u32 v35, 14336, v33
  s_lshl_b32 s76, s69, 2
  s_add_u32 s76, s76, s68
  s_lshl_b32 s77, s76, 15
  s_mul_i32 s78, s68, 28672
  s_add_u32 s78, s78, 32768
  s_waitcnt lgkmcnt(0)
  s_mov_b32 s28, s4
  s_mov_b32 s29, s5
  s_mov_b32 s30, 0x200000
  s_mov_b32 s31, 0x20000
  s_add_u32 s79, s72, 0
  s_and_b32 s79, s79, 7
  s_lshl_b32 s79, s79, 7
  s_add_u32 m0, s78, 0
  s_add_u32 s79, s79, s77
  buffer_load_dwordx4 v32, s[28:31], s79 offen offset:0 lds
  buffer_load_dwordx4 v33, s[28:31], s79 offen offset:1024 lds
  buffer_load_dwordx4 v34, s[28:31], s79 offen offset:2048 lds
  buffer_load_dwordx4 v35, s[28:31], s79 offen offset:3072 lds
  s_add_u32 s79, s72, 1
  s_and_b32 s79, s79, 7
  s_lshl_b32 s79, s79, 7
  s_add_u32 m0, s78, 4096
  s_add_u32 s79, s79, s77
  buffer_load_dwordx4 v32, s[28:31], s79 offen offset:0 lds
  buffer_load_dwordx4 v33, s[28:31], s79 offen offset:1024 lds
  buffer_load_dwordx4 v34, s[28:31], s79 offen offset:2048 lds
  buffer_load_dwordx4 v35, s[28:31], s79 offen offset:3072 lds
  s_add_u32 s79, s72, 2
  s_and_b32 s79, s79, 7
  s_lshl_b32 s79, s79, 7
  s_add_u32 m0, s78, 8192
  s_add_u32 s79, s79, s77
  buffer_load_dwordx4 v32, s[28:31], s79 offen offset:0 lds
  buffer_load_dwordx4 v33, s[28:31], s79 offen offset:1024 lds
  buffer_load_dwordx4 v34, s[28:31], s79 offen offset:2048 lds
  buffer_load_dwordx4 v35, s[28:31], s79 offen offset:3072 lds
  s_mov_b32 s32, s24
  s_mov_b32 s33, s25
  s_mov_b32 s34, 0x1000000
  s_mov_b32 s35, 0x20000
  s_mov_b32 s36, s22
  s_mov_b32 s37, s23
  s_mov_b32 s38, 0x100
  s_mov_b32 s39, 0x20000
  s_mul_i32 s27, s76, 147456
  s_lshl_b32 s80, s76, 5
  s_lshl_b32 s81, s71, 3
  s_add_u32 s80, s80, s81
  s_add_u32 s80, s80, s70
  s_lshl_b32 s80, s80, 7
  s_add_u32 s88, s80, 11534336
  s_mov_b32 s3, 0xbfb8aa3b
  s_mov_b32 s26, 0x3fb8aa3b
  v_and_b32 v36, 31, v0
  v_lshlrev_b32 v37, 7, v36
  v_bfe_u32 v38, v0, 1, 3
  v_lshrrev_b32 v39, 5, v0
  v_xor_b32 v38, v38, v39
  v_lshl_add_u32 v37, v38, 4, v37
  v_add_u32 v40, s78, v37
  v_xor_b32 v41, 32, v40
  v_xor_b32 v42, 64, v40
  v_xor_b32 v43, 96, v40
  v_lshrrev_b32 v8, 5, v0
  v_lshlrev_b32 v8, 10, v8
  v_bfe_u32 v9, v0, 2, 2
  v_lshl_add_u32 v8, v9, 7, v8
  v_bfe_u32 v9, v0, 3, 1
  v_lshl_add_u32 v8, v9, 6, v8
  v_and_b32 v9, 3, v0
  v_lshl_add_u32 v8, v9, 3, v8
  v_bfe_u32 v9, v0, 4, 1
  v_lshlrev_b32 v4, 5, v9
  v_xor_b32 v4, v4, v8
  v_xor_b32 v5, 64, v4
  v_xor_b32 v6, 8224, v4
  v_xor_b32 v7, 8288, v4
  v_mov_b32 v44, 0x3f803f80
  v_mov_b32 v48, 0
  v_mov_b32 v49, 0
  v_mov_b32 v50, 0
  v_mov_b32 v51, 0
  s_add_u32 s79, s72, 3
  s_and_b32 s79, s79, 7
  s_lshl_b32 s79, s79, 7
  s_add_u32 m0, s78, 12288
  s_add_u32 s79, s79, s77
  buffer_load_dwordx4 v32, s[28:31], s79 offen offset:0 lds
  buffer_load_dwordx4 v33, s[28:31], s79 offen offset:1024 lds
  buffer_load_dwordx4 v34, s[28:31], s79 offen offset:2048 lds
  buffer_load_dwordx4 v35, s[28:31], s79 offen offset:3072 lds
  s_waitcnt vmcnt(12)
  ds_read_b128 v[128:131], v40 offset:0
  ds_read_b128 v[132:135], v41 offset:0
  ds_read_b128 v[136:139], v42 offset:0
  ds_read_b128 v[140:143], v43 offset:0
  s_add_u32 s79, s72, 4
  s_and_b32 s79, s79, 7
  s_lshl_b32 s79, s79, 7
  s_add_u32 m0, s78, 16384
  s_add_u32 s79, s79, s77
  buffer_load_dwordx4 v32, s[28:31], s79 offen offset:0 lds
  buffer_load_dwordx4 v33, s[28:31], s79 offen offset:1024 lds
  buffer_load_dwordx4 v34, s[28:31], s79 offen offset:2048 lds
  buffer_load_dwordx4 v35, s[28:31], s79 offen offset:3072 lds
  s_waitcnt vmcnt(12)
  ds_read_b128 v[144:147], v40 offset:4096
  ds_read_b128 v[148:151], v41 offset:4096
  ds_read_b128 v[152:155], v42 offset:4096
  ds_read_b128 v[156:159], v43 offset:4096
  s_waitcnt lgkmcnt(7)
  v_dot2c_f32_bf16 v48, v128, v44
  v_dot2c_f32_bf16 v49, v128, v128
  v_dot2c_f32_bf16 v50, v129, v44
  v_dot2c_f32_bf16 v51, v129, v129
  v_dot2c_f32_bf16 v48, v130, v44
  v_dot2c_f32_bf16 v49, v130, v130
  v_dot2c_f32_bf16 v50, v131, v44
  v_dot2c_f32_bf16 v51, v131, v131
  s_waitcnt lgkmcnt(6)
  v_dot2c_f32_bf16 v48, v132, v44
  v_dot2c_f32_bf16 v49, v132, v132
  v_dot2c_f32_bf16 v50, v133, v44
  v_dot2c_f32_bf16 v51, v133, v133
  v_dot2c_f32_bf16 v48, v134, v44
  v_dot2c_f32_bf16 v49, v134, v134
  v_dot2c_f32_bf16 v50, v135, v44
  v_dot2c_f32_bf16 v51, v135, v135
  s_waitcnt lgkmcnt(5)
  v_dot2c_f32_bf16 v48, v136, v44
  v_dot2c_f32_bf16 v49, v136, v136
  v_dot2c_f32_bf16 v50, v137, v44
  v_dot2c_f32_bf16 v51, v137, v137
  v_dot2c_f32_bf16 v48, v138, v44
  v_dot2c_f32_bf16 v49, v138, v138
  v_dot2c_f32_bf16 v50, v139, v44
  v_dot2c_f32_bf16 v51, v139, v139
  s_waitcnt lgkmcnt(4)
  v_dot2c_f32_bf16 v48, v140, v44
  v_dot2c_f32_bf16 v49, v140, v140
  v_dot2c_f32_bf16 v50, v141, v44
  v_dot2c_f32_bf16 v51, v141, v141
  v_dot2c_f32_bf16 v48, v142, v44
  v_dot2c_f32_bf16 v49, v142, v142
  v_dot2c_f32_bf16 v50, v143, v44
  v_dot2c_f32_bf16 v51, v143, v143
  s_add_u32 s79, s72, 5
  s_and_b32 s79, s79, 7
  s_lshl_b32 s79, s79, 7
  s_add_u32 m0, s78, 20480
  s_add_u32 s79, s79, s77
  buffer_load_dwordx4 v32, s[28:31], s79 offen offset:0 lds
  buffer_load_dwordx4 v33, s[28:31], s79 offen offset:1024 lds
  buffer_load_dwordx4 v34, s[28:31], s79 offen offset:2048 lds
  buffer_load_dwordx4 v35, s[28:31], s79 offen offset:3072 lds
  s_waitcnt vmcnt(12)
  ds_read_b128 v[160:163], v40 offset:8192
  ds_read_b128 v[164:167], v41 offset:8192
  ds_read_b128 v[168:171], v42 offset:8192
  ds_read_b128 v[172:175], v43 offset:8192
  s_waitcnt lgkmcnt(7)
  v_dot2c_f32_bf16 v48, v144, v44
  v_dot2c_f32_bf16 v49, v144, v144
  v_dot2c_f32_bf16 v50, v145, v44
  v_dot2c_f32_bf16 v51, v145, v145
  v_dot2c_f32_bf16 v48, v146, v44
  v_dot2c_f32_bf16 v49, v146, v146
  v_dot2c_f32_bf16 v50, v147, v44
  v_dot2c_f32_bf16 v51, v147, v147
  s_waitcnt lgkmcnt(6)
  v_dot2c_f32_bf16 v48, v148, v44
  v_dot2c_f32_bf16 v49, v148, v148
  v_dot2c_f32_bf16 v50, v149, v44
  v_dot2c_f32_bf16 v51, v149, v149
  v_dot2c_f32_bf16 v48, v150, v44
  v_dot2c_f32_bf16 v49, v150, v150
  v_dot2c_f32_bf16 v50, v151, v44
  v_dot2c_f32_bf16 v51, v151, v151
  s_waitcnt lgkmcnt(5)
  v_dot2c_f32_bf16 v48, v152, v44
  v_dot2c_f32_bf16 v49, v152, v152
  v_dot2c_f32_bf16 v50, v153, v44
  v_dot2c_f32_bf16 v51, v153, v153
  v_dot2c_f32_bf16 v48, v154, v44
  v_dot2c_f32_bf16 v49, v154, v154
  v_dot2c_f32_bf16 v50, v155, v44
  v_dot2c_f32_bf16 v51, v155, v155
  s_waitcnt lgkmcnt(4)
  v_dot2c_f32_bf16 v48, v156, v44
  v_dot2c_f32_bf16 v49, v156, v156
  v_dot2c_f32_bf16 v50, v157, v44
  v_dot2c_f32_bf16 v51, v157, v157
  v_dot2c_f32_bf16 v48, v158, v44
  v_dot2c_f32_bf16 v49, v158, v158
  v_dot2c_f32_bf16 v50, v159, v44
  v_dot2c_f32_bf16 v51, v159, v159
  v_lshlrev_b32 v96, 16, v128
  v_and_b32 v97, s87, v128
  v_lshlrev_b32 v98, 16, v129
  v_and_b32 v99, s87, v129
  v_lshlrev_b32 v100, 16, v130
  v_and_b32 v101, s87, v130
  v_lshlrev_b32 v102, 16, v131
  v_and_b32 v103, s87, v131
  v_lshlrev_b32 v104, 16, v132
  v_and_b32 v105, s87, v132
  v_lshlrev_b32 v106, 16, v133
  v_and_b32 v107, s87, v133
  v_lshlrev_b32 v108, 16, v134
  v_and_b32 v109, s87, v134
  v_lshlrev_b32 v110, 16, v135
  v_and_b32 v111, s87, v135
  v_lshlrev_b32 v112, 16, v136
  v_and_b32 v113, s87, v136
  v_lshlrev_b32 v114, 16, v137
  v_and_b32 v115, s87, v137
  v_lshlrev_b32 v116, 16, v138
  v_and_b32 v117, s87, v138
  v_lshlrev_b32 v118, 16, v139
  v_and_b32 v119, s87, v139
  s_add_u32 s79, s72, 6
  s_and_b32 s79, s79, 7
  s_lshl_b32 s79, s79, 7
  s_add_u32 m0, s78, 24576
  s_add_u32 s79, s79, s77
  buffer_load_dwordx4 v32, s[28:31], s79 offen offset:0 lds
  buffer_load_dwordx4 v33, s[28:31], s79 offen offset:1024 lds
  buffer_load_dwordx4 v34, s[28:31], s79 offen offset:2048 lds
  buffer_load_dwordx4 v35, s[28:31], s79 offen offset:3072 lds
  s_waitcnt vmcnt(12)
  ds_read_b128 v[176:179], v40 offset:12288
  ds_read_b128 v[180:183], v41 offset:12288
  ds_read_b128 v[184:187], v42 offset:12288
  ds_read_b128 v[188:191], v43 offset:12288
  s_waitcnt lgkmcnt(7)
  v_dot2c_f32_bf16 v48, v160, v44
  v_dot2c_f32_bf16 v49, v160, v160
  v_dot2c_f32_bf16 v50, v161, v44
  v_dot2c_f32_bf16 v51, v161, v161
  v_dot2c_f32_bf16 v48, v162, v44
  v_dot2c_f32_bf16 v49, v162, v162
  v_dot2c_f32_bf16 v50, v163, v44
  v_dot2c_f32_bf16 v51, v163, v163
  s_waitcnt lgkmcnt(6)
  v_dot2c_f32_bf16 v48, v164, v44
  v_dot2c_f32_bf16 v49, v164, v164
  v_dot2c_f32_bf16 v50, v165, v44
  v_dot2c_f32_bf16 v51, v165, v165
  v_dot2c_f32_bf16 v48, v166, v44
  v_dot2c_f32_bf16 v49, v166, v166
  v_dot2c_f32_bf16 v50, v167, v44
  v_dot2c_f32_bf16 v51, v167, v167
  s_waitcnt lgkmcnt(5)
  v_dot2c_f32_bf16 v48, v168, v44
  v_dot2c_f32_bf16 v49, v168, v168
  v_dot2c_f32_bf16 v50, v169, v44
  v_dot2c_f32_bf16 v51, v169, v169
  v_dot2c_f32_bf16 v48, v170, v44
  v_dot2c_f32_bf16 v49, v170, v170
  v_dot2c_f32_bf16 v50, v171, v44
  v_dot2c_f32_bf16 v51, v171, v171
  s_waitcnt lgkmcnt(4)
  v_dot2c_f32_bf16 v48, v172, v44
  v_dot2c_f32_bf16 v49, v172, v172
  v_dot2c_f32_bf16 v50, v173, v44
  v_dot2c_f32_bf16 v51, v173, v173
  v_dot2c_f32_bf16 v48, v174, v44
  v_dot2c_f32_bf16 v49, v174, v174
  v_dot2c_f32_bf16 v50, v175, v44
  v_dot2c_f32_bf16 v51, v175, v175
  s_add_u32 s79, s72, 7
  s_and_b32 s79, s79, 7
  s_lshl_b32 s79, s79, 7
  s_add_u32 m0, s78, 0
  s_add_u32 s79, s79, s77
  buffer_load_dwordx4 v32, s[28:31], s79 offen offset:0 lds
  buffer_load_dwordx4 v33, s[28:31], s79 offen offset:1024 lds
  buffer_load_dwordx4 v34, s[28:31], s79 offen offset:2048 lds
  buffer_load_dwordx4 v35, s[28:31], s79 offen offset:3072 lds
  s_waitcnt vmcnt(12)
  ds_read_b128 v[192:195], v40 offset:16384
  ds_read_b128 v[196:199], v41 offset:16384
  ds_read_b128 v[200:203], v42 offset:16384
  ds_read_b128 v[204:207], v43 offset:16384
  s_waitcnt lgkmcnt(7)
  v_dot2c_f32_bf16 v48, v176, v44
  v_dot2c_f32_bf16 v49, v176, v176
  v_dot2c_f32_bf16 v50, v177, v44
  v_dot2c_f32_bf16 v51, v177, v177
  v_dot2c_f32_bf16 v48, v178, v44
  v_dot2c_f32_bf16 v49, v178, v178
  v_dot2c_f32_bf16 v50, v179, v44
  v_dot2c_f32_bf16 v51, v179, v179
  s_waitcnt lgkmcnt(6)
  v_dot2c_f32_bf16 v48, v180, v44
  v_dot2c_f32_bf16 v49, v180, v180
  v_dot2c_f32_bf16 v50, v181, v44
  v_dot2c_f32_bf16 v51, v181, v181
  v_dot2c_f32_bf16 v48, v182, v44
  v_dot2c_f32_bf16 v49, v182, v182
  v_dot2c_f32_bf16 v50, v183, v44
  v_dot2c_f32_bf16 v51, v183, v183
  s_waitcnt lgkmcnt(5)
  v_dot2c_f32_bf16 v48, v184, v44
  v_dot2c_f32_bf16 v49, v184, v184
  v_dot2c_f32_bf16 v50, v185, v44
  v_dot2c_f32_bf16 v51, v185, v185
  v_dot2c_f32_bf16 v48, v186, v44
  v_dot2c_f32_bf16 v49, v186, v186
  v_dot2c_f32_bf16 v50, v187, v44
  v_dot2c_f32_bf16 v51, v187, v187
  s_waitcnt lgkmcnt(4)
  v_dot2c_f32_bf16 v48, v188, v44
  v_dot2c_f32_bf16 v49, v188, v188
  v_dot2c_f32_bf16 v50, v189, v44
  v_dot2c_f32_bf16 v51, v189, v189
  v_dot2c_f32_bf16 v48, v190, v44
  v_dot2c_f32_bf16 v49, v190, v190
  v_dot2c_f32_bf16 v50, v191, v44
  v_dot2c_f32_bf16 v51, v191, v191
  s_waitcnt vmcnt(8)
  ds_read_b128 v[208:211], v40 offset:20480
  ds_read_b128 v[212:215], v41 offset:20480
  ds_read_b128 v[216:219], v42 offset:20480
  ds_read_b128 v[220:223], v43 offset:20480
  s_waitcnt lgkmcnt(7)
  v_dot2c_f32_bf16 v48, v192, v44
  v_dot2c_f32_bf16 v49, v192, v192
  v_dot2c_f32_bf16 v50, v193, v44
  v_dot2c_f32_bf16 v51, v193, v193
  v_dot2c_f32_bf16 v48, v194, v44
  v_dot2c_f32_bf16 v49, v194, v194
  v_dot2c_f32_bf16 v50, v195, v44
  v_dot2c_f32_bf16 v51, v195, v195
  s_waitcnt lgkmcnt(6)
  v_dot2c_f32_bf16 v48, v196, v44
  v_dot2c_f32_bf16 v49, v196, v196
  v_dot2c_f32_bf16 v50, v197, v44
  v_dot2c_f32_bf16 v51, v197, v197
  v_dot2c_f32_bf16 v48, v198, v44
  v_dot2c_f32_bf16 v49, v198, v198
  v_dot2c_f32_bf16 v50, v199, v44
  v_dot2c_f32_bf16 v51, v199, v199
  s_waitcnt lgkmcnt(5)
  v_dot2c_f32_bf16 v48, v200, v44
  v_dot2c_f32_bf16 v49, v200, v200
  v_dot2c_f32_bf16 v50, v201, v44
  v_dot2c_f32_bf16 v51, v201, v201
  v_dot2c_f32_bf16 v48, v202, v44
  v_dot2c_f32_bf16 v49, v202, v202
  v_dot2c_f32_bf16 v50, v203, v44
  v_dot2c_f32_bf16 v51, v203, v203
  s_waitcnt lgkmcnt(4)
  v_dot2c_f32_bf16 v48, v204, v44
  v_dot2c_f32_bf16 v49, v204, v204
  v_dot2c_f32_bf16 v50, v205, v44
  v_dot2c_f32_bf16 v51, v205, v205
  v_dot2c_f32_bf16 v48, v206, v44
  v_dot2c_f32_bf16 v49, v206, v206
  v_dot2c_f32_bf16 v50, v207, v44
  v_dot2c_f32_bf16 v51, v207, v207
  s_waitcnt vmcnt(4)
  ds_read_b128 v[224:227], v40 offset:24576
  ds_read_b128 v[228:231], v41 offset:24576
  ds_read_b128 v[232:235], v42 offset:24576
  ds_read_b128 v[236:239], v43 offset:24576
  s_waitcnt lgkmcnt(7)
  v_dot2c_f32_bf16 v48, v208, v44
  v_dot2c_f32_bf16 v49, v208, v208
  v_dot2c_f32_bf16 v50, v209, v44
  v_dot2c_f32_bf16 v51, v209, v209
  v_dot2c_f32_bf16 v48, v210, v44
  v_dot2c_f32_bf16 v49, v210, v210
  v_dot2c_f32_bf16 v50, v211, v44
  v_dot2c_f32_bf16 v51, v211, v211
  s_waitcnt lgkmcnt(6)
  v_dot2c_f32_bf16 v48, v212, v44
  v_dot2c_f32_bf16 v49, v212, v212
  v_dot2c_f32_bf16 v50, v213, v44
  v_dot2c_f32_bf16 v51, v213, v213
  v_dot2c_f32_bf16 v48, v214, v44
  v_dot2c_f32_bf16 v49, v214, v214
  v_dot2c_f32_bf16 v50, v215, v44
  v_dot2c_f32_bf16 v51, v215, v215
  s_waitcnt lgkmcnt(5)
  v_dot2c_f32_bf16 v48, v216, v44
  v_dot2c_f32_bf16 v49, v216, v216
  v_dot2c_f32_bf16 v50, v217, v44
  v_dot2c_f32_bf16 v51, v217, v217
  v_dot2c_f32_bf16 v48, v218, v44
  v_dot2c_f32_bf16 v49, v218, v218
  v_dot2c_f32_bf16 v50, v219, v44
  v_dot2c_f32_bf16 v51, v219, v219
  s_waitcnt lgkmcnt(4)
  v_dot2c_f32_bf16 v48, v220, v44
  v_dot2c_f32_bf16 v49, v220, v220
  v_dot2c_f32_bf16 v50, v221, v44
  v_dot2c_f32_bf16 v51, v221, v221
  v_dot2c_f32_bf16 v48, v222, v44
  v_dot2c_f32_bf16 v49, v222, v222
  v_dot2c_f32_bf16 v50, v223, v44
  v_dot2c_f32_bf16 v51, v223, v223
  s_waitcnt vmcnt(0)
  ds_read_b128 v[240:243], v40 offset:0
  ds_read_b128 v[244:247], v41 offset:0
  ds_read_b128 v[248:251], v42 offset:0
  ds_read_b128 v[252:255], v43 offset:0
  s_waitcnt lgkmcnt(7)
  v_dot2c_f32_bf16 v48, v224, v44
  v_dot2c_f32_bf16 v49, v224, v224
  v_dot2c_f32_bf16 v50, v225, v44
  v_dot2c_f32_bf16 v51, v225, v225
  v_dot2c_f32_bf16 v48, v226, v44
  v_dot2c_f32_bf16 v49, v226, v226
  v_dot2c_f32_bf16 v50, v227, v44
  v_dot2c_f32_bf16 v51, v227, v227
  s_waitcnt lgkmcnt(6)
  v_dot2c_f32_bf16 v48, v228, v44
  v_dot2c_f32_bf16 v49, v228, v228
  v_dot2c_f32_bf16 v50, v229, v44
  v_dot2c_f32_bf16 v51, v229, v229
  v_dot2c_f32_bf16 v48, v230, v44
  v_dot2c_f32_bf16 v49, v230, v230
  v_dot2c_f32_bf16 v50, v231, v44
  v_dot2c_f32_bf16 v51, v231, v231
  s_waitcnt lgkmcnt(5)
  v_dot2c_f32_bf16 v48, v232, v44
  v_dot2c_f32_bf16 v49, v232, v232
  v_dot2c_f32_bf16 v50, v233, v44
  v_dot2c_f32_bf16 v51, v233, v233
  v_dot2c_f32_bf16 v48, v234, v44
  v_dot2c_f32_bf16 v49, v234, v234
  v_dot2c_f32_bf16 v50, v235, v44
  v_dot2c_f32_bf16 v51, v235, v235
  s_waitcnt lgkmcnt(4)
  v_dot2c_f32_bf16 v48, v236, v44
  v_dot2c_f32_bf16 v49, v236, v236
  v_dot2c_f32_bf16 v50, v237, v44
  v_dot2c_f32_bf16 v51, v237, v237
  v_dot2c_f32_bf16 v48, v238, v44
  v_dot2c_f32_bf16 v49, v238, v238
  v_dot2c_f32_bf16 v50, v239, v44
  v_dot2c_f32_bf16 v51, v239, v239
  s_waitcnt lgkmcnt(0)
  s_mov_b32 s84, s77
  s_barrier
  s_cmp_eq_u32 s71, 1
  s_cbranch_scc1 L_p1t2
  ds_read_b64_tr_b16 v[12:13], v4 offset:0
  ds_read_b64_tr_b16 v[14:15], v4 offset:512
  ds_read_b64_tr_b16 v[16:17], v5 offset:0
  ds_read_b64_tr_b16 v[18:19], v5 offset:512
  ds_read_b64_tr_b16 v[20:21], v6 offset:0
  ds_read_b64_tr_b16 v[22:23], v6 offset:512
  ds_read_b64_tr_b16 v[24:25], v7 offset:0
  ds_read_b64_tr_b16 v[26:27], v7 offset:512
  ds_read_b64_tr_b16 v[28:29], v4 offset:2048
  ds_read_b64_tr_b16 v[30:31], v4 offset:2560
  buffer_load_dword v11, off, s[36:39], 0 sc1
  v_dot2c_f32_bf16 v48, v240, v44
  v_dot2c_f32_bf16 v49, v240, v240
  v_dot2c_f32_bf16 v50, v241, v44
  v_dot2c_f32_bf16 v51, v241, v241
  v_dot2c_f32_bf16 v48, v242, v44
  v_dot2c_f32_bf16 v49, v242, v242
  v_dot2c_f32_bf16 v50, v243, v44
  v_dot2c_f32_bf16 v51, v243, v243
  v_dot2c_f32_bf16 v48, v244, v44
  v_dot2c_f32_bf16 v49, v244, v244
  v_dot2c_f32_bf16 v50, v245, v44
  v_dot2c_f32_bf16 v51, v245, v245
  v_dot2c_f32_bf16 v48, v246, v44
  v_dot2c_f32_bf16 v49, v246, v246
  v_dot2c_f32_bf16 v50, v247, v44
  v_dot2c_f32_bf16 v51, v247, v247
  v_dot2c_f32_bf16 v48, v248, v44
  v_dot2c_f32_bf16 v49, v248, v248
  v_dot2c_f32_bf16 v50, v249, v44
  v_dot2c_f32_bf16 v51, v249, v249
  v_dot2c_f32_bf16 v48, v250, v44
  v_dot2c_f32_bf16 v49, v250, v250
  v_dot2c_f32_bf16 v50, v251, v44
  v_dot2c_f32_bf16 v51, v251, v251
  v_dot2c_f32_bf16 v48, v252, v44
  v_dot2c_f32_bf16 v49, v252, v252
  v_dot2c_f32_bf16 v50, v253, v44
  v_dot2c_f32_bf16 v51, v253, v253
  v_dot2c_f32_bf16 v48, v254, v44
  v_dot2c_f32_bf16 v49, v254, v254
  v_dot2c_f32_bf16 v50, v255, v44
  v_dot2c_f32_bf16 v51, v255, v255
  s_nop 2
  v_pk_add_f32 v[48:49], v[48:49], v[50:51]
  v_mov_b32 v50, v48
  v_mov_b32 v51, v49
  s_nop 0
  v_permlane32_swap_b32 v48, v50
  v_permlane32_swap_b32 v49, v51
  v_pk_add_f32 v[48:49], v[48:49], v[50:51]
  v_mul_f32 v48, 0x3b000000, v48
  v_mul_f32 v49, 0x3b000000, v49
  v_fma_f32 v49, -v48, v48, v49
  v_max_f32 v49, 0, v49
  v_add_f32 v49, 0x3727c5ac, v49
  v_rsq_f32 v2, v49
  s_nop 0
  v_mul_f32 v3, v48, v2
  v_fma_f32 v96, v96, v2, -v3
  v_fma_f32 v97, v97, v2, -v3
  v_fma_f32 v98, v98, v2, -v3
  v_fma_f32 v99, v99, v2, -v3
  v_fma_f32 v100, v100, v2, -v3
  v_fma_f32 v101, v101, v2, -v3
  v_fma_f32 v102, v102, v2, -v3
  v_fma_f32 v103, v103, v2, -v3
  v_cvt_pk_bf16_f32 v128, v96, v97
  v_cvt_pk_bf16_f32 v129, v98, v99
  v_cvt_pk_bf16_f32 v130, v100, v101
  v_cvt_pk_bf16_f32 v131, v102, v103
  v_fma_f32 v104, v104, v2, -v3
  v_fma_f32 v105, v105, v2, -v3
  v_fma_f32 v106, v106, v2, -v3
  v_fma_f32 v107, v107, v2, -v3
  v_fma_f32 v108, v108, v2, -v3
  v_fma_f32 v109, v109, v2, -v3
  v_fma_f32 v110, v110, v2, -v3
  v_fma_f32 v111, v111, v2, -v3
  s_mul_i32 s77, s70, 6144
  s_add_u32 s77, s77, s27
  s_add_u32 s77, s77, 65536
  s_and_b32 s79, s70, 1
  s_lshl_b32 s78, s79, 11
  s_add_u32 s78, s78, s77
  s_xor_b32 s79, s79, 1
  s_lshl_b32 s79, s79, 12
  s_add_u32 s79, s79, s77
  s_lshl_b32 s80, s68, 11
  s_add_u32 s80, s80, 98304
  s_waitcnt lgkmcnt(8)
  v_mfma_f32_32x32x16_bf16 v[32:47], v[12:15], v[128:131], 0
  ds_read_b64_tr_b16 v[12:13], v5 offset:2048
  ds_read_b64_tr_b16 v[14:15], v5 offset:2560
  v_cvt_pk_bf16_f32 v132, v104, v105
  v_fma_f32 v112, v112, v2, -v3
  v_fma_f32 v113, v113, v2, -v3
  v_lshlrev_b32 v120, 16, v140
  v_and_b32 v121, s87, v140
  s_waitcnt lgkmcnt(8)
  v_mfma_f32_32x32x16_bf16 v[48:63], v[16:19], v[128:131], 0
  ds_read_b64_tr_b16 v[16:17], v6 offset:2048
  ds_read_b64_tr_b16 v[18:19], v6 offset:2560
  s_waitcnt lgkmcnt(6)
  v_cvt_pk_bf16_f32 v133, v106, v107
  v_fma_f32 v114, v114, v2, -v3
  v_fma_f32 v115, v115, v2, -v3
  v_lshlrev_b32 v122, 16, v141
  v_and_b32 v123, s87, v141
  v_mfma_f32_32x32x16_bf16 v[64:79], v[20:23], v[128:131], 0
  ds_read_b64_tr_b16 v[20:21], v7 offset:2048
  ds_read_b64_tr_b16 v[22:23], v7 offset:2560
  v_cvt_pk_bf16_f32 v134, v108, v109
  v_fma_f32 v116, v116, v2, -v3
  v_fma_f32 v117, v117, v2, -v3
  v_lshlrev_b32 v124, 16, v142
  v_and_b32 v125, s87, v142
  v_mfma_f32_32x32x16_bf16 v[80:95], v[24:27], v[128:131], 0
  ds_read_b64_tr_b16 v[24:25], v4 offset:4096
  ds_read_b64_tr_b16 v[26:27], v4 offset:4608
  s_waitcnt lgkmcnt(6)
  v_cvt_pk_bf16_f32 v135, v110, v111
  v_fma_f32 v118, v118, v2, -v3
  v_fma_f32 v119, v119, v2, -v3
  v_lshlrev_b32 v126, 16, v143
  v_and_b32 v127, s87, v143
  v_mfma_f32_32x32x16_bf16 v[32:47], v[28:31], v[132:135], v[32:47]
  ds_read_b64_tr_b16 v[28:29], v5 offset:4096
  ds_read_b64_tr_b16 v[30:31], v5 offset:4608
  v_cvt_pk_bf16_f32 v136, v112, v113
  v_fma_f32 v120, v120, v2, -v3
  v_fma_f32 v121, v121, v2, -v3
  v_lshlrev_b32 v96, 16, v144
  v_and_b32 v97, s87, v144
  v_mfma_f32_32x32x16_bf16 v[48:63], v[12:15], v[132:135], v[48:63]
  ds_read_b64_tr_b16 v[12:13], v6 offset:4096
  ds_read_b64_tr_b16 v[14:15], v6 offset:4608
  s_waitcnt lgkmcnt(6)
  v_cvt_pk_bf16_f32 v137, v114, v115
  v_fma_f32 v122, v122, v2, -v3
  v_fma_f32 v123, v123, v2, -v3
  v_lshlrev_b32 v98, 16, v145
  v_and_b32 v99, s87, v145
  v_mfma_f32_32x32x16_bf16 v[64:79], v[16:19], v[132:135], v[64:79]
  ds_read_b64_tr_b16 v[16:17], v7 offset:4096
  ds_read_b64_tr_b16 v[18:19], v7 offset:4608
  v_cvt_pk_bf16_f32 v138, v116, v117
  v_fma_f32 v124, v124, v2, -v3
  v_fma_f32 v125, v125, v2, -v3
  v_lshlrev_b32 v100, 16, v146
  v_and_b32 v101, s87, v146
  v_mfma_f32_32x32x16_bf16 v[80:95], v[20:23], v[132:135], v[80:95]
  ds_read_b64_tr_b16 v[20:21], v4 offset:6144
  ds_read_b64_tr_b16 v[22:23], v4 offset:6656
  s_waitcnt lgkmcnt(6)
  v_cvt_pk_bf16_f32 v139, v118, v119
  v_fma_f32 v126, v126, v2, -v3
  v_fma_f32 v127, v127, v2, -v3
  v_lshlrev_b32 v102, 16, v147
  v_and_b32 v103, s87, v147
  v_mfma_f32_32x32x16_bf16 v[32:47], v[24:27], v[136:139], v[32:47]
  ds_read_b64_tr_b16 v[24:25], v5 offset:6144
  ds_read_b64_tr_b16 v[26:27], v5 offset:6656
  v_cvt_pk_bf16_f32 v140, v120, v121
  v_fma_f32 v96, v96, v2, -v3
  v_fma_f32 v97, v97, v2, -v3
  v_lshlrev_b32 v104, 16, v148
  v_and_b32 v105, s87, v148
  v_mfma_f32_32x32x16_bf16 v[48:63], v[28:31], v[136:139], v[48:63]
  ds_read_b64_tr_b16 v[28:29], v6 offset:6144
  ds_read_b64_tr_b16 v[30:31], v6 offset:6656
  s_waitcnt lgkmcnt(6)
  v_cvt_pk_bf16_f32 v141, v122, v123
  v_fma_f32 v98, v98, v2, -v3
  v_fma_f32 v99, v99, v2, -v3
  v_lshlrev_b32 v106, 16, v149
  v_and_b32 v107, s87, v149
  v_mfma_f32_32x32x16_bf16 v[64:79], v[12:15], v[136:139], v[64:79]
  ds_read_b64_tr_b16 v[12:13], v7 offset:6144
  ds_read_b64_tr_b16 v[14:15], v7 offset:6656
  v_cvt_pk_bf16_f32 v142, v124, v125
  v_fma_f32 v100, v100, v2, -v3
  v_fma_f32 v101, v101, v2, -v3
  v_lshlrev_b32 v108, 16, v150
  v_and_b32 v109, s87, v150
  v_mfma_f32_32x32x16_bf16 v[80:95], v[16:19], v[136:139], v[80:95]
  s_barrier
  ds_read_b64_tr_b16 v[16:17], v4 offset:16384
  ds_read_b64_tr_b16 v[18:19], v4 offset:16896
  s_waitcnt lgkmcnt(6)
  v_cvt_pk_bf16_f32 v143, v126, v127
  v_fma_f32 v102, v102, v2, -v3
  v_fma_f32 v103, v103, v2, -v3
  v_lshlrev_b32 v110, 16, v151
  v_and_b32 v111, s87, v151
  v_mfma_f32_32x32x16_bf16 v[32:47], v[20:23], v[140:143], v[32:47]
  ds_read_b64_tr_b16 v[20:21], v5 offset:16384
  ds_read_b64_tr_b16 v[22:23], v5 offset:16896
  v_cvt_pk_bf16_f32 v144, v96, v97
  v_fma_f32 v104, v104, v2, -v3
  v_fma_f32 v105, v105, v2, -v3
  v_lshlrev_b32 v112, 16, v152
  v_and_b32 v113, s87, v152
  v_mfma_f32_32x32x16_bf16 v[48:63], v[24:27], v[140:143], v[48:63]
  ds_read_b64_tr_b16 v[24:25], v6 offset:16384
  ds_read_b64_tr_b16 v[26:27], v6 offset:16896
  s_waitcnt lgkmcnt(6)
  v_cvt_pk_bf16_f32 v145, v98, v99
  v_fma_f32 v106, v106, v2, -v3
  v_fma_f32 v107, v107, v2, -v3
  v_lshlrev_b32 v114, 16, v153
  v_and_b32 v115, s87, v153
  v_mfma_f32_32x32x16_bf16 v[64:79], v[28:31], v[140:143], v[64:79]
  ds_read_b64_tr_b16 v[28:29], v7 offset:16384
  ds_read_b64_tr_b16 v[30:31], v7 offset:16896
  v_cvt_pk_bf16_f32 v146, v100, v101
  v_fma_f32 v108, v108, v2, -v3
  v_fma_f32 v109, v109, v2, -v3
  v_lshlrev_b32 v116, 16, v154
  v_and_b32 v117, s87, v154
  v_mfma_f32_32x32x16_bf16 v[80:95], v[12:15], v[140:143], v[80:95]
  ds_read_b64_tr_b16 v[12:13], v4 offset:18432
  ds_read_b64_tr_b16 v[14:15], v4 offset:18944
  s_waitcnt lgkmcnt(6)
  v_cvt_pk_bf16_f32 v147, v102, v103
  v_fma_f32 v110, v110, v2, -v3
  v_fma_f32 v111, v111, v2, -v3
  v_lshlrev_b32 v118, 16, v155
  v_and_b32 v119, s87, v155
  v_mfma_f32_32x32x16_bf16 v[32:47], v[16:19], v[144:147], v[32:47]
  ds_read_b64_tr_b16 v[16:17], v5 offset:18432
  ds_read_b64_tr_b16 v[18:19], v5 offset:18944
  v_cvt_pk_bf16_f32 v148, v104, v105
  v_fma_f32 v112, v112, v2, -v3
  v_fma_f32 v113, v113, v2, -v3
  v_lshlrev_b32 v120, 16, v156
  v_and_b32 v121, s87, v156
  v_mfma_f32_32x32x16_bf16 v[48:63], v[20:23], v[144:147], v[48:63]
  ds_read_b64_tr_b16 v[20:21], v6 offset:18432
  ds_read_b64_tr_b16 v[22:23], v6 offset:18944
  s_waitcnt lgkmcnt(6)
  v_cvt_pk_bf16_f32 v149, v106, v107
  v_fma_f32 v114, v114, v2, -v3
  v_fma_f32 v115, v115, v2, -v3
  v_lshlrev_b32 v122, 16, v157
  v_and_b32 v123, s87, v157
  v_mfma_f32_32x32x16_bf16 v[64:79], v[24:27], v[144:147], v[64:79]
  ds_read_b64_tr_b16 v[24:25], v7 offset:18432
  ds_read_b64_tr_b16 v[26:27], v7 offset:18944
  v_cvt_pk_bf16_f32 v150, v108, v109
  v_fma_f32 v116, v116, v2, -v3
  v_fma_f32 v117, v117, v2, -v3
  v_lshlrev_b32 v124, 16, v158
  v_and_b32 v125, s87, v158
  v_mfma_f32_32x32x16_bf16 v[80:95], v[28:31], v[144:147], v[80:95]
  ds_read_b64_tr_b16 v[28:29], v4 offset:20480
  ds_read_b64_tr_b16 v[30:31], v4 offset:20992
  s_waitcnt lgkmcnt(6)
  v_cvt_pk_bf16_f32 v151, v110, v111
  v_fma_f32 v118, v118, v2, -v3
  v_fma_f32 v119, v119, v2, -v3
  v_lshlrev_b32 v126, 16, v159
  v_and_b32 v127, s87, v159
  v_mfma_f32_32x32x16_bf16 v[32:47], v[12:15], v[148:151], v[32:47]
  ds_read_b64_tr_b16 v[12:13], v5 offset:20480
  ds_read_b64_tr_b16 v[14:15], v5 offset:20992
  v_cvt_pk_bf16_f32 v152, v112, v113
  v_fma_f32 v120, v120, v2, -v3
  v_fma_f32 v121, v121, v2, -v3
  v_lshlrev_b32 v96, 16, v160
  v_and_b32 v97, s87, v160
  v_mfma_f32_32x32x16_bf16 v[48:63], v[16:19], v[148:151], v[48:63]
  ds_read_b64_tr_b16 v[16:17], v6 offset:20480
  ds_read_b64_tr_b16 v[18:19], v6 offset:20992
  s_waitcnt lgkmcnt(6)
  v_cvt_pk_bf16_f32 v153, v114, v115
  v_fma_f32 v122, v122, v2, -v3
  v_fma_f32 v123, v123, v2, -v3
  v_lshlrev_b32 v98, 16, v161
  v_and_b32 v99, s87, v161
  v_mfma_f32_32x32x16_bf16 v[64:79], v[20:23], v[148:151], v[64:79]
  ds_read_b64_tr_b16 v[20:21], v7 offset:20480
  ds_read_b64_tr_b16 v[22:23], v7 offset:20992
  v_cvt_pk_bf16_f32 v154, v116, v117
  v_fma_f32 v124, v124, v2, -v3
  v_fma_f32 v125, v125, v2, -v3
  v_lshlrev_b32 v100, 16, v162
  v_and_b32 v101, s87, v162
  v_mfma_f32_32x32x16_bf16 v[80:95], v[24:27], v[148:151], v[80:95]
  ds_read_b64_tr_b16 v[24:25], v4 offset:22528
  ds_read_b64_tr_b16 v[26:27], v4 offset:23040
  s_waitcnt lgkmcnt(6)
  v_cvt_pk_bf16_f32 v155, v118, v119
  v_fma_f32 v126, v126, v2, -v3
  v_fma_f32 v127, v127, v2, -v3
  v_lshlrev_b32 v102, 16, v163
  v_and_b32 v103, s87, v163
  v_mfma_f32_32x32x16_bf16 v[32:47], v[28:31], v[152:155], v[32:47]
  ds_read_b64_tr_b16 v[28:29], v5 offset:22528
  ds_read_b64_tr_b16 v[30:31], v5 offset:23040
  v_cvt_pk_bf16_f32 v156, v120, v121
  v_fma_f32 v96, v96, v2, -v3
  v_fma_f32 v97, v97, v2, -v3
  v_lshlrev_b32 v104, 16, v164
  v_and_b32 v105, s87, v164
  v_mfma_f32_32x32x16_bf16 v[48:63], v[12:15], v[152:155], v[48:63]
  ds_read_b64_tr_b16 v[12:13], v6 offset:22528
  ds_read_b64_tr_b16 v[14:15], v6 offset:23040
  s_waitcnt lgkmcnt(6)
  v_cvt_pk_bf16_f32 v157, v122, v123
  v_fma_f32 v98, v98, v2, -v3
  v_fma_f32 v99, v99, v2, -v3
  v_lshlrev_b32 v106, 16, v165
  v_and_b32 v107, s87, v165
  v_mfma_f32_32x32x16_bf16 v[64:79], v[16:19], v[152:155], v[64:79]
  ds_read_b64_tr_b16 v[16:17], v7 offset:22528
  ds_read_b64_tr_b16 v[18:19], v7 offset:23040
  v_cvt_pk_bf16_f32 v158, v124, v125
  v_fma_f32 v100, v100, v2, -v3
  v_fma_f32 v101, v101, v2, -v3
  v_lshlrev_b32 v108, 16, v166
  v_and_b32 v109, s87, v166
  v_mfma_f32_32x32x16_bf16 v[80:95], v[20:23], v[152:155], v[80:95]
  s_barrier
  ds_read_b64_tr_b16 v[20:21], v4 offset:32768
  ds_read_b64_tr_b16 v[22:23], v4 offset:33280
  s_waitcnt lgkmcnt(6)
  v_cvt_pk_bf16_f32 v159, v126, v127
  v_fma_f32 v102, v102, v2, -v3
  v_fma_f32 v103, v103, v2, -v3
  v_lshlrev_b32 v110, 16, v167
  v_and_b32 v111, s87, v167
  v_mfma_f32_32x32x16_bf16 v[32:47], v[24:27], v[156:159], v[32:47]
  ds_read_b64_tr_b16 v[24:25], v5 offset:32768
  ds_read_b64_tr_b16 v[26:27], v5 offset:33280
  v_cvt_pk_bf16_f32 v160, v96, v97
  v_fma_f32 v104, v104, v2, -v3
  v_fma_f32 v105, v105, v2, -v3
  v_lshlrev_b32 v112, 16, v168
  v_and_b32 v113, s87, v168
  v_mfma_f32_32x32x16_bf16 v[48:63], v[28:31], v[156:159], v[48:63]
  ds_read_b64_tr_b16 v[28:29], v6 offset:32768
  ds_read_b64_tr_b16 v[30:31], v6 offset:33280
  s_waitcnt lgkmcnt(6)
  v_cvt_pk_bf16_f32 v161, v98, v99
  v_fma_f32 v106, v106, v2, -v3
  v_fma_f32 v107, v107, v2, -v3
  v_lshlrev_b32 v114, 16, v169
  v_and_b32 v115, s87, v169
  v_mfma_f32_32x32x16_bf16 v[64:79], v[12:15], v[156:159], v[64:79]
  ds_read_b64_tr_b16 v[12:13], v7 offset:32768
  ds_read_b64_tr_b16 v[14:15], v7 offset:33280
  v_cvt_pk_bf16_f32 v162, v100, v101
  v_fma_f32 v108, v108, v2, -v3
  v_fma_f32 v109, v109, v2, -v3
  v_lshlrev_b32 v116, 16, v170
  v_and_b32 v117, s87, v170
  v_mfma_f32_32x32x16_bf16 v[80:95], v[16:19], v[156:159], v[80:95]
  ds_read_b64_tr_b16 v[16:17], v4 offset:34816
  ds_read_b64_tr_b16 v[18:19], v4 offset:35328
  s_waitcnt lgkmcnt(6)
  v_cvt_pk_bf16_f32 v163, v102, v103
  v_fma_f32 v110, v110, v2, -v3
  v_fma_f32 v111, v111, v2, -v3
  v_lshlrev_b32 v118, 16, v171
  v_and_b32 v119, s87, v171
  v_mfma_f32_32x32x16_bf16 v[32:47], v[20:23], v[160:163], v[32:47]
  ds_read_b64_tr_b16 v[20:21], v5 offset:34816
  ds_read_b64_tr_b16 v[22:23], v5 offset:35328
  v_cvt_pk_bf16_f32 v164, v104, v105
  v_fma_f32 v112, v112, v2, -v3
  v_fma_f32 v113, v113, v2, -v3
  v_lshlrev_b32 v120, 16, v172
  v_and_b32 v121, s87, v172
  v_mfma_f32_32x32x16_bf16 v[48:63], v[24:27], v[160:163], v[48:63]
  ds_read_b64_tr_b16 v[24:25], v6 offset:34816
  ds_read_b64_tr_b16 v[26:27], v6 offset:35328
  s_waitcnt lgkmcnt(6)
  v_cvt_pk_bf16_f32 v165, v106, v107
  v_fma_f32 v114, v114, v2, -v3
  v_fma_f32 v115, v115, v2, -v3
  v_lshlrev_b32 v122, 16, v173
  v_and_b32 v123, s87, v173
  v_mfma_f32_32x32x16_bf16 v[64:79], v[28:31], v[160:163], v[64:79]
  ds_read_b64_tr_b16 v[28:29], v7 offset:34816
  ds_read_b64_tr_b16 v[30:31], v7 offset:35328
  v_cvt_pk_bf16_f32 v166, v108, v109
  v_fma_f32 v116, v116, v2, -v3
  v_fma_f32 v117, v117, v2, -v3
  v_lshlrev_b32 v124, 16, v174
  v_and_b32 v125, s87, v174
  v_mfma_f32_32x32x16_bf16 v[80:95], v[12:15], v[160:163], v[80:95]
  ds_read_b64_tr_b16 v[12:13], v4 offset:36864
  ds_read_b64_tr_b16 v[14:15], v4 offset:37376
  s_waitcnt lgkmcnt(6)
  v_cvt_pk_bf16_f32 v167, v110, v111
  v_fma_f32 v118, v118, v2, -v3
  v_fma_f32 v119, v119, v2, -v3
  v_lshlrev_b32 v126, 16, v175
  v_and_b32 v127, s87, v175
  v_mfma_f32_32x32x16_bf16 v[32:47], v[16:19], v[164:167], v[32:47]
  ds_read_b64_tr_b16 v[16:17], v5 offset:36864
  ds_read_b64_tr_b16 v[18:19], v5 offset:37376
  v_cvt_pk_bf16_f32 v168, v112, v113
  v_fma_f32 v120, v120, v2, -v3
  v_fma_f32 v121, v121, v2, -v3
  v_lshlrev_b32 v96, 16, v176
  v_and_b32 v97, s87, v176
  v_mfma_f32_32x32x16_bf16 v[48:63], v[20:23], v[164:167], v[48:63]
  ds_read_b64_tr_b16 v[20:21], v6 offset:36864
  ds_read_b64_tr_b16 v[22:23], v6 offset:37376
  s_waitcnt lgkmcnt(6)
  v_cvt_pk_bf16_f32 v169, v114, v115
  v_fma_f32 v122, v122, v2, -v3
  v_fma_f32 v123, v123, v2, -v3
  v_lshlrev_b32 v98, 16, v177
  v_and_b32 v99, s87, v177
  v_mfma_f32_32x32x16_bf16 v[64:79], v[24:27], v[164:167], v[64:79]
  ds_read_b64_tr_b16 v[24:25], v7 offset:36864
  ds_read_b64_tr_b16 v[26:27], v7 offset:37376
  v_cvt_pk_bf16_f32 v170, v116, v117
  v_fma_f32 v124, v124, v2, -v3
  v_fma_f32 v125, v125, v2, -v3
  v_lshlrev_b32 v100, 16, v178
  v_and_b32 v101, s87, v178
  v_mfma_f32_32x32x16_bf16 v[80:95], v[28:31], v[164:167], v[80:95]
  ds_read_b64_tr_b16 v[28:29], v4 offset:38912
  ds_read_b64_tr_b16 v[30:31], v4 offset:39424
  s_waitcnt lgkmcnt(6)
  v_cvt_pk_bf16_f32 v171, v118, v119
  v_fma_f32 v126, v126, v2, -v3
  v_fma_f32 v127, v127, v2, -v3
  v_lshlrev_b32 v102, 16, v179
  v_and_b32 v103, s87, v179
  v_mfma_f32_32x32x16_bf16 v[32:47], v[12:15], v[168:171], v[32:47]
  ds_read_b64_tr_b16 v[12:13], v5 offset:38912
  ds_read_b64_tr_b16 v[14:15], v5 offset:39424
  v_cvt_pk_bf16_f32 v172, v120, v121
  v_fma_f32 v96, v96, v2, -v3
  v_fma_f32 v97, v97, v2, -v3
  v_lshlrev_b32 v104, 16, v180
  v_and_b32 v105, s87, v180
  v_mfma_f32_32x32x16_bf16 v[48:63], v[16:19], v[168:171], v[48:63]
  ds_read_b64_tr_b16 v[16:17], v6 offset:38912
  ds_read_b64_tr_b16 v[18:19], v6 offset:39424
  s_waitcnt lgkmcnt(6)
  v_cvt_pk_bf16_f32 v173, v122, v123
  v_fma_f32 v98, v98, v2, -v3
  v_fma_f32 v99, v99, v2, -v3
  v_lshlrev_b32 v106, 16, v181
  v_and_b32 v107, s87, v181
  v_mfma_f32_32x32x16_bf16 v[64:79], v[20:23], v[168:171], v[64:79]
  ds_read_b64_tr_b16 v[20:21], v7 offset:38912
  ds_read_b64_tr_b16 v[22:23], v7 offset:39424
  v_cvt_pk_bf16_f32 v174, v124, v125
  v_fma_f32 v100, v100, v2, -v3
  v_fma_f32 v101, v101, v2, -v3
  v_lshlrev_b32 v108, 16, v182
  v_and_b32 v109, s87, v182
  v_mfma_f32_32x32x16_bf16 v[80:95], v[24:27], v[168:171], v[80:95]
  s_barrier
  ds_read_b64_tr_b16 v[24:25], v4 offset:49152
  ds_read_b64_tr_b16 v[26:27], v4 offset:49664
  s_waitcnt lgkmcnt(6)
  v_cvt_pk_bf16_f32 v175, v126, v127
  v_fma_f32 v102, v102, v2, -v3
  v_fma_f32 v103, v103, v2, -v3
  v_lshlrev_b32 v110, 16, v183
  v_and_b32 v111, s87, v183
  v_mfma_f32_32x32x16_bf16 v[32:47], v[28:31], v[172:175], v[32:47]
  ds_read_b64_tr_b16 v[28:29], v5 offset:49152
  ds_read_b64_tr_b16 v[30:31], v5 offset:49664
  v_cvt_pk_bf16_f32 v176, v96, v97
  v_fma_f32 v104, v104, v2, -v3
  v_fma_f32 v105, v105, v2, -v3
  v_lshlrev_b32 v112, 16, v184
  v_and_b32 v113, s87, v184
  v_mfma_f32_32x32x16_bf16 v[48:63], v[12:15], v[172:175], v[48:63]
  ds_read_b64_tr_b16 v[12:13], v6 offset:49152
  ds_read_b64_tr_b16 v[14:15], v6 offset:49664
  s_waitcnt lgkmcnt(6)
  v_cvt_pk_bf16_f32 v177, v98, v99
  v_fma_f32 v106, v106, v2, -v3
  v_fma_f32 v107, v107, v2, -v3
  v_lshlrev_b32 v114, 16, v185
  v_and_b32 v115, s87, v185
  v_mfma_f32_32x32x16_bf16 v[64:79], v[16:19], v[172:175], v[64:79]
  ds_read_b64_tr_b16 v[16:17], v7 offset:49152
  ds_read_b64_tr_b16 v[18:19], v7 offset:49664
  v_cvt_pk_bf16_f32 v178, v100, v101
  v_fma_f32 v108, v108, v2, -v3
  v_fma_f32 v109, v109, v2, -v3
  v_lshlrev_b32 v116, 16, v186
  v_and_b32 v117, s87, v186
  v_mfma_f32_32x32x16_bf16 v[80:95], v[20:23], v[172:175], v[80:95]
  ds_read_b64_tr_b16 v[20:21], v4 offset:51200
  ds_read_b64_tr_b16 v[22:23], v4 offset:51712
  s_waitcnt lgkmcnt(6)
  v_cvt_pk_bf16_f32 v179, v102, v103
  v_fma_f32 v110, v110, v2, -v3
  v_fma_f32 v111, v111, v2, -v3
  v_lshlrev_b32 v118, 16, v187
  v_and_b32 v119, s87, v187
  v_mfma_f32_32x32x16_bf16 v[32:47], v[24:27], v[176:179], v[32:47]
  ds_read_b64_tr_b16 v[24:25], v5 offset:51200
  ds_read_b64_tr_b16 v[26:27], v5 offset:51712
  v_cvt_pk_bf16_f32 v180, v104, v105
  v_fma_f32 v112, v112, v2, -v3
  v_fma_f32 v113, v113, v2, -v3
  v_lshlrev_b32 v120, 16, v188
  v_and_b32 v121, s87, v188
  v_mfma_f32_32x32x16_bf16 v[48:63], v[28:31], v[176:179], v[48:63]
  ds_read_b64_tr_b16 v[28:29], v6 offset:51200
  ds_read_b64_tr_b16 v[30:31], v6 offset:51712
  s_waitcnt lgkmcnt(6)
  v_cvt_pk_bf16_f32 v181, v106, v107
  v_fma_f32 v114, v114, v2, -v3
  v_fma_f32 v115, v115, v2, -v3
  v_lshlrev_b32 v122, 16, v189
  v_and_b32 v123, s87, v189
  v_mfma_f32_32x32x16_bf16 v[64:79], v[12:15], v[176:179], v[64:79]
  ds_read_b64_tr_b16 v[12:13], v7 offset:51200
  ds_read_b64_tr_b16 v[14:15], v7 offset:51712
  v_cvt_pk_bf16_f32 v182, v108, v109
  v_fma_f32 v116, v116, v2, -v3
  v_fma_f32 v117, v117, v2, -v3
  v_lshlrev_b32 v124, 16, v190
  v_and_b32 v125, s87, v190
  v_mfma_f32_32x32x16_bf16 v[80:95], v[16:19], v[176:179], v[80:95]
  ds_read_b64_tr_b16 v[16:17], v4 offset:53248
  ds_read_b64_tr_b16 v[18:19], v4 offset:53760
  s_waitcnt lgkmcnt(6)
  v_cvt_pk_bf16_f32 v183, v110, v111
  v_fma_f32 v118, v118, v2, -v3
  v_fma_f32 v119, v119, v2, -v3
  v_lshlrev_b32 v126, 16, v191
  v_and_b32 v127, s87, v191
  v_mfma_f32_32x32x16_bf16 v[32:47], v[20:23], v[180:183], v[32:47]
  ds_read_b64_tr_b16 v[20:21], v5 offset:53248
  ds_read_b64_tr_b16 v[22:23], v5 offset:53760
  v_cvt_pk_bf16_f32 v184, v112, v113
  v_fma_f32 v120, v120, v2, -v3
  v_fma_f32 v121, v121, v2, -v3
  v_lshlrev_b32 v96, 16, v192
  v_and_b32 v97, s87, v192
  v_mfma_f32_32x32x16_bf16 v[48:63], v[24:27], v[180:183], v[48:63]
  ds_read_b64_tr_b16 v[24:25], v6 offset:53248
  ds_read_b64_tr_b16 v[26:27], v6 offset:53760
  s_waitcnt lgkmcnt(6)
  v_cvt_pk_bf16_f32 v185, v114, v115
  v_fma_f32 v122, v122, v2, -v3
  v_fma_f32 v123, v123, v2, -v3
  v_lshlrev_b32 v98, 16, v193
  v_and_b32 v99, s87, v193
  v_mfma_f32_32x32x16_bf16 v[64:79], v[28:31], v[180:183], v[64:79]
  ds_read_b64_tr_b16 v[28:29], v7 offset:53248
  ds_read_b64_tr_b16 v[30:31], v7 offset:53760
  v_cvt_pk_bf16_f32 v186, v116, v117
  v_fma_f32 v124, v124, v2, -v3
  v_fma_f32 v125, v125, v2, -v3
  v_lshlrev_b32 v100, 16, v194
  v_and_b32 v101, s87, v194
  v_mfma_f32_32x32x16_bf16 v[80:95], v[12:15], v[180:183], v[80:95]
  ds_read_b64_tr_b16 v[12:13], v4 offset:55296
  ds_read_b64_tr_b16 v[14:15], v4 offset:55808
  s_waitcnt lgkmcnt(6)
  v_cvt_pk_bf16_f32 v187, v118, v119
  v_fma_f32 v126, v126, v2, -v3
  v_fma_f32 v127, v127, v2, -v3
  v_lshlrev_b32 v102, 16, v195
  v_and_b32 v103, s87, v195
  v_mfma_f32_32x32x16_bf16 v[32:47], v[16:19], v[184:187], v[32:47]
  ds_read_b64_tr_b16 v[16:17], v5 offset:55296
  ds_read_b64_tr_b16 v[18:19], v5 offset:55808
  v_cvt_pk_bf16_f32 v188, v120, v121
  v_fma_f32 v96, v96, v2, -v3
  v_fma_f32 v97, v97, v2, -v3
  v_lshlrev_b32 v104, 16, v196
  v_and_b32 v105, s87, v196
  v_mfma_f32_32x32x16_bf16 v[48:63], v[20:23], v[184:187], v[48:63]
  ds_read_b64_tr_b16 v[20:21], v6 offset:55296
  ds_read_b64_tr_b16 v[22:23], v6 offset:55808
  s_waitcnt lgkmcnt(6)
  v_cvt_pk_bf16_f32 v189, v122, v123
  v_fma_f32 v98, v98, v2, -v3
  v_fma_f32 v99, v99, v2, -v3
  v_lshlrev_b32 v106, 16, v197
  v_and_b32 v107, s87, v197
  v_mfma_f32_32x32x16_bf16 v[64:79], v[24:27], v[184:187], v[64:79]
  ds_read_b64_tr_b16 v[24:25], v7 offset:55296
  ds_read_b64_tr_b16 v[26:27], v7 offset:55808
  v_cvt_pk_bf16_f32 v190, v124, v125
  v_fma_f32 v100, v100, v2, -v3
  v_fma_f32 v101, v101, v2, -v3
  v_lshlrev_b32 v108, 16, v198
  v_and_b32 v109, s87, v198
  v_mfma_f32_32x32x16_bf16 v[80:95], v[28:31], v[184:187], v[80:95]
  s_barrier
  ds_read_b64_tr_b16 v[28:29], v4 offset:0
  ds_read_b64_tr_b16 v[30:31], v4 offset:512
  s_waitcnt lgkmcnt(6)
  v_cvt_pk_bf16_f32 v191, v126, v127
  v_fma_f32 v102, v102, v2, -v3
  v_fma_f32 v103, v103, v2, -v3
  v_lshlrev_b32 v110, 16, v199
  v_and_b32 v111, s87, v199
  v_mfma_f32_32x32x16_bf16 v[32:47], v[12:15], v[188:191], v[32:47]
  ds_read_b64_tr_b16 v[12:13], v5 offset:0
  ds_read_b64_tr_b16 v[14:15], v5 offset:512
  v_cvt_pk_bf16_f32 v192, v96, v97
  v_fma_f32 v104, v104, v2, -v3
  v_fma_f32 v105, v105, v2, -v3
  v_lshlrev_b32 v112, 16, v200
  v_and_b32 v113, s87, v200
  v_mfma_f32_32x32x16_bf16 v[48:63], v[16:19], v[188:191], v[48:63]
  ds_read_b64_tr_b16 v[16:17], v6 offset:0
  ds_read_b64_tr_b16 v[18:19], v6 offset:512
  s_waitcnt lgkmcnt(6)
  v_cvt_pk_bf16_f32 v193, v98, v99
  v_fma_f32 v106, v106, v2, -v3
  v_fma_f32 v107, v107, v2, -v3
  v_lshlrev_b32 v114, 16, v201
  v_and_b32 v115, s87, v201
  v_mfma_f32_32x32x16_bf16 v[64:79], v[20:23], v[188:191], v[64:79]
  ds_read_b64_tr_b16 v[20:21], v7 offset:0
  ds_read_b64_tr_b16 v[22:23], v7 offset:512
  v_cvt_pk_bf16_f32 v194, v100, v101
  v_fma_f32 v108, v108, v2, -v3
  v_fma_f32 v109, v109, v2, -v3
  v_lshlrev_b32 v116, 16, v202
  v_and_b32 v117, s87, v202
  v_mfma_f32_32x32x16_bf16 v[80:95], v[24:27], v[188:191], v[80:95]
  ds_read_b64_tr_b16 v[24:25], v4 offset:2048
  ds_read_b64_tr_b16 v[26:27], v4 offset:2560
  s_waitcnt lgkmcnt(6)
  v_cvt_pk_bf16_f32 v195, v102, v103
  v_fma_f32 v110, v110, v2, -v3
  v_fma_f32 v111, v111, v2, -v3
  v_lshlrev_b32 v118, 16, v203
  v_and_b32 v119, s87, v203
  v_mfma_f32_32x32x16_bf16 v[32:47], v[28:31], v[192:195], v[32:47]
  ds_read_b64_tr_b16 v[28:29], v5 offset:2048
  ds_read_b64_tr_b16 v[30:31], v5 offset:2560
  v_cvt_pk_bf16_f32 v196, v104, v105
  v_fma_f32 v112, v112, v2, -v3
  v_fma_f32 v113, v113, v2, -v3
  v_lshlrev_b32 v120, 16, v204
  v_and_b32 v121, s87, v204
  v_mfma_f32_32x32x16_bf16 v[48:63], v[12:15], v[192:195], v[48:63]
  ds_read_b64_tr_b16 v[12:13], v6 offset:2048
  ds_read_b64_tr_b16 v[14:15], v6 offset:2560
  s_waitcnt lgkmcnt(6)
  v_cvt_pk_bf16_f32 v197, v106, v107
  v_fma_f32 v114, v114, v2, -v3
  v_fma_f32 v115, v115, v2, -v3
  v_lshlrev_b32 v122, 16, v205
  v_and_b32 v123, s87, v205
  v_mfma_f32_32x32x16_bf16 v[64:79], v[16:19], v[192:195], v[64:79]
  ds_read_b64_tr_b16 v[16:17], v7 offset:2048
  ds_read_b64_tr_b16 v[18:19], v7 offset:2560
  v_cvt_pk_bf16_f32 v198, v108, v109
  v_fma_f32 v116, v116, v2, -v3
  v_fma_f32 v117, v117, v2, -v3
  v_lshlrev_b32 v124, 16, v206
  v_and_b32 v125, s87, v206
  v_mfma_f32_32x32x16_bf16 v[80:95], v[20:23], v[192:195], v[80:95]
  ds_read_b64_tr_b16 v[20:21], v4 offset:4096
  ds_read_b64_tr_b16 v[22:23], v4 offset:4608
  s_waitcnt lgkmcnt(6)
  v_cvt_pk_bf16_f32 v199, v110, v111
  v_fma_f32 v118, v118, v2, -v3
  v_fma_f32 v119, v119, v2, -v3
  v_lshlrev_b32 v126, 16, v207
  v_and_b32 v127, s87, v207
  v_mfma_f32_32x32x16_bf16 v[32:47], v[24:27], v[196:199], v[32:47]
  ds_read_b64_tr_b16 v[24:25], v5 offset:4096
  ds_read_b64_tr_b16 v[26:27], v5 offset:4608
  v_cvt_pk_bf16_f32 v200, v112, v113
  v_fma_f32 v120, v120, v2, -v3
  v_fma_f32 v121, v121, v2, -v3
  v_lshlrev_b32 v96, 16, v208
  v_and_b32 v97, s87, v208
  v_mfma_f32_32x32x16_bf16 v[48:63], v[28:31], v[196:199], v[48:63]
  ds_read_b64_tr_b16 v[28:29], v6 offset:4096
  ds_read_b64_tr_b16 v[30:31], v6 offset:4608
  s_waitcnt lgkmcnt(6)
  v_cvt_pk_bf16_f32 v201, v114, v115
  v_fma_f32 v122, v122, v2, -v3
  v_fma_f32 v123, v123, v2, -v3
  v_lshlrev_b32 v98, 16, v209
  v_and_b32 v99, s87, v209
  v_mfma_f32_32x32x16_bf16 v[64:79], v[12:15], v[196:199], v[64:79]
  ds_read_b64_tr_b16 v[12:13], v7 offset:4096
  ds_read_b64_tr_b16 v[14:15], v7 offset:4608
  v_cvt_pk_bf16_f32 v202, v116, v117
  v_fma_f32 v124, v124, v2, -v3
  v_fma_f32 v125, v125, v2, -v3
  v_lshlrev_b32 v100, 16, v210
  v_and_b32 v101, s87, v210
  v_mfma_f32_32x32x16_bf16 v[80:95], v[16:19], v[196:199], v[80:95]
  ds_read_b64_tr_b16 v[16:17], v4 offset:6144
  ds_read_b64_tr_b16 v[18:19], v4 offset:6656
  s_waitcnt lgkmcnt(6)
  v_cvt_pk_bf16_f32 v203, v118, v119
  v_fma_f32 v126, v126, v2, -v3
  v_fma_f32 v127, v127, v2, -v3
  v_lshlrev_b32 v102, 16, v211
  v_and_b32 v103, s87, v211
  v_mfma_f32_32x32x16_bf16 v[32:47], v[20:23], v[200:203], v[32:47]
  ds_read_b64_tr_b16 v[20:21], v5 offset:6144
  ds_read_b64_tr_b16 v[22:23], v5 offset:6656
  v_cvt_pk_bf16_f32 v204, v120, v121
  v_fma_f32 v96, v96, v2, -v3
  v_fma_f32 v97, v97, v2, -v3
  v_lshlrev_b32 v104, 16, v212
  v_and_b32 v105, s87, v212
  v_mfma_f32_32x32x16_bf16 v[48:63], v[24:27], v[200:203], v[48:63]
  ds_read_b64_tr_b16 v[24:25], v6 offset:6144
  ds_read_b64_tr_b16 v[26:27], v6 offset:6656
  s_waitcnt lgkmcnt(6)
  v_cvt_pk_bf16_f32 v205, v122, v123
  v_fma_f32 v98, v98, v2, -v3
  v_fma_f32 v99, v99, v2, -v3
  v_lshlrev_b32 v106, 16, v213
  v_and_b32 v107, s87, v213
  v_mfma_f32_32x32x16_bf16 v[64:79], v[28:31], v[200:203], v[64:79]
  ds_read_b64_tr_b16 v[28:29], v7 offset:6144
  ds_read_b64_tr_b16 v[30:31], v7 offset:6656
  v_cvt_pk_bf16_f32 v206, v124, v125
  v_fma_f32 v100, v100, v2, -v3
  v_fma_f32 v101, v101, v2, -v3
  v_lshlrev_b32 v108, 16, v214
  v_and_b32 v109, s87, v214
  v_mfma_f32_32x32x16_bf16 v[80:95], v[12:15], v[200:203], v[80:95]
  s_barrier
  ds_read_b64_tr_b16 v[12:13], v4 offset:16384
  ds_read_b64_tr_b16 v[14:15], v4 offset:16896
  s_waitcnt lgkmcnt(6)
  v_cvt_pk_bf16_f32 v207, v126, v127
  v_fma_f32 v102, v102, v2, -v3
  v_fma_f32 v103, v103, v2, -v3
  v_lshlrev_b32 v110, 16, v215
  v_and_b32 v111, s87, v215
  v_mfma_f32_32x32x16_bf16 v[32:47], v[16:19], v[204:207], v[32:47]
  ds_read_b64_tr_b16 v[16:17], v5 offset:16384
  ds_read_b64_tr_b16 v[18:19], v5 offset:16896
  v_cvt_pk_bf16_f32 v208, v96, v97
  v_fma_f32 v104, v104, v2, -v3
  v_fma_f32 v105, v105, v2, -v3
  v_lshlrev_b32 v112, 16, v216
  v_and_b32 v113, s87, v216
  v_mfma_f32_32x32x16_bf16 v[48:63], v[20:23], v[204:207], v[48:63]
  ds_read_b64_tr_b16 v[20:21], v6 offset:16384
  ds_read_b64_tr_b16 v[22:23], v6 offset:16896
  s_waitcnt lgkmcnt(6)
  v_cvt_pk_bf16_f32 v209, v98, v99
  v_fma_f32 v106, v106, v2, -v3
  v_fma_f32 v107, v107, v2, -v3
  v_lshlrev_b32 v114, 16, v217
  v_and_b32 v115, s87, v217
  v_mfma_f32_32x32x16_bf16 v[64:79], v[24:27], v[204:207], v[64:79]
  ds_read_b64_tr_b16 v[24:25], v7 offset:16384
  ds_read_b64_tr_b16 v[26:27], v7 offset:16896
  v_cvt_pk_bf16_f32 v210, v100, v101
  v_fma_f32 v108, v108, v2, -v3
  v_fma_f32 v109, v109, v2, -v3
  v_lshlrev_b32 v116, 16, v218
  v_and_b32 v117, s87, v218
  v_mfma_f32_32x32x16_bf16 v[80:95], v[28:31], v[204:207], v[80:95]
  ds_read_b64_tr_b16 v[28:29], v4 offset:18432
  ds_read_b64_tr_b16 v[30:31], v4 offset:18944
  s_waitcnt lgkmcnt(6)
  v_cvt_pk_bf16_f32 v211, v102, v103
  v_fma_f32 v110, v110, v2, -v3
  v_fma_f32 v111, v111, v2, -v3
  v_lshlrev_b32 v118, 16, v219
  v_and_b32 v119, s87, v219
  v_mfma_f32_32x32x16_bf16 v[32:47], v[12:15], v[208:211], v[32:47]
  ds_read_b64_tr_b16 v[12:13], v5 offset:18432
  ds_read_b64_tr_b16 v[14:15], v5 offset:18944
  v_cvt_pk_bf16_f32 v212, v104, v105
  v_fma_f32 v112, v112, v2, -v3
  v_fma_f32 v113, v113, v2, -v3
  v_lshlrev_b32 v120, 16, v220
  v_and_b32 v121, s87, v220
  v_mfma_f32_32x32x16_bf16 v[48:63], v[16:19], v[208:211], v[48:63]
  ds_read_b64_tr_b16 v[16:17], v6 offset:18432
  ds_read_b64_tr_b16 v[18:19], v6 offset:18944
  s_waitcnt lgkmcnt(6)
  v_cvt_pk_bf16_f32 v213, v106, v107
  v_fma_f32 v114, v114, v2, -v3
  v_fma_f32 v115, v115, v2, -v3
  v_lshlrev_b32 v122, 16, v221
  v_and_b32 v123, s87, v221
  v_mfma_f32_32x32x16_bf16 v[64:79], v[20:23], v[208:211], v[64:79]
  ds_read_b64_tr_b16 v[20:21], v7 offset:18432
  ds_read_b64_tr_b16 v[22:23], v7 offset:18944
  v_cvt_pk_bf16_f32 v214, v108, v109
  v_fma_f32 v116, v116, v2, -v3
  v_fma_f32 v117, v117, v2, -v3
  v_lshlrev_b32 v124, 16, v222
  v_and_b32 v125, s87, v222
  v_mfma_f32_32x32x16_bf16 v[80:95], v[24:27], v[208:211], v[80:95]
  ds_read_b64_tr_b16 v[24:25], v4 offset:20480
  ds_read_b64_tr_b16 v[26:27], v4 offset:20992
  s_waitcnt lgkmcnt(6)
  v_cvt_pk_bf16_f32 v215, v110, v111
  v_fma_f32 v118, v118, v2, -v3
  v_fma_f32 v119, v119, v2, -v3
  v_lshlrev_b32 v126, 16, v223
  v_and_b32 v127, s87, v223
  v_mfma_f32_32x32x16_bf16 v[32:47], v[28:31], v[212:215], v[32:47]
  ds_read_b64_tr_b16 v[28:29], v5 offset:20480
  ds_read_b64_tr_b16 v[30:31], v5 offset:20992
  v_cvt_pk_bf16_f32 v216, v112, v113
  v_fma_f32 v120, v120, v2, -v3
  v_fma_f32 v121, v121, v2, -v3
  v_lshlrev_b32 v96, 16, v224
  v_and_b32 v97, s87, v224
  v_mfma_f32_32x32x16_bf16 v[48:63], v[12:15], v[212:215], v[48:63]
  ds_read_b64_tr_b16 v[12:13], v6 offset:20480
  ds_read_b64_tr_b16 v[14:15], v6 offset:20992
  s_waitcnt lgkmcnt(6)
  v_cvt_pk_bf16_f32 v217, v114, v115
  v_fma_f32 v122, v122, v2, -v3
  v_fma_f32 v123, v123, v2, -v3
  v_lshlrev_b32 v98, 16, v225
  v_and_b32 v99, s87, v225
  v_mfma_f32_32x32x16_bf16 v[64:79], v[16:19], v[212:215], v[64:79]
  ds_read_b64_tr_b16 v[16:17], v7 offset:20480
  ds_read_b64_tr_b16 v[18:19], v7 offset:20992
  v_cvt_pk_bf16_f32 v218, v116, v117
  v_fma_f32 v124, v124, v2, -v3
  v_fma_f32 v125, v125, v2, -v3
  v_lshlrev_b32 v100, 16, v226
  v_and_b32 v101, s87, v226
  v_mfma_f32_32x32x16_bf16 v[80:95], v[20:23], v[212:215], v[80:95]
  ds_read_b64_tr_b16 v[20:21], v4 offset:22528
  ds_read_b64_tr_b16 v[22:23], v4 offset:23040
  s_waitcnt lgkmcnt(6)
  v_cvt_pk_bf16_f32 v219, v118, v119
  v_fma_f32 v126, v126, v2, -v3
  v_fma_f32 v127, v127, v2, -v3
  v_lshlrev_b32 v102, 16, v227
  v_and_b32 v103, s87, v227
  v_mfma_f32_32x32x16_bf16 v[32:47], v[24:27], v[216:219], v[32:47]
  ds_read_b64_tr_b16 v[24:25], v5 offset:22528
  ds_read_b64_tr_b16 v[26:27], v5 offset:23040
  v_cvt_pk_bf16_f32 v220, v120, v121
  v_fma_f32 v96, v96, v2, -v3
  v_fma_f32 v97, v97, v2, -v3
  v_lshlrev_b32 v104, 16, v228
  v_and_b32 v105, s87, v228
  v_mfma_f32_32x32x16_bf16 v[48:63], v[28:31], v[216:219], v[48:63]
  ds_read_b64_tr_b16 v[28:29], v6 offset:22528
  ds_read_b64_tr_b16 v[30:31], v6 offset:23040
  s_waitcnt lgkmcnt(6)
  v_cvt_pk_bf16_f32 v221, v122, v123
  v_fma_f32 v98, v98, v2, -v3
  v_fma_f32 v99, v99, v2, -v3
  v_lshlrev_b32 v106, 16, v229
  v_and_b32 v107, s87, v229
  v_mfma_f32_32x32x16_bf16 v[64:79], v[12:15], v[216:219], v[64:79]
  ds_read_b64_tr_b16 v[12:13], v7 offset:22528
  ds_read_b64_tr_b16 v[14:15], v7 offset:23040
  v_cvt_pk_bf16_f32 v222, v124, v125
  v_fma_f32 v100, v100, v2, -v3
  v_fma_f32 v101, v101, v2, -v3
  v_lshlrev_b32 v108, 16, v230
  v_and_b32 v109, s87, v230
  v_mfma_f32_32x32x16_bf16 v[80:95], v[16:19], v[216:219], v[80:95]
  s_barrier
  ds_read_b64_tr_b16 v[16:17], v4 offset:32768
  ds_read_b64_tr_b16 v[18:19], v4 offset:33280
  s_waitcnt lgkmcnt(6)
  v_cvt_pk_bf16_f32 v223, v126, v127
  v_fma_f32 v102, v102, v2, -v3
  v_fma_f32 v103, v103, v2, -v3
  v_lshlrev_b32 v110, 16, v231
  v_and_b32 v111, s87, v231
  v_mfma_f32_32x32x16_bf16 v[32:47], v[20:23], v[220:223], v[32:47]
  ds_read_b64_tr_b16 v[20:21], v5 offset:32768
  ds_read_b64_tr_b16 v[22:23], v5 offset:33280
  v_cvt_pk_bf16_f32 v224, v96, v97
  v_fma_f32 v104, v104, v2, -v3
  v_fma_f32 v105, v105, v2, -v3
  v_lshlrev_b32 v112, 16, v232
  v_and_b32 v113, s87, v232
  v_mfma_f32_32x32x16_bf16 v[48:63], v[24:27], v[220:223], v[48:63]
  ds_read_b64_tr_b16 v[24:25], v6 offset:32768
  ds_read_b64_tr_b16 v[26:27], v6 offset:33280
  s_waitcnt lgkmcnt(6)
  v_cvt_pk_bf16_f32 v225, v98, v99
  v_fma_f32 v106, v106, v2, -v3
  v_fma_f32 v107, v107, v2, -v3
  v_lshlrev_b32 v114, 16, v233
  v_and_b32 v115, s87, v233
  v_mfma_f32_32x32x16_bf16 v[64:79], v[28:31], v[220:223], v[64:79]
  ds_read_b64_tr_b16 v[28:29], v7 offset:32768
  ds_read_b64_tr_b16 v[30:31], v7 offset:33280
  v_cvt_pk_bf16_f32 v226, v100, v101
  v_fma_f32 v108, v108, v2, -v3
  v_fma_f32 v109, v109, v2, -v3
  v_lshlrev_b32 v116, 16, v234
  v_and_b32 v117, s87, v234
  v_mfma_f32_32x32x16_bf16 v[80:95], v[12:15], v[220:223], v[80:95]
  ds_read_b64_tr_b16 v[12:13], v4 offset:34816
  ds_read_b64_tr_b16 v[14:15], v4 offset:35328
  s_waitcnt lgkmcnt(6)
  v_cvt_pk_bf16_f32 v227, v102, v103
  v_fma_f32 v110, v110, v2, -v3
  v_fma_f32 v111, v111, v2, -v3
  v_lshlrev_b32 v118, 16, v235
  v_and_b32 v119, s87, v235
  v_mfma_f32_32x32x16_bf16 v[32:47], v[16:19], v[224:227], v[32:47]
  ds_read_b64_tr_b16 v[16:17], v5 offset:34816
  ds_read_b64_tr_b16 v[18:19], v5 offset:35328
  v_cvt_pk_bf16_f32 v228, v104, v105
  v_fma_f32 v112, v112, v2, -v3
  v_fma_f32 v113, v113, v2, -v3
  v_lshlrev_b32 v120, 16, v236
  v_and_b32 v121, s87, v236
  v_mfma_f32_32x32x16_bf16 v[48:63], v[20:23], v[224:227], v[48:63]
  ds_read_b64_tr_b16 v[20:21], v6 offset:34816
  ds_read_b64_tr_b16 v[22:23], v6 offset:35328
  s_waitcnt lgkmcnt(6)
  v_cvt_pk_bf16_f32 v229, v106, v107
  v_fma_f32 v114, v114, v2, -v3
  v_fma_f32 v115, v115, v2, -v3
  v_lshlrev_b32 v122, 16, v237
  v_and_b32 v123, s87, v237
  v_mfma_f32_32x32x16_bf16 v[64:79], v[24:27], v[224:227], v[64:79]
  ds_read_b64_tr_b16 v[24:25], v7 offset:34816
  ds_read_b64_tr_b16 v[26:27], v7 offset:35328
  v_cvt_pk_bf16_f32 v230, v108, v109
  v_fma_f32 v116, v116, v2, -v3
  v_fma_f32 v117, v117, v2, -v3
  v_lshlrev_b32 v124, 16, v238
  v_and_b32 v125, s87, v238
  v_mfma_f32_32x32x16_bf16 v[80:95], v[28:31], v[224:227], v[80:95]
  ds_read_b64_tr_b16 v[28:29], v4 offset:36864
  ds_read_b64_tr_b16 v[30:31], v4 offset:37376
  s_waitcnt lgkmcnt(6)
  v_cvt_pk_bf16_f32 v231, v110, v111
  v_fma_f32 v118, v118, v2, -v3
  v_fma_f32 v119, v119, v2, -v3
  v_lshlrev_b32 v126, 16, v239
  v_and_b32 v127, s87, v239
  v_mfma_f32_32x32x16_bf16 v[32:47], v[12:15], v[228:231], v[32:47]
  ds_read_b64_tr_b16 v[12:13], v5 offset:36864
  ds_read_b64_tr_b16 v[14:15], v5 offset:37376
  v_cvt_pk_bf16_f32 v232, v112, v113
  v_fma_f32 v120, v120, v2, -v3
  v_fma_f32 v121, v121, v2, -v3
  v_lshlrev_b32 v96, 16, v240
  v_and_b32 v97, s87, v240
  v_mfma_f32_32x32x16_bf16 v[48:63], v[16:19], v[228:231], v[48:63]
  ds_read_b64_tr_b16 v[16:17], v6 offset:36864
  ds_read_b64_tr_b16 v[18:19], v6 offset:37376
  s_waitcnt lgkmcnt(6)
  v_cvt_pk_bf16_f32 v233, v114, v115
  v_fma_f32 v122, v122, v2, -v3
  v_fma_f32 v123, v123, v2, -v3
  v_lshlrev_b32 v98, 16, v241
  v_and_b32 v99, s87, v241
  v_mfma_f32_32x32x16_bf16 v[64:79], v[20:23], v[228:231], v[64:79]
  ds_read_b64_tr_b16 v[20:21], v7 offset:36864
  ds_read_b64_tr_b16 v[22:23], v7 offset:37376
  v_cvt_pk_bf16_f32 v234, v116, v117
  v_fma_f32 v124, v124, v2, -v3
  v_fma_f32 v125, v125, v2, -v3
  v_lshlrev_b32 v100, 16, v242
  v_and_b32 v101, s87, v242
  v_mfma_f32_32x32x16_bf16 v[80:95], v[24:27], v[228:231], v[80:95]
  ds_read_b64_tr_b16 v[24:25], v4 offset:38912
  ds_read_b64_tr_b16 v[26:27], v4 offset:39424
  s_waitcnt lgkmcnt(6)
  v_cvt_pk_bf16_f32 v235, v118, v119
  v_fma_f32 v126, v126, v2, -v3
  v_fma_f32 v127, v127, v2, -v3
  v_lshlrev_b32 v102, 16, v243
  v_and_b32 v103, s87, v243
  v_mfma_f32_32x32x16_bf16 v[32:47], v[28:31], v[232:235], v[32:47]
  ds_read_b64_tr_b16 v[28:29], v5 offset:38912
  ds_read_b64_tr_b16 v[30:31], v5 offset:39424
  v_cvt_pk_bf16_f32 v236, v120, v121
  v_fma_f32 v96, v96, v2, -v3
  v_fma_f32 v97, v97, v2, -v3
  v_lshlrev_b32 v104, 16, v244
  v_and_b32 v105, s87, v244
  v_mfma_f32_32x32x16_bf16 v[48:63], v[12:15], v[232:235], v[48:63]
  ds_read_b64_tr_b16 v[12:13], v6 offset:38912
  ds_read_b64_tr_b16 v[14:15], v6 offset:39424
  s_waitcnt lgkmcnt(6)
  v_cvt_pk_bf16_f32 v237, v122, v123
  v_fma_f32 v98, v98, v2, -v3
  v_fma_f32 v99, v99, v2, -v3
  v_lshlrev_b32 v106, 16, v245
  v_and_b32 v107, s87, v245
  v_mfma_f32_32x32x16_bf16 v[64:79], v[16:19], v[232:235], v[64:79]
  ds_read_b64_tr_b16 v[16:17], v7 offset:38912
  ds_read_b64_tr_b16 v[18:19], v7 offset:39424
  v_cvt_pk_bf16_f32 v238, v124, v125
  v_fma_f32 v100, v100, v2, -v3
  v_fma_f32 v101, v101, v2, -v3
  v_lshlrev_b32 v108, 16, v246
  v_and_b32 v109, s87, v246
  v_mfma_f32_32x32x16_bf16 v[80:95], v[20:23], v[232:235], v[80:95]
  s_barrier
  ds_read_b64_tr_b16 v[20:21], v5 offset:49152
  ds_read_b64_tr_b16 v[22:23], v5 offset:49664
  s_waitcnt lgkmcnt(6)
  v_cvt_pk_bf16_f32 v239, v126, v127
  v_fma_f32 v102, v102, v2, -v3
  v_fma_f32 v103, v103, v2, -v3
  v_lshlrev_b32 v110, 16, v247
  v_and_b32 v111, s87, v247
  v_mfma_f32_32x32x16_bf16 v[32:47], v[24:27], v[236:239], v[32:47]
  ds_read_b64_tr_b16 v[24:25], v5 offset:51200
  ds_read_b64_tr_b16 v[26:27], v5 offset:51712
  v_cvt_pk_bf16_f32 v240, v96, v97
  v_fma_f32 v104, v104, v2, -v3
  v_fma_f32 v105, v105, v2, -v3
  v_lshlrev_b32 v112, 16, v248
  v_and_b32 v113, s87, v248
  v_mfma_f32_32x32x16_bf16 v[48:63], v[28:31], v[236:239], v[48:63]
  ds_read_b64_tr_b16 v[28:29], v5 offset:53248
  ds_read_b64_tr_b16 v[30:31], v5 offset:53760
  s_waitcnt lgkmcnt(6)
  v_cvt_pk_bf16_f32 v241, v98, v99
  v_fma_f32 v106, v106, v2, -v3
  v_fma_f32 v107, v107, v2, -v3
  v_lshlrev_b32 v114, 16, v249
  v_and_b32 v115, s87, v249
  v_mfma_f32_32x32x16_bf16 v[64:79], v[12:15], v[236:239], v[64:79]
  ds_read_b64_tr_b16 v[12:13], v5 offset:55296
  ds_read_b64_tr_b16 v[14:15], v5 offset:55808
  v_cvt_pk_bf16_f32 v242, v100, v101
  v_fma_f32 v108, v108, v2, -v3
  v_fma_f32 v109, v109, v2, -v3
  v_lshlrev_b32 v116, 16, v250
  v_and_b32 v117, s87, v250
  v_mfma_f32_32x32x16_bf16 v[80:95], v[16:19], v[236:239], v[80:95]
  ds_read_b64_tr_b16 v[16:17], v4 offset:49152
  ds_read_b64_tr_b16 v[18:19], v4 offset:49664
  s_waitcnt lgkmcnt(6)
  v_cvt_pk_bf16_f32 v243, v102, v103
  v_fma_f32 v110, v110, v2, -v3
  v_fma_f32 v111, v111, v2, -v3
  v_lshlrev_b32 v118, 16, v251
  v_and_b32 v119, s87, v251
  v_cvt_pk_bf16_f32 v244, v104, v105
  v_fma_f32 v112, v112, v2, -v3
  v_fma_f32 v113, v113, v2, -v3
  v_lshlrev_b32 v120, 16, v252
  v_and_b32 v121, s87, v252
  v_cvt_pk_bf16_f32 v245, v106, v107
  v_fma_f32 v114, v114, v2, -v3
  v_fma_f32 v115, v115, v2, -v3
  v_lshlrev_b32 v122, 16, v253
  v_and_b32 v123, s87, v253
  v_cvt_pk_bf16_f32 v246, v108, v109
  v_fma_f32 v116, v116, v2, -v3
  v_fma_f32 v117, v117, v2, -v3
  v_lshlrev_b32 v124, 16, v254
  v_and_b32 v125, s87, v254
  v_cvt_pk_bf16_f32 v247, v110, v111
  v_fma_f32 v118, v118, v2, -v3
  v_fma_f32 v119, v119, v2, -v3
  v_lshlrev_b32 v126, 16, v255
  v_and_b32 v127, s87, v255
  v_cvt_pk_bf16_f32 v248, v112, v113
  v_fma_f32 v120, v120, v2, -v3
  v_fma_f32 v121, v121, v2, -v3
  v_cvt_pk_bf16_f32 v249, v114, v115
  v_fma_f32 v122, v122, v2, -v3
  v_fma_f32 v123, v123, v2, -v3
  v_cvt_pk_bf16_f32 v250, v116, v117
  v_fma_f32 v124, v124, v2, -v3
  v_fma_f32 v125, v125, v2, -v3
  v_cvt_pk_bf16_f32 v251, v118, v119
  v_fma_f32 v126, v126, v2, -v3
  v_fma_f32 v127, v127, v2, -v3
  v_cvt_pk_bf16_f32 v252, v120, v121
  v_cvt_pk_bf16_f32 v253, v122, v123
  v_cvt_pk_bf16_f32 v254, v124, v125
  v_cvt_pk_bf16_f32 v255, v126, v127
  s_mov_b32 s86, 65536
  s_waitcnt vmcnt(0)
  v_readfirstlane_b32 s75, v11
L_np_1:
  s_nop 0
  s_cmp_lg_u32 s75, 0
  s_cbranch_scc1 L_nok_2
  s_sleep 1
  buffer_load_dword v11, off, s[36:39], 0 sc1
  s_waitcnt vmcnt(0)
  v_readfirstlane_b32 s75, v11
  s_sub_u32 s86, s86, 1
  s_cbranch_scc0 L_np_1
L_nok_2:
  s_nop 1
  v_mfma_f32_32x32x16_bf16 v[48:63], v[20:23], v[240:243], v[48:63]
  ds_read_b64_tr_b16 v[20:21], v4 offset:51200
  ds_read_b64_tr_b16 v[22:23], v4 offset:51712
  v_add_u32 v3, 158720, v1
  v_add_u32 v122, s80, v1
  v_mfma_f32_32x32x16_bf16 v[48:63], v[24:27], v[244:247], v[48:63]
  ds_read_b64_tr_b16 v[24:25], v4 offset:53248
  ds_read_b64_tr_b16 v[26:27], v4 offset:53760
  s_waitcnt lgkmcnt(6)
  ds_read_b128 v[112:115], v3
  ds_read_b128 v[116:119], v3 offset:1024
  v_and_b32 v2, 31, v0
  v_mfma_f32_32x32x16_bf16 v[48:63], v[28:31], v[248:251], v[48:63]
  ds_read_b64_tr_b16 v[28:29], v4 offset:55296
  ds_read_b64_tr_b16 v[30:31], v4 offset:55808
  v_lshlrev_b32 v2, 6, v2
  v_bfe_u32 v11, v0, 1, 2
  v_lshl_add_u32 v2, v11, 4, v2
  v_add_u32 v2, s80, v2
  v_mfma_f32_32x32x16_bf16 v[48:63], v[12:15], v[252:255], v[48:63]
  ds_read_b64_tr_b16 v[12:13], v6 offset:49152
  ds_read_b64_tr_b16 v[14:15], v6 offset:49664
  s_waitcnt lgkmcnt(8)
  v_and_b32 v11, 32, v0
  v_xor_b32 v120, v2, v11
  v_add_u32 v120, 32768, v120
  v_mfma_f32_32x32x16_bf16 v[32:47], v[16:19], v[240:243], v[32:47]
  ds_read_b64_tr_b16 v[16:17], v6 offset:51200
  ds_read_b64_tr_b16 v[18:19], v6 offset:51712
  v_xor_b32 v121, 16, v120
  v_lshl_add_u32 v2, v11, 8, v2
  v_xor_b32 v3, 16, v2
  v_xor_b32 v10, 32, v2
  v_mfma_f32_32x32x16_bf16 v[32:47], v[20:23], v[244:247], v[32:47]
  ds_read_b64_tr_b16 v[20:21], v6 offset:53248
  ds_read_b64_tr_b16 v[22:23], v6 offset:53760
  s_waitcnt lgkmcnt(6)
  v_xor_b32 v11, 48, v2
  v_cvt_pk_bf16_f32 v48, v48, v49
  v_cvt_pk_bf16_f32 v49, v50, v51
  v_mfma_f32_32x32x16_bf16 v[32:47], v[24:27], v[248:251], v[32:47]
  ds_read_b64_tr_b16 v[24:25], v6 offset:55296
  ds_read_b64_tr_b16 v[26:27], v6 offset:55808
  v_cvt_pk_bf16_f32 v50, v52, v53
  v_cvt_pk_bf16_f32 v51, v54, v55
  v_cvt_pk_bf16_f32 v52, v56, v57
  v_cvt_pk_bf16_f32 v53, v58, v59
  v_mfma_f32_32x32x16_bf16 v[32:47], v[28:31], v[252:255], v[32:47]
  ds_read_b64_tr_b16 v[28:29], v7 offset:49152
  ds_read_b64_tr_b16 v[30:31], v7 offset:49664
  s_waitcnt lgkmcnt(6)
  v_cvt_pk_bf16_f32 v54, v60, v61
  v_cvt_pk_bf16_f32 v55, v62, v63
  v_mfma_f32_32x32x16_bf16 v[64:79], v[12:15], v[240:243], v[64:79]
  ds_read_b64_tr_b16 v[12:13], v7 offset:51200
  ds_read_b64_tr_b16 v[14:15], v7 offset:51712
  ds_write_b128 v122, v[48:51] offset:16384
  ds_write_b128 v122, v[52:55] offset:24576
  v_mfma_f32_32x32x16_bf16 v[64:79], v[16:19], v[244:247], v[64:79]
  ds_read_b64_tr_b16 v[16:17], v7 offset:53248
  ds_read_b64_tr_b16 v[18:19], v7 offset:53760
  s_waitcnt lgkmcnt(8)
  v_cvt_pk_bf16_f32 v32, v32, v33
  v_cvt_pk_bf16_f32 v33, v34, v35
  v_cvt_pk_bf16_f32 v34, v36, v37
  v_mfma_f32_32x32x16_bf16 v[64:79], v[20:23], v[248:251], v[64:79]
  ds_read_b64_tr_b16 v[20:21], v7 offset:55296
  ds_read_b64_tr_b16 v[22:23], v7 offset:55808
  v_cvt_pk_bf16_f32 v35, v38, v39
  v_cvt_pk_bf16_f32 v36, v40, v41
  v_cvt_pk_bf16_f32 v37, v42, v43
  v_cvt_pk_bf16_f32 v38, v44, v45
  v_mfma_f32_32x32x16_bf16 v[64:79], v[24:27], v[252:255], v[64:79]
  s_waitcnt lgkmcnt(6)
  v_cvt_pk_bf16_f32 v39, v46, v47
  v_mfma_f32_32x32x16_bf16 v[80:95], v[28:31], v[240:243], v[80:95]
  v_mfma_f32_32x32x16_bf16 v[80:95], v[12:15], v[244:247], v[80:95]
  s_waitcnt lgkmcnt(0)
  s_nop 6
  v_cvt_pk_bf16_f32 v64, v64, v65
  v_cvt_pk_bf16_f32 v65, v66, v67
  v_cvt_pk_bf16_f32 v66, v68, v69
  v_mfma_f32_32x32x16_bf16 v[80:95], v[16:19], v[248:251], v[80:95]
  v_cvt_pk_bf16_f32 v67, v70, v71
  v_cvt_pk_bf16_f32 v68, v72, v73
  v_cvt_pk_bf16_f32 v69, v74, v75
  v_cvt_pk_bf16_f32 v70, v76, v77
  v_mfma_f32_32x32x16_bf16 v[80:95], v[20:23], v[252:255], v[80:95]
  v_cvt_pk_bf16_f32 v71, v78, v79
  v_mfma_f32_32x32x16_bf16 v[96:111], v[112:115], v[32:35], 0
  v_mfma_f32_32x32x16_bf16 v[96:111], v[116:119], v[36:39], v[96:111]
  s_barrier
  s_nop 7
  v_cvt_pk_bf16_f32 v80, v80, v81
  v_cvt_pk_bf16_f32 v81, v82, v83
  v_cvt_pk_bf16_f32 v82, v84, v85
  v_cvt_pk_bf16_f32 v83, v86, v87
  v_cvt_pk_bf16_f32 v84, v88, v89
  v_cvt_pk_bf16_f32 v85, v90, v91
  v_cvt_pk_bf16_f32 v86, v92, v93
  v_cvt_pk_bf16_f32 v87, v94, v95
  ds_write_b128 v120, v[64:67] offset:0
  ds_write_b128 v121, v[68:71] offset:0
  ds_write_b128 v120, v[80:83] offset:8192
  ds_write_b128 v121, v[84:87] offset:8192
  v_mul_u32_u24 v4, 8224, v9
  v_xor_b32 v4, v4, v8
  v_xor_b32 v5, 32, v4
  v_xor_b32 v6, 64, v4
  v_xor_b32 v7, 96, v4
  v_max3_f32 v122, v96, v97, v98
  v_min3_f32 v123, v96, v97, v98
  v_max3_f32 v122, v122, v99, v100
  v_min3_f32 v123, v123, v99, v100
  v_max3_f32 v122, v122, v101, v102
  v_min3_f32 v123, v123, v101, v102
  v_max3_f32 v122, v122, v103, v104
  v_min3_f32 v123, v123, v103, v104
  v_max3_f32 v122, v122, v105, v106
  v_min3_f32 v123, v123, v105, v106
  v_max3_f32 v122, v122, v107, v108
  v_min3_f32 v123, v123, v107, v108
  v_max3_f32 v122, v122, v109, v110
  v_min3_f32 v123, v123, v109, v110
  v_max_f32 v122, v122, v111
  v_min_f32 v123, v123, v111
  v_pk_mul_f32 v[122:123], v[122:123], s[26:27] op_sel_hi:[1,0]
  v_pk_fma_f32 v[48:49], v[96:97], s[26:27], v[122:123] op_sel_hi:[1,0,0] neg_lo:[0,0,1] neg_hi:[0,0,1]
  v_pk_fma_f32 v[96:97], v[96:97], s[26:27], v[122:123] op_sel:[0,0,1] op_sel_hi:[1,0,1] neg_lo:[1,0,0] neg_hi:[1,0,0]
  v_pk_fma_f32 v[50:51], v[98:99], s[26:27], v[122:123] op_sel_hi:[1,0,0] neg_lo:[0,0,1] neg_hi:[0,0,1]
  v_pk_fma_f32 v[98:99], v[98:99], s[26:27], v[122:123] op_sel:[0,0,1] op_sel_hi:[1,0,1] neg_lo:[1,0,0] neg_hi:[1,0,0]
  v_pk_fma_f32 v[52:53], v[100:101], s[26:27], v[122:123] op_sel_hi:[1,0,0] neg_lo:[0,0,1] neg_hi:[0,0,1]
  v_pk_fma_f32 v[100:101], v[100:101], s[26:27], v[122:123] op_sel:[0,0,1] op_sel_hi:[1,0,1] neg_lo:[1,0,0] neg_hi:[1,0,0]
  v_pk_fma_f32 v[54:55], v[102:103], s[26:27], v[122:123] op_sel_hi:[1,0,0] neg_lo:[0,0,1] neg_hi:[0,0,1]
  v_pk_fma_f32 v[102:103], v[102:103], s[26:27], v[122:123] op_sel:[0,0,1] op_sel_hi:[1,0,1] neg_lo:[1,0,0] neg_hi:[1,0,0]
  v_pk_fma_f32 v[56:57], v[104:105], s[26:27], v[122:123] op_sel_hi:[1,0,0] neg_lo:[0,0,1] neg_hi:[0,0,1]
  v_pk_fma_f32 v[104:105], v[104:105], s[26:27], v[122:123] op_sel:[0,0,1] op_sel_hi:[1,0,1] neg_lo:[1,0,0] neg_hi:[1,0,0]
  v_pk_fma_f32 v[58:59], v[106:107], s[26:27], v[122:123] op_sel_hi:[1,0,0] neg_lo:[0,0,1] neg_hi:[0,0,1]
  v_pk_fma_f32 v[106:107], v[106:107], s[26:27], v[122:123] op_sel:[0,0,1] op_sel_hi:[1,0,1] neg_lo:[1,0,0] neg_hi:[1,0,0]
  v_pk_fma_f32 v[60:61], v[108:109], s[26:27], v[122:123] op_sel_hi:[1,0,0] neg_lo:[0,0,1] neg_hi:[0,0,1]
  v_pk_fma_f32 v[108:109], v[108:109], s[26:27], v[122:123] op_sel:[0,0,1] op_sel_hi:[1,0,1] neg_lo:[1,0,0] neg_hi:[1,0,0]
  v_pk_fma_f32 v[62:63], v[110:111], s[26:27], v[122:123] op_sel_hi:[1,0,0] neg_lo:[0,0,1] neg_hi:[0,0,1]
  v_pk_fma_f32 v[110:111], v[110:111], s[26:27], v[122:123] op_sel:[0,0,1] op_sel_hi:[1,0,1] neg_lo:[1,0,0] neg_hi:[1,0,0]
  v_exp_f32 v48, v48
  v_exp_f32 v96, v96
  v_exp_f32 v49, v49
  v_exp_f32 v97, v97
  v_exp_f32 v50, v50
  v_exp_f32 v98, v98
  v_exp_f32 v51, v51
  v_exp_f32 v99, v99
  v_exp_f32 v52, v52
  v_exp_f32 v100, v100
  v_exp_f32 v53, v53
  v_exp_f32 v101, v101
  v_exp_f32 v54, v54
  v_exp_f32 v102, v102
  v_exp_f32 v55, v55
  v_exp_f32 v103, v103
  v_exp_f32 v56, v56
  v_exp_f32 v104, v104
  v_exp_f32 v57, v57
  v_exp_f32 v105, v105
  v_exp_f32 v58, v58
  v_exp_f32 v106, v106
  v_exp_f32 v59, v59
  v_exp_f32 v107, v107
  v_exp_f32 v60, v60
  v_exp_f32 v108, v108
  v_exp_f32 v61, v61
  v_exp_f32 v109, v109
  v_exp_f32 v62, v62
  v_exp_f32 v110, v110
  v_exp_f32 v63, v63
  v_exp_f32 v111, v111
  v_pk_add_f32 v[124:125], v[48:49], v[50:51]
  v_pk_add_f32 v[126:127], v[96:97], v[98:99]
  v_pk_add_f32 v[124:125], v[124:125], v[52:53]
  v_pk_add_f32 v[126:127], v[126:127], v[100:101]
  v_pk_add_f32 v[124:125], v[124:125], v[54:55]
  v_pk_add_f32 v[126:127], v[126:127], v[102:103]
  v_pk_add_f32 v[124:125], v[124:125], v[56:57]
  v_pk_add_f32 v[126:127], v[126:127], v[104:105]
  v_pk_add_f32 v[124:125], v[124:125], v[58:59]
  v_pk_add_f32 v[126:127], v[126:127], v[106:107]
  v_pk_add_f32 v[124:125], v[124:125], v[60:61]
  v_pk_add_f32 v[126:127], v[126:127], v[108:109]
  v_pk_add_f32 v[124:125], v[124:125], v[62:63]
  v_pk_add_f32 v[126:127], v[126:127], v[110:111]
  v_add_f32 v122, v124, v125
  v_add_f32 v123, v126, v127
  v_rcp_f32 v122, v122
  v_rcp_f32 v123, v123
  s_nop 0
  v_pk_mul_f32 v[48:49], v[48:49], v[122:123] op_sel_hi:[1,0]
  v_pk_mul_f32 v[50:51], v[50:51], v[122:123] op_sel_hi:[1,0]
  v_pk_mul_f32 v[52:53], v[52:53], v[122:123] op_sel_hi:[1,0]
  v_pk_mul_f32 v[54:55], v[54:55], v[122:123] op_sel_hi:[1,0]
  v_pk_mul_f32 v[56:57], v[56:57], v[122:123] op_sel_hi:[1,0]
  v_pk_mul_f32 v[58:59], v[58:59], v[122:123] op_sel_hi:[1,0]
  v_pk_mul_f32 v[60:61], v[60:61], v[122:123] op_sel_hi:[1,0]
  v_pk_mul_f32 v[62:63], v[62:63], v[122:123] op_sel_hi:[1,0]
  v_cvt_pk_bf16_f32 v48, v48, v49
  v_cvt_pk_bf16_f32 v49, v50, v51
  v_cvt_pk_bf16_f32 v50, v52, v53
  v_cvt_pk_bf16_f32 v51, v54, v55
  v_cvt_pk_bf16_f32 v52, v56, v57
  v_cvt_pk_bf16_f32 v53, v58, v59
  v_cvt_pk_bf16_f32 v54, v60, v61
  v_cvt_pk_bf16_f32 v55, v62, v63
  ds_write_b128 v2, v[48:51]
  ds_write_b128 v3, v[52:55]
  ds_read_b64_tr_b16 v[24:25], v4 offset:0
  ds_read_b64_tr_b16 v[26:27], v4 offset:512
  ds_read_b64_tr_b16 v[28:29], v5 offset:0
  ds_read_b64_tr_b16 v[30:31], v5 offset:512
  ds_read_b64_tr_b16 v[12:13], v6 offset:0
  ds_read_b64_tr_b16 v[14:15], v6 offset:512
  ds_read_b64_tr_b16 v[16:17], v7 offset:0
  ds_read_b64_tr_b16 v[18:19], v7 offset:512
  ds_read_b64_tr_b16 v[20:21], v4 offset:2048
  ds_read_b64_tr_b16 v[22:23], v4 offset:2560
  v_pk_mul_f32 v[96:97], v[96:97], v[122:123] op_sel:[0,1] op_sel_hi:[1,1]
  v_pk_mul_f32 v[98:99], v[98:99], v[122:123] op_sel:[0,1] op_sel_hi:[1,1]
  v_pk_mul_f32 v[100:101], v[100:101], v[122:123] op_sel:[0,1] op_sel_hi:[1,1]
  v_pk_mul_f32 v[102:103], v[102:103], v[122:123] op_sel:[0,1] op_sel_hi:[1,1]
  v_pk_mul_f32 v[104:105], v[104:105], v[122:123] op_sel:[0,1] op_sel_hi:[1,1]
  v_pk_mul_f32 v[106:107], v[106:107], v[122:123] op_sel:[0,1] op_sel_hi:[1,1]
  v_pk_mul_f32 v[108:109], v[108:109], v[122:123] op_sel:[0,1] op_sel_hi:[1,1]
  v_pk_mul_f32 v[110:111], v[110:111], v[122:123] op_sel:[0,1] op_sel_hi:[1,1]
  v_cvt_pk_bf16_f32 v96, v96, v97
  v_cvt_pk_bf16_f32 v97, v98, v99
  v_cvt_pk_bf16_f32 v98, v100, v101
  v_cvt_pk_bf16_f32 v99, v102, v103
  v_cvt_pk_bf16_f32 v100, v104, v105
  v_cvt_pk_bf16_f32 v101, v106, v107
  v_cvt_pk_bf16_f32 v102, v108, v109
  v_cvt_pk_bf16_f32 v103, v110, v111
  ds_write_b128 v10, v[96:99]
  ds_write_b128 v11, v[100:103]
  s_waitcnt lgkmcnt(0)
  s_barrier
  v_mfma_f32_32x32x16_bf16 v[32:47], v[24:27], v[128:131], 0
  ds_read_b64_tr_b16 v[24:25], v5 offset:2048
  ds_read_b64_tr_b16 v[26:27], v5 offset:2560
  v_mfma_f32_32x32x16_bf16 v[48:63], v[28:31], v[128:131], 0
  ds_read_b64_tr_b16 v[28:29], v6 offset:2048
  ds_read_b64_tr_b16 v[30:31], v6 offset:2560
  v_mfma_f32_32x32x16_bf16 v[64:79], v[12:15], v[128:131], 0
  ds_read_b64_tr_b16 v[12:13], v7 offset:2048
  ds_read_b64_tr_b16 v[14:15], v7 offset:2560
  v_mfma_f32_32x32x16_bf16 v[80:95], v[16:19], v[128:131], 0
  ds_read_b64_tr_b16 v[16:17], v4 offset:4096
  ds_read_b64_tr_b16 v[18:19], v4 offset:4608
  s_waitcnt lgkmcnt(6)
  v_mfma_f32_32x32x16_bf16 v[32:47], v[20:23], v[132:135], v[32:47]
  ds_read_b64_tr_b16 v[20:21], v5 offset:4096
  ds_read_b64_tr_b16 v[22:23], v5 offset:4608
  v_mfma_f32_32x32x16_bf16 v[48:63], v[24:27], v[132:135], v[48:63]
  ds_read_b64_tr_b16 v[24:25], v6 offset:4096
  ds_read_b64_tr_b16 v[26:27], v6 offset:4608
  s_waitcnt lgkmcnt(6)
  v_mfma_f32_32x32x16_bf16 v[64:79], v[28:31], v[132:135], v[64:79]
  ds_read_b64_tr_b16 v[28:29], v7 offset:4096
  ds_read_b64_tr_b16 v[30:31], v7 offset:4608
  v_mfma_f32_32x32x16_bf16 v[80:95], v[12:15], v[132:135], v[80:95]
  ds_read_b64_tr_b16 v[12:13], v4 offset:6144
  ds_read_b64_tr_b16 v[14:15], v4 offset:6656
  s_waitcnt lgkmcnt(6)
  v_mfma_f32_32x32x16_bf16 v[32:47], v[16:19], v[136:139], v[32:47]
  ds_read_b64_tr_b16 v[16:17], v5 offset:6144
  ds_read_b64_tr_b16 v[18:19], v5 offset:6656
  v_mfma_f32_32x32x16_bf16 v[48:63], v[20:23], v[136:139], v[48:63]
  ds_read_b64_tr_b16 v[20:21], v6 offset:6144
  ds_read_b64_tr_b16 v[22:23], v6 offset:6656
  s_waitcnt lgkmcnt(6)
  v_mfma_f32_32x32x16_bf16 v[64:79], v[24:27], v[136:139], v[64:79]
  ds_read_b64_tr_b16 v[24:25], v7 offset:6144
  ds_read_b64_tr_b16 v[26:27], v7 offset:6656
  v_mfma_f32_32x32x16_bf16 v[80:95], v[28:31], v[136:139], v[80:95]
  s_barrier
  ds_read_b64_tr_b16 v[28:29], v4 offset:16384
  ds_read_b64_tr_b16 v[30:31], v4 offset:16896
  s_waitcnt lgkmcnt(6)
  v_mfma_f32_32x32x16_bf16 v[32:47], v[12:15], v[140:143], v[32:47]
  ds_read_b64_tr_b16 v[12:13], v5 offset:16384
  ds_read_b64_tr_b16 v[14:15], v5 offset:16896
  v_mfma_f32_32x32x16_bf16 v[48:63], v[16:19], v[140:143], v[48:63]
  ds_read_b64_tr_b16 v[16:17], v6 offset:16384
  ds_read_b64_tr_b16 v[18:19], v6 offset:16896
  s_waitcnt lgkmcnt(6)
  v_mfma_f32_32x32x16_bf16 v[64:79], v[20:23], v[140:143], v[64:79]
  ds_read_b64_tr_b16 v[20:21], v7 offset:16384
  ds_read_b64_tr_b16 v[22:23], v7 offset:16896
  v_mfma_f32_32x32x16_bf16 v[80:95], v[24:27], v[140:143], v[80:95]
  ds_read_b64_tr_b16 v[24:25], v4 offset:18432
  ds_read_b64_tr_b16 v[26:27], v4 offset:18944
  s_waitcnt lgkmcnt(6)
  v_mfma_f32_32x32x16_bf16 v[32:47], v[28:31], v[144:147], v[32:47]
  ds_read_b64_tr_b16 v[28:29], v5 offset:18432
  ds_read_b64_tr_b16 v[30:31], v5 offset:18944
  v_mfma_f32_32x32x16_bf16 v[48:63], v[12:15], v[144:147], v[48:63]
  ds_read_b64_tr_b16 v[12:13], v6 offset:18432
  ds_read_b64_tr_b16 v[14:15], v6 offset:18944
  s_waitcnt lgkmcnt(6)
  v_mfma_f32_32x32x16_bf16 v[64:79], v[16:19], v[144:147], v[64:79]
  ds_read_b64_tr_b16 v[16:17], v7 offset:18432
  ds_read_b64_tr_b16 v[18:19], v7 offset:18944
  v_mfma_f32_32x32x16_bf16 v[80:95], v[20:23], v[144:147], v[80:95]
  ds_read_b64_tr_b16 v[20:21], v4 offset:20480
  ds_read_b64_tr_b16 v[22:23], v4 offset:20992
  s_waitcnt lgkmcnt(6)
  v_mfma_f32_32x32x16_bf16 v[32:47], v[24:27], v[148:151], v[32:47]
  ds_read_b64_tr_b16 v[24:25], v5 offset:20480
  ds_read_b64_tr_b16 v[26:27], v5 offset:20992
  v_mfma_f32_32x32x16_bf16 v[48:63], v[28:31], v[148:151], v[48:63]
  ds_read_b64_tr_b16 v[28:29], v6 offset:20480
  ds_read_b64_tr_b16 v[30:31], v6 offset:20992
  s_waitcnt lgkmcnt(6)
  v_mfma_f32_32x32x16_bf16 v[64:79], v[12:15], v[148:151], v[64:79]
  ds_read_b64_tr_b16 v[12:13], v7 offset:20480
  ds_read_b64_tr_b16 v[14:15], v7 offset:20992
  s_mul_i32 s76, s75, 0x9e3779b1
  s_lshr_b32 s81, s76, 15
  s_xor_b32 s76, s76, s81
  v_mfma_f32_32x32x16_bf16 v[80:95], v[16:19], v[148:151], v[80:95]
  ds_read_b64_tr_b16 v[16:17], v4 offset:22528
  ds_read_b64_tr_b16 v[18:19], v4 offset:23040
  s_waitcnt lgkmcnt(6)
  s_and_b32 s76, s76, 0xfffdfffd
  s_or_b32 s76, s76, 0x00010001
  v_mfma_f32_32x32x16_bf16 v[32:47], v[20:23], v[152:155], v[32:47]
  ds_read_b64_tr_b16 v[20:21], v5 offset:22528
  ds_read_b64_tr_b16 v[22:23], v5 offset:23040
  s_mov_b32 s89, 0x00010001
  v_and_b32 v2, 7, v0
  v_lshlrev_b32 v2, 2, v2
  v_mfma_f32_32x32x16_bf16 v[48:63], v[24:27], v[152:155], v[48:63]
  ds_read_b64_tr_b16 v[24:25], v6 offset:22528
  ds_read_b64_tr_b16 v[26:27], v6 offset:23040
  s_waitcnt lgkmcnt(6)
  v_bfe_u32 v2, s76, v2, 4
  v_lshl_or_b32 v2, v2, 15, v2
  v_mfma_f32_32x32x16_bf16 v[64:79], v[28:31], v[152:155], v[64:79]
  ds_read_b64_tr_b16 v[28:29], v7 offset:22528
  ds_read_b64_tr_b16 v[30:31], v7 offset:23040
  v_lshrrev_b32 v3, 2, v2
  v_mfma_f32_32x32x16_bf16 v[80:95], v[12:15], v[152:155], v[80:95]
  s_barrier
  ds_read_b64_tr_b16 v[12:13], v4 offset:32768
  ds_read_b64_tr_b16 v[14:15], v4 offset:33280
  s_waitcnt lgkmcnt(6)
  v_mfma_f32_32x32x16_bf16 v[32:47], v[16:19], v[156:159], v[32:47]
  ds_read_b64_tr_b16 v[16:17], v5 offset:32768
  ds_read_b64_tr_b16 v[18:19], v5 offset:33280
  v_mfma_f32_32x32x16_bf16 v[48:63], v[20:23], v[156:159], v[48:63]
  ds_read_b64_tr_b16 v[20:21], v6 offset:32768
  ds_read_b64_tr_b16 v[22:23], v6 offset:33280
  s_waitcnt lgkmcnt(6)
  v_mfma_f32_32x32x16_bf16 v[64:79], v[24:27], v[156:159], v[64:79]
  ds_read_b64_tr_b16 v[24:25], v7 offset:32768
  ds_read_b64_tr_b16 v[26:27], v7 offset:33280
  v_mfma_f32_32x32x16_bf16 v[80:95], v[28:31], v[156:159], v[80:95]
  ds_read_b64_tr_b16 v[28:29], v4 offset:34816
  ds_read_b64_tr_b16 v[30:31], v4 offset:35328
  s_waitcnt lgkmcnt(6)
  v_mfma_f32_32x32x16_bf16 v[32:47], v[12:15], v[160:163], v[32:47]
  ds_read_b64_tr_b16 v[12:13], v5 offset:34816
  ds_read_b64_tr_b16 v[14:15], v5 offset:35328
  v_mfma_f32_32x32x16_bf16 v[48:63], v[16:19], v[160:163], v[48:63]
  ds_read_b64_tr_b16 v[16:17], v6 offset:34816
  ds_read_b64_tr_b16 v[18:19], v6 offset:35328
  s_waitcnt lgkmcnt(6)
  v_mfma_f32_32x32x16_bf16 v[64:79], v[20:23], v[160:163], v[64:79]
  ds_read_b64_tr_b16 v[20:21], v7 offset:34816
  ds_read_b64_tr_b16 v[22:23], v7 offset:35328
  v_mfma_f32_32x32x16_bf16 v[80:95], v[24:27], v[160:163], v[80:95]
  ds_read_b64_tr_b16 v[24:25], v4 offset:36864
  ds_read_b64_tr_b16 v[26:27], v4 offset:37376
  s_waitcnt lgkmcnt(6)
  v_mfma_f32_32x32x16_bf16 v[32:47], v[28:31], v[164:167], v[32:47]
  ds_read_b64_tr_b16 v[28:29], v5 offset:36864
  ds_read_b64_tr_b16 v[30:31], v5 offset:37376
  v_mfma_f32_32x32x16_bf16 v[48:63], v[12:15], v[164:167], v[48:63]
  ds_read_b64_tr_b16 v[12:13], v6 offset:36864
  ds_read_b64_tr_b16 v[14:15], v6 offset:37376
  s_waitcnt lgkmcnt(6)
  v_mfma_f32_32x32x16_bf16 v[64:79], v[16:19], v[164:167], v[64:79]
  ds_read_b64_tr_b16 v[16:17], v7 offset:36864
  ds_read_b64_tr_b16 v[18:19], v7 offset:37376
  v_mfma_f32_32x32x16_bf16 v[80:95], v[20:23], v[164:167], v[80:95]
  ds_read_b64_tr_b16 v[20:21], v4 offset:38912
  ds_read_b64_tr_b16 v[22:23], v4 offset:39424
  s_waitcnt lgkmcnt(6)
  v_mfma_f32_32x32x16_bf16 v[32:47], v[24:27], v[168:171], v[32:47]
  ds_read_b64_tr_b16 v[24:25], v5 offset:38912
  ds_read_b64_tr_b16 v[26:27], v5 offset:39424
  v_mfma_f32_32x32x16_bf16 v[48:63], v[28:31], v[168:171], v[48:63]
  ds_read_b64_tr_b16 v[28:29], v6 offset:38912
  ds_read_b64_tr_b16 v[30:31], v6 offset:39424
  s_waitcnt lgkmcnt(6)
  v_mfma_f32_32x32x16_bf16 v[64:79], v[12:15], v[168:171], v[64:79]
  ds_read_b64_tr_b16 v[12:13], v7 offset:38912
  ds_read_b64_tr_b16 v[14:15], v7 offset:39424
  v_mfma_f32_32x32x16_bf16 v[80:95], v[16:19], v[168:171], v[80:95]
  s_barrier
  ds_read_b64_tr_b16 v[16:17], v4 offset:49152
  ds_read_b64_tr_b16 v[18:19], v4 offset:49664
  s_waitcnt lgkmcnt(6)
  v_mfma_f32_32x32x16_bf16 v[32:47], v[20:23], v[172:175], v[32:47]
  ds_read_b64_tr_b16 v[20:21], v5 offset:49152
  ds_read_b64_tr_b16 v[22:23], v5 offset:49664
  v_mfma_f32_32x32x16_bf16 v[48:63], v[24:27], v[172:175], v[48:63]
  ds_read_b64_tr_b16 v[24:25], v6 offset:49152
  ds_read_b64_tr_b16 v[26:27], v6 offset:49664
  s_waitcnt lgkmcnt(6)
  v_mfma_f32_32x32x16_bf16 v[64:79], v[28:31], v[172:175], v[64:79]
  ds_read_b64_tr_b16 v[28:29], v7 offset:49152
  ds_read_b64_tr_b16 v[30:31], v7 offset:49664
  v_mfma_f32_32x32x16_bf16 v[80:95], v[12:15], v[172:175], v[80:95]
  ds_read_b64_tr_b16 v[12:13], v4 offset:51200
  ds_read_b64_tr_b16 v[14:15], v4 offset:51712
  s_waitcnt lgkmcnt(6)
  v_mfma_f32_32x32x16_bf16 v[32:47], v[16:19], v[176:179], v[32:47]
  ds_read_b64_tr_b16 v[16:17], v5 offset:51200
  ds_read_b64_tr_b16 v[18:19], v5 offset:51712
  v_mfma_f32_32x32x16_bf16 v[48:63], v[20:23], v[176:179], v[48:63]
  ds_read_b64_tr_b16 v[20:21], v6 offset:51200
  ds_read_b64_tr_b16 v[22:23], v6 offset:51712
  s_waitcnt lgkmcnt(6)
  v_mfma_f32_32x32x16_bf16 v[64:79], v[24:27], v[176:179], v[64:79]
  ds_read_b64_tr_b16 v[24:25], v7 offset:51200
  ds_read_b64_tr_b16 v[26:27], v7 offset:51712
  v_mfma_f32_32x32x16_bf16 v[80:95], v[28:31], v[176:179], v[80:95]
  ds_read_b64_tr_b16 v[28:29], v4 offset:53248
  ds_read_b64_tr_b16 v[30:31], v4 offset:53760
  s_waitcnt lgkmcnt(6)
  v_mfma_f32_32x32x16_bf16 v[32:47], v[12:15], v[180:183], v[32:47]
  ds_read_b64_tr_b16 v[12:13], v5 offset:53248
  ds_read_b64_tr_b16 v[14:15], v5 offset:53760
  v_mfma_f32_32x32x16_bf16 v[48:63], v[16:19], v[180:183], v[48:63]
  ds_read_b64_tr_b16 v[16:17], v6 offset:53248
  ds_read_b64_tr_b16 v[18:19], v6 offset:53760
  s_waitcnt lgkmcnt(6)
  v_mfma_f32_32x32x16_bf16 v[64:79], v[20:23], v[180:183], v[64:79]
  ds_read_b64_tr_b16 v[20:21], v7 offset:53248
  ds_read_b64_tr_b16 v[22:23], v7 offset:53760
  v_mfma_f32_32x32x16_bf16 v[80:95], v[24:27], v[180:183], v[80:95]
  ds_read_b64_tr_b16 v[24:25], v4 offset:55296
  ds_read_b64_tr_b16 v[26:27], v4 offset:55808
  s_waitcnt lgkmcnt(6)
  v_mfma_f32_32x32x16_bf16 v[32:47], v[28:31], v[184:187], v[32:47]
  ds_read_b64_tr_b16 v[28:29], v5 offset:55296
  ds_read_b64_tr_b16 v[30:31], v5 offset:55808
  v_mfma_f32_32x32x16_bf16 v[48:63], v[12:15], v[184:187], v[48:63]
  ds_read_b64_tr_b16 v[12:13], v6 offset:55296
  ds_read_b64_tr_b16 v[14:15], v6 offset:55808
  s_waitcnt lgkmcnt(6)
  v_mfma_f32_32x32x16_bf16 v[64:79], v[16:19], v[184:187], v[64:79]
  ds_read_b64_tr_b16 v[16:17], v7 offset:55296
  ds_read_b64_tr_b16 v[18:19], v7 offset:55808
  v_mfma_f32_32x32x16_bf16 v[80:95], v[20:23], v[184:187], v[80:95]
  s_barrier
  ds_read_b64_tr_b16 v[20:21], v4 offset:0
  ds_read_b64_tr_b16 v[22:23], v4 offset:512
  s_waitcnt lgkmcnt(6)
  v_mfma_f32_32x32x16_bf16 v[32:47], v[24:27], v[188:191], v[32:47]
  ds_read_b64_tr_b16 v[24:25], v5 offset:0
  ds_read_b64_tr_b16 v[26:27], v5 offset:512
  v_mfma_f32_32x32x16_bf16 v[48:63], v[28:31], v[188:191], v[48:63]
  ds_read_b64_tr_b16 v[28:29], v6 offset:0
  ds_read_b64_tr_b16 v[30:31], v6 offset:512
  s_waitcnt lgkmcnt(6)
  v_mfma_f32_32x32x16_bf16 v[64:79], v[12:15], v[188:191], v[64:79]
  ds_read_b64_tr_b16 v[12:13], v7 offset:0
  ds_read_b64_tr_b16 v[14:15], v7 offset:512
  v_mfma_f32_32x32x16_bf16 v[80:95], v[16:19], v[188:191], v[80:95]
  ds_read_b64_tr_b16 v[16:17], v4 offset:2048
  ds_read_b64_tr_b16 v[18:19], v4 offset:2560
  s_waitcnt lgkmcnt(6)
  v_mfma_f32_32x32x16_bf16 v[32:47], v[20:23], v[192:195], v[32:47]
  ds_read_b64_tr_b16 v[20:21], v5 offset:2048
  ds_read_b64_tr_b16 v[22:23], v5 offset:2560
  v_mfma_f32_32x32x16_bf16 v[48:63], v[24:27], v[192:195], v[48:63]
  ds_read_b64_tr_b16 v[24:25], v6 offset:2048
  ds_read_b64_tr_b16 v[26:27], v6 offset:2560
  s_waitcnt lgkmcnt(6)
  v_mfma_f32_32x32x16_bf16 v[64:79], v[28:31], v[192:195], v[64:79]
  ds_read_b64_tr_b16 v[28:29], v7 offset:2048
  ds_read_b64_tr_b16 v[30:31], v7 offset:2560
  v_mfma_f32_32x32x16_bf16 v[80:95], v[12:15], v[192:195], v[80:95]
  ds_read_b64_tr_b16 v[12:13], v4 offset:4096
  ds_read_b64_tr_b16 v[14:15], v4 offset:4608
  s_waitcnt lgkmcnt(6)
  v_mfma_f32_32x32x16_bf16 v[32:47], v[16:19], v[196:199], v[32:47]
  ds_read_b64_tr_b16 v[16:17], v5 offset:4096
  ds_read_b64_tr_b16 v[18:19], v5 offset:4608
  v_mfma_f32_32x32x16_bf16 v[48:63], v[20:23], v[196:199], v[48:63]
  ds_read_b64_tr_b16 v[20:21], v6 offset:4096
  ds_read_b64_tr_b16 v[22:23], v6 offset:4608
  s_waitcnt lgkmcnt(6)
  v_mfma_f32_32x32x16_bf16 v[64:79], v[24:27], v[196:199], v[64:79]
  ds_read_b64_tr_b16 v[24:25], v7 offset:4096
  ds_read_b64_tr_b16 v[26:27], v7 offset:4608
  v_mfma_f32_32x32x16_bf16 v[80:95], v[28:31], v[196:199], v[80:95]
  ds_read_b64_tr_b16 v[28:29], v4 offset:6144
  ds_read_b64_tr_b16 v[30:31], v4 offset:6656
  s_waitcnt lgkmcnt(6)
  v_mfma_f32_32x32x16_bf16 v[32:47], v[12:15], v[200:203], v[32:47]
  ds_read_b64_tr_b16 v[12:13], v5 offset:6144
  ds_read_b64_tr_b16 v[14:15], v5 offset:6656
  v_mfma_f32_32x32x16_bf16 v[48:63], v[16:19], v[200:203], v[48:63]
  ds_read_b64_tr_b16 v[16:17], v6 offset:6144
  ds_read_b64_tr_b16 v[18:19], v6 offset:6656
  s_waitcnt lgkmcnt(6)
  v_mfma_f32_32x32x16_bf16 v[64:79], v[20:23], v[200:203], v[64:79]
  ds_read_b64_tr_b16 v[20:21], v7 offset:6144
  ds_read_b64_tr_b16 v[22:23], v7 offset:6656
  v_mfma_f32_32x32x16_bf16 v[80:95], v[24:27], v[200:203], v[80:95]
  s_barrier
  ds_read_b64_tr_b16 v[24:25], v4 offset:16384
  ds_read_b64_tr_b16 v[26:27], v4 offset:16896
  s_waitcnt lgkmcnt(6)
  v_mfma_f32_32x32x16_bf16 v[32:47], v[28:31], v[204:207], v[32:47]
  ds_read_b64_tr_b16 v[28:29], v5 offset:16384
  ds_read_b64_tr_b16 v[30:31], v5 offset:16896
  v_mfma_f32_32x32x16_bf16 v[48:63], v[12:15], v[204:207], v[48:63]
  ds_read_b64_tr_b16 v[12:13], v6 offset:16384
  ds_read_b64_tr_b16 v[14:15], v6 offset:16896
  s_waitcnt lgkmcnt(6)
  v_mfma_f32_32x32x16_bf16 v[64:79], v[16:19], v[204:207], v[64:79]
  ds_read_b64_tr_b16 v[16:17], v7 offset:16384
  ds_read_b64_tr_b16 v[18:19], v7 offset:16896
  v_mfma_f32_32x32x16_bf16 v[80:95], v[20:23], v[204:207], v[80:95]
  ds_read_b64_tr_b16 v[20:21], v4 offset:18432
  ds_read_b64_tr_b16 v[22:23], v4 offset:18944
  s_waitcnt lgkmcnt(6)
  v_mfma_f32_32x32x16_bf16 v[32:47], v[24:27], v[208:211], v[32:47]
  ds_read_b64_tr_b16 v[24:25], v5 offset:18432
  ds_read_b64_tr_b16 v[26:27], v5 offset:18944
  v_mfma_f32_32x32x16_bf16 v[48:63], v[28:31], v[208:211], v[48:63]
  ds_read_b64_tr_b16 v[28:29], v6 offset:18432
  ds_read_b64_tr_b16 v[30:31], v6 offset:18944
  s_waitcnt lgkmcnt(6)
  v_mfma_f32_32x32x16_bf16 v[64:79], v[12:15], v[208:211], v[64:79]
  ds_read_b64_tr_b16 v[12:13], v7 offset:18432
  ds_read_b64_tr_b16 v[14:15], v7 offset:18944
  v_mfma_f32_32x32x16_bf16 v[80:95], v[16:19], v[208:211], v[80:95]
  ds_read_b64_tr_b16 v[16:17], v4 offset:20480
  ds_read_b64_tr_b16 v[18:19], v4 offset:20992
  s_waitcnt lgkmcnt(6)
  v_mfma_f32_32x32x16_bf16 v[32:47], v[20:23], v[212:215], v[32:47]
  ds_read_b64_tr_b16 v[20:21], v5 offset:20480
  ds_read_b64_tr_b16 v[22:23], v5 offset:20992
  v_mfma_f32_32x32x16_bf16 v[48:63], v[24:27], v[212:215], v[48:63]
  ds_read_b64_tr_b16 v[24:25], v6 offset:20480
  ds_read_b64_tr_b16 v[26:27], v6 offset:20992
  s_waitcnt lgkmcnt(6)
  v_mfma_f32_32x32x16_bf16 v[64:79], v[28:31], v[212:215], v[64:79]
  ds_read_b64_tr_b16 v[28:29], v7 offset:20480
  ds_read_b64_tr_b16 v[30:31], v7 offset:20992
  v_mfma_f32_32x32x16_bf16 v[80:95], v[12:15], v[212:215], v[80:95]
  ds_read_b64_tr_b16 v[12:13], v4 offset:22528
  ds_read_b64_tr_b16 v[14:15], v4 offset:23040
  s_waitcnt lgkmcnt(6)
  v_mfma_f32_32x32x16_bf16 v[32:47], v[16:19], v[216:219], v[32:47]
  ds_read_b64_tr_b16 v[16:17], v5 offset:22528
  ds_read_b64_tr_b16 v[18:19], v5 offset:23040
  v_mfma_f32_32x32x16_bf16 v[48:63], v[20:23], v[216:219], v[48:63]
  ds_read_b64_tr_b16 v[20:21], v6 offset:22528
  ds_read_b64_tr_b16 v[22:23], v6 offset:23040
  s_waitcnt lgkmcnt(6)
  v_mfma_f32_32x32x16_bf16 v[64:79], v[24:27], v[216:219], v[64:79]
  ds_read_b64_tr_b16 v[24:25], v7 offset:22528
  ds_read_b64_tr_b16 v[26:27], v7 offset:23040
  v_mfma_f32_32x32x16_bf16 v[80:95], v[28:31], v[216:219], v[80:95]
  s_barrier
  ds_read_b64_tr_b16 v[28:29], v4 offset:32768
  ds_read_b64_tr_b16 v[30:31], v4 offset:33280
  s_waitcnt lgkmcnt(6)
  v_mfma_f32_32x32x16_bf16 v[32:47], v[12:15], v[220:223], v[32:47]
  ds_read_b64_tr_b16 v[12:13], v5 offset:32768
  ds_read_b64_tr_b16 v[14:15], v5 offset:33280
  v_mfma_f32_32x32x16_bf16 v[48:63], v[16:19], v[220:223], v[48:63]
  ds_read_b64_tr_b16 v[16:17], v6 offset:32768
  ds_read_b64_tr_b16 v[18:19], v6 offset:33280
  s_waitcnt lgkmcnt(6)
  v_mfma_f32_32x32x16_bf16 v[64:79], v[20:23], v[220:223], v[64:79]
  ds_read_b64_tr_b16 v[20:21], v7 offset:32768
  ds_read_b64_tr_b16 v[22:23], v7 offset:33280
  v_mfma_f32_32x32x16_bf16 v[80:95], v[24:27], v[220:223], v[80:95]
  ds_read_b64_tr_b16 v[24:25], v4 offset:34816
  ds_read_b64_tr_b16 v[26:27], v4 offset:35328
  s_waitcnt lgkmcnt(6)
  v_mfma_f32_32x32x16_bf16 v[32:47], v[28:31], v[224:227], v[32:47]
  ds_read_b64_tr_b16 v[28:29], v5 offset:34816
  ds_read_b64_tr_b16 v[30:31], v5 offset:35328
  v_mfma_f32_32x32x16_bf16 v[48:63], v[12:15], v[224:227], v[48:63]
  ds_read_b64_tr_b16 v[12:13], v6 offset:34816
  ds_read_b64_tr_b16 v[14:15], v6 offset:35328
  s_waitcnt lgkmcnt(6)
  v_mfma_f32_32x32x16_bf16 v[64:79], v[16:19], v[224:227], v[64:79]
  ds_read_b64_tr_b16 v[16:17], v7 offset:34816
  ds_read_b64_tr_b16 v[18:19], v7 offset:35328
  v_mfma_f32_32x32x16_bf16 v[80:95], v[20:23], v[224:227], v[80:95]
  ds_read_b64_tr_b16 v[20:21], v4 offset:36864
  ds_read_b64_tr_b16 v[22:23], v4 offset:37376
  s_waitcnt lgkmcnt(6)
  v_mfma_f32_32x32x16_bf16 v[32:47], v[24:27], v[228:231], v[32:47]
  ds_read_b64_tr_b16 v[24:25], v5 offset:36864
  ds_read_b64_tr_b16 v[26:27], v5 offset:37376
  v_mfma_f32_32x32x16_bf16 v[48:63], v[28:31], v[228:231], v[48:63]
  ds_read_b64_tr_b16 v[28:29], v6 offset:36864
  ds_read_b64_tr_b16 v[30:31], v6 offset:37376
  s_waitcnt lgkmcnt(6)
  v_mfma_f32_32x32x16_bf16 v[64:79], v[12:15], v[228:231], v[64:79]
  ds_read_b64_tr_b16 v[12:13], v7 offset:36864
  ds_read_b64_tr_b16 v[14:15], v7 offset:37376
  v_mfma_f32_32x32x16_bf16 v[80:95], v[16:19], v[228:231], v[80:95]
  ds_read_b64_tr_b16 v[16:17], v4 offset:38912
  ds_read_b64_tr_b16 v[18:19], v4 offset:39424
  s_waitcnt lgkmcnt(6)
  v_mfma_f32_32x32x16_bf16 v[32:47], v[20:23], v[232:235], v[32:47]
  ds_read_b64_tr_b16 v[20:21], v5 offset:38912
  ds_read_b64_tr_b16 v[22:23], v5 offset:39424
  v_mfma_f32_32x32x16_bf16 v[48:63], v[24:27], v[232:235], v[48:63]
  ds_read_b64_tr_b16 v[24:25], v6 offset:38912
  ds_read_b64_tr_b16 v[26:27], v6 offset:39424
  s_waitcnt lgkmcnt(6)
  v_mfma_f32_32x32x16_bf16 v[64:79], v[28:31], v[232:235], v[64:79]
  ds_read_b64_tr_b16 v[28:29], v7 offset:38912
  ds_read_b64_tr_b16 v[30:31], v7 offset:39424
  v_mfma_f32_32x32x16_bf16 v[80:95], v[12:15], v[232:235], v[80:95]
  s_barrier
  ds_read_b64_tr_b16 v[12:13], v4 offset:49152
  ds_read_b64_tr_b16 v[14:15], v4 offset:49664
  s_waitcnt lgkmcnt(6)
  v_mfma_f32_32x32x16_bf16 v[32:47], v[16:19], v[236:239], v[32:47]
  ds_read_b64_tr_b16 v[16:17], v4 offset:51200
  ds_read_b64_tr_b16 v[18:19], v4 offset:51712
  v_mfma_f32_32x32x16_bf16 v[48:63], v[20:23], v[236:239], v[48:63]
  ds_read_b64_tr_b16 v[20:21], v4 offset:53248
  ds_read_b64_tr_b16 v[22:23], v4 offset:53760
  s_waitcnt lgkmcnt(6)
  v_mfma_f32_32x32x16_bf16 v[64:79], v[24:27], v[236:239], v[64:79]
  ds_read_b64_tr_b16 v[24:25], v4 offset:55296
  ds_read_b64_tr_b16 v[26:27], v4 offset:55808
  v_mfma_f32_32x32x16_bf16 v[80:95], v[28:31], v[236:239], v[80:95]
  ds_read_b64_tr_b16 v[28:29], v5 offset:49152
  ds_read_b64_tr_b16 v[30:31], v5 offset:49664
  s_waitcnt lgkmcnt(6)
  v_mfma_f32_32x32x16_bf16 v[32:47], v[12:15], v[240:243], v[32:47]
  ds_read_b64_tr_b16 v[12:13], v5 offset:51200
  ds_read_b64_tr_b16 v[14:15], v5 offset:51712
  v_mfma_f32_32x32x16_bf16 v[32:47], v[16:19], v[244:247], v[32:47]
  ds_read_b64_tr_b16 v[16:17], v5 offset:53248
  ds_read_b64_tr_b16 v[18:19], v5 offset:53760
  s_waitcnt lgkmcnt(6)
  v_mfma_f32_32x32x16_bf16 v[32:47], v[20:23], v[248:251], v[32:47]
  ds_read_b64_tr_b16 v[20:21], v5 offset:55296
  ds_read_b64_tr_b16 v[22:23], v5 offset:55808
  v_mfma_f32_32x32x16_bf16 v[32:47], v[24:27], v[252:255], v[32:47]
  ds_read_b64_tr_b16 v[24:25], v6 offset:49152
  ds_read_b64_tr_b16 v[26:27], v6 offset:49664
  s_waitcnt lgkmcnt(6)
  v_mfma_f32_32x32x16_bf16 v[48:63], v[28:31], v[240:243], v[48:63]
  ds_read_b64_tr_b16 v[28:29], v6 offset:51200
  ds_read_b64_tr_b16 v[30:31], v6 offset:51712
  v_mfma_f32_32x32x16_bf16 v[48:63], v[12:15], v[244:247], v[48:63]
  ds_read_b64_tr_b16 v[12:13], v6 offset:53248
  ds_read_b64_tr_b16 v[14:15], v6 offset:53760
  s_waitcnt lgkmcnt(6)
  s_nop 1
  v_mul_f32 v32, s3, v32
  v_mul_f32 v33, s3, v33
  v_mfma_f32_32x32x16_bf16 v[48:63], v[16:19], v[248:251], v[48:63]
  ds_read_b64_tr_b16 v[16:17], v6 offset:55296
  ds_read_b64_tr_b16 v[18:19], v6 offset:55808
  v_mul_f32 v34, s3, v34
  v_mul_f32 v35, s3, v35
  v_mul_f32 v36, s3, v36
  v_mfma_f32_32x32x16_bf16 v[48:63], v[20:23], v[252:255], v[48:63]
  ds_read_b64_tr_b16 v[20:21], v7 offset:49152
  ds_read_b64_tr_b16 v[22:23], v7 offset:49664
  s_waitcnt lgkmcnt(6)
  v_mul_f32 v37, s3, v37
  v_mul_f32 v38, s3, v38
  v_mfma_f32_32x32x16_bf16 v[64:79], v[24:27], v[240:243], v[64:79]
  ds_read_b64_tr_b16 v[24:25], v7 offset:51200
  ds_read_b64_tr_b16 v[26:27], v7 offset:51712
  v_mul_f32 v39, s3, v39
  v_exp_f32 v32, v32
  v_mfma_f32_32x32x16_bf16 v[64:79], v[28:31], v[244:247], v[64:79]
  ds_read_b64_tr_b16 v[28:29], v7 offset:53248
  ds_read_b64_tr_b16 v[30:31], v7 offset:53760
  s_waitcnt lgkmcnt(6)
  v_exp_f32 v33, v33
  v_mfma_f32_32x32x16_bf16 v[64:79], v[12:15], v[248:251], v[64:79]
  ds_read_b64_tr_b16 v[12:13], v7 offset:55296
  ds_read_b64_tr_b16 v[14:15], v7 offset:55808
  v_exp_f32 v34, v34
  v_lshlrev_b32 v4, 5, v9
  v_xor_b32 v4, v4, v8
  v_xor_b32 v5, 64, v4
  v_xor_b32 v6, 8224, v4
  v_xor_b32 v7, 8288, v4
  s_lshl_b32 s80, s68, 2
  s_add_u32 s80, s80, 158208
  v_mov_b32 v8, s80
  v_mov_b32 v9, 1
  v_mfma_f32_32x32x16_bf16 v[64:79], v[16:19], v[252:255], v[64:79]
  s_barrier
  ds_read_b64_tr_b16 v[16:17], v4 offset:0
  ds_read_b64_tr_b16 v[18:19], v4 offset:512
  s_waitcnt lgkmcnt(6)
  v_exp_f32 v35, v35
  v_mfma_f32_32x32x16_bf16 v[80:95], v[20:23], v[240:243], v[80:95]
  ds_read_b64_tr_b16 v[20:21], v5 offset:0
  ds_read_b64_tr_b16 v[22:23], v5 offset:512
  v_exp_f32 v36, v36
  v_exp_f32 v37, v37
  v_mfma_f32_32x32x16_bf16 v[80:95], v[24:27], v[244:247], v[80:95]
  ds_read_b64_tr_b16 v[24:25], v4 offset:2048
  ds_read_b64_tr_b16 v[26:27], v4 offset:2560
  s_waitcnt lgkmcnt(6)
  v_exp_f32 v38, v38
  v_exp_f32 v39, v39
  v_mfma_f32_32x32x16_bf16 v[80:95], v[28:31], v[248:251], v[80:95]
  ds_read_b64_tr_b16 v[28:29], v5 offset:2048
  ds_read_b64_tr_b16 v[30:31], v5 offset:2560
  v_add_f32 v32, 1.0, v32
  v_add_f32 v33, 1.0, v33
  v_add_f32 v34, 1.0, v34
  v_add_f32 v35, 1.0, v35
  v_add_f32 v36, 1.0, v36
  v_mfma_f32_32x32x16_bf16 v[80:95], v[12:15], v[252:255], v[80:95]
  ds_read_b64_tr_b16 v[12:13], v4 offset:4096
  ds_read_b64_tr_b16 v[14:15], v4 offset:4608
  s_waitcnt lgkmcnt(6)
  v_add_f32 v37, 1.0, v37
  v_add_f32 v38, 1.0, v38
  v_add_f32 v39, 1.0, v39
  v_mfma_f32_32x32x16_bf16 v[96:111], v[16:19], v[128:131], 0
  ds_read_b64_tr_b16 v[16:17], v5 offset:4096
  ds_read_b64_tr_b16 v[18:19], v5 offset:4608
  v_rcp_f32 v32, v32
  v_rcp_f32 v33, v33
  v_mfma_f32_32x32x16_bf16 v[112:127], v[20:23], v[128:131], 0
  ds_read_b64_tr_b16 v[20:21], v4 offset:6144
  ds_read_b64_tr_b16 v[22:23], v4 offset:6656
  s_waitcnt lgkmcnt(6)
  v_rcp_f32 v34, v34
  v_rcp_f32 v35, v35
  v_mfma_f32_32x32x16_bf16 v[96:111], v[24:27], v[132:135], v[96:111]
  ds_read_b64_tr_b16 v[24:25], v5 offset:6144
  ds_read_b64_tr_b16 v[26:27], v5 offset:6656
  v_rcp_f32 v36, v36
  v_rcp_f32 v37, v37
  v_mfma_f32_32x32x16_bf16 v[112:127], v[28:31], v[132:135], v[112:127]
  ds_read_b64_tr_b16 v[28:29], v6 offset:0
  ds_read_b64_tr_b16 v[30:31], v6 offset:512
  s_waitcnt lgkmcnt(6)
  v_rcp_f32 v38, v38
  v_rcp_f32 v39, v39
  v_mfma_f32_32x32x16_bf16 v[96:111], v[12:15], v[136:139], v[96:111]
  ds_read_b64_tr_b16 v[12:13], v7 offset:0
  ds_read_b64_tr_b16 v[14:15], v7 offset:512
  v_mul_f32 v40, v40, v32
  v_mul_f32 v41, v41, v33
  v_mul_f32 v42, v42, v34
  v_mul_f32 v43, v43, v35
  v_mul_f32 v44, v44, v36
  v_mfma_f32_32x32x16_bf16 v[112:127], v[16:19], v[136:139], v[112:127]
  ds_read_b64_tr_b16 v[16:17], v6 offset:2048
  ds_read_b64_tr_b16 v[18:19], v6 offset:2560
  s_waitcnt lgkmcnt(6)
  v_mul_f32 v45, v45, v37
  v_mul_f32 v46, v46, v38
  v_mul_f32 v47, v47, v39
  v_cvt_pk_bf16_f32 v32, v40, v41
  v_mfma_f32_32x32x16_bf16 v[96:111], v[20:23], v[140:143], v[96:111]
  ds_read_b64_tr_b16 v[20:21], v7 offset:2048
  ds_read_b64_tr_b16 v[22:23], v7 offset:2560
  v_cvt_pk_bf16_f32 v33, v42, v43
  v_cvt_pk_bf16_f32 v34, v44, v45
  v_cvt_pk_bf16_f32 v35, v46, v47
  v_bfi_b32 v32, s89, v2, v32
  v_bfi_b32 v34, s89, v3, v34
  v_mfma_f32_32x32x16_bf16 v[112:127], v[24:27], v[140:143], v[112:127]
  ds_read_b64_tr_b16 v[24:25], v6 offset:4096
  ds_read_b64_tr_b16 v[26:27], v6 offset:4608
  s_waitcnt lgkmcnt(6)
  buffer_store_dwordx4 v[32:35], v1, s[32:35], s78 offen offset:0 sc1
  v_mul_f32 v48, s3, v48
  v_mul_f32 v49, s3, v49
  v_mul_f32 v50, s3, v50
  v_mfma_f32_32x32x16_bf16 v[96:111], v[28:31], v[144:147], v[96:111]
  ds_read_b64_tr_b16 v[28:29], v7 offset:4096
  ds_read_b64_tr_b16 v[30:31], v7 offset:4608
  v_mul_f32 v51, s3, v51
  v_mul_f32 v52, s3, v52
  v_mul_f32 v53, s3, v53
  v_mul_f32 v54, s3, v54
  v_mul_f32 v55, s3, v55
  v_mfma_f32_32x32x16_bf16 v[112:127], v[12:15], v[144:147], v[112:127]
  ds_read_b64_tr_b16 v[12:13], v6 offset:6144
  ds_read_b64_tr_b16 v[14:15], v6 offset:6656
  s_waitcnt lgkmcnt(6)
  v_exp_f32 v48, v48
  v_exp_f32 v49, v49
  v_mfma_f32_32x32x16_bf16 v[96:111], v[16:19], v[148:151], v[96:111]
  ds_read_b64_tr_b16 v[16:17], v7 offset:6144
  ds_read_b64_tr_b16 v[18:19], v7 offset:6656
  v_exp_f32 v50, v50
  v_exp_f32 v51, v51
  v_mfma_f32_32x32x16_bf16 v[112:127], v[20:23], v[148:151], v[112:127]
  s_barrier
  ds_read_b64_tr_b16 v[20:21], v4 offset:16384
  ds_read_b64_tr_b16 v[22:23], v4 offset:16896
  s_waitcnt lgkmcnt(6)
  v_exp_f32 v52, v52
  v_mfma_f32_32x32x16_bf16 v[96:111], v[24:27], v[152:155], v[96:111]
  ds_read_b64_tr_b16 v[24:25], v5 offset:16384
  ds_read_b64_tr_b16 v[26:27], v5 offset:16896
  v_exp_f32 v53, v53
  v_exp_f32 v54, v54
  v_mfma_f32_32x32x16_bf16 v[112:127], v[28:31], v[152:155], v[112:127]
  ds_read_b64_tr_b16 v[28:29], v4 offset:18432
  ds_read_b64_tr_b16 v[30:31], v4 offset:18944
  s_waitcnt lgkmcnt(6)
  v_exp_f32 v55, v55
  v_add_f32 v48, 1.0, v48
  v_add_f32 v49, 1.0, v49
  v_mfma_f32_32x32x16_bf16 v[96:111], v[12:15], v[156:159], v[96:111]
  ds_read_b64_tr_b16 v[12:13], v5 offset:18432
  ds_read_b64_tr_b16 v[14:15], v5 offset:18944
  v_add_f32 v50, 1.0, v50
  v_add_f32 v51, 1.0, v51
  v_add_f32 v52, 1.0, v52
  v_add_f32 v53, 1.0, v53
  v_add_f32 v54, 1.0, v54
  v_mfma_f32_32x32x16_bf16 v[112:127], v[16:19], v[156:159], v[112:127]
  ds_read_b64_tr_b16 v[16:17], v4 offset:20480
  ds_read_b64_tr_b16 v[18:19], v4 offset:20992
  s_waitcnt lgkmcnt(6)
  v_add_f32 v55, 1.0, v55
  v_rcp_f32 v48, v48
  v_mfma_f32_32x32x16_bf16 v[96:111], v[20:23], v[160:163], v[96:111]
  ds_read_b64_tr_b16 v[20:21], v5 offset:20480
  ds_read_b64_tr_b16 v[22:23], v5 offset:20992
  v_rcp_f32 v49, v49
  v_rcp_f32 v50, v50
  v_mfma_f32_32x32x16_bf16 v[112:127], v[24:27], v[160:163], v[112:127]
  ds_read_b64_tr_b16 v[24:25], v4 offset:22528
  ds_read_b64_tr_b16 v[26:27], v4 offset:23040
  s_waitcnt lgkmcnt(6)
  v_rcp_f32 v51, v51
  v_rcp_f32 v52, v52
  v_mfma_f32_32x32x16_bf16 v[96:111], v[28:31], v[164:167], v[96:111]
  ds_read_b64_tr_b16 v[28:29], v5 offset:22528
  ds_read_b64_tr_b16 v[30:31], v5 offset:23040
  v_rcp_f32 v53, v53
  v_rcp_f32 v54, v54
  v_mfma_f32_32x32x16_bf16 v[112:127], v[12:15], v[164:167], v[112:127]
  ds_read_b64_tr_b16 v[12:13], v6 offset:16384
  ds_read_b64_tr_b16 v[14:15], v6 offset:16896
  s_waitcnt lgkmcnt(6)
  v_rcp_f32 v55, v55
  v_mul_f32 v56, v56, v48
  v_mul_f32 v57, v57, v49
  v_mfma_f32_32x32x16_bf16 v[96:111], v[16:19], v[168:171], v[96:111]
  ds_read_b64_tr_b16 v[16:17], v7 offset:16384
  ds_read_b64_tr_b16 v[18:19], v7 offset:16896
  v_mul_f32 v58, v58, v50
  v_mul_f32 v59, v59, v51
  v_mul_f32 v60, v60, v52
  v_mul_f32 v61, v61, v53
  v_mul_f32 v62, v62, v54
  v_mfma_f32_32x32x16_bf16 v[112:127], v[20:23], v[168:171], v[112:127]
  ds_read_b64_tr_b16 v[20:21], v6 offset:18432
  ds_read_b64_tr_b16 v[22:23], v6 offset:18944
  s_waitcnt lgkmcnt(6)
  v_mul_f32 v63, v63, v55
  v_cvt_pk_bf16_f32 v48, v56, v57
  v_cvt_pk_bf16_f32 v49, v58, v59
  v_cvt_pk_bf16_f32 v50, v60, v61
  v_mfma_f32_32x32x16_bf16 v[96:111], v[24:27], v[172:175], v[96:111]
  ds_read_b64_tr_b16 v[24:25], v7 offset:18432
  ds_read_b64_tr_b16 v[26:27], v7 offset:18944
  v_cvt_pk_bf16_f32 v51, v62, v63
  v_bfi_b32 v48, s89, v2, v48
  v_bfi_b32 v50, s89, v3, v50
  v_mfma_f32_32x32x16_bf16 v[112:127], v[28:31], v[172:175], v[112:127]
  ds_read_b64_tr_b16 v[28:29], v6 offset:20480
  ds_read_b64_tr_b16 v[30:31], v6 offset:20992
  s_waitcnt lgkmcnt(6)
  buffer_store_dwordx4 v[48:51], v1, s[32:35], s78 offen offset:1024 sc1
  v_mul_f32 v64, s3, v64
  v_mul_f32 v65, s3, v65
  v_mul_f32 v66, s3, v66
  v_mfma_f32_32x32x16_bf16 v[96:111], v[12:15], v[176:179], v[96:111]
  ds_read_b64_tr_b16 v[12:13], v7 offset:20480
  ds_read_b64_tr_b16 v[14:15], v7 offset:20992
  v_mul_f32 v67, s3, v67
  v_mul_f32 v68, s3, v68
  v_mul_f32 v69, s3, v69
  v_mul_f32 v70, s3, v70
  v_mul_f32 v71, s3, v71
  v_mfma_f32_32x32x16_bf16 v[112:127], v[16:19], v[176:179], v[112:127]
  ds_read_b64_tr_b16 v[16:17], v6 offset:22528
  ds_read_b64_tr_b16 v[18:19], v6 offset:23040
  s_waitcnt lgkmcnt(6)
  v_exp_f32 v64, v64
  v_exp_f32 v65, v65
  v_mfma_f32_32x32x16_bf16 v[96:111], v[20:23], v[180:183], v[96:111]
  ds_read_b64_tr_b16 v[20:21], v7 offset:22528
  ds_read_b64_tr_b16 v[22:23], v7 offset:23040
  v_exp_f32 v66, v66
  v_exp_f32 v67, v67
  v_mfma_f32_32x32x16_bf16 v[112:127], v[24:27], v[180:183], v[112:127]
  ds_write_b32 v8, v9 offset:0
  v_add_u32 v4, 0x10000, v4
  v_add_u32 v5, 0x10000, v5
  v_add_u32 v6, 0x10000, v6
  v_add_u32 v7, 0x10000, v7
  ds_read_b64_tr_b16 v[24:25], v4 offset:32768
  ds_read_b64_tr_b16 v[26:27], v4 offset:33280
  s_waitcnt lgkmcnt(7)
  v_exp_f32 v68, v68
  v_mfma_f32_32x32x16_bf16 v[96:111], v[28:31], v[184:187], v[96:111]
  ds_read_b64_tr_b16 v[28:29], v4 offset:34816
  ds_read_b64_tr_b16 v[30:31], v4 offset:35328
  v_exp_f32 v69, v69
  v_exp_f32 v70, v70
  v_mfma_f32_32x32x16_bf16 v[112:127], v[12:15], v[184:187], v[112:127]
  ds_read_b64_tr_b16 v[12:13], v4 offset:36864
  ds_read_b64_tr_b16 v[14:15], v4 offset:37376
  s_waitcnt lgkmcnt(7)
  v_exp_f32 v71, v71
  v_add_f32 v64, 1.0, v64
  v_add_f32 v65, 1.0, v65
  v_mfma_f32_32x32x16_bf16 v[96:111], v[16:19], v[188:191], v[96:111]
  ds_read_b64_tr_b16 v[16:17], v4 offset:38912
  ds_read_b64_tr_b16 v[18:19], v4 offset:39424
  v_add_f32 v66, 1.0, v66
  v_add_f32 v67, 1.0, v67
  v_add_f32 v68, 1.0, v68
  v_add_f32 v69, 1.0, v69
  v_add_f32 v70, 1.0, v70
  v_mfma_f32_32x32x16_bf16 v[112:127], v[20:23], v[188:191], v[112:127]
  ds_read_b64_tr_b16 v[20:21], v6 offset:32768
  ds_read_b64_tr_b16 v[22:23], v6 offset:33280
  s_waitcnt lgkmcnt(6)
  v_add_f32 v71, 1.0, v71
  v_rcp_f32 v64, v64
  v_mfma_f32_32x32x16_bf16 v[96:111], v[24:27], v[192:195], v[96:111]
  ds_read_b64_tr_b16 v[24:25], v6 offset:34816
  ds_read_b64_tr_b16 v[26:27], v6 offset:35328
  v_rcp_f32 v65, v65
  v_rcp_f32 v66, v66
  v_mfma_f32_32x32x16_bf16 v[96:111], v[28:31], v[196:199], v[96:111]
  ds_read_b64_tr_b16 v[28:29], v6 offset:36864
  ds_read_b64_tr_b16 v[30:31], v6 offset:37376
  s_waitcnt lgkmcnt(6)
  v_rcp_f32 v67, v67
  v_rcp_f32 v68, v68
  v_mfma_f32_32x32x16_bf16 v[96:111], v[12:15], v[200:203], v[96:111]
  ds_read_b64_tr_b16 v[12:13], v6 offset:38912
  ds_read_b64_tr_b16 v[14:15], v6 offset:39424
  v_rcp_f32 v69, v69
  v_rcp_f32 v70, v70
  v_mfma_f32_32x32x16_bf16 v[96:111], v[16:19], v[204:207], v[96:111]
  ds_write_b32 v8, v9 offset:16
  ds_read_b64_tr_b16 v[16:17], v4 offset:49152
  ds_read_b64_tr_b16 v[18:19], v4 offset:49664
  s_waitcnt lgkmcnt(7)
  v_rcp_f32 v71, v71
  v_mul_f32 v72, v72, v64
  v_mfma_f32_32x32x16_bf16 v[96:111], v[20:23], v[208:211], v[96:111]
  ds_read_b64_tr_b16 v[20:21], v4 offset:51200
  ds_read_b64_tr_b16 v[22:23], v4 offset:51712
  v_mul_f32 v73, v73, v65
  v_mul_f32 v74, v74, v66
  v_mul_f32 v75, v75, v67
  v_mul_f32 v76, v76, v68
  v_mul_f32 v77, v77, v69
  v_mfma_f32_32x32x16_bf16 v[96:111], v[24:27], v[212:215], v[96:111]
  ds_read_b64_tr_b16 v[24:25], v4 offset:53248
  ds_read_b64_tr_b16 v[26:27], v4 offset:53760
  s_waitcnt lgkmcnt(7)
  v_mul_f32 v78, v78, v70
  v_mul_f32 v79, v79, v71
  v_cvt_pk_bf16_f32 v64, v72, v73
  v_cvt_pk_bf16_f32 v65, v74, v75
  v_mfma_f32_32x32x16_bf16 v[96:111], v[28:31], v[216:219], v[96:111]
  ds_read_b64_tr_b16 v[28:29], v4 offset:55296
  ds_read_b64_tr_b16 v[30:31], v4 offset:55808
  v_cvt_pk_bf16_f32 v66, v76, v77
  v_cvt_pk_bf16_f32 v67, v78, v79
  v_bfi_b32 v64, s89, v2, v64
  v_bfi_b32 v66, s89, v3, v66
  v_mfma_f32_32x32x16_bf16 v[96:111], v[12:15], v[220:223], v[96:111]
  ds_read_b64_tr_b16 v[12:13], v6 offset:49152
  ds_read_b64_tr_b16 v[14:15], v6 offset:49664
  s_waitcnt lgkmcnt(6)
  buffer_store_dwordx4 v[64:67], v1, s[32:35], s78 offen offset:2048 sc1
  v_mul_f32 v80, s3, v80
  v_mul_f32 v81, s3, v81
  v_mul_f32 v82, s3, v82
  v_mfma_f32_32x32x16_bf16 v[96:111], v[16:19], v[224:227], v[96:111]
  ds_read_b64_tr_b16 v[16:17], v6 offset:51200
  ds_read_b64_tr_b16 v[18:19], v6 offset:51712
  v_mul_f32 v83, s3, v83
  v_mul_f32 v84, s3, v84
  v_mul_f32 v85, s3, v85
  v_mul_f32 v86, s3, v86
  v_mul_f32 v87, s3, v87
  v_mfma_f32_32x32x16_bf16 v[96:111], v[20:23], v[228:231], v[96:111]
  ds_read_b64_tr_b16 v[20:21], v6 offset:53248
  ds_read_b64_tr_b16 v[22:23], v6 offset:53760
  s_waitcnt lgkmcnt(6)
  v_exp_f32 v80, v80
  v_exp_f32 v81, v81
  v_mfma_f32_32x32x16_bf16 v[96:111], v[24:27], v[232:235], v[96:111]
  ds_read_b64_tr_b16 v[24:25], v6 offset:55296
  ds_read_b64_tr_b16 v[26:27], v6 offset:55808
  v_exp_f32 v82, v82
  v_exp_f32 v83, v83
  v_mfma_f32_32x32x16_bf16 v[96:111], v[28:31], v[236:239], v[96:111]
  ds_read_b64_tr_b16 v[28:29], v5 offset:32768
  ds_read_b64_tr_b16 v[30:31], v5 offset:33280
  s_waitcnt lgkmcnt(6)
  v_exp_f32 v84, v84
  v_exp_f32 v85, v85
  v_mfma_f32_32x32x16_bf16 v[96:111], v[12:15], v[240:243], v[96:111]
  ds_read_b64_tr_b16 v[12:13], v5 offset:34816
  ds_read_b64_tr_b16 v[14:15], v5 offset:35328
  v_exp_f32 v86, v86
  v_exp_f32 v87, v87
  v_add_f32 v80, 1.0, v80
  v_mfma_f32_32x32x16_bf16 v[96:111], v[16:19], v[244:247], v[96:111]
  ds_read_b64_tr_b16 v[16:17], v5 offset:36864
  ds_read_b64_tr_b16 v[18:19], v5 offset:37376
  s_waitcnt lgkmcnt(6)
  v_add_f32 v81, 1.0, v81
  v_add_f32 v82, 1.0, v82
  v_add_f32 v83, 1.0, v83
  v_add_f32 v84, 1.0, v84
  v_mfma_f32_32x32x16_bf16 v[96:111], v[20:23], v[248:251], v[96:111]
  ds_read_b64_tr_b16 v[20:21], v5 offset:38912
  ds_read_b64_tr_b16 v[22:23], v5 offset:39424
  v_add_f32 v85, 1.0, v85
  v_add_f32 v86, 1.0, v86
  v_add_f32 v87, 1.0, v87
  v_rcp_f32 v80, v80
  v_mfma_f32_32x32x16_bf16 v[96:111], v[24:27], v[252:255], v[96:111]
  ds_read_b64_tr_b16 v[24:25], v7 offset:32768
  ds_read_b64_tr_b16 v[26:27], v7 offset:33280
  s_waitcnt lgkmcnt(6)
  v_rcp_f32 v81, v81
  v_rcp_f32 v82, v82
  v_mfma_f32_32x32x16_bf16 v[112:127], v[28:31], v[192:195], v[112:127]
  ds_read_b64_tr_b16 v[28:29], v7 offset:34816
  ds_read_b64_tr_b16 v[30:31], v7 offset:35328
  v_rcp_f32 v83, v83
  v_rcp_f32 v84, v84
  v_mfma_f32_32x32x16_bf16 v[112:127], v[12:15], v[196:199], v[112:127]
  ds_read_b64_tr_b16 v[12:13], v7 offset:36864
  ds_read_b64_tr_b16 v[14:15], v7 offset:37376
  s_waitcnt lgkmcnt(6)
  v_rcp_f32 v85, v85
  v_rcp_f32 v86, v86
  v_mfma_f32_32x32x16_bf16 v[112:127], v[16:19], v[200:203], v[112:127]
  ds_read_b64_tr_b16 v[16:17], v7 offset:38912
  ds_read_b64_tr_b16 v[18:19], v7 offset:39424
  v_rcp_f32 v87, v87
  v_mul_f32 v88, v88, v80
  v_mul_f32 v89, v89, v81
  v_mul_f32 v90, v90, v82
  v_mfma_f32_32x32x16_bf16 v[112:127], v[20:23], v[204:207], v[112:127]
  ds_read_b64_tr_b16 v[20:21], v5 offset:49152
  ds_read_b64_tr_b16 v[22:23], v5 offset:49664
  s_waitcnt lgkmcnt(6)
  v_mul_f32 v91, v91, v83
  v_mul_f32 v92, v92, v84
  v_mul_f32 v93, v93, v85
  v_mul_f32 v94, v94, v86
  v_mfma_f32_32x32x16_bf16 v[112:127], v[24:27], v[208:211], v[112:127]
  ds_read_b64_tr_b16 v[24:25], v5 offset:51200
  ds_read_b64_tr_b16 v[26:27], v5 offset:51712
  v_mul_f32 v95, v95, v87
  v_cvt_pk_bf16_f32 v80, v88, v89
  v_cvt_pk_bf16_f32 v81, v90, v91
  v_cvt_pk_bf16_f32 v82, v92, v93
  v_cvt_pk_bf16_f32 v83, v94, v95
  v_mfma_f32_32x32x16_bf16 v[112:127], v[28:31], v[212:215], v[112:127]
  ds_read_b64_tr_b16 v[28:29], v5 offset:53248
  ds_read_b64_tr_b16 v[30:31], v5 offset:53760
  s_waitcnt lgkmcnt(6)
  v_bfi_b32 v80, s89, v2, v80
  v_bfi_b32 v82, s89, v3, v82
  v_mfma_f32_32x32x16_bf16 v[112:127], v[12:15], v[216:219], v[112:127]
  ds_read_b64_tr_b16 v[12:13], v5 offset:55296
  ds_read_b64_tr_b16 v[14:15], v5 offset:55808
  buffer_store_dwordx4 v[80:83], v1, s[32:35], s78 offen offset:3072 sc1
  v_mul_f32 v96, s3, v96
  v_mul_f32 v97, s3, v97
  v_mul_f32 v98, s3, v98
  v_mul_f32 v99, s3, v99
  v_mfma_f32_32x32x16_bf16 v[112:127], v[16:19], v[220:223], v[112:127]
  ds_read_b64_tr_b16 v[16:17], v7 offset:49152
  ds_read_b64_tr_b16 v[18:19], v7 offset:49664
  s_waitcnt lgkmcnt(6)
  v_mul_f32 v100, s3, v100
  v_mul_f32 v101, s3, v101
  v_mul_f32 v102, s3, v102
  v_mul_f32 v103, s3, v103
  v_mfma_f32_32x32x16_bf16 v[112:127], v[20:23], v[224:227], v[112:127]
  ds_read_b64_tr_b16 v[20:21], v7 offset:51200
  ds_read_b64_tr_b16 v[22:23], v7 offset:51712
  v_exp_f32 v96, v96
  v_exp_f32 v97, v97
  v_mfma_f32_32x32x16_bf16 v[112:127], v[24:27], v[228:231], v[112:127]
  ds_read_b64_tr_b16 v[24:25], v7 offset:53248
  ds_read_b64_tr_b16 v[26:27], v7 offset:53760
  s_waitcnt lgkmcnt(6)
  v_exp_f32 v98, v98
  v_exp_f32 v99, v99
  v_mfma_f32_32x32x16_bf16 v[112:127], v[28:31], v[232:235], v[112:127]
  ds_read_b64_tr_b16 v[28:29], v7 offset:55296
  ds_read_b64_tr_b16 v[30:31], v7 offset:55808
  v_exp_f32 v100, v100
  v_exp_f32 v101, v101
  v_mfma_f32_32x32x16_bf16 v[112:127], v[12:15], v[236:239], v[112:127]
  s_waitcnt lgkmcnt(4)
  v_exp_f32 v102, v102
  v_exp_f32 v103, v103
  v_mfma_f32_32x32x16_bf16 v[112:127], v[16:19], v[240:243], v[112:127]
  v_add_f32 v96, 1.0, v96
  v_add_f32 v97, 1.0, v97
  v_add_f32 v98, 1.0, v98
  v_add_f32 v99, 1.0, v99
  v_add_f32 v100, 1.0, v100
  v_mfma_f32_32x32x16_bf16 v[112:127], v[20:23], v[244:247], v[112:127]
  s_waitcnt lgkmcnt(0)
  v_add_f32 v101, 1.0, v101
  v_add_f32 v102, 1.0, v102
  v_add_f32 v103, 1.0, v103
  v_mfma_f32_32x32x16_bf16 v[112:127], v[24:27], v[248:251], v[112:127]
  v_rcp_f32 v96, v96
  v_rcp_f32 v97, v97
  v_mfma_f32_32x32x16_bf16 v[112:127], v[28:31], v[252:255], v[112:127]
  v_rcp_f32 v98, v98
  v_rcp_f32 v99, v99
  ds_write_b32 v8, v9 offset:32
  v_rcp_f32 v100, v100
  v_rcp_f32 v101, v101
  v_rcp_f32 v102, v102
  v_rcp_f32 v103, v103
  v_mul_f32 v104, v104, v96
  v_mul_f32 v105, v105, v97
  v_mul_f32 v106, v106, v98
  v_mul_f32 v107, v107, v99
  v_mul_f32 v108, v108, v100
  v_mul_f32 v109, v109, v101
  v_mul_f32 v110, v110, v102
  v_mul_f32 v111, v111, v103
  v_cvt_pk_bf16_f32 v96, v104, v105
  v_cvt_pk_bf16_f32 v97, v106, v107
  v_cvt_pk_bf16_f32 v98, v108, v109
  v_cvt_pk_bf16_f32 v99, v110, v111
  v_bfi_b32 v96, s89, v2, v96
  v_bfi_b32 v98, s89, v3, v98
  buffer_store_dwordx4 v[96:99], v1, s[32:35], s79 offen offset:0 sc1
  v_mul_f32 v112, s3, v112
  v_mul_f32 v113, s3, v113
  v_mul_f32 v114, s3, v114
  v_mul_f32 v115, s3, v115
  v_mul_f32 v116, s3, v116
  v_mul_f32 v117, s3, v117
  v_mul_f32 v118, s3, v118
  v_mul_f32 v119, s3, v119
  v_exp_f32 v112, v112
  v_exp_f32 v113, v113
  v_exp_f32 v114, v114
  v_exp_f32 v115, v115
  v_exp_f32 v116, v116
  v_exp_f32 v117, v117
  v_exp_f32 v118, v118
  v_exp_f32 v119, v119
  v_add_f32 v112, 1.0, v112
  v_add_f32 v113, 1.0, v113
  v_add_f32 v114, 1.0, v114
  v_add_f32 v115, 1.0, v115
  v_add_f32 v116, 1.0, v116
  v_add_f32 v117, 1.0, v117
  v_add_f32 v118, 1.0, v118
  v_add_f32 v119, 1.0, v119
  v_rcp_f32 v112, v112
  v_rcp_f32 v113, v113
  v_rcp_f32 v114, v114
  v_rcp_f32 v115, v115
  v_rcp_f32 v116, v116
  v_rcp_f32 v117, v117
  v_rcp_f32 v118, v118
  v_rcp_f32 v119, v119
  v_mul_f32 v120, v120, v112
  v_mul_f32 v121, v121, v113
  v_mul_f32 v122, v122, v114
  v_mul_f32 v123, v123, v115
  v_mul_f32 v124, v124, v116
  v_mul_f32 v125, v125, v117
  v_mul_f32 v126, v126, v118
  v_mul_f32 v127, v127, v119
  v_cvt_pk_bf16_f32 v112, v120, v121
  v_cvt_pk_bf16_f32 v113, v122, v123
  v_cvt_pk_bf16_f32 v114, v124, v125
  v_cvt_pk_bf16_f32 v115, v126, v127
  v_bfi_b32 v112, s89, v2, v112
  v_bfi_b32 v114, s89, v3, v114
  buffer_store_dwordx4 v[112:115], v1, s[32:35], s79 offen offset:1024 sc1
  s_endpgm
L_p1t2:
  ds_read_b64_tr_b16 v[12:13], v4 offset:0
  ds_read_b64_tr_b16 v[14:15], v4 offset:512
  ds_read_b64_tr_b16 v[16:17], v5 offset:0
  ds_read_b64_tr_b16 v[18:19], v5 offset:512
  ds_read_b64_tr_b16 v[20:21], v4 offset:2048
  ds_read_b64_tr_b16 v[22:23], v4 offset:2560
  ds_read_b64_tr_b16 v[24:25], v5 offset:2048
  ds_read_b64_tr_b16 v[26:27], v5 offset:2560
  ds_read_b64_tr_b16 v[28:29], v4 offset:4096
  ds_read_b64_tr_b16 v[30:31], v4 offset:4608
  buffer_load_dword v11, off, s[36:39], 0 sc1
  v_dot2c_f32_bf16 v48, v240, v44
  v_dot2c_f32_bf16 v49, v240, v240
  v_dot2c_f32_bf16 v50, v241, v44
  v_dot2c_f32_bf16 v51, v241, v241
  v_dot2c_f32_bf16 v48, v242, v44
  v_dot2c_f32_bf16 v49, v242, v242
  v_dot2c_f32_bf16 v50, v243, v44
  v_dot2c_f32_bf16 v51, v243, v243
  v_dot2c_f32_bf16 v48, v244, v44
  v_dot2c_f32_bf16 v49, v244, v244
  v_dot2c_f32_bf16 v50, v245, v44
  v_dot2c_f32_bf16 v51, v245, v245
  v_dot2c_f32_bf16 v48, v246, v44
  v_dot2c_f32_bf16 v49, v246, v246
  v_dot2c_f32_bf16 v50, v247, v44
  v_dot2c_f32_bf16 v51, v247, v247
  v_dot2c_f32_bf16 v48, v248, v44
  v_dot2c_f32_bf16 v49, v248, v248
  v_dot2c_f32_bf16 v50, v249, v44
  v_dot2c_f32_bf16 v51, v249, v249
  v_dot2c_f32_bf16 v48, v250, v44
  v_dot2c_f32_bf16 v49, v250, v250
  v_dot2c_f32_bf16 v50, v251, v44
  v_dot2c_f32_bf16 v51, v251, v251
  v_dot2c_f32_bf16 v48, v252, v44
  v_dot2c_f32_bf16 v49, v252, v252
  v_dot2c_f32_bf16 v50, v253, v44
  v_dot2c_f32_bf16 v51, v253, v253
  v_dot2c_f32_bf16 v48, v254, v44
  v_dot2c_f32_bf16 v49, v254, v254
  v_dot2c_f32_bf16 v50, v255, v44
  v_dot2c_f32_bf16 v51, v255, v255
  s_nop 2
  v_pk_add_f32 v[48:49], v[48:49], v[50:51]
  v_mov_b32 v50, v48
  v_mov_b32 v51, v49
  s_nop 0
  v_permlane32_swap_b32 v48, v50
  v_permlane32_swap_b32 v49, v51
  v_pk_add_f32 v[48:49], v[48:49], v[50:51]
  v_mul_f32 v48, 0x3b000000, v48
  v_mul_f32 v49, 0x3b000000, v49
  v_fma_f32 v49, -v48, v48, v49
  v_max_f32 v49, 0, v49
  v_add_f32 v49, 0x3727c5ac, v49
  v_rsq_f32 v2, v49
  s_nop 0
  v_mul_f32 v3, v48, v2
  v_fma_f32 v96, v96, v2, -v3
  v_fma_f32 v97, v97, v2, -v3
  v_fma_f32 v98, v98, v2, -v3
  v_fma_f32 v99, v99, v2, -v3
  v_fma_f32 v100, v100, v2, -v3
  v_fma_f32 v101, v101, v2, -v3
  v_fma_f32 v102, v102, v2, -v3
  v_fma_f32 v103, v103, v2, -v3
  v_cvt_pk_bf16_f32 v128, v96, v97
  v_cvt_pk_bf16_f32 v129, v98, v99
  v_cvt_pk_bf16_f32 v130, v100, v101
  v_cvt_pk_bf16_f32 v131, v102, v103
  v_fma_f32 v104, v104, v2, -v3
  v_fma_f32 v105, v105, v2, -v3
  v_fma_f32 v106, v106, v2, -v3
  v_fma_f32 v107, v107, v2, -v3
  v_fma_f32 v108, v108, v2, -v3
  v_fma_f32 v109, v109, v2, -v3
  v_fma_f32 v110, v110, v2, -v3
  v_fma_f32 v111, v111, v2, -v3
  s_lshl_b32 s77, s70, 13
  s_add_u32 s77, s77, s27
  s_add_u32 s78, s77, 4096
  s_lshl_b32 s80, s68, 12
  s_add_u32 s80, s80, 114688
  s_waitcnt lgkmcnt(8)
  v_mfma_f32_32x32x16_bf16 v[32:47], v[12:15], v[128:131], 0
  ds_read_b64_tr_b16 v[12:13], v5 offset:4096
  ds_read_b64_tr_b16 v[14:15], v5 offset:4608
  v_cvt_pk_bf16_f32 v132, v104, v105
  v_cvt_pk_bf16_f32 v133, v106, v107
  v_fma_f32 v112, v112, v2, -v3
  v_fma_f32 v113, v113, v2, -v3
  v_fma_f32 v114, v114, v2, -v3
  v_fma_f32 v115, v115, v2, -v3
  v_lshlrev_b32 v120, 16, v140
  v_and_b32 v121, s87, v140
  v_lshlrev_b32 v122, 16, v141
  v_and_b32 v123, s87, v141
  s_waitcnt lgkmcnt(8)
  v_mfma_f32_32x32x16_bf16 v[48:63], v[16:19], v[128:131], 0
  ds_read_b64_tr_b16 v[16:17], v4 offset:6144
  ds_read_b64_tr_b16 v[18:19], v4 offset:6656
  s_waitcnt lgkmcnt(6)
  v_cvt_pk_bf16_f32 v134, v108, v109
  v_cvt_pk_bf16_f32 v135, v110, v111
  v_fma_f32 v116, v116, v2, -v3
  v_fma_f32 v117, v117, v2, -v3
  v_fma_f32 v118, v118, v2, -v3
  v_fma_f32 v119, v119, v2, -v3
  v_lshlrev_b32 v124, 16, v142
  v_and_b32 v125, s87, v142
  v_lshlrev_b32 v126, 16, v143
  v_and_b32 v127, s87, v143
  v_mfma_f32_32x32x16_bf16 v[32:47], v[20:23], v[132:135], v[32:47]
  ds_read_b64_tr_b16 v[20:21], v5 offset:6144
  ds_read_b64_tr_b16 v[22:23], v5 offset:6656
  v_cvt_pk_bf16_f32 v136, v112, v113
  v_cvt_pk_bf16_f32 v137, v114, v115
  v_fma_f32 v120, v120, v2, -v3
  v_fma_f32 v121, v121, v2, -v3
  v_fma_f32 v122, v122, v2, -v3
  v_fma_f32 v123, v123, v2, -v3
  v_lshlrev_b32 v96, 16, v144
  v_and_b32 v97, s87, v144
  v_lshlrev_b32 v98, 16, v145
  v_and_b32 v99, s87, v145
  v_mfma_f32_32x32x16_bf16 v[48:63], v[24:27], v[132:135], v[48:63]
  ds_read_b64_tr_b16 v[24:25], v6 offset:0
  ds_read_b64_tr_b16 v[26:27], v6 offset:512
  s_waitcnt lgkmcnt(6)
  v_cvt_pk_bf16_f32 v138, v116, v117
  v_cvt_pk_bf16_f32 v139, v118, v119
  v_fma_f32 v124, v124, v2, -v3
  v_fma_f32 v125, v125, v2, -v3
  v_fma_f32 v126, v126, v2, -v3
  v_fma_f32 v127, v127, v2, -v3
  v_lshlrev_b32 v100, 16, v146
  v_and_b32 v101, s87, v146
  v_lshlrev_b32 v102, 16, v147
  v_and_b32 v103, s87, v147
  v_mfma_f32_32x32x16_bf16 v[32:47], v[28:31], v[136:139], v[32:47]
  ds_read_b64_tr_b16 v[28:29], v7 offset:0
  ds_read_b64_tr_b16 v[30:31], v7 offset:512
  v_cvt_pk_bf16_f32 v140, v120, v121
  v_cvt_pk_bf16_f32 v141, v122, v123
  v_fma_f32 v96, v96, v2, -v3
  v_fma_f32 v97, v97, v2, -v3
  v_fma_f32 v98, v98, v2, -v3
  v_fma_f32 v99, v99, v2, -v3
  v_lshlrev_b32 v104, 16, v148
  v_and_b32 v105, s87, v148
  v_lshlrev_b32 v106, 16, v149
  v_and_b32 v107, s87, v149
  v_mfma_f32_32x32x16_bf16 v[48:63], v[12:15], v[136:139], v[48:63]
  ds_read_b64_tr_b16 v[12:13], v6 offset:2048
  ds_read_b64_tr_b16 v[14:15], v6 offset:2560
  s_waitcnt lgkmcnt(6)
  v_cvt_pk_bf16_f32 v142, v124, v125
  v_cvt_pk_bf16_f32 v143, v126, v127
  v_fma_f32 v100, v100, v2, -v3
  v_fma_f32 v101, v101, v2, -v3
  v_fma_f32 v102, v102, v2, -v3
  v_fma_f32 v103, v103, v2, -v3
  v_lshlrev_b32 v108, 16, v150
  v_and_b32 v109, s87, v150
  v_lshlrev_b32 v110, 16, v151
  v_and_b32 v111, s87, v151
  v_mfma_f32_32x32x16_bf16 v[32:47], v[16:19], v[140:143], v[32:47]
  ds_read_b64_tr_b16 v[16:17], v7 offset:2048
  ds_read_b64_tr_b16 v[18:19], v7 offset:2560
  v_cvt_pk_bf16_f32 v144, v96, v97
  v_cvt_pk_bf16_f32 v145, v98, v99
  v_fma_f32 v104, v104, v2, -v3
  v_fma_f32 v105, v105, v2, -v3
  v_fma_f32 v106, v106, v2, -v3
  v_fma_f32 v107, v107, v2, -v3
  v_lshlrev_b32 v112, 16, v152
  v_and_b32 v113, s87, v152
  v_lshlrev_b32 v114, 16, v153
  v_and_b32 v115, s87, v153
  v_mfma_f32_32x32x16_bf16 v[48:63], v[20:23], v[140:143], v[48:63]
  ds_read_b64_tr_b16 v[20:21], v6 offset:4096
  ds_read_b64_tr_b16 v[22:23], v6 offset:4608
  s_waitcnt lgkmcnt(6)
  v_cvt_pk_bf16_f32 v146, v100, v101
  v_cvt_pk_bf16_f32 v147, v102, v103
  v_fma_f32 v108, v108, v2, -v3
  v_fma_f32 v109, v109, v2, -v3
  v_fma_f32 v110, v110, v2, -v3
  v_fma_f32 v111, v111, v2, -v3
  v_lshlrev_b32 v116, 16, v154
  v_and_b32 v117, s87, v154
  v_lshlrev_b32 v118, 16, v155
  v_and_b32 v119, s87, v155
  v_mfma_f32_32x32x16_bf16 v[32:47], v[24:27], v[144:147], v[32:47]
  ds_read_b64_tr_b16 v[24:25], v7 offset:4096
  ds_read_b64_tr_b16 v[26:27], v7 offset:4608
  v_cvt_pk_bf16_f32 v148, v104, v105
  v_cvt_pk_bf16_f32 v149, v106, v107
  v_fma_f32 v112, v112, v2, -v3
  v_fma_f32 v113, v113, v2, -v3
  v_fma_f32 v114, v114, v2, -v3
  v_fma_f32 v115, v115, v2, -v3
  v_lshlrev_b32 v120, 16, v156
  v_and_b32 v121, s87, v156
  v_lshlrev_b32 v122, 16, v157
  v_and_b32 v123, s87, v157
  v_mfma_f32_32x32x16_bf16 v[48:63], v[28:31], v[144:147], v[48:63]
  ds_read_b64_tr_b16 v[28:29], v6 offset:6144
  ds_read_b64_tr_b16 v[30:31], v6 offset:6656
  s_waitcnt lgkmcnt(6)
  v_cvt_pk_bf16_f32 v150, v108, v109
  v_cvt_pk_bf16_f32 v151, v110, v111
  v_fma_f32 v116, v116, v2, -v3
  v_fma_f32 v117, v117, v2, -v3
  v_fma_f32 v118, v118, v2, -v3
  v_fma_f32 v119, v119, v2, -v3
  v_lshlrev_b32 v124, 16, v158
  v_and_b32 v125, s87, v158
  v_lshlrev_b32 v126, 16, v159
  v_and_b32 v127, s87, v159
  v_mfma_f32_32x32x16_bf16 v[32:47], v[12:15], v[148:151], v[32:47]
  ds_read_b64_tr_b16 v[12:13], v7 offset:6144
  ds_read_b64_tr_b16 v[14:15], v7 offset:6656
  v_cvt_pk_bf16_f32 v152, v112, v113
  v_cvt_pk_bf16_f32 v153, v114, v115
  v_fma_f32 v120, v120, v2, -v3
  v_fma_f32 v121, v121, v2, -v3
  v_fma_f32 v122, v122, v2, -v3
  v_fma_f32 v123, v123, v2, -v3
  v_lshlrev_b32 v96, 16, v160
  v_and_b32 v97, s87, v160
  v_lshlrev_b32 v98, 16, v161
  v_and_b32 v99, s87, v161
  v_mfma_f32_32x32x16_bf16 v[48:63], v[16:19], v[148:151], v[48:63]
  s_barrier
  ds_read_b64_tr_b16 v[16:17], v4 offset:16384
  ds_read_b64_tr_b16 v[18:19], v4 offset:16896
  s_waitcnt lgkmcnt(6)
  v_cvt_pk_bf16_f32 v154, v116, v117
  v_cvt_pk_bf16_f32 v155, v118, v119
  v_fma_f32 v124, v124, v2, -v3
  v_fma_f32 v125, v125, v2, -v3
  v_fma_f32 v126, v126, v2, -v3
  v_fma_f32 v127, v127, v2, -v3
  v_lshlrev_b32 v100, 16, v162
  v_and_b32 v101, s87, v162
  v_lshlrev_b32 v102, 16, v163
  v_and_b32 v103, s87, v163
  v_mfma_f32_32x32x16_bf16 v[32:47], v[20:23], v[152:155], v[32:47]
  ds_read_b64_tr_b16 v[20:21], v5 offset:16384
  ds_read_b64_tr_b16 v[22:23], v5 offset:16896
  v_cvt_pk_bf16_f32 v156, v120, v121
  v_cvt_pk_bf16_f32 v157, v122, v123
  v_fma_f32 v96, v96, v2, -v3
  v_fma_f32 v97, v97, v2, -v3
  v_fma_f32 v98, v98, v2, -v3
  v_fma_f32 v99, v99, v2, -v3
  v_lshlrev_b32 v104, 16, v164
  v_and_b32 v105, s87, v164
  v_lshlrev_b32 v106, 16, v165
  v_and_b32 v107, s87, v165
  v_mfma_f32_32x32x16_bf16 v[48:63], v[24:27], v[152:155], v[48:63]
  ds_read_b64_tr_b16 v[24:25], v4 offset:18432
  ds_read_b64_tr_b16 v[26:27], v4 offset:18944
  s_waitcnt lgkmcnt(6)
  v_cvt_pk_bf16_f32 v158, v124, v125
  v_cvt_pk_bf16_f32 v159, v126, v127
  v_fma_f32 v100, v100, v2, -v3
  v_fma_f32 v101, v101, v2, -v3
  v_fma_f32 v102, v102, v2, -v3
  v_fma_f32 v103, v103, v2, -v3
  v_lshlrev_b32 v108, 16, v166
  v_and_b32 v109, s87, v166
  v_lshlrev_b32 v110, 16, v167
  v_and_b32 v111, s87, v167
  v_mfma_f32_32x32x16_bf16 v[32:47], v[28:31], v[156:159], v[32:47]
  ds_read_b64_tr_b16 v[28:29], v5 offset:18432
  ds_read_b64_tr_b16 v[30:31], v5 offset:18944
  v_cvt_pk_bf16_f32 v160, v96, v97
  v_cvt_pk_bf16_f32 v161, v98, v99
  v_fma_f32 v104, v104, v2, -v3
  v_fma_f32 v105, v105, v2, -v3
  v_fma_f32 v106, v106, v2, -v3
  v_fma_f32 v107, v107, v2, -v3
  v_lshlrev_b32 v112, 16, v168
  v_and_b32 v113, s87, v168
  v_lshlrev_b32 v114, 16, v169
  v_and_b32 v115, s87, v169
  v_mfma_f32_32x32x16_bf16 v[48:63], v[12:15], v[156:159], v[48:63]
  ds_read_b64_tr_b16 v[12:13], v4 offset:20480
  ds_read_b64_tr_b16 v[14:15], v4 offset:20992
  s_waitcnt lgkmcnt(6)
  v_cvt_pk_bf16_f32 v162, v100, v101
  v_cvt_pk_bf16_f32 v163, v102, v103
  v_fma_f32 v108, v108, v2, -v3
  v_fma_f32 v109, v109, v2, -v3
  v_fma_f32 v110, v110, v2, -v3
  v_fma_f32 v111, v111, v2, -v3
  v_lshlrev_b32 v116, 16, v170
  v_and_b32 v117, s87, v170
  v_lshlrev_b32 v118, 16, v171
  v_and_b32 v119, s87, v171
  v_mfma_f32_32x32x16_bf16 v[32:47], v[16:19], v[160:163], v[32:47]
  ds_read_b64_tr_b16 v[16:17], v5 offset:20480
  ds_read_b64_tr_b16 v[18:19], v5 offset:20992
  v_cvt_pk_bf16_f32 v164, v104, v105
  v_cvt_pk_bf16_f32 v165, v106, v107
  v_fma_f32 v112, v112, v2, -v3
  v_fma_f32 v113, v113, v2, -v3
  v_fma_f32 v114, v114, v2, -v3
  v_fma_f32 v115, v115, v2, -v3
  v_lshlrev_b32 v120, 16, v172
  v_and_b32 v121, s87, v172
  v_lshlrev_b32 v122, 16, v173
  v_and_b32 v123, s87, v173
  v_mfma_f32_32x32x16_bf16 v[48:63], v[20:23], v[160:163], v[48:63]
  ds_read_b64_tr_b16 v[20:21], v4 offset:22528
  ds_read_b64_tr_b16 v[22:23], v4 offset:23040
  s_waitcnt lgkmcnt(6)
  v_cvt_pk_bf16_f32 v166, v108, v109
  v_cvt_pk_bf16_f32 v167, v110, v111
  v_fma_f32 v116, v116, v2, -v3
  v_fma_f32 v117, v117, v2, -v3
  v_fma_f32 v118, v118, v2, -v3
  v_fma_f32 v119, v119, v2, -v3
  v_lshlrev_b32 v124, 16, v174
  v_and_b32 v125, s87, v174
  v_lshlrev_b32 v126, 16, v175
  v_and_b32 v127, s87, v175
  v_mfma_f32_32x32x16_bf16 v[32:47], v[24:27], v[164:167], v[32:47]
  ds_read_b64_tr_b16 v[24:25], v5 offset:22528
  ds_read_b64_tr_b16 v[26:27], v5 offset:23040
  v_cvt_pk_bf16_f32 v168, v112, v113
  v_cvt_pk_bf16_f32 v169, v114, v115
  v_fma_f32 v120, v120, v2, -v3
  v_fma_f32 v121, v121, v2, -v3
  v_fma_f32 v122, v122, v2, -v3
  v_fma_f32 v123, v123, v2, -v3
  v_lshlrev_b32 v96, 16, v176
  v_and_b32 v97, s87, v176
  v_lshlrev_b32 v98, 16, v177
  v_and_b32 v99, s87, v177
  v_mfma_f32_32x32x16_bf16 v[48:63], v[28:31], v[164:167], v[48:63]
  ds_read_b64_tr_b16 v[28:29], v6 offset:16384
  ds_read_b64_tr_b16 v[30:31], v6 offset:16896
  s_waitcnt lgkmcnt(6)
  v_cvt_pk_bf16_f32 v170, v116, v117
  v_cvt_pk_bf16_f32 v171, v118, v119
  v_fma_f32 v124, v124, v2, -v3
  v_fma_f32 v125, v125, v2, -v3
  v_fma_f32 v126, v126, v2, -v3
  v_fma_f32 v127, v127, v2, -v3
  v_lshlrev_b32 v100, 16, v178
  v_and_b32 v101, s87, v178
  v_lshlrev_b32 v102, 16, v179
  v_and_b32 v103, s87, v179
  v_mfma_f32_32x32x16_bf16 v[32:47], v[12:15], v[168:171], v[32:47]
  ds_read_b64_tr_b16 v[12:13], v7 offset:16384
  ds_read_b64_tr_b16 v[14:15], v7 offset:16896
  v_cvt_pk_bf16_f32 v172, v120, v121
  v_cvt_pk_bf16_f32 v173, v122, v123
  v_fma_f32 v96, v96, v2, -v3
  v_fma_f32 v97, v97, v2, -v3
  v_fma_f32 v98, v98, v2, -v3
  v_fma_f32 v99, v99, v2, -v3
  v_lshlrev_b32 v104, 16, v180
  v_and_b32 v105, s87, v180
  v_lshlrev_b32 v106, 16, v181
  v_and_b32 v107, s87, v181
  v_mfma_f32_32x32x16_bf16 v[48:63], v[16:19], v[168:171], v[48:63]
  ds_read_b64_tr_b16 v[16:17], v6 offset:18432
  ds_read_b64_tr_b16 v[18:19], v6 offset:18944
  s_waitcnt lgkmcnt(6)
  v_cvt_pk_bf16_f32 v174, v124, v125
  v_cvt_pk_bf16_f32 v175, v126, v127
  v_fma_f32 v100, v100, v2, -v3
  v_fma_f32 v101, v101, v2, -v3
  v_fma_f32 v102, v102, v2, -v3
  v_fma_f32 v103, v103, v2, -v3
  v_lshlrev_b32 v108, 16, v182
  v_and_b32 v109, s87, v182
  v_lshlrev_b32 v110, 16, v183
  v_and_b32 v111, s87, v183
  v_mfma_f32_32x32x16_bf16 v[32:47], v[20:23], v[172:175], v[32:47]
  ds_read_b64_tr_b16 v[20:21], v7 offset:18432
  ds_read_b64_tr_b16 v[22:23], v7 offset:18944
  v_cvt_pk_bf16_f32 v176, v96, v97
  v_cvt_pk_bf16_f32 v177, v98, v99
  v_fma_f32 v104, v104, v2, -v3
  v_fma_f32 v105, v105, v2, -v3
  v_fma_f32 v106, v106, v2, -v3
  v_fma_f32 v107, v107, v2, -v3
  v_lshlrev_b32 v112, 16, v184
  v_and_b32 v113, s87, v184
  v_lshlrev_b32 v114, 16, v185
  v_and_b32 v115, s87, v185
  v_mfma_f32_32x32x16_bf16 v[48:63], v[24:27], v[172:175], v[48:63]
  ds_read_b64_tr_b16 v[24:25], v6 offset:20480
  ds_read_b64_tr_b16 v[26:27], v6 offset:20992
  s_waitcnt lgkmcnt(6)
  v_cvt_pk_bf16_f32 v178, v100, v101
  v_cvt_pk_bf16_f32 v179, v102, v103
  v_fma_f32 v108, v108, v2, -v3
  v_fma_f32 v109, v109, v2, -v3
  v_fma_f32 v110, v110, v2, -v3
  v_fma_f32 v111, v111, v2, -v3
  v_lshlrev_b32 v116, 16, v186
  v_and_b32 v117, s87, v186
  v_lshlrev_b32 v118, 16, v187
  v_and_b32 v119, s87, v187
  v_mfma_f32_32x32x16_bf16 v[32:47], v[28:31], v[176:179], v[32:47]
  ds_read_b64_tr_b16 v[28:29], v7 offset:20480
  ds_read_b64_tr_b16 v[30:31], v7 offset:20992
  v_cvt_pk_bf16_f32 v180, v104, v105
  v_cvt_pk_bf16_f32 v181, v106, v107
  v_fma_f32 v112, v112, v2, -v3
  v_fma_f32 v113, v113, v2, -v3
  v_fma_f32 v114, v114, v2, -v3
  v_fma_f32 v115, v115, v2, -v3
  v_lshlrev_b32 v120, 16, v188
  v_and_b32 v121, s87, v188
  v_lshlrev_b32 v122, 16, v189
  v_and_b32 v123, s87, v189
  v_mfma_f32_32x32x16_bf16 v[48:63], v[12:15], v[176:179], v[48:63]
  ds_read_b64_tr_b16 v[12:13], v6 offset:22528
  ds_read_b64_tr_b16 v[14:15], v6 offset:23040
  s_waitcnt lgkmcnt(6)
  v_cvt_pk_bf16_f32 v182, v108, v109
  v_cvt_pk_bf16_f32 v183, v110, v111
  v_fma_f32 v116, v116, v2, -v3
  v_fma_f32 v117, v117, v2, -v3
  v_fma_f32 v118, v118, v2, -v3
  v_fma_f32 v119, v119, v2, -v3
  v_lshlrev_b32 v124, 16, v190
  v_and_b32 v125, s87, v190
  v_lshlrev_b32 v126, 16, v191
  v_and_b32 v127, s87, v191
  v_mfma_f32_32x32x16_bf16 v[32:47], v[16:19], v[180:183], v[32:47]
  ds_read_b64_tr_b16 v[16:17], v7 offset:22528
  ds_read_b64_tr_b16 v[18:19], v7 offset:23040
  v_cvt_pk_bf16_f32 v184, v112, v113
  v_cvt_pk_bf16_f32 v185, v114, v115
  v_fma_f32 v120, v120, v2, -v3
  v_fma_f32 v121, v121, v2, -v3
  v_fma_f32 v122, v122, v2, -v3
  v_fma_f32 v123, v123, v2, -v3
  v_lshlrev_b32 v96, 16, v192
  v_and_b32 v97, s87, v192
  v_lshlrev_b32 v98, 16, v193
  v_and_b32 v99, s87, v193
  v_mfma_f32_32x32x16_bf16 v[48:63], v[20:23], v[180:183], v[48:63]
  s_barrier
  ds_read_b64_tr_b16 v[20:21], v4 offset:32768
  ds_read_b64_tr_b16 v[22:23], v4 offset:33280
  s_waitcnt lgkmcnt(6)
  v_cvt_pk_bf16_f32 v186, v116, v117
  v_cvt_pk_bf16_f32 v187, v118, v119
  v_fma_f32 v124, v124, v2, -v3
  v_fma_f32 v125, v125, v2, -v3
  v_fma_f32 v126, v126, v2, -v3
  v_fma_f32 v127, v127, v2, -v3
  v_lshlrev_b32 v100, 16, v194
  v_and_b32 v101, s87, v194
  v_lshlrev_b32 v102, 16, v195
  v_and_b32 v103, s87, v195
  v_mfma_f32_32x32x16_bf16 v[32:47], v[24:27], v[184:187], v[32:47]
  ds_read_b64_tr_b16 v[24:25], v5 offset:32768
  ds_read_b64_tr_b16 v[26:27], v5 offset:33280
  v_cvt_pk_bf16_f32 v188, v120, v121
  v_cvt_pk_bf16_f32 v189, v122, v123
  v_fma_f32 v96, v96, v2, -v3
  v_fma_f32 v97, v97, v2, -v3
  v_fma_f32 v98, v98, v2, -v3
  v_fma_f32 v99, v99, v2, -v3
  v_lshlrev_b32 v104, 16, v196
  v_and_b32 v105, s87, v196
  v_lshlrev_b32 v106, 16, v197
  v_and_b32 v107, s87, v197
  v_mfma_f32_32x32x16_bf16 v[48:63], v[28:31], v[184:187], v[48:63]
  ds_read_b64_tr_b16 v[28:29], v4 offset:34816
  ds_read_b64_tr_b16 v[30:31], v4 offset:35328
  s_waitcnt lgkmcnt(6)
  v_cvt_pk_bf16_f32 v190, v124, v125
  v_cvt_pk_bf16_f32 v191, v126, v127
  v_fma_f32 v100, v100, v2, -v3
  v_fma_f32 v101, v101, v2, -v3
  v_fma_f32 v102, v102, v2, -v3
  v_fma_f32 v103, v103, v2, -v3
  v_lshlrev_b32 v108, 16, v198
  v_and_b32 v109, s87, v198
  v_lshlrev_b32 v110, 16, v199
  v_and_b32 v111, s87, v199
  v_mfma_f32_32x32x16_bf16 v[32:47], v[12:15], v[188:191], v[32:47]
  ds_read_b64_tr_b16 v[12:13], v5 offset:34816
  ds_read_b64_tr_b16 v[14:15], v5 offset:35328
  v_cvt_pk_bf16_f32 v192, v96, v97
  v_cvt_pk_bf16_f32 v193, v98, v99
  v_fma_f32 v104, v104, v2, -v3
  v_fma_f32 v105, v105, v2, -v3
  v_fma_f32 v106, v106, v2, -v3
  v_fma_f32 v107, v107, v2, -v3
  v_lshlrev_b32 v112, 16, v200
  v_and_b32 v113, s87, v200
  v_lshlrev_b32 v114, 16, v201
  v_and_b32 v115, s87, v201
  v_mfma_f32_32x32x16_bf16 v[48:63], v[16:19], v[188:191], v[48:63]
  ds_read_b64_tr_b16 v[16:17], v4 offset:36864
  ds_read_b64_tr_b16 v[18:19], v4 offset:37376
  s_waitcnt lgkmcnt(6)
  v_cvt_pk_bf16_f32 v194, v100, v101
  v_cvt_pk_bf16_f32 v195, v102, v103
  v_fma_f32 v108, v108, v2, -v3
  v_fma_f32 v109, v109, v2, -v3
  v_fma_f32 v110, v110, v2, -v3
  v_fma_f32 v111, v111, v2, -v3
  v_lshlrev_b32 v116, 16, v202
  v_and_b32 v117, s87, v202
  v_lshlrev_b32 v118, 16, v203
  v_and_b32 v119, s87, v203
  v_mfma_f32_32x32x16_bf16 v[32:47], v[20:23], v[192:195], v[32:47]
  ds_read_b64_tr_b16 v[20:21], v5 offset:36864
  ds_read_b64_tr_b16 v[22:23], v5 offset:37376
  v_cvt_pk_bf16_f32 v196, v104, v105
  v_cvt_pk_bf16_f32 v197, v106, v107
  v_fma_f32 v112, v112, v2, -v3
  v_fma_f32 v113, v113, v2, -v3
  v_fma_f32 v114, v114, v2, -v3
  v_fma_f32 v115, v115, v2, -v3
  v_lshlrev_b32 v120, 16, v204
  v_and_b32 v121, s87, v204
  v_lshlrev_b32 v122, 16, v205
  v_and_b32 v123, s87, v205
  v_mfma_f32_32x32x16_bf16 v[48:63], v[24:27], v[192:195], v[48:63]
  ds_read_b64_tr_b16 v[24:25], v4 offset:38912
  ds_read_b64_tr_b16 v[26:27], v4 offset:39424
  s_waitcnt lgkmcnt(6)
  v_cvt_pk_bf16_f32 v198, v108, v109
  v_cvt_pk_bf16_f32 v199, v110, v111
  v_fma_f32 v116, v116, v2, -v3
  v_fma_f32 v117, v117, v2, -v3
  v_fma_f32 v118, v118, v2, -v3
  v_fma_f32 v119, v119, v2, -v3
  v_lshlrev_b32 v124, 16, v206
  v_and_b32 v125, s87, v206
  v_lshlrev_b32 v126, 16, v207
  v_and_b32 v127, s87, v207
  v_mfma_f32_32x32x16_bf16 v[32:47], v[28:31], v[196:199], v[32:47]
  ds_read_b64_tr_b16 v[28:29], v5 offset:38912
  ds_read_b64_tr_b16 v[30:31], v5 offset:39424
  v_cvt_pk_bf16_f32 v200, v112, v113
  v_cvt_pk_bf16_f32 v201, v114, v115
  v_fma_f32 v120, v120, v2, -v3
  v_fma_f32 v121, v121, v2, -v3
  v_fma_f32 v122, v122, v2, -v3
  v_fma_f32 v123, v123, v2, -v3
  v_lshlrev_b32 v96, 16, v208
  v_and_b32 v97, s87, v208
  v_lshlrev_b32 v98, 16, v209
  v_and_b32 v99, s87, v209
  v_mfma_f32_32x32x16_bf16 v[48:63], v[12:15], v[196:199], v[48:63]
  ds_read_b64_tr_b16 v[12:13], v6 offset:32768
  ds_read_b64_tr_b16 v[14:15], v6 offset:33280
  s_waitcnt lgkmcnt(6)
  v_cvt_pk_bf16_f32 v202, v116, v117
  v_cvt_pk_bf16_f32 v203, v118, v119
  v_fma_f32 v124, v124, v2, -v3
  v_fma_f32 v125, v125, v2, -v3
  v_fma_f32 v126, v126, v2, -v3
  v_fma_f32 v127, v127, v2, -v3
  v_lshlrev_b32 v100, 16, v210
  v_and_b32 v101, s87, v210
  v_lshlrev_b32 v102, 16, v211
  v_and_b32 v103, s87, v211
  v_mfma_f32_32x32x16_bf16 v[32:47], v[16:19], v[200:203], v[32:47]
  ds_read_b64_tr_b16 v[16:17], v7 offset:32768
  ds_read_b64_tr_b16 v[18:19], v7 offset:33280
  v_cvt_pk_bf16_f32 v204, v120, v121
  v_cvt_pk_bf16_f32 v205, v122, v123
  v_fma_f32 v96, v96, v2, -v3
  v_fma_f32 v97, v97, v2, -v3
  v_fma_f32 v98, v98, v2, -v3
  v_fma_f32 v99, v99, v2, -v3
  v_lshlrev_b32 v104, 16, v212
  v_and_b32 v105, s87, v212
  v_lshlrev_b32 v106, 16, v213
  v_and_b32 v107, s87, v213
  v_mfma_f32_32x32x16_bf16 v[48:63], v[20:23], v[200:203], v[48:63]
  ds_read_b64_tr_b16 v[20:21], v6 offset:34816
  ds_read_b64_tr_b16 v[22:23], v6 offset:35328
  s_waitcnt lgkmcnt(6)
  v_cvt_pk_bf16_f32 v206, v124, v125
  v_cvt_pk_bf16_f32 v207, v126, v127
  v_fma_f32 v100, v100, v2, -v3
  v_fma_f32 v101, v101, v2, -v3
  v_fma_f32 v102, v102, v2, -v3
  v_fma_f32 v103, v103, v2, -v3
  v_lshlrev_b32 v108, 16, v214
  v_and_b32 v109, s87, v214
  v_lshlrev_b32 v110, 16, v215
  v_and_b32 v111, s87, v215
  v_mfma_f32_32x32x16_bf16 v[32:47], v[24:27], v[204:207], v[32:47]
  ds_read_b64_tr_b16 v[24:25], v7 offset:34816
  ds_read_b64_tr_b16 v[26:27], v7 offset:35328
  v_cvt_pk_bf16_f32 v208, v96, v97
  v_cvt_pk_bf16_f32 v209, v98, v99
  v_fma_f32 v104, v104, v2, -v3
  v_fma_f32 v105, v105, v2, -v3
  v_fma_f32 v106, v106, v2, -v3
  v_fma_f32 v107, v107, v2, -v3
  v_lshlrev_b32 v112, 16, v216
  v_and_b32 v113, s87, v216
  v_lshlrev_b32 v114, 16, v217
  v_and_b32 v115, s87, v217
  v_mfma_f32_32x32x16_bf16 v[48:63], v[28:31], v[204:207], v[48:63]
  ds_read_b64_tr_b16 v[28:29], v6 offset:36864
  ds_read_b64_tr_b16 v[30:31], v6 offset:37376
  s_waitcnt lgkmcnt(6)
  v_cvt_pk_bf16_f32 v210, v100, v101
  v_cvt_pk_bf16_f32 v211, v102, v103
  v_fma_f32 v108, v108, v2, -v3
  v_fma_f32 v109, v109, v2, -v3
  v_fma_f32 v110, v110, v2, -v3
  v_fma_f32 v111, v111, v2, -v3
  v_lshlrev_b32 v116, 16, v218
  v_and_b32 v117, s87, v218
  v_lshlrev_b32 v118, 16, v219
  v_and_b32 v119, s87, v219
  v_mfma_f32_32x32x16_bf16 v[32:47], v[12:15], v[208:211], v[32:47]
  ds_read_b64_tr_b16 v[12:13], v7 offset:36864
  ds_read_b64_tr_b16 v[14:15], v7 offset:37376
  v_cvt_pk_bf16_f32 v212, v104, v105
  v_cvt_pk_bf16_f32 v213, v106, v107
  v_fma_f32 v112, v112, v2, -v3
  v_fma_f32 v113, v113, v2, -v3
  v_fma_f32 v114, v114, v2, -v3
  v_fma_f32 v115, v115, v2, -v3
  v_lshlrev_b32 v120, 16, v220
  v_and_b32 v121, s87, v220
  v_lshlrev_b32 v122, 16, v221
  v_and_b32 v123, s87, v221
  v_mfma_f32_32x32x16_bf16 v[48:63], v[16:19], v[208:211], v[48:63]
  ds_read_b64_tr_b16 v[16:17], v6 offset:38912
  ds_read_b64_tr_b16 v[18:19], v6 offset:39424
  s_waitcnt lgkmcnt(6)
  v_cvt_pk_bf16_f32 v214, v108, v109
  v_cvt_pk_bf16_f32 v215, v110, v111
  v_fma_f32 v116, v116, v2, -v3
  v_fma_f32 v117, v117, v2, -v3
  v_fma_f32 v118, v118, v2, -v3
  v_fma_f32 v119, v119, v2, -v3
  v_lshlrev_b32 v124, 16, v222
  v_and_b32 v125, s87, v222
  v_lshlrev_b32 v126, 16, v223
  v_and_b32 v127, s87, v223
  v_mfma_f32_32x32x16_bf16 v[32:47], v[20:23], v[212:215], v[32:47]
  ds_read_b64_tr_b16 v[20:21], v7 offset:38912
  ds_read_b64_tr_b16 v[22:23], v7 offset:39424
  v_cvt_pk_bf16_f32 v216, v112, v113
  v_cvt_pk_bf16_f32 v217, v114, v115
  v_fma_f32 v120, v120, v2, -v3
  v_fma_f32 v121, v121, v2, -v3
  v_fma_f32 v122, v122, v2, -v3
  v_fma_f32 v123, v123, v2, -v3
  v_lshlrev_b32 v96, 16, v224
  v_and_b32 v97, s87, v224
  v_lshlrev_b32 v98, 16, v225
  v_and_b32 v99, s87, v225
  v_mfma_f32_32x32x16_bf16 v[48:63], v[24:27], v[212:215], v[48:63]
  s_barrier
  ds_read_b64_tr_b16 v[24:25], v4 offset:49152
  ds_read_b64_tr_b16 v[26:27], v4 offset:49664
  s_waitcnt lgkmcnt(6)
  v_cvt_pk_bf16_f32 v218, v116, v117
  v_cvt_pk_bf16_f32 v219, v118, v119
  v_fma_f32 v124, v124, v2, -v3
  v_fma_f32 v125, v125, v2, -v3
  v_fma_f32 v126, v126, v2, -v3
  v_fma_f32 v127, v127, v2, -v3
  v_lshlrev_b32 v100, 16, v226
  v_and_b32 v101, s87, v226
  v_lshlrev_b32 v102, 16, v227
  v_and_b32 v103, s87, v227
  v_mfma_f32_32x32x16_bf16 v[32:47], v[28:31], v[216:219], v[32:47]
  ds_read_b64_tr_b16 v[28:29], v5 offset:49152
  ds_read_b64_tr_b16 v[30:31], v5 offset:49664
  v_cvt_pk_bf16_f32 v220, v120, v121
  v_cvt_pk_bf16_f32 v221, v122, v123
  v_fma_f32 v96, v96, v2, -v3
  v_fma_f32 v97, v97, v2, -v3
  v_fma_f32 v98, v98, v2, -v3
  v_fma_f32 v99, v99, v2, -v3
  v_lshlrev_b32 v104, 16, v228
  v_and_b32 v105, s87, v228
  v_lshlrev_b32 v106, 16, v229
  v_and_b32 v107, s87, v229
  v_mfma_f32_32x32x16_bf16 v[48:63], v[12:15], v[216:219], v[48:63]
  ds_read_b64_tr_b16 v[12:13], v4 offset:51200
  ds_read_b64_tr_b16 v[14:15], v4 offset:51712
  s_waitcnt lgkmcnt(6)
  v_cvt_pk_bf16_f32 v222, v124, v125
  v_cvt_pk_bf16_f32 v223, v126, v127
  v_fma_f32 v100, v100, v2, -v3
  v_fma_f32 v101, v101, v2, -v3
  v_fma_f32 v102, v102, v2, -v3
  v_fma_f32 v103, v103, v2, -v3
  v_lshlrev_b32 v108, 16, v230
  v_and_b32 v109, s87, v230
  v_lshlrev_b32 v110, 16, v231
  v_and_b32 v111, s87, v231
  v_mfma_f32_32x32x16_bf16 v[32:47], v[16:19], v[220:223], v[32:47]
  ds_read_b64_tr_b16 v[16:17], v5 offset:51200
  ds_read_b64_tr_b16 v[18:19], v5 offset:51712
  v_cvt_pk_bf16_f32 v224, v96, v97
  v_cvt_pk_bf16_f32 v225, v98, v99
  v_fma_f32 v104, v104, v2, -v3
  v_fma_f32 v105, v105, v2, -v3
  v_fma_f32 v106, v106, v2, -v3
  v_fma_f32 v107, v107, v2, -v3
  v_lshlrev_b32 v112, 16, v232
  v_and_b32 v113, s87, v232
  v_lshlrev_b32 v114, 16, v233
  v_and_b32 v115, s87, v233
  v_mfma_f32_32x32x16_bf16 v[48:63], v[20:23], v[220:223], v[48:63]
  ds_read_b64_tr_b16 v[20:21], v4 offset:53248
  ds_read_b64_tr_b16 v[22:23], v4 offset:53760
  s_waitcnt lgkmcnt(6)
  v_cvt_pk_bf16_f32 v226, v100, v101
  v_cvt_pk_bf16_f32 v227, v102, v103
  v_fma_f32 v108, v108, v2, -v3
  v_fma_f32 v109, v109, v2, -v3
  v_fma_f32 v110, v110, v2, -v3
  v_fma_f32 v111, v111, v2, -v3
  v_lshlrev_b32 v116, 16, v234
  v_and_b32 v117, s87, v234
  v_lshlrev_b32 v118, 16, v235
  v_and_b32 v119, s87, v235
  v_mfma_f32_32x32x16_bf16 v[32:47], v[24:27], v[224:227], v[32:47]
  ds_read_b64_tr_b16 v[24:25], v5 offset:53248
  ds_read_b64_tr_b16 v[26:27], v5 offset:53760
  v_cvt_pk_bf16_f32 v228, v104, v105
  v_cvt_pk_bf16_f32 v229, v106, v107
  v_fma_f32 v112, v112, v2, -v3
  v_fma_f32 v113, v113, v2, -v3
  v_fma_f32 v114, v114, v2, -v3
  v_fma_f32 v115, v115, v2, -v3
  v_lshlrev_b32 v120, 16, v236
  v_and_b32 v121, s87, v236
  v_lshlrev_b32 v122, 16, v237
  v_and_b32 v123, s87, v237
  v_mfma_f32_32x32x16_bf16 v[48:63], v[28:31], v[224:227], v[48:63]
  ds_read_b64_tr_b16 v[28:29], v4 offset:55296
  ds_read_b64_tr_b16 v[30:31], v4 offset:55808
  s_waitcnt lgkmcnt(6)
  v_cvt_pk_bf16_f32 v230, v108, v109
  v_cvt_pk_bf16_f32 v231, v110, v111
  v_fma_f32 v116, v116, v2, -v3
  v_fma_f32 v117, v117, v2, -v3
  v_fma_f32 v118, v118, v2, -v3
  v_fma_f32 v119, v119, v2, -v3
  v_lshlrev_b32 v124, 16, v238
  v_and_b32 v125, s87, v238
  v_lshlrev_b32 v126, 16, v239
  v_and_b32 v127, s87, v239
  v_mfma_f32_32x32x16_bf16 v[32:47], v[12:15], v[228:231], v[32:47]
  ds_read_b64_tr_b16 v[12:13], v5 offset:55296
  ds_read_b64_tr_b16 v[14:15], v5 offset:55808
  v_cvt_pk_bf16_f32 v232, v112, v113
  v_cvt_pk_bf16_f32 v233, v114, v115
  v_fma_f32 v120, v120, v2, -v3
  v_fma_f32 v121, v121, v2, -v3
  v_fma_f32 v122, v122, v2, -v3
  v_fma_f32 v123, v123, v2, -v3
  v_lshlrev_b32 v96, 16, v240
  v_and_b32 v97, s87, v240
  v_lshlrev_b32 v98, 16, v241
  v_and_b32 v99, s87, v241
  v_mfma_f32_32x32x16_bf16 v[48:63], v[16:19], v[228:231], v[48:63]
  ds_read_b64_tr_b16 v[16:17], v6 offset:49152
  ds_read_b64_tr_b16 v[18:19], v6 offset:49664
  s_waitcnt lgkmcnt(6)
  v_cvt_pk_bf16_f32 v234, v116, v117
  v_cvt_pk_bf16_f32 v235, v118, v119
  v_fma_f32 v124, v124, v2, -v3
  v_fma_f32 v125, v125, v2, -v3
  v_fma_f32 v126, v126, v2, -v3
  v_fma_f32 v127, v127, v2, -v3
  v_lshlrev_b32 v100, 16, v242
  v_and_b32 v101, s87, v242
  v_lshlrev_b32 v102, 16, v243
  v_and_b32 v103, s87, v243
  v_mfma_f32_32x32x16_bf16 v[32:47], v[20:23], v[232:235], v[32:47]
  ds_read_b64_tr_b16 v[20:21], v7 offset:49152
  ds_read_b64_tr_b16 v[22:23], v7 offset:49664
  v_cvt_pk_bf16_f32 v236, v120, v121
  v_cvt_pk_bf16_f32 v237, v122, v123
  v_fma_f32 v96, v96, v2, -v3
  v_fma_f32 v97, v97, v2, -v3
  v_fma_f32 v98, v98, v2, -v3
  v_fma_f32 v99, v99, v2, -v3
  v_lshlrev_b32 v104, 16, v244
  v_and_b32 v105, s87, v244
  v_lshlrev_b32 v106, 16, v245
  v_and_b32 v107, s87, v245
  v_mfma_f32_32x32x16_bf16 v[48:63], v[24:27], v[232:235], v[48:63]
  ds_read_b64_tr_b16 v[24:25], v6 offset:51200
  ds_read_b64_tr_b16 v[26:27], v6 offset:51712
  s_waitcnt lgkmcnt(6)
  v_cvt_pk_bf16_f32 v238, v124, v125
  v_cvt_pk_bf16_f32 v239, v126, v127
  v_fma_f32 v100, v100, v2, -v3
  v_fma_f32 v101, v101, v2, -v3
  v_fma_f32 v102, v102, v2, -v3
  v_fma_f32 v103, v103, v2, -v3
  v_lshlrev_b32 v108, 16, v246
  v_and_b32 v109, s87, v246
  v_lshlrev_b32 v110, 16, v247
  v_and_b32 v111, s87, v247
  v_mfma_f32_32x32x16_bf16 v[32:47], v[28:31], v[236:239], v[32:47]
  ds_read_b64_tr_b16 v[28:29], v7 offset:51200
  ds_read_b64_tr_b16 v[30:31], v7 offset:51712
  v_cvt_pk_bf16_f32 v240, v96, v97
  v_cvt_pk_bf16_f32 v241, v98, v99
  v_fma_f32 v104, v104, v2, -v3
  v_fma_f32 v105, v105, v2, -v3
  v_fma_f32 v106, v106, v2, -v3
  v_fma_f32 v107, v107, v2, -v3
  v_lshlrev_b32 v112, 16, v248
  v_and_b32 v113, s87, v248
  v_lshlrev_b32 v114, 16, v249
  v_and_b32 v115, s87, v249
  v_mfma_f32_32x32x16_bf16 v[48:63], v[12:15], v[236:239], v[48:63]
  ds_read_b64_tr_b16 v[12:13], v6 offset:53248
  ds_read_b64_tr_b16 v[14:15], v6 offset:53760
  s_waitcnt lgkmcnt(6)
  v_cvt_pk_bf16_f32 v242, v100, v101
  v_cvt_pk_bf16_f32 v243, v102, v103
  v_fma_f32 v108, v108, v2, -v3
  v_fma_f32 v109, v109, v2, -v3
  v_fma_f32 v110, v110, v2, -v3
  v_fma_f32 v111, v111, v2, -v3
  v_lshlrev_b32 v116, 16, v250
  v_and_b32 v117, s87, v250
  v_lshlrev_b32 v118, 16, v251
  v_and_b32 v119, s87, v251
  v_mfma_f32_32x32x16_bf16 v[32:47], v[16:19], v[240:243], v[32:47]
  ds_read_b64_tr_b16 v[16:17], v7 offset:53248
  ds_read_b64_tr_b16 v[18:19], v7 offset:53760
  v_cvt_pk_bf16_f32 v244, v104, v105
  v_cvt_pk_bf16_f32 v245, v106, v107
  v_fma_f32 v112, v112, v2, -v3
  v_fma_f32 v113, v113, v2, -v3
  v_fma_f32 v114, v114, v2, -v3
  v_fma_f32 v115, v115, v2, -v3
  v_lshlrev_b32 v120, 16, v252
  v_and_b32 v121, s87, v252
  v_lshlrev_b32 v122, 16, v253
  v_and_b32 v123, s87, v253
  v_mfma_f32_32x32x16_bf16 v[48:63], v[20:23], v[240:243], v[48:63]
  ds_read_b64_tr_b16 v[20:21], v6 offset:55296
  ds_read_b64_tr_b16 v[22:23], v6 offset:55808
  s_waitcnt lgkmcnt(6)
  v_cvt_pk_bf16_f32 v246, v108, v109
  v_cvt_pk_bf16_f32 v247, v110, v111
  v_fma_f32 v116, v116, v2, -v3
  v_fma_f32 v117, v117, v2, -v3
  v_fma_f32 v118, v118, v2, -v3
  v_fma_f32 v119, v119, v2, -v3
  v_lshlrev_b32 v124, 16, v254
  v_and_b32 v125, s87, v254
  v_lshlrev_b32 v126, 16, v255
  v_and_b32 v127, s87, v255
  v_mfma_f32_32x32x16_bf16 v[32:47], v[24:27], v[244:247], v[32:47]
  ds_read_b64_tr_b16 v[24:25], v7 offset:55296
  ds_read_b64_tr_b16 v[26:27], v7 offset:55808
  v_cvt_pk_bf16_f32 v248, v112, v113
  v_cvt_pk_bf16_f32 v249, v114, v115
  v_fma_f32 v120, v120, v2, -v3
  v_fma_f32 v121, v121, v2, -v3
  v_fma_f32 v122, v122, v2, -v3
  v_fma_f32 v123, v123, v2, -v3
  v_cvt_pk_bf16_f32 v250, v116, v117
  v_cvt_pk_bf16_f32 v251, v118, v119
  v_fma_f32 v124, v124, v2, -v3
  v_fma_f32 v125, v125, v2, -v3
  v_fma_f32 v126, v126, v2, -v3
  v_fma_f32 v127, v127, v2, -v3
  v_cvt_pk_bf16_f32 v252, v120, v121
  v_cvt_pk_bf16_f32 v253, v122, v123
  v_cvt_pk_bf16_f32 v254, v124, v125
  v_cvt_pk_bf16_f32 v255, v126, v127
  s_mov_b32 s86, 65536
  s_waitcnt vmcnt(0)
  v_readfirstlane_b32 s75, v11
L_np_3:
  s_nop 0
  s_cmp_lg_u32 s75, 0
  s_cbranch_scc1 L_nok_4
  s_sleep 1
  buffer_load_dword v11, off, s[36:39], 0 sc1
  s_waitcnt vmcnt(0)
  v_readfirstlane_b32 s75, v11
  s_sub_u32 s86, s86, 1
  s_cbranch_scc0 L_np_3
L_nok_4:
  s_nop 1
  v_mul_u32_u24 v4, 8224, v9
  v_xor_b32 v4, v4, v8
  v_xor_b32 v5, 32, v4
  v_xor_b32 v6, 64, v4
  v_xor_b32 v7, 96, v4
  v_add_u32 v10, s80, v1
  s_lshl_b32 s80, s68, 2
  s_add_u32 s80, s80, 158208
  v_mov_b32 v8, s80
  v_mov_b32 v9, 1
  v_mfma_f32_32x32x16_bf16 v[48:63], v[28:31], v[244:247], v[48:63]
  s_barrier
  ds_read_b64_tr_b16 v[28:29], v4 offset:0
  ds_read_b64_tr_b16 v[30:31], v4 offset:512
  s_waitcnt lgkmcnt(6)
  v_mfma_f32_32x32x16_bf16 v[32:47], v[12:15], v[248:251], v[32:47]
  ds_read_b64_tr_b16 v[12:13], v5 offset:0
  ds_read_b64_tr_b16 v[14:15], v5 offset:512
  v_mfma_f32_32x32x16_bf16 v[48:63], v[16:19], v[248:251], v[48:63]
  ds_read_b64_tr_b16 v[16:17], v6 offset:0
  ds_read_b64_tr_b16 v[18:19], v6 offset:512
  s_waitcnt lgkmcnt(6)
  v_mfma_f32_32x32x16_bf16 v[32:47], v[20:23], v[252:255], v[32:47]
  ds_read_b64_tr_b16 v[20:21], v7 offset:0
  ds_read_b64_tr_b16 v[22:23], v7 offset:512
  v_mfma_f32_32x32x16_bf16 v[48:63], v[24:27], v[252:255], v[48:63]
  ds_read_b64_tr_b16 v[24:25], v4 offset:2048
  ds_read_b64_tr_b16 v[26:27], v4 offset:2560
  s_waitcnt lgkmcnt(6)
  v_mfma_f32_32x32x16_bf16 v[64:79], v[28:31], v[128:131], 0
  ds_read_b64_tr_b16 v[28:29], v5 offset:2048
  ds_read_b64_tr_b16 v[30:31], v5 offset:2560
  v_mfma_f32_32x32x16_bf16 v[80:95], v[12:15], v[128:131], 0
  ds_read_b64_tr_b16 v[12:13], v6 offset:2048
  ds_read_b64_tr_b16 v[14:15], v6 offset:2560
  s_waitcnt lgkmcnt(6)
  v_cvt_pk_bf16_f32 v32, v32, v33
  v_cvt_pk_bf16_f32 v33, v34, v35
  v_cvt_pk_bf16_f32 v34, v36, v37
  v_cvt_pk_bf16_f32 v35, v38, v39
  v_mfma_f32_32x32x16_bf16 v[96:111], v[16:19], v[128:131], 0
  ds_read_b64_tr_b16 v[16:17], v7 offset:2048
  ds_read_b64_tr_b16 v[18:19], v7 offset:2560
  v_cvt_pk_bf16_f32 v36, v40, v41
  v_cvt_pk_bf16_f32 v37, v42, v43
  v_cvt_pk_bf16_f32 v38, v44, v45
  v_cvt_pk_bf16_f32 v39, v46, v47
  v_mfma_f32_32x32x16_bf16 v[112:127], v[20:23], v[128:131], 0
  ds_read_b64_tr_b16 v[20:21], v4 offset:4096
  ds_read_b64_tr_b16 v[22:23], v4 offset:4608
  s_waitcnt lgkmcnt(6)
  ds_write_b128 v10, v[32:35] offset:0
  ds_write_b128 v10, v[36:39] offset:1024
  v_cvt_pk_bf16_f32 v48, v48, v49
  v_cvt_pk_bf16_f32 v49, v50, v51
  v_mfma_f32_32x32x16_bf16 v[64:79], v[24:27], v[132:135], v[64:79]
  ds_read_b64_tr_b16 v[24:25], v5 offset:4096
  ds_read_b64_tr_b16 v[26:27], v5 offset:4608
  v_cvt_pk_bf16_f32 v50, v52, v53
  v_cvt_pk_bf16_f32 v51, v54, v55
  v_cvt_pk_bf16_f32 v52, v56, v57
  v_cvt_pk_bf16_f32 v53, v58, v59
  v_cvt_pk_bf16_f32 v54, v60, v61
  v_mfma_f32_32x32x16_bf16 v[80:95], v[28:31], v[132:135], v[80:95]
  ds_read_b64_tr_b16 v[28:29], v6 offset:4096
  ds_read_b64_tr_b16 v[30:31], v6 offset:4608
  s_waitcnt lgkmcnt(8)
  v_cvt_pk_bf16_f32 v55, v62, v63
  v_mfma_f32_32x32x16_bf16 v[96:111], v[12:15], v[132:135], v[96:111]
  ds_read_b64_tr_b16 v[12:13], v7 offset:4096
  ds_read_b64_tr_b16 v[14:15], v7 offset:4608
  ds_write_b128 v10, v[48:51] offset:2048
  ds_write_b128 v10, v[52:55] offset:3072
  v_mfma_f32_32x32x16_bf16 v[112:127], v[16:19], v[132:135], v[112:127]
  ds_read_b64_tr_b16 v[16:17], v4 offset:6144
  ds_read_b64_tr_b16 v[18:19], v4 offset:6656
  s_waitcnt lgkmcnt(8)
  v_mfma_f32_32x32x16_bf16 v[64:79], v[20:23], v[136:139], v[64:79]
  ds_read_b64_tr_b16 v[20:21], v5 offset:6144
  ds_read_b64_tr_b16 v[22:23], v5 offset:6656
  v_mfma_f32_32x32x16_bf16 v[80:95], v[24:27], v[136:139], v[80:95]
  ds_read_b64_tr_b16 v[24:25], v6 offset:6144
  ds_read_b64_tr_b16 v[26:27], v6 offset:6656
  s_waitcnt lgkmcnt(8)
  v_mfma_f32_32x32x16_bf16 v[96:111], v[28:31], v[136:139], v[96:111]
  ds_read_b64_tr_b16 v[28:29], v7 offset:6144
  ds_read_b64_tr_b16 v[30:31], v7 offset:6656
  v_mfma_f32_32x32x16_bf16 v[112:127], v[12:15], v[136:139], v[112:127]
  s_barrier
  ds_read_b64_tr_b16 v[12:13], v4 offset:16384
  ds_read_b64_tr_b16 v[14:15], v4 offset:16896
  s_waitcnt lgkmcnt(6)
  v_mfma_f32_32x32x16_bf16 v[64:79], v[16:19], v[140:143], v[64:79]
  ds_read_b64_tr_b16 v[16:17], v5 offset:16384
  ds_read_b64_tr_b16 v[18:19], v5 offset:16896
  v_mfma_f32_32x32x16_bf16 v[80:95], v[20:23], v[140:143], v[80:95]
  ds_read_b64_tr_b16 v[20:21], v6 offset:16384
  ds_read_b64_tr_b16 v[22:23], v6 offset:16896
  s_waitcnt lgkmcnt(6)
  v_mfma_f32_32x32x16_bf16 v[96:111], v[24:27], v[140:143], v[96:111]
  ds_read_b64_tr_b16 v[24:25], v7 offset:16384
  ds_read_b64_tr_b16 v[26:27], v7 offset:16896
  v_mfma_f32_32x32x16_bf16 v[112:127], v[28:31], v[140:143], v[112:127]
  ds_read_b64_tr_b16 v[28:29], v4 offset:18432
  ds_read_b64_tr_b16 v[30:31], v4 offset:18944
  s_waitcnt lgkmcnt(6)
  v_mfma_f32_32x32x16_bf16 v[64:79], v[12:15], v[144:147], v[64:79]
  ds_read_b64_tr_b16 v[12:13], v5 offset:18432
  ds_read_b64_tr_b16 v[14:15], v5 offset:18944
  v_mfma_f32_32x32x16_bf16 v[80:95], v[16:19], v[144:147], v[80:95]
  ds_read_b64_tr_b16 v[16:17], v6 offset:18432
  ds_read_b64_tr_b16 v[18:19], v6 offset:18944
  s_waitcnt lgkmcnt(6)
  v_mfma_f32_32x32x16_bf16 v[96:111], v[20:23], v[144:147], v[96:111]
  ds_read_b64_tr_b16 v[20:21], v7 offset:18432
  ds_read_b64_tr_b16 v[22:23], v7 offset:18944
  v_mfma_f32_32x32x16_bf16 v[112:127], v[24:27], v[144:147], v[112:127]
  ds_read_b64_tr_b16 v[24:25], v4 offset:20480
  ds_read_b64_tr_b16 v[26:27], v4 offset:20992
  s_waitcnt lgkmcnt(6)
  v_mfma_f32_32x32x16_bf16 v[64:79], v[28:31], v[148:151], v[64:79]
  ds_read_b64_tr_b16 v[28:29], v5 offset:20480
  ds_read_b64_tr_b16 v[30:31], v5 offset:20992
  v_mfma_f32_32x32x16_bf16 v[80:95], v[12:15], v[148:151], v[80:95]
  ds_read_b64_tr_b16 v[12:13], v6 offset:20480
  ds_read_b64_tr_b16 v[14:15], v6 offset:20992
  s_waitcnt lgkmcnt(6)
  v_mfma_f32_32x32x16_bf16 v[96:111], v[16:19], v[148:151], v[96:111]
  ds_read_b64_tr_b16 v[16:17], v7 offset:20480
  ds_read_b64_tr_b16 v[18:19], v7 offset:20992
  v_mfma_f32_32x32x16_bf16 v[112:127], v[20:23], v[148:151], v[112:127]
  ds_read_b64_tr_b16 v[20:21], v4 offset:22528
  ds_read_b64_tr_b16 v[22:23], v4 offset:23040
  s_waitcnt lgkmcnt(6)
  v_mfma_f32_32x32x16_bf16 v[64:79], v[24:27], v[152:155], v[64:79]
  ds_read_b64_tr_b16 v[24:25], v5 offset:22528
  ds_read_b64_tr_b16 v[26:27], v5 offset:23040
  v_mfma_f32_32x32x16_bf16 v[80:95], v[28:31], v[152:155], v[80:95]
  ds_read_b64_tr_b16 v[28:29], v6 offset:22528
  ds_read_b64_tr_b16 v[30:31], v6 offset:23040
  s_waitcnt lgkmcnt(6)
  v_mfma_f32_32x32x16_bf16 v[96:111], v[12:15], v[152:155], v[96:111]
  ds_read_b64_tr_b16 v[12:13], v7 offset:22528
  ds_read_b64_tr_b16 v[14:15], v7 offset:23040
  s_mul_i32 s76, s75, 0x9e3779b1
  s_lshr_b32 s81, s76, 15
  s_xor_b32 s76, s76, s81
  s_and_b32 s76, s76, 0xfffdfffd
  s_or_b32 s76, s76, 0x00010001
  v_mfma_f32_32x32x16_bf16 v[112:127], v[16:19], v[152:155], v[112:127]
  s_barrier
  ds_read_b64_tr_b16 v[16:17], v4 offset:32768
  ds_read_b64_tr_b16 v[18:19], v4 offset:33280
  s_waitcnt lgkmcnt(6)
  s_mov_b32 s89, 0x00010001
  v_and_b32 v2, 7, v0
  v_mfma_f32_32x32x16_bf16 v[64:79], v[20:23], v[156:159], v[64:79]
  ds_read_b64_tr_b16 v[20:21], v5 offset:32768
  ds_read_b64_tr_b16 v[22:23], v5 offset:33280
  v_lshlrev_b32 v2, 2, v2
  v_bfe_u32 v2, s76, v2, 4
  v_lshl_or_b32 v2, v2, 15, v2
  v_lshrrev_b32 v3, 2, v2
  v_mfma_f32_32x32x16_bf16 v[80:95], v[24:27], v[156:159], v[80:95]
  ds_read_b64_tr_b16 v[24:25], v6 offset:32768
  ds_read_b64_tr_b16 v[26:27], v6 offset:33280
  s_waitcnt lgkmcnt(6)
  v_mfma_f32_32x32x16_bf16 v[96:111], v[28:31], v[156:159], v[96:111]
  ds_read_b64_tr_b16 v[28:29], v7 offset:32768
  ds_read_b64_tr_b16 v[30:31], v7 offset:33280
  v_mfma_f32_32x32x16_bf16 v[112:127], v[12:15], v[156:159], v[112:127]
  ds_read_b64_tr_b16 v[12:13], v4 offset:34816
  ds_read_b64_tr_b16 v[14:15], v4 offset:35328
  s_waitcnt lgkmcnt(6)
  v_mfma_f32_32x32x16_bf16 v[64:79], v[16:19], v[160:163], v[64:79]
  ds_read_b64_tr_b16 v[16:17], v5 offset:34816
  ds_read_b64_tr_b16 v[18:19], v5 offset:35328
  v_mfma_f32_32x32x16_bf16 v[80:95], v[20:23], v[160:163], v[80:95]
  ds_read_b64_tr_b16 v[20:21], v6 offset:34816
  ds_read_b64_tr_b16 v[22:23], v6 offset:35328
  s_waitcnt lgkmcnt(6)
  v_mfma_f32_32x32x16_bf16 v[96:111], v[24:27], v[160:163], v[96:111]
  ds_read_b64_tr_b16 v[24:25], v7 offset:34816
  ds_read_b64_tr_b16 v[26:27], v7 offset:35328
  v_mfma_f32_32x32x16_bf16 v[112:127], v[28:31], v[160:163], v[112:127]
  ds_read_b64_tr_b16 v[28:29], v4 offset:36864
  ds_read_b64_tr_b16 v[30:31], v4 offset:37376
  s_waitcnt lgkmcnt(6)
  v_mfma_f32_32x32x16_bf16 v[64:79], v[12:15], v[164:167], v[64:79]
  ds_read_b64_tr_b16 v[12:13], v5 offset:36864
  ds_read_b64_tr_b16 v[14:15], v5 offset:37376
  v_mfma_f32_32x32x16_bf16 v[80:95], v[16:19], v[164:167], v[80:95]
  ds_read_b64_tr_b16 v[16:17], v6 offset:36864
  ds_read_b64_tr_b16 v[18:19], v6 offset:37376
  s_waitcnt lgkmcnt(6)
  v_mfma_f32_32x32x16_bf16 v[96:111], v[20:23], v[164:167], v[96:111]
  ds_read_b64_tr_b16 v[20:21], v7 offset:36864
  ds_read_b64_tr_b16 v[22:23], v7 offset:37376
  v_mfma_f32_32x32x16_bf16 v[112:127], v[24:27], v[164:167], v[112:127]
  ds_read_b64_tr_b16 v[24:25], v4 offset:38912
  ds_read_b64_tr_b16 v[26:27], v4 offset:39424
  s_waitcnt lgkmcnt(6)
  v_mfma_f32_32x32x16_bf16 v[64:79], v[28:31], v[168:171], v[64:79]
  ds_read_b64_tr_b16 v[28:29], v5 offset:38912
  ds_read_b64_tr_b16 v[30:31], v5 offset:39424
  v_mfma_f32_32x32x16_bf16 v[80:95], v[12:15], v[168:171], v[80:95]
  ds_read_b64_tr_b16 v[12:13], v6 offset:38912
  ds_read_b64_tr_b16 v[14:15], v6 offset:39424
  s_waitcnt lgkmcnt(6)
  v_mfma_f32_32x32x16_bf16 v[96:111], v[16:19], v[168:171], v[96:111]
  ds_read_b64_tr_b16 v[16:17], v7 offset:38912
  ds_read_b64_tr_b16 v[18:19], v7 offset:39424
  v_mfma_f32_32x32x16_bf16 v[112:127], v[20:23], v[168:171], v[112:127]
  s_barrier
  ds_read_b64_tr_b16 v[20:21], v4 offset:49152
  ds_read_b64_tr_b16 v[22:23], v4 offset:49664
  s_waitcnt lgkmcnt(6)
  v_mfma_f32_32x32x16_bf16 v[64:79], v[24:27], v[172:175], v[64:79]
  ds_read_b64_tr_b16 v[24:25], v5 offset:49152
  ds_read_b64_tr_b16 v[26:27], v5 offset:49664
  v_mfma_f32_32x32x16_bf16 v[80:95], v[28:31], v[172:175], v[80:95]
  ds_read_b64_tr_b16 v[28:29], v6 offset:49152
  ds_read_b64_tr_b16 v[30:31], v6 offset:49664
  s_waitcnt lgkmcnt(6)
  v_mfma_f32_32x32x16_bf16 v[96:111], v[12:15], v[172:175], v[96:111]
  ds_read_b64_tr_b16 v[12:13], v7 offset:49152
  ds_read_b64_tr_b16 v[14:15], v7 offset:49664
  v_mfma_f32_32x32x16_bf16 v[112:127], v[16:19], v[172:175], v[112:127]
  ds_read_b64_tr_b16 v[16:17], v4 offset:51200
  ds_read_b64_tr_b16 v[18:19], v4 offset:51712
  s_waitcnt lgkmcnt(6)
  v_mfma_f32_32x32x16_bf16 v[64:79], v[20:23], v[176:179], v[64:79]
  ds_read_b64_tr_b16 v[20:21], v5 offset:51200
  ds_read_b64_tr_b16 v[22:23], v5 offset:51712
  v_mfma_f32_32x32x16_bf16 v[80:95], v[24:27], v[176:179], v[80:95]
  ds_read_b64_tr_b16 v[24:25], v6 offset:51200
  ds_read_b64_tr_b16 v[26:27], v6 offset:51712
  s_waitcnt lgkmcnt(6)
  v_mfma_f32_32x32x16_bf16 v[96:111], v[28:31], v[176:179], v[96:111]
  ds_read_b64_tr_b16 v[28:29], v7 offset:51200
  ds_read_b64_tr_b16 v[30:31], v7 offset:51712
  v_mfma_f32_32x32x16_bf16 v[112:127], v[12:15], v[176:179], v[112:127]
  ds_read_b64_tr_b16 v[12:13], v4 offset:53248
  ds_read_b64_tr_b16 v[14:15], v4 offset:53760
  s_waitcnt lgkmcnt(6)
  v_mfma_f32_32x32x16_bf16 v[64:79], v[16:19], v[180:183], v[64:79]
  ds_read_b64_tr_b16 v[16:17], v5 offset:53248
  ds_read_b64_tr_b16 v[18:19], v5 offset:53760
  v_mfma_f32_32x32x16_bf16 v[80:95], v[20:23], v[180:183], v[80:95]
  ds_read_b64_tr_b16 v[20:21], v6 offset:53248
  ds_read_b64_tr_b16 v[22:23], v6 offset:53760
  s_waitcnt lgkmcnt(6)
  v_mfma_f32_32x32x16_bf16 v[96:111], v[24:27], v[180:183], v[96:111]
  ds_read_b64_tr_b16 v[24:25], v7 offset:53248
  ds_read_b64_tr_b16 v[26:27], v7 offset:53760
  v_mfma_f32_32x32x16_bf16 v[112:127], v[28:31], v[180:183], v[112:127]
  ds_read_b64_tr_b16 v[28:29], v4 offset:55296
  ds_read_b64_tr_b16 v[30:31], v4 offset:55808
  s_waitcnt lgkmcnt(6)
  v_mfma_f32_32x32x16_bf16 v[64:79], v[12:15], v[184:187], v[64:79]
  ds_read_b64_tr_b16 v[12:13], v5 offset:55296
  ds_read_b64_tr_b16 v[14:15], v5 offset:55808
  v_mfma_f32_32x32x16_bf16 v[80:95], v[16:19], v[184:187], v[80:95]
  ds_read_b64_tr_b16 v[16:17], v6 offset:55296
  ds_read_b64_tr_b16 v[18:19], v6 offset:55808
  s_waitcnt lgkmcnt(6)
  v_mfma_f32_32x32x16_bf16 v[96:111], v[20:23], v[184:187], v[96:111]
  ds_read_b64_tr_b16 v[20:21], v7 offset:55296
  ds_read_b64_tr_b16 v[22:23], v7 offset:55808
  v_mfma_f32_32x32x16_bf16 v[112:127], v[24:27], v[184:187], v[112:127]
  s_barrier
  ds_read_b64_tr_b16 v[24:25], v4 offset:0
  ds_read_b64_tr_b16 v[26:27], v4 offset:512
  s_waitcnt lgkmcnt(6)
  v_mfma_f32_32x32x16_bf16 v[64:79], v[28:31], v[188:191], v[64:79]
  ds_read_b64_tr_b16 v[28:29], v5 offset:0
  ds_read_b64_tr_b16 v[30:31], v5 offset:512
  v_mfma_f32_32x32x16_bf16 v[80:95], v[12:15], v[188:191], v[80:95]
  ds_read_b64_tr_b16 v[12:13], v6 offset:0
  ds_read_b64_tr_b16 v[14:15], v6 offset:512
  s_waitcnt lgkmcnt(6)
  v_mfma_f32_32x32x16_bf16 v[96:111], v[16:19], v[188:191], v[96:111]
  ds_read_b64_tr_b16 v[16:17], v7 offset:0
  ds_read_b64_tr_b16 v[18:19], v7 offset:512
  v_mfma_f32_32x32x16_bf16 v[112:127], v[20:23], v[188:191], v[112:127]
  ds_read_b64_tr_b16 v[20:21], v4 offset:2048
  ds_read_b64_tr_b16 v[22:23], v4 offset:2560
  s_waitcnt lgkmcnt(6)
  v_mfma_f32_32x32x16_bf16 v[64:79], v[24:27], v[192:195], v[64:79]
  ds_read_b64_tr_b16 v[24:25], v5 offset:2048
  ds_read_b64_tr_b16 v[26:27], v5 offset:2560
  v_mfma_f32_32x32x16_bf16 v[80:95], v[28:31], v[192:195], v[80:95]
  ds_read_b64_tr_b16 v[28:29], v6 offset:2048
  ds_read_b64_tr_b16 v[30:31], v6 offset:2560
  s_waitcnt lgkmcnt(6)
  v_mfma_f32_32x32x16_bf16 v[96:111], v[12:15], v[192:195], v[96:111]
  ds_read_b64_tr_b16 v[12:13], v7 offset:2048
  ds_read_b64_tr_b16 v[14:15], v7 offset:2560
  v_mfma_f32_32x32x16_bf16 v[112:127], v[16:19], v[192:195], v[112:127]
  ds_read_b64_tr_b16 v[16:17], v4 offset:4096
  ds_read_b64_tr_b16 v[18:19], v4 offset:4608
  s_waitcnt lgkmcnt(6)
  v_mfma_f32_32x32x16_bf16 v[64:79], v[20:23], v[196:199], v[64:79]
  ds_read_b64_tr_b16 v[20:21], v5 offset:4096
  ds_read_b64_tr_b16 v[22:23], v5 offset:4608
  v_mfma_f32_32x32x16_bf16 v[80:95], v[24:27], v[196:199], v[80:95]
  ds_read_b64_tr_b16 v[24:25], v6 offset:4096
  ds_read_b64_tr_b16 v[26:27], v6 offset:4608
  s_waitcnt lgkmcnt(6)
  v_mfma_f32_32x32x16_bf16 v[96:111], v[28:31], v[196:199], v[96:111]
  ds_read_b64_tr_b16 v[28:29], v7 offset:4096
  ds_read_b64_tr_b16 v[30:31], v7 offset:4608
  v_mfma_f32_32x32x16_bf16 v[112:127], v[12:15], v[196:199], v[112:127]
  ds_read_b64_tr_b16 v[12:13], v4 offset:6144
  ds_read_b64_tr_b16 v[14:15], v4 offset:6656
  s_waitcnt lgkmcnt(6)
  v_mfma_f32_32x32x16_bf16 v[64:79], v[16:19], v[200:203], v[64:79]
  ds_read_b64_tr_b16 v[16:17], v5 offset:6144
  ds_read_b64_tr_b16 v[18:19], v5 offset:6656
  v_mfma_f32_32x32x16_bf16 v[80:95], v[20:23], v[200:203], v[80:95]
  ds_read_b64_tr_b16 v[20:21], v6 offset:6144
  ds_read_b64_tr_b16 v[22:23], v6 offset:6656
  s_waitcnt lgkmcnt(6)
  v_mfma_f32_32x32x16_bf16 v[96:111], v[24:27], v[200:203], v[96:111]
  ds_read_b64_tr_b16 v[24:25], v7 offset:6144
  ds_read_b64_tr_b16 v[26:27], v7 offset:6656
  v_mfma_f32_32x32x16_bf16 v[112:127], v[28:31], v[200:203], v[112:127]
  s_barrier
  ds_read_b64_tr_b16 v[28:29], v4 offset:16384
  ds_read_b64_tr_b16 v[30:31], v4 offset:16896
  s_waitcnt lgkmcnt(6)
  v_mfma_f32_32x32x16_bf16 v[64:79], v[12:15], v[204:207], v[64:79]
  ds_read_b64_tr_b16 v[12:13], v5 offset:16384
  ds_read_b64_tr_b16 v[14:15], v5 offset:16896
  v_mfma_f32_32x32x16_bf16 v[80:95], v[16:19], v[204:207], v[80:95]
  ds_read_b64_tr_b16 v[16:17], v6 offset:16384
  ds_read_b64_tr_b16 v[18:19], v6 offset:16896
  s_waitcnt lgkmcnt(6)
  v_mfma_f32_32x32x16_bf16 v[96:111], v[20:23], v[204:207], v[96:111]
  ds_read_b64_tr_b16 v[20:21], v7 offset:16384
  ds_read_b64_tr_b16 v[22:23], v7 offset:16896
  v_mfma_f32_32x32x16_bf16 v[112:127], v[24:27], v[204:207], v[112:127]
  ds_read_b64_tr_b16 v[24:25], v4 offset:18432
  ds_read_b64_tr_b16 v[26:27], v4 offset:18944
  s_waitcnt lgkmcnt(6)
  v_mfma_f32_32x32x16_bf16 v[64:79], v[28:31], v[208:211], v[64:79]
  ds_read_b64_tr_b16 v[28:29], v5 offset:18432
  ds_read_b64_tr_b16 v[30:31], v5 offset:18944
  v_mfma_f32_32x32x16_bf16 v[80:95], v[12:15], v[208:211], v[80:95]
  ds_read_b64_tr_b16 v[12:13], v6 offset:18432
  ds_read_b64_tr_b16 v[14:15], v6 offset:18944
  s_waitcnt lgkmcnt(6)
  v_mfma_f32_32x32x16_bf16 v[96:111], v[16:19], v[208:211], v[96:111]
  ds_read_b64_tr_b16 v[16:17], v7 offset:18432
  ds_read_b64_tr_b16 v[18:19], v7 offset:18944
  v_mfma_f32_32x32x16_bf16 v[112:127], v[20:23], v[208:211], v[112:127]
  ds_read_b64_tr_b16 v[20:21], v4 offset:20480
  ds_read_b64_tr_b16 v[22:23], v4 offset:20992
  s_waitcnt lgkmcnt(6)
  v_mfma_f32_32x32x16_bf16 v[64:79], v[24:27], v[212:215], v[64:79]
  ds_read_b64_tr_b16 v[24:25], v5 offset:20480
  ds_read_b64_tr_b16 v[26:27], v5 offset:20992
  v_mfma_f32_32x32x16_bf16 v[80:95], v[28:31], v[212:215], v[80:95]
  ds_read_b64_tr_b16 v[28:29], v6 offset:20480
  ds_read_b64_tr_b16 v[30:31], v6 offset:20992
  s_waitcnt lgkmcnt(6)
  v_mfma_f32_32x32x16_bf16 v[96:111], v[12:15], v[212:215], v[96:111]
  ds_read_b64_tr_b16 v[12:13], v7 offset:20480
  ds_read_b64_tr_b16 v[14:15], v7 offset:20992
  v_mfma_f32_32x32x16_bf16 v[112:127], v[16:19], v[212:215], v[112:127]
  ds_read_b64_tr_b16 v[16:17], v4 offset:22528
  ds_read_b64_tr_b16 v[18:19], v4 offset:23040
  s_waitcnt lgkmcnt(6)
  v_mfma_f32_32x32x16_bf16 v[64:79], v[20:23], v[216:219], v[64:79]
  ds_read_b64_tr_b16 v[20:21], v5 offset:22528
  ds_read_b64_tr_b16 v[22:23], v5 offset:23040
  v_mfma_f32_32x32x16_bf16 v[80:95], v[24:27], v[216:219], v[80:95]
  ds_read_b64_tr_b16 v[24:25], v6 offset:22528
  ds_read_b64_tr_b16 v[26:27], v6 offset:23040
  s_waitcnt lgkmcnt(6)
  v_mfma_f32_32x32x16_bf16 v[96:111], v[28:31], v[216:219], v[96:111]
  ds_read_b64_tr_b16 v[28:29], v7 offset:22528
  ds_read_b64_tr_b16 v[30:31], v7 offset:23040
  v_mfma_f32_32x32x16_bf16 v[112:127], v[12:15], v[216:219], v[112:127]
  s_barrier
  ds_read_b64_tr_b16 v[12:13], v4 offset:32768
  ds_read_b64_tr_b16 v[14:15], v4 offset:33280
  s_waitcnt lgkmcnt(6)
  v_mfma_f32_32x32x16_bf16 v[64:79], v[16:19], v[220:223], v[64:79]
  ds_read_b64_tr_b16 v[16:17], v5 offset:32768
  ds_read_b64_tr_b16 v[18:19], v5 offset:33280
  v_mfma_f32_32x32x16_bf16 v[80:95], v[20:23], v[220:223], v[80:95]
  ds_read_b64_tr_b16 v[20:21], v6 offset:32768
  ds_read_b64_tr_b16 v[22:23], v6 offset:33280
  s_waitcnt lgkmcnt(6)
  v_mfma_f32_32x32x16_bf16 v[96:111], v[24:27], v[220:223], v[96:111]
  ds_read_b64_tr_b16 v[24:25], v7 offset:32768
  ds_read_b64_tr_b16 v[26:27], v7 offset:33280
  v_mfma_f32_32x32x16_bf16 v[112:127], v[28:31], v[220:223], v[112:127]
  ds_read_b64_tr_b16 v[28:29], v4 offset:34816
  ds_read_b64_tr_b16 v[30:31], v4 offset:35328
  s_waitcnt lgkmcnt(6)
  v_mfma_f32_32x32x16_bf16 v[64:79], v[12:15], v[224:227], v[64:79]
  ds_read_b64_tr_b16 v[12:13], v5 offset:34816
  ds_read_b64_tr_b16 v[14:15], v5 offset:35328
  v_mfma_f32_32x32x16_bf16 v[80:95], v[16:19], v[224:227], v[80:95]
  ds_read_b64_tr_b16 v[16:17], v6 offset:34816
  ds_read_b64_tr_b16 v[18:19], v6 offset:35328
  s_waitcnt lgkmcnt(6)
  v_mfma_f32_32x32x16_bf16 v[96:111], v[20:23], v[224:227], v[96:111]
  ds_read_b64_tr_b16 v[20:21], v7 offset:34816
  ds_read_b64_tr_b16 v[22:23], v7 offset:35328
  v_mfma_f32_32x32x16_bf16 v[112:127], v[24:27], v[224:227], v[112:127]
  ds_read_b64_tr_b16 v[24:25], v4 offset:36864
  ds_read_b64_tr_b16 v[26:27], v4 offset:37376
  s_waitcnt lgkmcnt(6)
  v_mfma_f32_32x32x16_bf16 v[64:79], v[28:31], v[228:231], v[64:79]
  ds_read_b64_tr_b16 v[28:29], v5 offset:36864
  ds_read_b64_tr_b16 v[30:31], v5 offset:37376
  v_mfma_f32_32x32x16_bf16 v[80:95], v[12:15], v[228:231], v[80:95]
  ds_read_b64_tr_b16 v[12:13], v6 offset:36864
  ds_read_b64_tr_b16 v[14:15], v6 offset:37376
  s_waitcnt lgkmcnt(6)
  v_mfma_f32_32x32x16_bf16 v[96:111], v[16:19], v[228:231], v[96:111]
  ds_read_b64_tr_b16 v[16:17], v7 offset:36864
  ds_read_b64_tr_b16 v[18:19], v7 offset:37376
  v_mfma_f32_32x32x16_bf16 v[112:127], v[20:23], v[228:231], v[112:127]
  ds_read_b64_tr_b16 v[20:21], v4 offset:38912
  ds_read_b64_tr_b16 v[22:23], v4 offset:39424
  s_waitcnt lgkmcnt(6)
  v_mfma_f32_32x32x16_bf16 v[64:79], v[24:27], v[232:235], v[64:79]
  ds_read_b64_tr_b16 v[24:25], v5 offset:38912
  ds_read_b64_tr_b16 v[26:27], v5 offset:39424
  v_mfma_f32_32x32x16_bf16 v[80:95], v[28:31], v[232:235], v[80:95]
  ds_read_b64_tr_b16 v[28:29], v6 offset:38912
  ds_read_b64_tr_b16 v[30:31], v6 offset:39424
  s_waitcnt lgkmcnt(6)
  v_mfma_f32_32x32x16_bf16 v[96:111], v[12:15], v[232:235], v[96:111]
  ds_read_b64_tr_b16 v[12:13], v7 offset:38912
  ds_read_b64_tr_b16 v[14:15], v7 offset:39424
  v_mfma_f32_32x32x16_bf16 v[112:127], v[16:19], v[232:235], v[112:127]
  s_barrier
  ds_read_b64_tr_b16 v[16:17], v4 offset:49152
  ds_read_b64_tr_b16 v[18:19], v4 offset:49664
  s_waitcnt lgkmcnt(6)
  v_mfma_f32_32x32x16_bf16 v[64:79], v[20:23], v[236:239], v[64:79]
  ds_read_b64_tr_b16 v[20:21], v4 offset:51200
  ds_read_b64_tr_b16 v[22:23], v4 offset:51712
  v_mfma_f32_32x32x16_bf16 v[80:95], v[24:27], v[236:239], v[80:95]
  ds_read_b64_tr_b16 v[24:25], v4 offset:53248
  ds_read_b64_tr_b16 v[26:27], v4 offset:53760
  s_waitcnt lgkmcnt(6)
  v_mfma_f32_32x32x16_bf16 v[96:111], v[28:31], v[236:239], v[96:111]
  ds_read_b64_tr_b16 v[28:29], v4 offset:55296
  ds_read_b64_tr_b16 v[30:31], v4 offset:55808
  v_mfma_f32_32x32x16_bf16 v[112:127], v[12:15], v[236:239], v[112:127]
  ds_read_b64_tr_b16 v[12:13], v5 offset:49152
  ds_read_b64_tr_b16 v[14:15], v5 offset:49664
  s_waitcnt lgkmcnt(6)
  v_mfma_f32_32x32x16_bf16 v[64:79], v[16:19], v[240:243], v[64:79]
  ds_read_b64_tr_b16 v[16:17], v5 offset:51200
  ds_read_b64_tr_b16 v[18:19], v5 offset:51712
  v_mfma_f32_32x32x16_bf16 v[64:79], v[20:23], v[244:247], v[64:79]
  ds_read_b64_tr_b16 v[20:21], v5 offset:53248
  ds_read_b64_tr_b16 v[22:23], v5 offset:53760
  s_waitcnt lgkmcnt(6)
  v_mfma_f32_32x32x16_bf16 v[64:79], v[24:27], v[248:251], v[64:79]
  ds_read_b64_tr_b16 v[24:25], v5 offset:55296
  ds_read_b64_tr_b16 v[26:27], v5 offset:55808
  v_mfma_f32_32x32x16_bf16 v[64:79], v[28:31], v[252:255], v[64:79]
  ds_read_b64_tr_b16 v[28:29], v6 offset:49152
  ds_read_b64_tr_b16 v[30:31], v6 offset:49664
  s_waitcnt lgkmcnt(6)
  v_mfma_f32_32x32x16_bf16 v[80:95], v[12:15], v[240:243], v[80:95]
  ds_read_b64_tr_b16 v[12:13], v6 offset:51200
  ds_read_b64_tr_b16 v[14:15], v6 offset:51712
  v_mfma_f32_32x32x16_bf16 v[80:95], v[16:19], v[244:247], v[80:95]
  ds_read_b64_tr_b16 v[16:17], v6 offset:53248
  ds_read_b64_tr_b16 v[18:19], v6 offset:53760
  s_waitcnt lgkmcnt(6)
  s_nop 1
  v_mul_f32 v64, s3, v64
  v_mul_f32 v65, s3, v65
  v_mul_f32 v66, s3, v66
  v_mul_f32 v67, s3, v67
  v_mul_f32 v68, s3, v68
  v_mfma_f32_32x32x16_bf16 v[80:95], v[20:23], v[248:251], v[80:95]
  ds_read_b64_tr_b16 v[20:21], v6 offset:55296
  ds_read_b64_tr_b16 v[22:23], v6 offset:55808
  v_mul_f32 v69, s3, v69
  v_mul_f32 v70, s3, v70
  v_mul_f32 v71, s3, v71
  v_exp_f32 v64, v64
  v_mfma_f32_32x32x16_bf16 v[80:95], v[24:27], v[252:255], v[80:95]
  ds_read_b64_tr_b16 v[24:25], v7 offset:49152
  ds_read_b64_tr_b16 v[26:27], v7 offset:49664
  s_waitcnt lgkmcnt(6)
  v_exp_f32 v65, v65
  v_exp_f32 v66, v66
  v_mfma_f32_32x32x16_bf16 v[96:111], v[28:31], v[240:243], v[96:111]
  ds_read_b64_tr_b16 v[28:29], v7 offset:51200
  ds_read_b64_tr_b16 v[30:31], v7 offset:51712
  v_exp_f32 v67, v67
  v_exp_f32 v68, v68
  v_mfma_f32_32x32x16_bf16 v[96:111], v[12:15], v[244:247], v[96:111]
  ds_read_b64_tr_b16 v[12:13], v7 offset:53248
  ds_read_b64_tr_b16 v[14:15], v7 offset:53760
  s_waitcnt lgkmcnt(6)
  v_exp_f32 v69, v69
  v_exp_f32 v70, v70
  v_mfma_f32_32x32x16_bf16 v[96:111], v[16:19], v[248:251], v[96:111]
  ds_read_b64_tr_b16 v[16:17], v7 offset:55296
  ds_read_b64_tr_b16 v[18:19], v7 offset:55808
  v_exp_f32 v71, v71
  v_add_f32 v64, 1.0, v64
  v_add_f32 v65, 1.0, v65
  v_add_f32 v66, 1.0, v66
  v_mfma_f32_32x32x16_bf16 v[96:111], v[20:23], v[252:255], v[96:111]
  s_barrier
  ds_read_b64_tr_b16 v[20:21], v4 offset:0
  ds_read_b64_tr_b16 v[22:23], v4 offset:512
  s_waitcnt lgkmcnt(6)
  v_add_f32 v67, 1.0, v67
  v_add_f32 v68, 1.0, v68
  v_add_f32 v69, 1.0, v69
  v_add_f32 v70, 1.0, v70
  v_mfma_f32_32x32x16_bf16 v[112:127], v[24:27], v[240:243], v[112:127]
  ds_read_b64_tr_b16 v[24:25], v4 offset:2048
  ds_read_b64_tr_b16 v[26:27], v4 offset:2560
  v_add_f32 v71, 1.0, v71
  v_rcp_f32 v64, v64
  v_rcp_f32 v65, v65
  v_mfma_f32_32x32x16_bf16 v[112:127], v[28:31], v[244:247], v[112:127]
  ds_read_b64_tr_b16 v[28:29], v4 offset:4096
  ds_read_b64_tr_b16 v[30:31], v4 offset:4608
  s_waitcnt lgkmcnt(6)
  v_rcp_f32 v66, v66
  v_rcp_f32 v67, v67
  v_mfma_f32_32x32x16_bf16 v[112:127], v[12:15], v[248:251], v[112:127]
  ds_read_b64_tr_b16 v[12:13], v4 offset:6144
  ds_read_b64_tr_b16 v[14:15], v4 offset:6656
  v_rcp_f32 v68, v68
  v_rcp_f32 v69, v69
  v_mfma_f32_32x32x16_bf16 v[112:127], v[16:19], v[252:255], v[112:127]
  ds_read_b64_tr_b16 v[16:17], v5 offset:0
  ds_read_b64_tr_b16 v[18:19], v5 offset:512
  s_waitcnt lgkmcnt(6)
  v_rcp_f32 v70, v70
  v_rcp_f32 v71, v71
  v_mfma_f32_32x32x16_bf16 v[32:47], v[20:23], v[128:131], 0
  ds_read_b64_tr_b16 v[20:21], v5 offset:2048
  ds_read_b64_tr_b16 v[22:23], v5 offset:2560
  v_mul_f32 v72, v72, v64
  v_mul_f32 v73, v73, v65
  v_mul_f32 v74, v74, v66
  v_mul_f32 v75, v75, v67
  v_mul_f32 v76, v76, v68
  v_mfma_f32_32x32x16_bf16 v[32:47], v[24:27], v[132:135], v[32:47]
  ds_read_b64_tr_b16 v[24:25], v5 offset:4096
  ds_read_b64_tr_b16 v[26:27], v5 offset:4608
  s_waitcnt lgkmcnt(6)
  v_mul_f32 v77, v77, v69
  v_mul_f32 v78, v78, v70
  v_mul_f32 v79, v79, v71
  v_cvt_pk_bf16_f32 v64, v72, v73
  v_mfma_f32_32x32x16_bf16 v[32:47], v[28:31], v[136:139], v[32:47]
  ds_read_b64_tr_b16 v[28:29], v5 offset:6144
  ds_read_b64_tr_b16 v[30:31], v5 offset:6656
  v_cvt_pk_bf16_f32 v65, v74, v75
  v_cvt_pk_bf16_f32 v66, v76, v77
  v_cvt_pk_bf16_f32 v67, v78, v79
  v_bfi_b32 v64, s89, v2, v64
  v_bfi_b32 v66, s89, v3, v66
  v_mfma_f32_32x32x16_bf16 v[32:47], v[12:15], v[140:143], v[32:47]
  s_barrier
  ds_read_b64_tr_b16 v[12:13], v4 offset:16384
  ds_read_b64_tr_b16 v[14:15], v4 offset:16896
  s_waitcnt lgkmcnt(6)
  buffer_store_dwordx4 v[64:67], v1, s[32:35], s77 offen offset:0 sc1
  v_mul_f32 v80, s3, v80
  v_mul_f32 v81, s3, v81
  v_mul_f32 v82, s3, v82
  v_mfma_f32_32x32x16_bf16 v[48:63], v[16:19], v[128:131], 0
  ds_read_b64_tr_b16 v[16:17], v4 offset:18432
  ds_read_b64_tr_b16 v[18:19], v4 offset:18944
  v_mul_f32 v83, s3, v83
  v_mul_f32 v84, s3, v84
  v_mul_f32 v85, s3, v85
  v_mul_f32 v86, s3, v86
  v_mul_f32 v87, s3, v87
  v_mfma_f32_32x32x16_bf16 v[48:63], v[20:23], v[132:135], v[48:63]
  ds_read_b64_tr_b16 v[20:21], v4 offset:20480
  ds_read_b64_tr_b16 v[22:23], v4 offset:20992
  s_waitcnt lgkmcnt(6)
  v_exp_f32 v80, v80
  v_exp_f32 v81, v81
  v_mfma_f32_32x32x16_bf16 v[48:63], v[24:27], v[136:139], v[48:63]
  ds_read_b64_tr_b16 v[24:25], v4 offset:22528
  ds_read_b64_tr_b16 v[26:27], v4 offset:23040
  v_exp_f32 v82, v82
  v_exp_f32 v83, v83
  v_mfma_f32_32x32x16_bf16 v[48:63], v[28:31], v[140:143], v[48:63]
  ds_read_b64_tr_b16 v[28:29], v5 offset:16384
  ds_read_b64_tr_b16 v[30:31], v5 offset:16896
  s_waitcnt lgkmcnt(6)
  v_exp_f32 v84, v84
  v_exp_f32 v85, v85
  v_mfma_f32_32x32x16_bf16 v[32:47], v[12:15], v[144:147], v[32:47]
  ds_read_b64_tr_b16 v[12:13], v5 offset:18432
  ds_read_b64_tr_b16 v[14:15], v5 offset:18944
  v_exp_f32 v86, v86
  v_exp_f32 v87, v87
  v_add_f32 v80, 1.0, v80
  v_mfma_f32_32x32x16_bf16 v[32:47], v[16:19], v[148:151], v[32:47]
  ds_read_b64_tr_b16 v[16:17], v5 offset:20480
  ds_read_b64_tr_b16 v[18:19], v5 offset:20992
  s_waitcnt lgkmcnt(6)
  v_add_f32 v81, 1.0, v81
  v_add_f32 v82, 1.0, v82
  v_add_f32 v83, 1.0, v83
  v_add_f32 v84, 1.0, v84
  v_mfma_f32_32x32x16_bf16 v[32:47], v[20:23], v[152:155], v[32:47]
  ds_read_b64_tr_b16 v[20:21], v5 offset:22528
  ds_read_b64_tr_b16 v[22:23], v5 offset:23040
  v_add_f32 v85, 1.0, v85
  v_add_f32 v86, 1.0, v86
  v_add_f32 v87, 1.0, v87
  v_rcp_f32 v80, v80
  v_mfma_f32_32x32x16_bf16 v[32:47], v[24:27], v[156:159], v[32:47]
  ds_read_b64_tr_b16 v[24:25], v6 offset:0
  ds_read_b64_tr_b16 v[26:27], v6 offset:512
  s_waitcnt lgkmcnt(6)
  v_rcp_f32 v81, v81
  v_rcp_f32 v82, v82
  v_mfma_f32_32x32x16_bf16 v[48:63], v[28:31], v[144:147], v[48:63]
  ds_read_b64_tr_b16 v[28:29], v6 offset:2048
  ds_read_b64_tr_b16 v[30:31], v6 offset:2560
  v_rcp_f32 v83, v83
  v_rcp_f32 v84, v84
  v_mfma_f32_32x32x16_bf16 v[48:63], v[12:15], v[148:151], v[48:63]
  ds_read_b64_tr_b16 v[12:13], v6 offset:4096
  ds_read_b64_tr_b16 v[14:15], v6 offset:4608
  s_waitcnt lgkmcnt(6)
  v_rcp_f32 v85, v85
  v_rcp_f32 v86, v86
  v_mfma_f32_32x32x16_bf16 v[48:63], v[16:19], v[152:155], v[48:63]
  ds_read_b64_tr_b16 v[16:17], v6 offset:6144
  ds_read_b64_tr_b16 v[18:19], v6 offset:6656
  v_rcp_f32 v87, v87
  v_mul_f32 v88, v88, v80
  v_mul_f32 v89, v89, v81
  v_mul_f32 v90, v90, v82
  v_mfma_f32_32x32x16_bf16 v[48:63], v[20:23], v[156:159], v[48:63]
  ds_read_b64_tr_b16 v[20:21], v7 offset:0
  ds_read_b64_tr_b16 v[22:23], v7 offset:512
  s_waitcnt lgkmcnt(6)
  v_mul_f32 v91, v91, v83
  v_mul_f32 v92, v92, v84
  v_mul_f32 v93, v93, v85
  v_mul_f32 v94, v94, v86
  v_mfma_f32_32x32x16_bf16 v[64:79], v[24:27], v[128:131], 0
  ds_read_b64_tr_b16 v[24:25], v7 offset:2048
  ds_read_b64_tr_b16 v[26:27], v7 offset:2560
  v_mul_f32 v95, v95, v87
  v_cvt_pk_bf16_f32 v80, v88, v89
  v_cvt_pk_bf16_f32 v81, v90, v91
  v_cvt_pk_bf16_f32 v82, v92, v93
  v_cvt_pk_bf16_f32 v83, v94, v95
  v_mfma_f32_32x32x16_bf16 v[64:79], v[28:31], v[132:135], v[64:79]
  ds_read_b64_tr_b16 v[28:29], v7 offset:4096
  ds_read_b64_tr_b16 v[30:31], v7 offset:4608
  s_waitcnt lgkmcnt(6)
  v_bfi_b32 v80, s89, v2, v80
  v_bfi_b32 v82, s89, v3, v82
  v_mfma_f32_32x32x16_bf16 v[64:79], v[12:15], v[136:139], v[64:79]
  ds_read_b64_tr_b16 v[12:13], v7 offset:6144
  ds_read_b64_tr_b16 v[14:15], v7 offset:6656
  buffer_store_dwordx4 v[80:83], v1, s[32:35], s77 offen offset:1024 sc1
  v_mul_f32 v96, s3, v96
  v_mul_f32 v97, s3, v97
  v_mul_f32 v98, s3, v98
  v_mul_f32 v99, s3, v99
  v_mfma_f32_32x32x16_bf16 v[64:79], v[16:19], v[140:143], v[64:79]
  ds_read_b64_tr_b16 v[16:17], v6 offset:16384
  ds_read_b64_tr_b16 v[18:19], v6 offset:16896
  s_waitcnt lgkmcnt(6)
  v_mul_f32 v100, s3, v100
  v_mul_f32 v101, s3, v101
  v_mul_f32 v102, s3, v102
  v_mul_f32 v103, s3, v103
  v_mfma_f32_32x32x16_bf16 v[80:95], v[20:23], v[128:131], 0
  ds_read_b64_tr_b16 v[20:21], v6 offset:18432
  ds_read_b64_tr_b16 v[22:23], v6 offset:18944
  v_exp_f32 v96, v96
  v_exp_f32 v97, v97
  v_mfma_f32_32x32x16_bf16 v[80:95], v[24:27], v[132:135], v[80:95]
  ds_read_b64_tr_b16 v[24:25], v6 offset:20480
  ds_read_b64_tr_b16 v[26:27], v6 offset:20992
  s_waitcnt lgkmcnt(6)
  v_exp_f32 v98, v98
  v_exp_f32 v99, v99
  v_mfma_f32_32x32x16_bf16 v[80:95], v[28:31], v[136:139], v[80:95]
  ds_read_b64_tr_b16 v[28:29], v6 offset:22528
  ds_read_b64_tr_b16 v[30:31], v6 offset:23040
  v_exp_f32 v100, v100
  v_exp_f32 v101, v101
  v_mfma_f32_32x32x16_bf16 v[80:95], v[12:15], v[140:143], v[80:95]
  ds_read_b64_tr_b16 v[12:13], v7 offset:16384
  ds_read_b64_tr_b16 v[14:15], v7 offset:16896
  s_waitcnt lgkmcnt(6)
  v_exp_f32 v102, v102
  v_exp_f32 v103, v103
  v_mfma_f32_32x32x16_bf16 v[64:79], v[16:19], v[144:147], v[64:79]
  ds_read_b64_tr_b16 v[16:17], v7 offset:18432
  ds_read_b64_tr_b16 v[18:19], v7 offset:18944
  v_add_f32 v96, 1.0, v96
  v_add_f32 v97, 1.0, v97
  v_add_f32 v98, 1.0, v98
  v_add_f32 v99, 1.0, v99
  v_add_f32 v100, 1.0, v100
  v_mfma_f32_32x32x16_bf16 v[64:79], v[20:23], v[148:151], v[64:79]
  ds_read_b64_tr_b16 v[20:21], v7 offset:20480
  ds_read_b64_tr_b16 v[22:23], v7 offset:20992
  s_waitcnt lgkmcnt(6)
  v_add_f32 v101, 1.0, v101
  v_add_f32 v102, 1.0, v102
  v_add_f32 v103, 1.0, v103
  v_mfma_f32_32x32x16_bf16 v[64:79], v[24:27], v[152:155], v[64:79]
  ds_read_b64_tr_b16 v[24:25], v7 offset:22528
  ds_read_b64_tr_b16 v[26:27], v7 offset:23040
  v_rcp_f32 v96, v96
  v_rcp_f32 v97, v97
  v_mfma_f32_32x32x16_bf16 v[64:79], v[28:31], v[156:159], v[64:79]
  s_barrier
  ds_read_b64_tr_b16 v[28:29], v4 offset:32768
  ds_read_b64_tr_b16 v[30:31], v4 offset:33280
  s_waitcnt lgkmcnt(6)
  v_rcp_f32 v98, v98
  v_mfma_f32_32x32x16_bf16 v[80:95], v[12:15], v[144:147], v[80:95]
  ds_read_b64_tr_b16 v[12:13], v5 offset:32768
  ds_read_b64_tr_b16 v[14:15], v5 offset:33280
  v_rcp_f32 v99, v99
  v_rcp_f32 v100, v100
  v_mfma_f32_32x32x16_bf16 v[80:95], v[16:19], v[148:151], v[80:95]
  ds_read_b64_tr_b16 v[16:17], v6 offset:32768
  ds_read_b64_tr_b16 v[18:19], v6 offset:33280
  s_waitcnt lgkmcnt(6)
  v_rcp_f32 v101, v101
  v_rcp_f32 v102, v102
  v_mfma_f32_32x32x16_bf16 v[80:95], v[20:23], v[152:155], v[80:95]
  ds_read_b64_tr_b16 v[20:21], v7 offset:32768
  ds_read_b64_tr_b16 v[22:23], v7 offset:33280
  v_rcp_f32 v103, v103
  v_mul_f32 v104, v104, v96
  v_mul_f32 v105, v105, v97
  v_mul_f32 v106, v106, v98
  v_mfma_f32_32x32x16_bf16 v[80:95], v[24:27], v[156:159], v[80:95]
  ds_read_b64_tr_b16 v[24:25], v4 offset:34816
  ds_read_b64_tr_b16 v[26:27], v4 offset:35328
  s_waitcnt lgkmcnt(6)
  v_mul_f32 v107, v107, v99
  v_mul_f32 v108, v108, v100
  v_mul_f32 v109, v109, v101
  v_mul_f32 v110, v110, v102
  v_mfma_f32_32x32x16_bf16 v[32:47], v[28:31], v[160:163], v[32:47]
  ds_read_b64_tr_b16 v[28:29], v5 offset:34816
  ds_read_b64_tr_b16 v[30:31], v5 offset:35328
  v_mul_f32 v111, v111, v103
  v_cvt_pk_bf16_f32 v96, v104, v105
  v_cvt_pk_bf16_f32 v97, v106, v107
  v_cvt_pk_bf16_f32 v98, v108, v109
  v_cvt_pk_bf16_f32 v99, v110, v111
  v_mfma_f32_32x32x16_bf16 v[48:63], v[12:15], v[160:163], v[48:63]
  ds_read_b64_tr_b16 v[12:13], v6 offset:34816
  ds_read_b64_tr_b16 v[14:15], v6 offset:35328
  s_waitcnt lgkmcnt(6)
  v_bfi_b32 v96, s89, v2, v96
  v_bfi_b32 v98, s89, v3, v98
  v_mfma_f32_32x32x16_bf16 v[64:79], v[16:19], v[160:163], v[64:79]
  ds_read_b64_tr_b16 v[16:17], v7 offset:34816
  ds_read_b64_tr_b16 v[18:19], v7 offset:35328
  buffer_store_dwordx4 v[96:99], v1, s[32:35], s77 offen offset:2048 sc1
  v_mul_f32 v112, s3, v112
  v_mul_f32 v113, s3, v113
  v_mul_f32 v114, s3, v114
  v_mul_f32 v115, s3, v115
  v_mfma_f32_32x32x16_bf16 v[80:95], v[20:23], v[160:163], v[80:95]
  ds_read_b64_tr_b16 v[20:21], v4 offset:36864
  ds_read_b64_tr_b16 v[22:23], v4 offset:37376
  s_waitcnt lgkmcnt(6)
  v_mul_f32 v116, s3, v116
  v_mul_f32 v117, s3, v117
  v_mul_f32 v118, s3, v118
  v_mul_f32 v119, s3, v119
  v_mfma_f32_32x32x16_bf16 v[32:47], v[24:27], v[164:167], v[32:47]
  ds_read_b64_tr_b16 v[24:25], v5 offset:36864
  ds_read_b64_tr_b16 v[26:27], v5 offset:37376
  v_exp_f32 v112, v112
  v_exp_f32 v113, v113
  v_mfma_f32_32x32x16_bf16 v[48:63], v[28:31], v[164:167], v[48:63]
  ds_read_b64_tr_b16 v[28:29], v6 offset:36864
  ds_read_b64_tr_b16 v[30:31], v6 offset:37376
  s_waitcnt lgkmcnt(6)
  v_exp_f32 v114, v114
  v_exp_f32 v115, v115
  v_mfma_f32_32x32x16_bf16 v[64:79], v[12:15], v[164:167], v[64:79]
  ds_read_b64_tr_b16 v[12:13], v7 offset:36864
  ds_read_b64_tr_b16 v[14:15], v7 offset:37376
  v_exp_f32 v116, v116
  v_exp_f32 v117, v117
  v_mfma_f32_32x32x16_bf16 v[80:95], v[16:19], v[164:167], v[80:95]
  ds_read_b64_tr_b16 v[16:17], v4 offset:38912
  ds_read_b64_tr_b16 v[18:19], v4 offset:39424
  s_waitcnt lgkmcnt(6)
  v_exp_f32 v118, v118
  v_exp_f32 v119, v119
  v_mfma_f32_32x32x16_bf16 v[32:47], v[20:23], v[168:171], v[32:47]
  ds_read_b64_tr_b16 v[20:21], v5 offset:38912
  ds_read_b64_tr_b16 v[22:23], v5 offset:39424
  v_add_f32 v112, 1.0, v112
  v_add_f32 v113, 1.0, v113
  v_add_f32 v114, 1.0, v114
  v_add_f32 v115, 1.0, v115
  v_add_f32 v116, 1.0, v116
  v_mfma_f32_32x32x16_bf16 v[48:63], v[24:27], v[168:171], v[48:63]
  ds_read_b64_tr_b16 v[24:25], v6 offset:38912
  ds_read_b64_tr_b16 v[26:27], v6 offset:39424
  s_waitcnt lgkmcnt(6)
  v_add_f32 v117, 1.0, v117
  v_add_f32 v118, 1.0, v118
  v_add_f32 v119, 1.0, v119
  v_mfma_f32_32x32x16_bf16 v[64:79], v[28:31], v[168:171], v[64:79]
  ds_read_b64_tr_b16 v[28:29], v7 offset:38912
  ds_read_b64_tr_b16 v[30:31], v7 offset:39424
  v_rcp_f32 v112, v112
  v_rcp_f32 v113, v113
  v_mfma_f32_32x32x16_bf16 v[80:95], v[12:15], v[168:171], v[80:95]
  s_barrier
  ds_read_b64_tr_b16 v[12:13], v4 offset:49152
  ds_read_b64_tr_b16 v[14:15], v4 offset:49664
  s_waitcnt lgkmcnt(6)
  v_rcp_f32 v114, v114
  v_mfma_f32_32x32x16_bf16 v[32:47], v[16:19], v[172:175], v[32:47]
  ds_read_b64_tr_b16 v[16:17], v5 offset:49152
  ds_read_b64_tr_b16 v[18:19], v5 offset:49664
  v_rcp_f32 v115, v115
  v_rcp_f32 v116, v116
  v_mfma_f32_32x32x16_bf16 v[48:63], v[20:23], v[172:175], v[48:63]
  ds_read_b64_tr_b16 v[20:21], v6 offset:49152
  ds_read_b64_tr_b16 v[22:23], v6 offset:49664
  s_waitcnt lgkmcnt(6)
  v_rcp_f32 v117, v117
  v_rcp_f32 v118, v118
  v_mfma_f32_32x32x16_bf16 v[64:79], v[24:27], v[172:175], v[64:79]
  ds_read_b64_tr_b16 v[24:25], v7 offset:49152
  ds_read_b64_tr_b16 v[26:27], v7 offset:49664
  v_rcp_f32 v119, v119
  v_mul_f32 v120, v120, v112
  v_mul_f32 v121, v121, v113
  v_mul_f32 v122, v122, v114
  v_mfma_f32_32x32x16_bf16 v[80:95], v[28:31], v[172:175], v[80:95]
  ds_read_b64_tr_b16 v[28:29], v4 offset:51200
  ds_read_b64_tr_b16 v[30:31], v4 offset:51712
  s_waitcnt lgkmcnt(6)
  v_mul_f32 v123, v123, v115
  v_mul_f32 v124, v124, v116
  v_mul_f32 v125, v125, v117
  v_mul_f32 v126, v126, v118
  v_mfma_f32_32x32x16_bf16 v[32:47], v[12:15], v[176:179], v[32:47]
  ds_read_b64_tr_b16 v[12:13], v5 offset:51200
  ds_read_b64_tr_b16 v[14:15], v5 offset:51712
  v_mul_f32 v127, v127, v119
  v_cvt_pk_bf16_f32 v112, v120, v121
  v_cvt_pk_bf16_f32 v113, v122, v123
  v_cvt_pk_bf16_f32 v114, v124, v125
  v_cvt_pk_bf16_f32 v115, v126, v127
  v_mfma_f32_32x32x16_bf16 v[48:63], v[16:19], v[176:179], v[48:63]
  ds_read_b64_tr_b16 v[16:17], v6 offset:51200
  ds_read_b64_tr_b16 v[18:19], v6 offset:51712
  s_waitcnt lgkmcnt(6)
  v_bfi_b32 v112, s89, v2, v112
  v_bfi_b32 v114, s89, v3, v114
  v_mfma_f32_32x32x16_bf16 v[64:79], v[20:23], v[176:179], v[64:79]
  ds_read_b64_tr_b16 v[20:21], v7 offset:51200
  ds_read_b64_tr_b16 v[22:23], v7 offset:51712
  buffer_store_dwordx4 v[112:115], v1, s[32:35], s77 offen offset:3072 sc1
  v_mfma_f32_32x32x16_bf16 v[80:95], v[24:27], v[176:179], v[80:95]
  ds_read_b64_tr_b16 v[24:25], v4 offset:53248
  ds_read_b64_tr_b16 v[26:27], v4 offset:53760
  s_waitcnt lgkmcnt(6)
  v_mfma_f32_32x32x16_bf16 v[32:47], v[28:31], v[180:183], v[32:47]
  ds_read_b64_tr_b16 v[28:29], v5 offset:53248
  ds_read_b64_tr_b16 v[30:31], v5 offset:53760
  v_mfma_f32_32x32x16_bf16 v[48:63], v[12:15], v[180:183], v[48:63]
  ds_read_b64_tr_b16 v[12:13], v6 offset:53248
  ds_read_b64_tr_b16 v[14:15], v6 offset:53760
  s_waitcnt lgkmcnt(6)
  v_mfma_f32_32x32x16_bf16 v[64:79], v[16:19], v[180:183], v[64:79]
  ds_read_b64_tr_b16 v[16:17], v7 offset:53248
  ds_read_b64_tr_b16 v[18:19], v7 offset:53760
  v_mfma_f32_32x32x16_bf16 v[80:95], v[20:23], v[180:183], v[80:95]
  ds_read_b64_tr_b16 v[20:21], v4 offset:55296
  ds_read_b64_tr_b16 v[22:23], v4 offset:55808
  s_waitcnt lgkmcnt(6)
  v_mfma_f32_32x32x16_bf16 v[32:47], v[24:27], v[184:187], v[32:47]
  ds_read_b64_tr_b16 v[24:25], v5 offset:55296
  ds_read_b64_tr_b16 v[26:27], v5 offset:55808
  v_mfma_f32_32x32x16_bf16 v[48:63], v[28:31], v[184:187], v[48:63]
  ds_read_b64_tr_b16 v[28:29], v6 offset:55296
  ds_read_b64_tr_b16 v[30:31], v6 offset:55808
  s_waitcnt lgkmcnt(6)
  v_mfma_f32_32x32x16_bf16 v[64:79], v[12:15], v[184:187], v[64:79]
  ds_read_b64_tr_b16 v[12:13], v7 offset:55296
  ds_read_b64_tr_b16 v[14:15], v7 offset:55808
  v_mfma_f32_32x32x16_bf16 v[80:95], v[16:19], v[184:187], v[80:95]
  s_barrier
  ds_read_b64_tr_b16 v[16:17], v4 offset:0
  ds_read_b64_tr_b16 v[18:19], v4 offset:512
  s_waitcnt lgkmcnt(6)
  v_mfma_f32_32x32x16_bf16 v[32:47], v[20:23], v[188:191], v[32:47]
  ds_read_b64_tr_b16 v[20:21], v5 offset:0
  ds_read_b64_tr_b16 v[22:23], v5 offset:512
  v_mfma_f32_32x32x16_bf16 v[48:63], v[24:27], v[188:191], v[48:63]
  ds_read_b64_tr_b16 v[24:25], v6 offset:0
  ds_read_b64_tr_b16 v[26:27], v6 offset:512
  s_waitcnt lgkmcnt(6)
  v_mfma_f32_32x32x16_bf16 v[64:79], v[28:31], v[188:191], v[64:79]
  ds_read_b64_tr_b16 v[28:29], v7 offset:0
  ds_read_b64_tr_b16 v[30:31], v7 offset:512
  v_mfma_f32_32x32x16_bf16 v[80:95], v[12:15], v[188:191], v[80:95]
  ds_read_b64_tr_b16 v[12:13], v4 offset:2048
  ds_read_b64_tr_b16 v[14:15], v4 offset:2560
  s_waitcnt lgkmcnt(6)
  v_mfma_f32_32x32x16_bf16 v[32:47], v[16:19], v[192:195], v[32:47]
  ds_read_b64_tr_b16 v[16:17], v5 offset:2048
  ds_read_b64_tr_b16 v[18:19], v5 offset:2560
  v_mfma_f32_32x32x16_bf16 v[48:63], v[20:23], v[192:195], v[48:63]
  ds_read_b64_tr_b16 v[20:21], v6 offset:2048
  ds_read_b64_tr_b16 v[22:23], v6 offset:2560
  s_waitcnt lgkmcnt(6)
  v_mfma_f32_32x32x16_bf16 v[64:79], v[24:27], v[192:195], v[64:79]
  ds_read_b64_tr_b16 v[24:25], v7 offset:2048
  ds_read_b64_tr_b16 v[26:27], v7 offset:2560
  v_mfma_f32_32x32x16_bf16 v[80:95], v[28:31], v[192:195], v[80:95]
  ds_read_b64_tr_b16 v[28:29], v4 offset:4096
  ds_read_b64_tr_b16 v[30:31], v4 offset:4608
  s_waitcnt lgkmcnt(6)
  v_mfma_f32_32x32x16_bf16 v[32:47], v[12:15], v[196:199], v[32:47]
  ds_read_b64_tr_b16 v[12:13], v5 offset:4096
  ds_read_b64_tr_b16 v[14:15], v5 offset:4608
  v_mfma_f32_32x32x16_bf16 v[48:63], v[16:19], v[196:199], v[48:63]
  ds_read_b64_tr_b16 v[16:17], v6 offset:4096
  ds_read_b64_tr_b16 v[18:19], v6 offset:4608
  s_waitcnt lgkmcnt(6)
  v_mfma_f32_32x32x16_bf16 v[64:79], v[20:23], v[196:199], v[64:79]
  ds_read_b64_tr_b16 v[20:21], v7 offset:4096
  ds_read_b64_tr_b16 v[22:23], v7 offset:4608
  v_mfma_f32_32x32x16_bf16 v[80:95], v[24:27], v[196:199], v[80:95]
  ds_read_b64_tr_b16 v[24:25], v4 offset:6144
  ds_read_b64_tr_b16 v[26:27], v4 offset:6656
  s_waitcnt lgkmcnt(6)
  v_mfma_f32_32x32x16_bf16 v[32:47], v[28:31], v[200:203], v[32:47]
  ds_read_b64_tr_b16 v[28:29], v5 offset:6144
  ds_read_b64_tr_b16 v[30:31], v5 offset:6656
  v_mfma_f32_32x32x16_bf16 v[48:63], v[12:15], v[200:203], v[48:63]
  ds_read_b64_tr_b16 v[12:13], v6 offset:6144
  ds_read_b64_tr_b16 v[14:15], v6 offset:6656
  s_waitcnt lgkmcnt(6)
  v_mfma_f32_32x32x16_bf16 v[64:79], v[16:19], v[200:203], v[64:79]
  ds_read_b64_tr_b16 v[16:17], v7 offset:6144
  ds_read_b64_tr_b16 v[18:19], v7 offset:6656
  v_mfma_f32_32x32x16_bf16 v[80:95], v[20:23], v[200:203], v[80:95]
  s_barrier
  ds_read_b64_tr_b16 v[20:21], v4 offset:16384
  ds_read_b64_tr_b16 v[22:23], v4 offset:16896
  s_waitcnt lgkmcnt(6)
  v_mfma_f32_32x32x16_bf16 v[32:47], v[24:27], v[204:207], v[32:47]
  ds_read_b64_tr_b16 v[24:25], v5 offset:16384
  ds_read_b64_tr_b16 v[26:27], v5 offset:16896
  v_mfma_f32_32x32x16_bf16 v[48:63], v[28:31], v[204:207], v[48:63]
  ds_read_b64_tr_b16 v[28:29], v6 offset:16384
  ds_read_b64_tr_b16 v[30:31], v6 offset:16896
  s_waitcnt lgkmcnt(6)
  v_mfma_f32_32x32x16_bf16 v[64:79], v[12:15], v[204:207], v[64:79]
  ds_read_b64_tr_b16 v[12:13], v7 offset:16384
  ds_read_b64_tr_b16 v[14:15], v7 offset:16896
  v_mfma_f32_32x32x16_bf16 v[80:95], v[16:19], v[204:207], v[80:95]
  ds_read_b64_tr_b16 v[16:17], v4 offset:18432
  ds_read_b64_tr_b16 v[18:19], v4 offset:18944
  s_waitcnt lgkmcnt(6)
  v_mfma_f32_32x32x16_bf16 v[32:47], v[20:23], v[208:211], v[32:47]
  ds_read_b64_tr_b16 v[20:21], v5 offset:18432
  ds_read_b64_tr_b16 v[22:23], v5 offset:18944
  v_mfma_f32_32x32x16_bf16 v[48:63], v[24:27], v[208:211], v[48:63]
  ds_read_b64_tr_b16 v[24:25], v6 offset:18432
  ds_read_b64_tr_b16 v[26:27], v6 offset:18944
  s_waitcnt lgkmcnt(6)
  v_mfma_f32_32x32x16_bf16 v[64:79], v[28:31], v[208:211], v[64:79]
  ds_read_b64_tr_b16 v[28:29], v7 offset:18432
  ds_read_b64_tr_b16 v[30:31], v7 offset:18944
  v_mfma_f32_32x32x16_bf16 v[80:95], v[12:15], v[208:211], v[80:95]
  ds_read_b64_tr_b16 v[12:13], v4 offset:20480
  ds_read_b64_tr_b16 v[14:15], v4 offset:20992
  s_waitcnt lgkmcnt(6)
  v_mfma_f32_32x32x16_bf16 v[32:47], v[16:19], v[212:215], v[32:47]
  ds_read_b64_tr_b16 v[16:17], v5 offset:20480
  ds_read_b64_tr_b16 v[18:19], v5 offset:20992
  v_mfma_f32_32x32x16_bf16 v[48:63], v[20:23], v[212:215], v[48:63]
  ds_read_b64_tr_b16 v[20:21], v6 offset:20480
  ds_read_b64_tr_b16 v[22:23], v6 offset:20992
  s_waitcnt lgkmcnt(6)
  v_mfma_f32_32x32x16_bf16 v[64:79], v[24:27], v[212:215], v[64:79]
  ds_read_b64_tr_b16 v[24:25], v7 offset:20480
  ds_read_b64_tr_b16 v[26:27], v7 offset:20992
  v_mfma_f32_32x32x16_bf16 v[80:95], v[28:31], v[212:215], v[80:95]
  ds_read_b64_tr_b16 v[28:29], v4 offset:22528
  ds_read_b64_tr_b16 v[30:31], v4 offset:23040
  s_waitcnt lgkmcnt(6)
  v_mfma_f32_32x32x16_bf16 v[32:47], v[12:15], v[216:219], v[32:47]
  ds_read_b64_tr_b16 v[12:13], v5 offset:22528
  ds_read_b64_tr_b16 v[14:15], v5 offset:23040
  v_mfma_f32_32x32x16_bf16 v[48:63], v[16:19], v[216:219], v[48:63]
  ds_read_b64_tr_b16 v[16:17], v6 offset:22528
  ds_read_b64_tr_b16 v[18:19], v6 offset:23040
  s_waitcnt lgkmcnt(6)
  v_mfma_f32_32x32x16_bf16 v[64:79], v[20:23], v[216:219], v[64:79]
  ds_read_b64_tr_b16 v[20:21], v7 offset:22528
  ds_read_b64_tr_b16 v[22:23], v7 offset:23040
  v_mfma_f32_32x32x16_bf16 v[80:95], v[24:27], v[216:219], v[80:95]
  ds_write_b32 v8, v9 offset:0
  v_add_u32 v4, 0x10000, v4
  v_add_u32 v5, 0x10000, v5
  v_add_u32 v6, 0x10000, v6
  v_add_u32 v7, 0x10000, v7
  ds_read_b64_tr_b16 v[24:25], v4 offset:32768
  ds_read_b64_tr_b16 v[26:27], v4 offset:33280
  s_waitcnt lgkmcnt(7)
  v_mfma_f32_32x32x16_bf16 v[32:47], v[28:31], v[220:223], v[32:47]
  ds_read_b64_tr_b16 v[28:29], v4 offset:34816
  ds_read_b64_tr_b16 v[30:31], v4 offset:35328
  v_mfma_f32_32x32x16_bf16 v[48:63], v[12:15], v[220:223], v[48:63]
  ds_read_b64_tr_b16 v[12:13], v4 offset:36864
  ds_read_b64_tr_b16 v[14:15], v4 offset:37376
  s_waitcnt lgkmcnt(7)
  v_mfma_f32_32x32x16_bf16 v[64:79], v[16:19], v[220:223], v[64:79]
  ds_read_b64_tr_b16 v[16:17], v4 offset:38912
  ds_read_b64_tr_b16 v[18:19], v4 offset:39424
  v_mfma_f32_32x32x16_bf16 v[80:95], v[20:23], v[220:223], v[80:95]
  ds_write_b32 v8, v9 offset:16
  ds_read_b64_tr_b16 v[20:21], v4 offset:49152
  ds_read_b64_tr_b16 v[22:23], v4 offset:49664
  s_waitcnt lgkmcnt(7)
  v_mfma_f32_32x32x16_bf16 v[32:47], v[24:27], v[224:227], v[32:47]
  ds_read_b64_tr_b16 v[24:25], v4 offset:51200
  ds_read_b64_tr_b16 v[26:27], v4 offset:51712
  v_mfma_f32_32x32x16_bf16 v[32:47], v[28:31], v[228:231], v[32:47]
  ds_read_b64_tr_b16 v[28:29], v4 offset:53248
  ds_read_b64_tr_b16 v[30:31], v4 offset:53760
  s_waitcnt lgkmcnt(7)
  v_mfma_f32_32x32x16_bf16 v[32:47], v[12:15], v[232:235], v[32:47]
  ds_read_b64_tr_b16 v[12:13], v4 offset:55296
  ds_read_b64_tr_b16 v[14:15], v4 offset:55808
  v_mfma_f32_32x32x16_bf16 v[32:47], v[16:19], v[236:239], v[32:47]
  ds_read_b64_tr_b16 v[16:17], v5 offset:32768
  ds_read_b64_tr_b16 v[18:19], v5 offset:33280
  s_waitcnt lgkmcnt(6)
  v_mfma_f32_32x32x16_bf16 v[32:47], v[20:23], v[240:243], v[32:47]
  ds_read_b64_tr_b16 v[20:21], v5 offset:34816
  ds_read_b64_tr_b16 v[22:23], v5 offset:35328
  v_mfma_f32_32x32x16_bf16 v[32:47], v[24:27], v[244:247], v[32:47]
  ds_read_b64_tr_b16 v[24:25], v5 offset:36864
  ds_read_b64_tr_b16 v[26:27], v5 offset:37376
  s_waitcnt lgkmcnt(6)
  v_mfma_f32_32x32x16_bf16 v[32:47], v[28:31], v[248:251], v[32:47]
  ds_read_b64_tr_b16 v[28:29], v5 offset:38912
  ds_read_b64_tr_b16 v[30:31], v5 offset:39424
  v_mfma_f32_32x32x16_bf16 v[32:47], v[12:15], v[252:255], v[32:47]
  ds_read_b64_tr_b16 v[12:13], v5 offset:49152
  ds_read_b64_tr_b16 v[14:15], v5 offset:49664
  s_waitcnt lgkmcnt(6)
  v_mfma_f32_32x32x16_bf16 v[48:63], v[16:19], v[224:227], v[48:63]
  ds_read_b64_tr_b16 v[16:17], v5 offset:51200
  ds_read_b64_tr_b16 v[18:19], v5 offset:51712
  v_mfma_f32_32x32x16_bf16 v[48:63], v[20:23], v[228:231], v[48:63]
  ds_read_b64_tr_b16 v[20:21], v5 offset:53248
  ds_read_b64_tr_b16 v[22:23], v5 offset:53760
  s_waitcnt lgkmcnt(6)
  s_nop 1
  v_mul_f32 v32, s3, v32
  v_mul_f32 v33, s3, v33
  v_mul_f32 v34, s3, v34
  v_mul_f32 v35, s3, v35
  v_mfma_f32_32x32x16_bf16 v[48:63], v[24:27], v[232:235], v[48:63]
  ds_read_b64_tr_b16 v[24:25], v5 offset:55296
  ds_read_b64_tr_b16 v[26:27], v5 offset:55808
  v_mul_f32 v36, s3, v36
  v_mul_f32 v37, s3, v37
  v_mul_f32 v38, s3, v38
  v_mul_f32 v39, s3, v39
  v_mfma_f32_32x32x16_bf16 v[48:63], v[28:31], v[236:239], v[48:63]
  ds_read_b64_tr_b16 v[28:29], v6 offset:32768
  ds_read_b64_tr_b16 v[30:31], v6 offset:33280
  s_waitcnt lgkmcnt(6)
  v_exp_f32 v32, v32
  v_exp_f32 v33, v33
  v_mfma_f32_32x32x16_bf16 v[48:63], v[12:15], v[240:243], v[48:63]
  ds_read_b64_tr_b16 v[12:13], v6 offset:34816
  ds_read_b64_tr_b16 v[14:15], v6 offset:35328
  v_exp_f32 v34, v34
  v_exp_f32 v35, v35
  v_mfma_f32_32x32x16_bf16 v[48:63], v[16:19], v[244:247], v[48:63]
  ds_read_b64_tr_b16 v[16:17], v6 offset:36864
  ds_read_b64_tr_b16 v[18:19], v6 offset:37376
  s_waitcnt lgkmcnt(6)
  v_exp_f32 v36, v36
  v_exp_f32 v37, v37
  v_mfma_f32_32x32x16_bf16 v[48:63], v[20:23], v[248:251], v[48:63]
  ds_read_b64_tr_b16 v[20:21], v6 offset:38912
  ds_read_b64_tr_b16 v[22:23], v6 offset:39424
  v_exp_f32 v38, v38
  v_exp_f32 v39, v39
  v_add_f32 v32, 1.0, v32
  v_mfma_f32_32x32x16_bf16 v[48:63], v[24:27], v[252:255], v[48:63]
  ds_read_b64_tr_b16 v[24:25], v6 offset:49152
  ds_read_b64_tr_b16 v[26:27], v6 offset:49664
  s_waitcnt lgkmcnt(6)
  v_add_f32 v33, 1.0, v33
  v_add_f32 v34, 1.0, v34
  v_add_f32 v35, 1.0, v35
  v_add_f32 v36, 1.0, v36
  v_mfma_f32_32x32x16_bf16 v[64:79], v[28:31], v[224:227], v[64:79]
  ds_read_b64_tr_b16 v[28:29], v6 offset:51200
  ds_read_b64_tr_b16 v[30:31], v6 offset:51712
  v_add_f32 v37, 1.0, v37
  v_add_f32 v38, 1.0, v38
  v_add_f32 v39, 1.0, v39
  v_rcp_f32 v32, v32
  v_mfma_f32_32x32x16_bf16 v[64:79], v[12:15], v[228:231], v[64:79]
  ds_read_b64_tr_b16 v[12:13], v6 offset:53248
  ds_read_b64_tr_b16 v[14:15], v6 offset:53760
  s_waitcnt lgkmcnt(6)
  v_rcp_f32 v33, v33
  v_rcp_f32 v34, v34
  v_mfma_f32_32x32x16_bf16 v[64:79], v[16:19], v[232:235], v[64:79]
  ds_read_b64_tr_b16 v[16:17], v6 offset:55296
  ds_read_b64_tr_b16 v[18:19], v6 offset:55808
  v_rcp_f32 v35, v35
  v_rcp_f32 v36, v36
  v_mfma_f32_32x32x16_bf16 v[64:79], v[20:23], v[236:239], v[64:79]
  ds_read_b64_tr_b16 v[20:21], v7 offset:32768
  ds_read_b64_tr_b16 v[22:23], v7 offset:33280
  s_waitcnt lgkmcnt(6)
  v_rcp_f32 v37, v37
  v_rcp_f32 v38, v38
  v_mfma_f32_32x32x16_bf16 v[64:79], v[24:27], v[240:243], v[64:79]
  ds_read_b64_tr_b16 v[24:25], v7 offset:34816
  ds_read_b64_tr_b16 v[26:27], v7 offset:35328
  v_rcp_f32 v39, v39
  v_mul_f32 v40, v40, v32
  v_mul_f32 v41, v41, v33
  v_mul_f32 v42, v42, v34
  v_mfma_f32_32x32x16_bf16 v[64:79], v[28:31], v[244:247], v[64:79]
  ds_read_b64_tr_b16 v[28:29], v7 offset:36864
  ds_read_b64_tr_b16 v[30:31], v7 offset:37376
  s_waitcnt lgkmcnt(6)
  v_mul_f32 v43, v43, v35
  v_mul_f32 v44, v44, v36
  v_mul_f32 v45, v45, v37
  v_mul_f32 v46, v46, v38
  v_mfma_f32_32x32x16_bf16 v[64:79], v[12:15], v[248:251], v[64:79]
  ds_read_b64_tr_b16 v[12:13], v7 offset:38912
  ds_read_b64_tr_b16 v[14:15], v7 offset:39424
  v_mul_f32 v47, v47, v39
  v_cvt_pk_bf16_f32 v32, v40, v41
  v_cvt_pk_bf16_f32 v33, v42, v43
  v_cvt_pk_bf16_f32 v34, v44, v45
  v_cvt_pk_bf16_f32 v35, v46, v47
  v_mfma_f32_32x32x16_bf16 v[64:79], v[16:19], v[252:255], v[64:79]
  ds_read_b64_tr_b16 v[16:17], v7 offset:49152
  ds_read_b64_tr_b16 v[18:19], v7 offset:49664
  s_waitcnt lgkmcnt(6)
  v_bfi_b32 v32, s89, v2, v32
  v_bfi_b32 v34, s89, v3, v34
  v_mfma_f32_32x32x16_bf16 v[80:95], v[20:23], v[224:227], v[80:95]
  ds_read_b64_tr_b16 v[20:21], v7 offset:51200
  ds_read_b64_tr_b16 v[22:23], v7 offset:51712
  buffer_store_dwordx4 v[32:35], v1, s[32:35], s78 offen offset:0 sc1
  v_mul_f32 v48, s3, v48
  v_mul_f32 v49, s3, v49
  v_mul_f32 v50, s3, v50
  v_mul_f32 v51, s3, v51
  v_mfma_f32_32x32x16_bf16 v[80:95], v[24:27], v[228:231], v[80:95]
  ds_read_b64_tr_b16 v[24:25], v7 offset:53248
  ds_read_b64_tr_b16 v[26:27], v7 offset:53760
  s_waitcnt lgkmcnt(6)
  v_mul_f32 v52, s3, v52
  v_mul_f32 v53, s3, v53
  v_mul_f32 v54, s3, v54
  v_mul_f32 v55, s3, v55
  v_mfma_f32_32x32x16_bf16 v[80:95], v[28:31], v[232:235], v[80:95]
  ds_read_b64_tr_b16 v[28:29], v7 offset:55296
  ds_read_b64_tr_b16 v[30:31], v7 offset:55808
  v_exp_f32 v48, v48
  v_exp_f32 v49, v49
  v_mfma_f32_32x32x16_bf16 v[80:95], v[12:15], v[236:239], v[80:95]
  s_waitcnt lgkmcnt(4)
  v_exp_f32 v50, v50
  v_exp_f32 v51, v51
  v_mfma_f32_32x32x16_bf16 v[80:95], v[16:19], v[240:243], v[80:95]
  v_exp_f32 v52, v52
  v_exp_f32 v53, v53
  v_mfma_f32_32x32x16_bf16 v[80:95], v[20:23], v[244:247], v[80:95]
  s_waitcnt lgkmcnt(0)
  v_exp_f32 v54, v54
  v_exp_f32 v55, v55
  v_mfma_f32_32x32x16_bf16 v[80:95], v[24:27], v[248:251], v[80:95]
  v_add_f32 v48, 1.0, v48
  v_add_f32 v49, 1.0, v49
  v_add_f32 v50, 1.0, v50
  v_add_f32 v51, 1.0, v51
  v_add_f32 v52, 1.0, v52
  v_mfma_f32_32x32x16_bf16 v[80:95], v[28:31], v[252:255], v[80:95]
  v_add_f32 v53, 1.0, v53
  v_add_f32 v54, 1.0, v54
  v_add_f32 v55, 1.0, v55
  v_rcp_f32 v48, v48
  ds_write_b32 v8, v9 offset:32
  v_rcp_f32 v49, v49
  v_rcp_f32 v50, v50
  v_rcp_f32 v51, v51
  v_rcp_f32 v52, v52
  v_rcp_f32 v53, v53
  v_rcp_f32 v54, v54
  v_rcp_f32 v55, v55
  v_mul_f32 v56, v56, v48
  v_mul_f32 v57, v57, v49
  v_mul_f32 v58, v58, v50
  v_mul_f32 v59, v59, v51
  v_mul_f32 v60, v60, v52
  v_mul_f32 v61, v61, v53
  v_mul_f32 v62, v62, v54
  v_mul_f32 v63, v63, v55
  v_cvt_pk_bf16_f32 v48, v56, v57
  v_cvt_pk_bf16_f32 v49, v58, v59
  v_cvt_pk_bf16_f32 v50, v60, v61
  v_cvt_pk_bf16_f32 v51, v62, v63
  v_bfi_b32 v48, s89, v2, v48
  v_bfi_b32 v50, s89, v3, v50
  buffer_store_dwordx4 v[48:51], v1, s[32:35], s78 offen offset:1024 sc1
  v_mul_f32 v64, s3, v64
  v_mul_f32 v65, s3, v65
  v_mul_f32 v66, s3, v66
  v_mul_f32 v67, s3, v67
  v_mul_f32 v68, s3, v68
  v_mul_f32 v69, s3, v69
  v_mul_f32 v70, s3, v70
  v_mul_f32 v71, s3, v71
  v_exp_f32 v64, v64
  v_exp_f32 v65, v65
  v_exp_f32 v66, v66
  v_exp_f32 v67, v67
  v_exp_f32 v68, v68
  v_exp_f32 v69, v69
  v_exp_f32 v70, v70
  v_exp_f32 v71, v71
  v_add_f32 v64, 1.0, v64
  v_add_f32 v65, 1.0, v65
  v_add_f32 v66, 1.0, v66
  v_add_f32 v67, 1.0, v67
  v_add_f32 v68, 1.0, v68
  v_add_f32 v69, 1.0, v69
  v_add_f32 v70, 1.0, v70
  v_add_f32 v71, 1.0, v71
  v_rcp_f32 v64, v64
  v_rcp_f32 v65, v65
  v_rcp_f32 v66, v66
  v_rcp_f32 v67, v67
  v_rcp_f32 v68, v68
  v_rcp_f32 v69, v69
  v_rcp_f32 v70, v70
  v_rcp_f32 v71, v71
  v_mul_f32 v72, v72, v64
  v_mul_f32 v73, v73, v65
  v_mul_f32 v74, v74, v66
  v_mul_f32 v75, v75, v67
  v_mul_f32 v76, v76, v68
  v_mul_f32 v77, v77, v69
  v_mul_f32 v78, v78, v70
  v_mul_f32 v79, v79, v71
  v_cvt_pk_bf16_f32 v64, v72, v73
  v_cvt_pk_bf16_f32 v65, v74, v75
  v_cvt_pk_bf16_f32 v66, v76, v77
  v_cvt_pk_bf16_f32 v67, v78, v79
  v_bfi_b32 v64, s89, v2, v64
  v_bfi_b32 v66, s89, v3, v66
  buffer_store_dwordx4 v[64:67], v1, s[32:35], s78 offen offset:2048 sc1
  v_mul_f32 v80, s3, v80
  v_mul_f32 v81, s3, v81
  v_mul_f32 v82, s3, v82
  v_mul_f32 v83, s3, v83
  v_mul_f32 v84, s3, v84
  v_mul_f32 v85, s3, v85
  v_mul_f32 v86, s3, v86
  v_mul_f32 v87, s3, v87
  v_exp_f32 v80, v80
  v_exp_f32 v81, v81
  v_exp_f32 v82, v82
  v_exp_f32 v83, v83
  v_exp_f32 v84, v84
  v_exp_f32 v85, v85
  v_exp_f32 v86, v86
  v_exp_f32 v87, v87
  v_add_f32 v80, 1.0, v80
  v_add_f32 v81, 1.0, v81
  v_add_f32 v82, 1.0, v82
  v_add_f32 v83, 1.0, v83
  v_add_f32 v84, 1.0, v84
  v_add_f32 v85, 1.0, v85
  v_add_f32 v86, 1.0, v86
  v_add_f32 v87, 1.0, v87
  v_rcp_f32 v80, v80
  v_rcp_f32 v81, v81
  v_rcp_f32 v82, v82
  v_rcp_f32 v83, v83
  v_rcp_f32 v84, v84
  v_rcp_f32 v85, v85
  v_rcp_f32 v86, v86
  v_rcp_f32 v87, v87
  v_mul_f32 v88, v88, v80
  v_mul_f32 v89, v89, v81
  v_mul_f32 v90, v90, v82
  v_mul_f32 v91, v91, v83
  v_mul_f32 v92, v92, v84
  v_mul_f32 v93, v93, v85
  v_mul_f32 v94, v94, v86
  v_mul_f32 v95, v95, v87
  v_cvt_pk_bf16_f32 v80, v88, v89
  v_cvt_pk_bf16_f32 v81, v90, v91
  v_cvt_pk_bf16_f32 v82, v92, v93
  v_cvt_pk_bf16_f32 v83, v94, v95
  v_bfi_b32 v80, s89, v2, v80
  v_bfi_b32 v82, s89, v3, v82
  buffer_store_dwordx4 v[80:83], v1, s[32:35], s78 offen offset:3072 sc1
  s_endpgm
L_p2:
  v_lshrrev_b32 v12, 3, v0
  v_and_b32 v13, 7, v0
  v_lshlrev_b32 v13, 4, v13
  v_bfe_u32 v14, v0, 4, 1
  v_lshlrev_b32 v14, 6, v14
  v_xor_b32 v13, v13, v14
  s_waitcnt lgkmcnt(0)
  s_mov_b32 s40, s6
  s_mov_b32 s41, s7
  s_mov_b32 s42, 0x180000
  s_mov_b32 s43, 0x20000
  s_mov_b32 s28, s4
  s_mov_b32 s29, s5
  s_mov_b32 s30, 0x200000
  s_mov_b32 s31, 0x20000
  s_mov_b32 s44, s14
  s_mov_b32 s45, s15
  s_mov_b32 s46, 0x1c0000
  s_mov_b32 s47, 0x20000
  s_mov_b32 s48, s16
  s_mov_b32 s49, s17
  s_mov_b32 s50, 0x1c0000
  s_mov_b32 s51, 0x20000
  s_cmp_eq_u32 s71, 1
  s_cbranch_scc1 L_p2t2
  s_lshl_b32 s27, s68, 11
  s_mov_b32 s60, s8
  s_mov_b32 s61, s9
  s_mov_b32 s62, 0x4000
  s_mov_b32 s63, 0x20000
  s_mov_b32 s32, s24
  s_mov_b32 s33, s25
  s_mov_b32 s34, 0x1000000
  s_mov_b32 s35, 0x20000
  s_mov_b32 s36, s22
  s_mov_b32 s37, s23
  s_mov_b32 s38, 0x100
  s_mov_b32 s39, 0x20000
  s_mov_b32 s52, s18
  s_mov_b32 s53, s19
  s_mov_b32 s54, 0x1c0000
  s_mov_b32 s55, 0x20000
  s_mov_b32 s56, s10
  s_mov_b32 s57, s11
  s_mov_b32 s58, 0x80000
  s_mov_b32 s59, 0x20000
  s_mov_b32 s64, s20
  s_mov_b32 s65, s21
  s_mov_b32 s66, 0x200000
  s_mov_b32 s67, 0x20000
  s_mov_b32 s24, 0x3fb8aa3b
  s_lshl_b32 s88, s68, 1
  s_add_u32 s88, s88, s74
  s_add_u32 s89, s88, 1
  s_and_b32 s88, s88, 7
  s_and_b32 s89, s89, 7
  s_lshr_b32 s76, s74, 1
  s_add_u32 s76, s76, s73
  s_add_u32 s90, s76, 0
  s_and_b32 s90, s90, 3
  s_add_u32 s91, s76, 1
  s_and_b32 s91, s91, 3
  s_add_u32 s92, s76, 2
  s_and_b32 s92, s92, 3
  s_add_u32 s93, s76, 3
  s_and_b32 s93, s93, 3
  s_mul_i32 s81, s73, 294912
  s_lshl_b32 s76, s74, 7
  v_lshl_add_u32 v6, v12, 10, v13
  v_add_u32 v6, s76, v6
  v_add_u32 v7, 7168, v6
  v_lshrrev_b32 v14, 5, v0
  v_lshlrev_b32 v14, 9, v14
  v_bfe_u32 v15, v0, 2, 2
  v_lshl_add_u32 v14, v15, 7, v14
  v_bfe_u32 v15, v0, 3, 1
  v_lshl_add_u32 v14, v15, 6, v14
  v_bfe_u32 v15, v0, 4, 1
  v_lshl_add_u32 v14, v15, 5, v14
  v_and_b32 v15, 3, v0
  v_lshl_add_u32 v14, v15, 3, v14
  s_and_b32 s76, s68, 1
  s_lshl_b32 s76, s76, 6
  v_xor_b32 v14, s76, v14
  s_lshl_b32 s76, s68, 12
  s_add_u32 s76, s76, 65536
  v_add_u32 v8, s76, v14
  v_xor_b32 v9, 64, v8
  s_lshr_b32 s76, s68, 1
  s_mul_i32 s77, s76, 147456
  s_sub_u32 s78, 147456, s77
  s_add_u32 s77, s77, s81
  s_add_u32 s78, s78, s81
  v_add_u32 v10, s77, v1
  v_add_u32 v11, s78, v1
  s_lshl_b32 s4, s88, 13
  s_add_u32 s6, s4, 4096
  s_lshl_b32 s12, s88, 12
  s_mul_i32 s76, s88, 6144
  s_and_b32 s77, s88, 1
  s_lshl_b32 s78, s77, 11
  s_add_u32 s8, s76, s78
  s_add_u32 s8, s8, 65536
  s_lshl_b32 s78, s77, 12
  s_sub_u32 s10, s76, s78
  s_add_u32 s10, s10, 69632
  s_lshl_b32 s5, s89, 13
  s_add_u32 s7, s5, 4096
  s_lshl_b32 s13, s89, 12
  s_mul_i32 s76, s89, 6144
  s_and_b32 s77, s89, 1
  s_lshl_b32 s78, s77, 11
  s_add_u32 s9, s76, s78
  s_add_u32 s9, s9, 65536
  s_lshl_b32 s78, s77, 12
  s_sub_u32 s11, s76, s78
  s_add_u32 s11, s11, 69632
  s_lshl_b32 s90, s90, 10
  s_lshl_b32 s91, s91, 10
  s_lshl_b32 s92, s92, 10
  s_lshl_b32 s93, s93, 10
  s_and_b32 s14, s90, 1024
  s_and_b32 s15, s91, 1024
  s_lshl_b32 s99, s68, 12
  v_mov_b32 v16, 0x3f803f80
  v_mov_b32 v17, 0x3f803f80
  v_mov_b32 v18, 0x3f803f80
  v_mov_b32 v19, 0x3f803f80
  v_mov_b32 v20, 0
  v_mov_b32 v21, 0
  v_mov_b32 v22, 0
  v_mov_b32 v23, 0
  v_add_u32 v14, s27, v1
  v_add_u32 v14, 149504, v14
  ds_write_b128 v14, v[16:19]
  ds_write_b128 v14, v[16:19] offset:1024
  v_add_u32 v14, 157696, v1
  ds_write_b128 v14, v[20:23]
  s_lshl_b32 s76, s68, 11
  s_add_u32 s76, s76, 114688
  v_and_b32 v100, 31, v0
  v_lshlrev_b32 v100, 6, v100
  v_bfe_u32 v14, v0, 1, 2
  v_lshl_add_u32 v100, v14, 4, v100
  v_lshrrev_b32 v14, 5, v0
  v_lshl_add_u32 v100, v14, 13, v100
  v_add_u32 v100, s76, v100
  v_xor_b32 v101, 16, v100
  v_xor_b32 v102, 32, v100
  v_xor_b32 v103, 48, v100
  v_add_u32 v111, s76, v1
  v_lshrrev_b32 v14, 5, v0
  v_lshlrev_b32 v14, 9, v14
  v_bfe_u32 v15, v0, 2, 2
  v_lshl_add_u32 v14, v15, 6, v14
  v_and_b32 v15, 1, v0
  v_lshl_add_u32 v14, v15, 5, v14
  v_bfe_u32 v15, v0, 4, 1
  v_lshl_add_u32 v14, v15, 4, v14
  v_bfe_u32 v15, v0, 1, 1
  v_lshl_add_u32 v14, v15, 3, v14
  v_bfe_u32 v15, v0, 3, 1
  v_lshlrev_b32 v15, 4, v15
  v_xor_b32 v14, v14, v15
  s_and_b32 s76, s68, 1
  s_lshl_b32 s76, s76, 4
  v_xor_b32 v106, s76, v14
  s_lshr_b32 s76, s68, 1
  s_lshl_b32 s76, s76, 13
  s_add_u32 s76, s76, 131072
  v_mov_b32 v96, s76
  v_mov_b32 v97, 149504
  s_mov_b32 s82, 0x0000ffff
  s_mov_b32 s83, 0x0000ffff
  v_cndmask_b32 v96, v97, v96, s[82:83]
  v_add_u32 v106, v96, v106
  v_xor_b32 v107, 32, v106
  s_lshl_b32 s76, s68, 13
  s_add_u32 s76, s76, 98304
  v_add_u32 v104, s76, v14
  v_xor_b32 v105, 32, v104
  v_and_b32 v14, 31, v0
  v_lshrrev_b32 v15, 5, v0
  v_lshlrev_b32 v108, 4, v14
  v_lshl_add_u32 v108, v15, 8, v108
  v_add_u32 v109, 512, v108
  v_lshlrev_b32 v96, 5, v15
  v_add_u32 v96, 1024, v96
  v_add_u32 v97, 16, v96
  v_cmp_eq_u32 vcc, 16, v14
  s_nop 1
  v_cndmask_b32 v108, v108, v96, vcc
  v_cndmask_b32 v109, v109, v97, vcc
  v_mov_b32 v96, 0x7f000000
  v_cmp_lt_u32 vcc, 16, v14
  s_nop 1
  v_cndmask_b32 v108, v108, v96, vcc
  v_cndmask_b32 v109, v109, v96, vcc
  s_lshl_b32 s76, s70, 4
  s_add_u32 s76, s76, s69
  s_lshl_b32 s76, s76, 2
  s_add_u32 s76, s76, s68
  s_mul_i32 s94, s76, 1152
  s_add_u32 s94, s94, 10485760
  s_lshl_b32 s95, s76, 7
  s_add_u32 s95, s95, 12058624
  s_or_b32 s76, s2, s68
  s_cmp_lg_u32 s76, 0
  s_cbranch_scc1 L_nn_5
  s_memrealtime s[100:101]
  s_waitcnt lgkmcnt(0)
  s_or_b32 s76, s100, 1
  v_mov_b32 v240, s76
  v_mov_b32 v241, 0
  v_lshlrev_b32 v242, 26, v0
  buffer_atomic_cmpswap v[240:241], v242, s[36:39], 0 offen sc1
  s_nop 1
L_nn_5:
  s_lshl_b32 s77, s70, 11
  s_mov_b32 m0, 147456
  s_nop 0
  buffer_load_dwordx4 v1, s[60:63], s77 offen lds
  buffer_load_dwordx4 v1, s[60:63], s77 offen offset:1024 lds
  s_lshl_b32 s76, s68, 4
  v_add_u32 v14, s76, v12
  v_mul_u32_u24 v14, 3072, v14
  v_add_u32 v2, v14, v13
  v_xor_b32 v15, 32, v13
  v_add_u32 v4, v14, v15
  v_add_u32 v3, 23552, v2
  v_add_u32 v5, 23552, v4
  s_lshl_b32 s3, s70, 7
  s_add_u32 s3, s3, 1024
  v_add_u32 v4, 1024, v4
  v_add_u32 v5, 1024, v5
  s_add_u32 s76, s72, 0
  s_and_b32 s76, s76, 7
  s_mul_i32 s76, s76, 196608
  s_add_u32 s77, s76, s3
  s_add_u32 m0, s27, 0
  s_nop 0
  buffer_load_dwordx4 v2, s[40:43], s77 offen offset:0 lds
  buffer_load_dwordx4 v3, s[40:43], s77 offen offset:1024 lds
  s_add_u32 m0, s27, 8192
  s_nop 0
  buffer_load_dwordx4 v4, s[40:43], s77 offen offset:0 lds
  buffer_load_dwordx4 v5, s[40:43], s77 offen offset:1024 lds
  s_add_u32 s76, s72, 1
  s_and_b32 s76, s76, 7
  s_mul_i32 s76, s76, 196608
  s_add_u32 s77, s76, s3
  s_add_u32 m0, s27, 16384
  s_nop 0
  buffer_load_dwordx4 v2, s[40:43], s77 offen offset:0 lds
  buffer_load_dwordx4 v3, s[40:43], s77 offen offset:1024 lds
  s_add_u32 m0, s27, 24576
  s_nop 0
  buffer_load_dwordx4 v4, s[40:43], s77 offen offset:0 lds
  buffer_load_dwordx4 v5, s[40:43], s77 offen offset:1024 lds
  s_waitcnt lgkmcnt(0)
  s_waitcnt vmcnt(4)
  s_barrier
  s_add_u32 s76, s72, 2
  s_and_b32 s76, s76, 7
  s_mul_i32 s76, s76, 196608
  s_add_u32 s77, s76, s3
  s_add_u32 m0, s27, 32768
  s_nop 0
  buffer_load_dwordx4 v2, s[40:43], s77 offen offset:0 lds
  buffer_load_dwordx4 v3, s[40:43], s77 offen offset:1024 lds
  s_add_u32 m0, s27, 40960
  s_nop 0
  buffer_load_dwordx4 v4, s[40:43], s77 offen offset:0 lds
  buffer_load_dwordx4 v5, s[40:43], s77 offen offset:1024 lds
  s_add_u32 s76, s72, 3
  s_and_b32 s76, s76, 7
  s_mul_i32 s76, s76, 196608
  s_add_u32 s77, s76, s3
  s_add_u32 m0, s27, 49152
  s_nop 0
  buffer_load_dwordx4 v2, s[40:43], s77 offen offset:0 lds
  buffer_load_dwordx4 v3, s[40:43], s77 offen offset:1024 lds
  s_add_u32 m0, s27, 57344
  s_nop 0
  buffer_load_dwordx4 v4, s[40:43], s77 offen offset:0 lds
  buffer_load_dwordx4 v5, s[40:43], s77 offen offset:1024 lds
  s_lshl_b32 s76, s2, 2
  s_add_u32 s76, s76, s68
  s_mul_i32 s77, s76, 1792
  s_lshl_b32 s78, s76, 9
  s_mul_i32 s79, s76, 1536
  v_lshlrev_b32 v14, 5, v0
  v_lshlrev_b32 v15, 3, v0
  buffer_load_dword v234, v14, s[52:55], s77 offen
  buffer_load_dword v235, v15, s[56:59], s78 offen
  s_waitcnt vmcnt(10)
  s_barrier
  buffer_load_dword v110, off, s[36:39], 0 sc1
  v_and_b32 v14, 1, v0
  v_lshlrev_b32 v14, 9, v14
  v_lshrrev_b32 v15, 5, v0
  v_lshl_add_u32 v14, v15, 7, v14
  v_bfe_u32 v15, v0, 2, 2
  v_lshl_add_u32 v14, v15, 5, v14
  v_bfe_u32 v15, v0, 4, 1
  v_lshl_add_u32 v14, v15, 4, v14
  v_bfe_u32 v15, v0, 1, 1
  v_lshl_add_u32 v14, v15, 3, v14
  v_add_u32 v14, 147456, v14
  ds_read_b64_tr_b16 v[32:33], v14 offset:0
  ds_read_b64_tr_b16 v[34:35], v14 offset:256
  ds_read_b64_tr_b16 v[36:37], v14 offset:1024
  ds_read_b64_tr_b16 v[38:39], v14 offset:1280
  s_mov_b32 s82, 0x0f0f0f0f
  s_mov_b32 s83, 0x0f0f0f0f
  s_waitcnt lgkmcnt(3)
  v_cndmask_b32 v16, 0, v32, s[82:83]
  v_cndmask_b32 v20, v32, 0, s[82:83]
  v_cndmask_b32 v17, 0, v33, s[82:83]
  v_cndmask_b32 v21, v33, 0, s[82:83]
  s_waitcnt lgkmcnt(2)
  v_cndmask_b32 v18, 0, v34, s[82:83]
  v_cndmask_b32 v22, v34, 0, s[82:83]
  v_cndmask_b32 v19, 0, v35, s[82:83]
  v_cndmask_b32 v23, v35, 0, s[82:83]
  s_waitcnt lgkmcnt(1)
  v_cndmask_b32 v24, 0, v36, s[82:83]
  v_cndmask_b32 v28, v36, 0, s[82:83]
  v_cndmask_b32 v25, 0, v37, s[82:83]
  v_cndmask_b32 v29, v37, 0, s[82:83]
  s_waitcnt lgkmcnt(0)
  v_cndmask_b32 v26, 0, v38, s[82:83]
  v_cndmask_b32 v30, v38, 0, s[82:83]
  v_cndmask_b32 v27, 0, v39, s[82:83]
  v_cndmask_b32 v31, v39, 0, s[82:83]
  v_add_u32 v14, 158720, v1
  ds_write_b128 v14, v[16:19] offset:0
  ds_write_b128 v14, v[20:23] offset:1024
  s_waitcnt lgkmcnt(0)
  s_lshl_b32 s76, s2, 2
  s_add_u32 s76, s76, s68
  s_mul_i32 s77, s76, 1792
  s_lshl_b32 s78, s76, 9
  s_mul_i32 s79, s76, 1536
  v_lshlrev_b32 v14, 5, v0
  v_lshlrev_b32 v15, 3, v0
  buffer_load_dword v232, v14, s[44:47], s77 offen
  buffer_load_dword v233, v14, s[48:51], s77 offen
  s_waitcnt vmcnt(9)
  s_barrier
  s_add_u32 s76, s72, 4
  s_and_b32 s76, s76, 7
  s_mul_i32 s76, s76, 196608
  s_add_u32 s77, s76, s3
  s_add_u32 m0, s27, 0
  s_nop 0
  buffer_load_dwordx4 v2, s[40:43], s77 offen offset:0 lds
  buffer_load_dwordx4 v3, s[40:43], s77 offen offset:1024 lds
  s_add_u32 m0, s27, 8192
  s_nop 0
  buffer_load_dwordx4 v4, s[40:43], s77 offen offset:0 lds
  buffer_load_dwordx4 v5, s[40:43], s77 offen offset:1024 lds
  s_add_u32 s78, s4, s90
  s_add_u32 m0, s99, 131072
  s_lshl_b32 s78, s78, 4
  buffer_load_dwordx4 v6, s[52:55], s78 offen offset:0 lds
  buffer_load_dwordx4 v7, s[52:55], s78 offen offset:1024 lds
  s_add_u32 s78, s4, s91
  s_add_u32 m0, s99, 133120
  s_lshl_b32 s78, s78, 4
  buffer_load_dwordx4 v6, s[52:55], s78 offen offset:0 lds
  buffer_load_dwordx4 v7, s[52:55], s78 offen offset:1024 lds
  s_waitcnt vmcnt(13)
  s_barrier
  s_mov_b32 s86, 65536
  s_waitcnt vmcnt(10)
  v_readfirstlane_b32 s75, v110
L_np_6:
  s_nop 0
  s_cmp_lg_u32 s75, 0
  s_cbranch_scc1 L_nok_7
  s_sleep 1
  buffer_load_dword v110, off, s[36:39], 0 sc1
  s_waitcnt vmcnt(0)
  v_readfirstlane_b32 s75, v110
  s_sub_u32 s86, s86, 1
  s_cbranch_scc0 L_np_6
L_nok_7:
  s_nop 1
  s_add_u32 s76, s72, 5
  s_and_b32 s76, s76, 7
  s_mul_i32 s76, s76, 196608
  s_add_u32 s77, s76, s3
  s_add_u32 m0, s27, 16384
  s_nop 0
  buffer_load_dwordx4 v2, s[40:43], s77 offen offset:0 lds
  buffer_load_dwordx4 v3, s[40:43], s77 offen offset:1024 lds
  s_add_u32 m0, s27, 24576
  s_nop 0
  buffer_load_dwordx4 v4, s[40:43], s77 offen offset:0 lds
  buffer_load_dwordx4 v5, s[40:43], s77 offen offset:1024 lds
  s_add_u32 s78, s4, s92
  s_add_u32 m0, s99, 65536
  s_lshl_b32 s78, s78, 4
  buffer_load_dwordx4 v6, s[52:55], s78 offen offset:0 lds
  buffer_load_dwordx4 v7, s[52:55], s78 offen offset:1024 lds
  s_add_u32 s78, s4, s93
  s_add_u32 m0, s99, 67584
  s_lshl_b32 s78, s78, 4
  buffer_load_dwordx4 v6, s[52:55], s78 offen offset:0 lds
  buffer_load_dwordx4 v7, s[52:55], s78 offen offset:1024 lds
  s_waitcnt vmcnt(12)
  s_barrier
  s_add_u32 s76, s72, 6
  s_and_b32 s76, s76, 7
  s_mul_i32 s76, s76, 196608
  s_add_u32 s77, s76, s3
  s_add_u32 m0, s27, 32768
  s_nop 0
  buffer_load_dwordx4 v2, s[40:43], s77 offen offset:0 lds
  buffer_load_dwordx4 v3, s[40:43], s77 offen offset:1024 lds
  s_add_u32 m0, s27, 40960
  s_nop 0
  buffer_load_dwordx4 v4, s[40:43], s77 offen offset:0 lds
  buffer_load_dwordx4 v5, s[40:43], s77 offen offset:1024 lds
  v_add_u32 v8, 65536, v8
  v_add_u32 v9, 65536, v9
  s_waitcnt vmcnt(14)
  ds_read_b64_tr_b16 v[112:113], v8 offset:0
  ds_read_b64_tr_b16 v[114:115], v8 offset:1024
  ds_read_b64_tr_b16 v[116:117], v9 offset:0
  ds_read_b64_tr_b16 v[118:119], v9 offset:1024
  s_waitcnt vmcnt(12)
  ds_read_b64_tr_b16 v[120:121], v8 offset:2048
  ds_read_b64_tr_b16 v[122:123], v8 offset:3072
  ds_read_b64_tr_b16 v[124:125], v9 offset:2048
  ds_read_b64_tr_b16 v[126:127], v9 offset:3072
  s_waitcnt lgkmcnt(4)
  s_add_u32 s78, s5, s90
  s_add_u32 m0, s99, 131072
  s_lshl_b32 s78, s78, 4
  buffer_load_dwordx4 v6, s[52:55], s78 offen offset:0 lds
  buffer_load_dwordx4 v7, s[52:55], s78 offen offset:1024 lds
  s_waitcnt lgkmcnt(0)
  s_add_u32 s78, s5, s91
  s_add_u32 m0, s99, 133120
  s_lshl_b32 s78, s78, 4
  buffer_load_dwordx4 v6, s[52:55], s78 offen offset:0 lds
  buffer_load_dwordx4 v7, s[52:55], s78 offen offset:1024 lds
  s_waitcnt vmcnt(12)
  s_barrier
  s_add_u32 s76, s72, 7
  s_and_b32 s76, s76, 7
  s_mul_i32 s76, s76, 196608
  s_add_u32 s77, s76, s3
  s_add_u32 m0, s27, 49152
  s_nop 0
  buffer_load_dwordx4 v2, s[40:43], s77 offen offset:0 lds
  buffer_load_dwordx4 v3, s[40:43], s77 offen offset:1024 lds
  s_add_u32 m0, s27, 57344
  s_nop 0
  buffer_load_dwordx4 v4, s[40:43], s77 offen offset:0 lds
  buffer_load_dwordx4 v5, s[40:43], s77 offen offset:1024 lds
  v_subrev_u32 v8, 65536, v8
  v_subrev_u32 v9, 65536, v9
  s_waitcnt vmcnt(14)
  ds_read_b64_tr_b16 v[128:129], v8 offset:0
  ds_read_b64_tr_b16 v[130:131], v8 offset:1024
  ds_read_b64_tr_b16 v[132:133], v9 offset:0
  ds_read_b64_tr_b16 v[134:135], v9 offset:1024
  s_waitcnt vmcnt(12)
  ds_read_b64_tr_b16 v[136:137], v8 offset:2048
  ds_read_b64_tr_b16 v[138:139], v8 offset:3072
  ds_read_b64_tr_b16 v[140:141], v9 offset:2048
  ds_read_b64_tr_b16 v[142:143], v9 offset:3072
  s_waitcnt lgkmcnt(4)
  s_add_u32 s78, s5, s92
  s_add_u32 m0, s99, 65536
  s_lshl_b32 s78, s78, 4
  buffer_load_dwordx4 v6, s[52:55], s78 offen offset:0 lds
  buffer_load_dwordx4 v7, s[52:55], s78 offen offset:1024 lds
  s_waitcnt lgkmcnt(0)
  s_add_u32 s78, s5, s93
  s_add_u32 m0, s99, 67584
  s_lshl_b32 s78, s78, 4
  buffer_load_dwordx4 v6, s[52:55], s78 offen offset:0 lds
  buffer_load_dwordx4 v7, s[52:55], s78 offen offset:1024 lds
  s_waitcnt vmcnt(12)
  s_barrier
  s_lshl_b32 s76, s68, 4
  v_add_u32 v14, s76, v12
  v_mul_u32_u24 v14, 3584, v14
  v_add_u32 v2, v14, v13
  v_xor_b32 v15, 32, v13
  v_add_u32 v4, v14, v15
  v_add_u32 v3, 27648, v2
  v_add_u32 v5, 27648, v4
  s_mul_i32 s3, s70, 192
  s_and_b32 s76, s70, 1
  s_lshl_b32 s76, s76, 6
  s_add_u32 s3, s3, s76
  s_add_u32 s3, s3, 2048
  s_add_u32 s76, s72, 0
  s_and_b32 s76, s76, 7
  s_mul_i32 s76, s76, 229376
  s_add_u32 s77, s76, s3
  s_add_u32 m0, s27, 0
  s_nop 0
  buffer_load_dwordx4 v2, s[44:47], s77 offen offset:0 lds
  buffer_load_dwordx4 v3, s[44:47], s77 offen offset:1024 lds
  s_add_u32 m0, s27, 8192
  s_nop 0
  buffer_load_dwordx4 v4, s[48:51], s77 offen offset:0 lds
  buffer_load_dwordx4 v5, s[48:51], s77 offen offset:1024 lds
  v_add_u32 v8, 65536, v8
  v_add_u32 v9, 65536, v9
  s_waitcnt vmcnt(14)
  ds_read_b64_tr_b16 v[144:145], v8 offset:0
  ds_read_b64_tr_b16 v[146:147], v8 offset:1024
  ds_read_b64_tr_b16 v[148:149], v9 offset:0
  ds_read_b64_tr_b16 v[150:151], v9 offset:1024
  s_waitcnt vmcnt(12)
  ds_read_b64_tr_b16 v[152:153], v8 offset:2048
  ds_read_b64_tr_b16 v[154:155], v8 offset:3072
  ds_read_b64_tr_b16 v[156:157], v9 offset:2048
  ds_read_b64_tr_b16 v[158:159], v9 offset:3072
  s_add_u32 s78, s8, s90
  s_add_u32 m0, s99, 81920
  s_lshl_b32 s78, s78, 4
  buffer_load_dwordx4 v6, s[52:55], s78 offen offset:0 lds
  buffer_load_dwordx4 v7, s[52:55], s78 offen offset:1024 lds
  s_add_u32 s78, s8, s91
  s_add_u32 m0, s99, 83968
  s_lshl_b32 s78, s78, 4
  buffer_load_dwordx4 v6, s[52:55], s78 offen offset:0 lds
  buffer_load_dwordx4 v7, s[52:55], s78 offen offset:1024 lds
  s_waitcnt vmcnt(12)
  s_barrier
  s_add_u32 s76, s72, 1
  s_and_b32 s76, s76, 7
  s_mul_i32 s76, s76, 229376
  s_add_u32 s77, s76, s3
  s_add_u32 m0, s27, 16384
  s_nop 0
  buffer_load_dwordx4 v2, s[44:47], s77 offen offset:0 lds
  buffer_load_dwordx4 v3, s[44:47], s77 offen offset:1024 lds
  s_add_u32 m0, s27, 24576
  s_nop 0
  buffer_load_dwordx4 v4, s[48:51], s77 offen offset:0 lds
  buffer_load_dwordx4 v5, s[48:51], s77 offen offset:1024 lds
  v_subrev_u32 v8, 65536, v8
  v_subrev_u32 v9, 65536, v9
  s_waitcnt vmcnt(14)
  ds_read_b64_tr_b16 v[160:161], v8 offset:0
  ds_read_b64_tr_b16 v[162:163], v8 offset:1024
  ds_read_b64_tr_b16 v[164:165], v9 offset:0
  ds_read_b64_tr_b16 v[166:167], v9 offset:1024
  s_waitcnt vmcnt(12)
  ds_read_b64_tr_b16 v[168:169], v8 offset:2048
  ds_read_b64_tr_b16 v[170:171], v8 offset:3072
  ds_read_b64_tr_b16 v[172:173], v9 offset:2048
  ds_read_b64_tr_b16 v[174:175], v9 offset:3072
  s_waitcnt lgkmcnt(4)
  s_add_u32 s78, s8, s92
  s_add_u32 m0, s99, 65536
  s_lshl_b32 s78, s78, 4
  buffer_load_dwordx4 v6, s[52:55], s78 offen offset:0 lds
  buffer_load_dwordx4 v7, s[52:55], s78 offen offset:1024 lds
  s_waitcnt lgkmcnt(0)
  s_add_u32 s78, s8, s93
  s_add_u32 m0, s99, 67584
  s_lshl_b32 s78, s78, 4
  buffer_load_dwordx4 v6, s[52:55], s78 offen offset:0 lds
  buffer_load_dwordx4 v7, s[52:55], s78 offen offset:1024 lds
  s_waitcnt vmcnt(12)
  s_barrier
  ds_read_b128 v[16:19], v111 offset:0
  ds_read_b128 v[20:23], v111 offset:8192
  s_add_u32 s76, s72, 2
  s_and_b32 s76, s76, 7
  s_mul_i32 s76, s76, 229376
  s_add_u32 s77, s76, s3
  s_add_u32 m0, s27, 32768
  s_nop 0
  buffer_load_dwordx4 v2, s[44:47], s77 offen offset:0 lds
  buffer_load_dwordx4 v3, s[44:47], s77 offen offset:1024 lds
  s_add_u32 m0, s27, 40960
  s_nop 0
  buffer_load_dwordx4 v4, s[48:51], s77 offen offset:0 lds
  buffer_load_dwordx4 v5, s[48:51], s77 offen offset:1024 lds
  s_setprio 2
  s_waitcnt lgkmcnt(1)
  v_mfma_f32_32x32x16_bf16 v[32:47], v[24:27], v[16:19], 0
  s_waitcnt lgkmcnt(0)
  v_mfma_f32_32x32x16_bf16 v[32:47], v[28:31], v[20:23], v[32:47]
  s_nop 11
  v_max3_f32 v64, v32, v33, v34
  v_min3_f32 v65, v32, v33, v34
  v_max3_f32 v64, v64, v35, v36
  v_min3_f32 v65, v65, v35, v36
  v_max3_f32 v64, v64, v37, v38
  v_min3_f32 v65, v65, v37, v38
  v_max3_f32 v64, v64, v39, v40
  v_min3_f32 v65, v65, v39, v40
  v_max3_f32 v64, v64, v41, v42
  v_min3_f32 v65, v65, v41, v42
  v_max3_f32 v64, v64, v43, v44
  v_min3_f32 v65, v65, v43, v44
  v_max3_f32 v64, v64, v45, v46
  v_min3_f32 v65, v65, v45, v46
  v_max_f32 v64, v64, v47
  v_min_f32 v65, v65, v47
  v_pk_mul_f32 v[64:65], v[64:65], s[24:25] op_sel_hi:[1,0]
  v_pk_fma_f32 v[48:49], v[32:33], s[24:25], v[64:65] op_sel_hi:[1,0,0] neg_lo:[0,0,1] neg_hi:[0,0,1]
  v_pk_fma_f32 v[32:33], v[32:33], s[24:25], v[64:65] op_sel:[0,0,1] op_sel_hi:[1,0,1] neg_lo:[1,0,0] neg_hi:[1,0,0]
  v_pk_fma_f32 v[50:51], v[34:35], s[24:25], v[64:65] op_sel_hi:[1,0,0] neg_lo:[0,0,1] neg_hi:[0,0,1]
  v_pk_fma_f32 v[34:35], v[34:35], s[24:25], v[64:65] op_sel:[0,0,1] op_sel_hi:[1,0,1] neg_lo:[1,0,0] neg_hi:[1,0,0]
  v_pk_fma_f32 v[52:53], v[36:37], s[24:25], v[64:65] op_sel_hi:[1,0,0] neg_lo:[0,0,1] neg_hi:[0,0,1]
  v_pk_fma_f32 v[36:37], v[36:37], s[24:25], v[64:65] op_sel:[0,0,1] op_sel_hi:[1,0,1] neg_lo:[1,0,0] neg_hi:[1,0,0]
  v_pk_fma_f32 v[54:55], v[38:39], s[24:25], v[64:65] op_sel_hi:[1,0,0] neg_lo:[0,0,1] neg_hi:[0,0,1]
  v_pk_fma_f32 v[38:39], v[38:39], s[24:25], v[64:65] op_sel:[0,0,1] op_sel_hi:[1,0,1] neg_lo:[1,0,0] neg_hi:[1,0,0]
  v_pk_fma_f32 v[56:57], v[40:41], s[24:25], v[64:65] op_sel_hi:[1,0,0] neg_lo:[0,0,1] neg_hi:[0,0,1]
  v_pk_fma_f32 v[40:41], v[40:41], s[24:25], v[64:65] op_sel:[0,0,1] op_sel_hi:[1,0,1] neg_lo:[1,0,0] neg_hi:[1,0,0]
  v_pk_fma_f32 v[58:59], v[42:43], s[24:25], v[64:65] op_sel_hi:[1,0,0] neg_lo:[0,0,1] neg_hi:[0,0,1]
  v_pk_fma_f32 v[42:43], v[42:43], s[24:25], v[64:65] op_sel:[0,0,1] op_sel_hi:[1,0,1] neg_lo:[1,0,0] neg_hi:[1,0,0]
  v_pk_fma_f32 v[60:61], v[44:45], s[24:25], v[64:65] op_sel_hi:[1,0,0] neg_lo:[0,0,1] neg_hi:[0,0,1]
  v_pk_fma_f32 v[44:45], v[44:45], s[24:25], v[64:65] op_sel:[0,0,1] op_sel_hi:[1,0,1] neg_lo:[1,0,0] neg_hi:[1,0,0]
  v_pk_fma_f32 v[62:63], v[46:47], s[24:25], v[64:65] op_sel_hi:[1,0,0] neg_lo:[0,0,1] neg_hi:[0,0,1]
  v_pk_fma_f32 v[46:47], v[46:47], s[24:25], v[64:65] op_sel:[0,0,1] op_sel_hi:[1,0,1] neg_lo:[1,0,0] neg_hi:[1,0,0]
  v_exp_f32 v48, v48
  v_exp_f32 v32, v32
  v_exp_f32 v49, v49
  v_exp_f32 v33, v33
  v_exp_f32 v50, v50
  v_exp_f32 v34, v34
  v_exp_f32 v51, v51
  v_exp_f32 v35, v35
  v_exp_f32 v52, v52
  v_exp_f32 v36, v36
  v_exp_f32 v53, v53
  v_exp_f32 v37, v37
  v_exp_f32 v54, v54
  v_exp_f32 v38, v38
  v_exp_f32 v55, v55
  v_exp_f32 v39, v39
  v_exp_f32 v56, v56
  v_exp_f32 v40, v40
  v_exp_f32 v57, v57
  v_exp_f32 v41, v41
  v_exp_f32 v58, v58
  v_exp_f32 v42, v42
  v_exp_f32 v59, v59
  v_exp_f32 v43, v43
  v_exp_f32 v60, v60
  v_exp_f32 v44, v44
  v_exp_f32 v61, v61
  v_exp_f32 v45, v45
  v_exp_f32 v62, v62
  v_exp_f32 v46, v46
  v_exp_f32 v63, v63
  v_exp_f32 v47, v47
  v_pk_add_f32 v[66:67], v[48:49], v[50:51]
  v_pk_add_f32 v[68:69], v[32:33], v[34:35]
  v_pk_add_f32 v[66:67], v[66:67], v[52:53]
  v_pk_add_f32 v[68:69], v[68:69], v[36:37]
  v_pk_add_f32 v[66:67], v[66:67], v[54:55]
  v_pk_add_f32 v[68:69], v[68:69], v[38:39]
  v_pk_add_f32 v[66:67], v[66:67], v[56:57]
  v_pk_add_f32 v[68:69], v[68:69], v[40:41]
  v_pk_add_f32 v[66:67], v[66:67], v[58:59]
  v_pk_add_f32 v[68:69], v[68:69], v[42:43]
  v_pk_add_f32 v[66:67], v[66:67], v[60:61]
  v_pk_add_f32 v[68:69], v[68:69], v[44:45]
  v_pk_add_f32 v[66:67], v[66:67], v[62:63]
  v_pk_add_f32 v[68:69], v[68:69], v[46:47]
  v_add_f32 v64, v66, v67
  v_add_f32 v65, v68, v69
  v_rcp_f32 v64, v64
  v_rcp_f32 v65, v65
  s_nop 0
  v_pk_mul_f32 v[48:49], v[48:49], v[64:65] op_sel_hi:[1,0]
  v_pk_mul_f32 v[50:51], v[50:51], v[64:65] op_sel_hi:[1,0]
  v_pk_mul_f32 v[52:53], v[52:53], v[64:65] op_sel_hi:[1,0]
  v_pk_mul_f32 v[54:55], v[54:55], v[64:65] op_sel_hi:[1,0]
  v_pk_mul_f32 v[56:57], v[56:57], v[64:65] op_sel_hi:[1,0]
  v_pk_mul_f32 v[58:59], v[58:59], v[64:65] op_sel_hi:[1,0]
  v_pk_mul_f32 v[60:61], v[60:61], v[64:65] op_sel_hi:[1,0]
  v_pk_mul_f32 v[62:63], v[62:63], v[64:65] op_sel_hi:[1,0]
  v_cvt_pk_bf16_f32 v48, v48, v49
  v_cvt_pk_bf16_f32 v49, v50, v51
  v_cvt_pk_bf16_f32 v50, v52, v53
  v_cvt_pk_bf16_f32 v51, v54, v55
  v_cvt_pk_bf16_f32 v52, v56, v57
  v_cvt_pk_bf16_f32 v53, v58, v59
  v_cvt_pk_bf16_f32 v54, v60, v61
  v_cvt_pk_bf16_f32 v55, v62, v63
  ds_write_b128 v100, v[48:51]
  ds_write_b128 v101, v[52:55]
  v_pk_mul_f32 v[32:33], v[32:33], v[64:65] op_sel:[0,1] op_sel_hi:[1,1]
  v_pk_mul_f32 v[34:35], v[34:35], v[64:65] op_sel:[0,1] op_sel_hi:[1,1]
  v_pk_mul_f32 v[36:37], v[36:37], v[64:65] op_sel:[0,1] op_sel_hi:[1,1]
  v_pk_mul_f32 v[38:39], v[38:39], v[64:65] op_sel:[0,1] op_sel_hi:[1,1]
  v_pk_mul_f32 v[40:41], v[40:41], v[64:65] op_sel:[0,1] op_sel_hi:[1,1]
  v_pk_mul_f32 v[42:43], v[42:43], v[64:65] op_sel:[0,1] op_sel_hi:[1,1]
  v_pk_mul_f32 v[44:45], v[44:45], v[64:65] op_sel:[0,1] op_sel_hi:[1,1]
  v_pk_mul_f32 v[46:47], v[46:47], v[64:65] op_sel:[0,1] op_sel_hi:[1,1]
  v_cvt_pk_bf16_f32 v32, v32, v33
  v_cvt_pk_bf16_f32 v33, v34, v35
  v_cvt_pk_bf16_f32 v34, v36, v37
  v_cvt_pk_bf16_f32 v35, v38, v39
  v_cvt_pk_bf16_f32 v36, v40, v41
  v_cvt_pk_bf16_f32 v37, v42, v43
  v_cvt_pk_bf16_f32 v38, v44, v45
  v_cvt_pk_bf16_f32 v39, v46, v47
  ds_write_b128 v102, v[32:35]
  ds_write_b128 v103, v[36:39]
  s_setprio 0
  s_waitcnt lgkmcnt(0)
  s_barrier
  s_setprio 2
  ds_read_b64_tr_b16 v[32:33], v104 offset:0
  ds_read_b64_tr_b16 v[34:35], v105 offset:256
  ds_read_b64_tr_b16 v[64:65], v106 offset:0
  ds_read_b64_tr_b16 v[66:67], v107 offset:256
  ds_read_b64_tr_b16 v[36:37], v104 offset:1024
  ds_read_b64_tr_b16 v[38:39], v105 offset:1280
  ds_read_b64_tr_b16 v[68:69], v106 offset:1024
  ds_read_b64_tr_b16 v[70:71], v107 offset:1280
  ds_read_b64_tr_b16 v[40:41], v104 offset:2048
  ds_read_b64_tr_b16 v[42:43], v105 offset:2304
  ds_read_b64_tr_b16 v[72:73], v106 offset:2048
  ds_read_b64_tr_b16 v[74:75], v107 offset:2304
  ds_read_b64_tr_b16 v[44:45], v104 offset:3072
  ds_read_b64_tr_b16 v[46:47], v105 offset:3328
  ds_read_b64_tr_b16 v[76:77], v106 offset:3072
  ds_read_b64_tr_b16 v[78:79], v107 offset:3328
  ds_read_b64_tr_b16 v[48:49], v104 offset:4096
  ds_read_b64_tr_b16 v[50:51], v105 offset:4352
  ds_read_b64_tr_b16 v[80:81], v106 offset:4096
  ds_read_b64_tr_b16 v[82:83], v107 offset:4352
  ds_read_b64_tr_b16 v[52:53], v104 offset:5120
  ds_read_b64_tr_b16 v[54:55], v105 offset:5376
  ds_read_b64_tr_b16 v[84:85], v106 offset:5120
  ds_read_b64_tr_b16 v[86:87], v107 offset:5376
  ds_read_b64_tr_b16 v[56:57], v104 offset:6144
  ds_read_b64_tr_b16 v[58:59], v105 offset:6400
  ds_read_b64_tr_b16 v[88:89], v106 offset:6144
  ds_read_b64_tr_b16 v[90:91], v107 offset:6400
  ds_read_b64_tr_b16 v[60:61], v104 offset:7168
  ds_read_b64_tr_b16 v[62:63], v105 offset:7424
  ds_read_b64_tr_b16 v[92:93], v106 offset:7168
  ds_read_b64_tr_b16 v[94:95], v107 offset:7424
  s_setprio 2
  s_waitcnt lgkmcnt(15)
  v_mfma_f32_32x32x16_bf16 v[16:31], v[32:35], v[64:67], 0
  v_mfma_f32_32x32x16_bf16 v[16:31], v[36:39], v[68:71], v[16:31]
  v_mfma_f32_32x32x16_bf16 v[16:31], v[40:43], v[72:75], v[16:31]
  v_mfma_f32_32x32x16_bf16 v[16:31], v[44:47], v[76:79], v[16:31]
  s_waitcnt lgkmcnt(12)
  v_mfma_f32_32x32x16_bf16 v[16:31], v[48:51], v[80:83], v[16:31]
  s_waitcnt lgkmcnt(8)
  v_mfma_f32_32x32x16_bf16 v[16:31], v[52:55], v[84:87], v[16:31]
  s_waitcnt lgkmcnt(4)
  v_mfma_f32_32x32x16_bf16 v[16:31], v[56:59], v[88:91], v[16:31]
  s_waitcnt lgkmcnt(0)
  v_mfma_f32_32x32x16_bf16 v[16:31], v[60:63], v[92:95], v[16:31]
  s_nop 11
  v_cvt_pk_bf16_f32 v16, v16, v17
  v_cvt_pk_bf16_f32 v17, v18, v19
  v_cvt_pk_bf16_f32 v18, v20, v21
  v_cvt_pk_bf16_f32 v19, v22, v23
  v_cvt_pk_bf16_f32 v20, v24, v25
  v_cvt_pk_bf16_f32 v21, v26, v27
  v_cvt_pk_bf16_f32 v22, v28, v29
  v_cvt_pk_bf16_f32 v23, v30, v31
  buffer_store_dwordx4 v[16:19], v108, s[32:35], s94 offen sc1
  buffer_store_dwordx4 v[20:23], v109, s[32:35], s94 offen sc1
  s_setprio 0
  s_waitcnt vmcnt(16)
  ds_read_b64_tr_b16 v[176:177], v8 offset:16384
  ds_read_b64_tr_b16 v[178:179], v8 offset:17408
  ds_read_b64_tr_b16 v[180:181], v9 offset:16384
  ds_read_b64_tr_b16 v[182:183], v9 offset:17408
  s_waitcnt vmcnt(14)
  ds_read_b64_tr_b16 v[184:185], v8 offset:18432
  ds_read_b64_tr_b16 v[186:187], v8 offset:19456
  ds_read_b64_tr_b16 v[188:189], v9 offset:18432
  ds_read_b64_tr_b16 v[190:191], v9 offset:19456
  s_waitcnt lgkmcnt(4)
  s_add_u32 s78, s9, s90
  s_add_u32 m0, s99, 81920
  s_lshl_b32 s78, s78, 4
  buffer_load_dwordx4 v6, s[52:55], s78 offen offset:0 lds
  buffer_load_dwordx4 v7, s[52:55], s78 offen offset:1024 lds
  s_waitcnt lgkmcnt(0)
  s_add_u32 s78, s9, s91
  s_add_u32 m0, s99, 83968
  s_lshl_b32 s78, s78, 4
  buffer_load_dwordx4 v6, s[52:55], s78 offen offset:0 lds
  buffer_load_dwordx4 v7, s[52:55], s78 offen offset:1024 lds
  s_waitcnt vmcnt(14)
  s_barrier
  s_add_u32 s76, s72, 3
  s_and_b32 s76, s76, 7
  s_mul_i32 s76, s76, 229376
  s_add_u32 s77, s76, s3
  s_add_u32 m0, s27, 49152
  s_nop 0
  buffer_load_dwordx4 v2, s[44:47], s77 offen offset:0 lds
  buffer_load_dwordx4 v3, s[44:47], s77 offen offset:1024 lds
  s_add_u32 m0, s27, 57344
  s_nop 0
  buffer_load_dwordx4 v4, s[48:51], s77 offen offset:0 lds
  buffer_load_dwordx4 v5, s[48:51], s77 offen offset:1024 lds
  s_waitcnt vmcnt(16)
  ds_read_b64_tr_b16 v[192:193], v8 offset:0
  ds_read_b64_tr_b16 v[194:195], v8 offset:1024
  ds_read_b64_tr_b16 v[196:197], v9 offset:0
  ds_read_b64_tr_b16 v[198:199], v9 offset:1024
  s_waitcnt vmcnt(14)
  ds_read_b64_tr_b16 v[200:201], v8 offset:2048
  ds_read_b64_tr_b16 v[202:203], v8 offset:3072
  ds_read_b64_tr_b16 v[204:205], v9 offset:2048
  ds_read_b64_tr_b16 v[206:207], v9 offset:3072
  s_waitcnt vmcnt(10)
  s_barrier
  s_add_u32 s77, s75, 1
  v_mov_b32 v96, s77
  v_lshlrev_b32 v97, 26, v0
  s_waitcnt vmcnt(8)
  buffer_store_dword v96, v97, s[32:35], s95 offen sc1
  s_mov_b32 s100, 0x33333333
  s_mov_b32 s101, 0x33333333
  s_mov_b32 s84, 0xcccccccc
  s_mov_b32 s85, 0xcccccccc
  s_add_u32 s76, s72, 4
  s_and_b32 s76, s76, 7
  s_mul_i32 s76, s76, 229376
  s_add_u32 s77, s76, s3
  s_add_u32 m0, s27, 0
  s_nop 0
  buffer_load_dwordx4 v2, s[44:47], s77 offen offset:0 lds
  buffer_load_dwordx4 v3, s[44:47], s77 offen offset:1024 lds
  s_add_u32 m0, s27, 8192
  s_nop 0
  buffer_load_dwordx4 v4, s[48:51], s77 offen offset:0 lds
  buffer_load_dwordx4 v5, s[48:51], s77 offen offset:1024 lds
  s_lshl_b32 s76, s68, 4
  v_add_u32 v14, s76, v12
  v_mul_u32_u24 v14, 3584, v14
  v_lshrrev_b32 v15, 1, v13
  v_and_b32 v15, 32, v15
  v_add_u32 v14, v14, v15
  v_and_b32 v15, 16, v13
  v_add_u32 v14, v14, v15
  v_add_u32 v15, 27648, v14
  s_mul_i32 s26, s70, 192
  s_and_b32 s76, s70, 1
  s_xor_b32 s76, s76, 1
  s_lshl_b32 s76, s76, 7
  s_add_u32 s26, s26, s76
  s_add_u32 s26, s26, 2048
  s_add_u32 s76, s72, 4
  s_and_b32 s76, s76, 7
  s_mul_i32 s76, s76, 229376
  s_add_u32 s77, s76, s26
  s_add_u32 m0, s27, 98304
  s_mov_b64 exec, s[100:101]
  buffer_load_dwordx4 v14, s[44:47], s77 offen offset:0 lds
  buffer_load_dwordx4 v15, s[44:47], s77 offen offset:1024 lds
  s_mov_b64 exec, s[84:85]
  buffer_load_dwordx4 v14, s[48:51], s77 offen offset:0 lds
  buffer_load_dwordx4 v15, s[48:51], s77 offen offset:1024 lds
  s_mov_b64 exec, -1
  s_waitcnt vmcnt(15)
  ds_read_b64_tr_b16 v[208:209], v8 offset:16384
  ds_read_b64_tr_b16 v[210:211], v8 offset:17408
  ds_read_b64_tr_b16 v[212:213], v9 offset:16384
  ds_read_b64_tr_b16 v[214:215], v9 offset:17408
  s_waitcnt vmcnt(13)
  ds_read_b64_tr_b16 v[216:217], v8 offset:18432
  ds_read_b64_tr_b16 v[218:219], v8 offset:19456
  ds_read_b64_tr_b16 v[220:221], v9 offset:18432
  ds_read_b64_tr_b16 v[222:223], v9 offset:19456
  s_waitcnt lgkmcnt(12)
  s_add_u32 s78, s9, s92
  s_add_u32 m0, s99, 65536
  s_lshl_b32 s78, s78, 4
  buffer_load_dwordx4 v6, s[52:55], s78 offen offset:0 lds
  buffer_load_dwordx4 v7, s[52:55], s78 offen offset:1024 lds
  s_waitcnt lgkmcnt(8)
  s_add_u32 s78, s9, s93
  s_add_u32 m0, s99, 67584
  s_lshl_b32 s78, s78, 4
  buffer_load_dwordx4 v6, s[52:55], s78 offen offset:0 lds
  buffer_load_dwordx4 v7, s[52:55], s78 offen offset:1024 lds
  s_waitcnt vmcnt(13)
  s_barrier
  s_mov_b32 s100, 0x33333333
  s_mov_b32 s101, 0x33333333
  s_mov_b32 s84, 0xcccccccc
  s_mov_b32 s85, 0xcccccccc
  s_add_u32 s76, s72, 5
  s_and_b32 s76, s76, 7
  s_mul_i32 s76, s76, 229376
  s_add_u32 s77, s76, s3
  s_add_u32 m0, s27, 16384
  s_nop 0
  buffer_load_dwordx4 v2, s[44:47], s77 offen offset:0 lds
  buffer_load_dwordx4 v3, s[44:47], s77 offen offset:1024 lds
  s_add_u32 m0, s27, 24576
  s_nop 0
  buffer_load_dwordx4 v4, s[48:51], s77 offen offset:0 lds
  buffer_load_dwordx4 v5, s[48:51], s77 offen offset:1024 lds
  s_add_u32 s76, s72, 5
  s_and_b32 s76, s76, 7
  s_mul_i32 s76, s76, 229376
  s_add_u32 s77, s76, s26
  s_add_u32 m0, s27, 106496
  s_mov_b64 exec, s[84:85]
  buffer_load_dwordx4 v14, s[44:47], s77 offen offset:0 lds
  buffer_load_dwordx4 v15, s[44:47], s77 offen offset:1024 lds
  s_mov_b64 exec, s[100:101]
  buffer_load_dwordx4 v14, s[48:51], s77 offen offset:0 lds
  buffer_load_dwordx4 v15, s[48:51], s77 offen offset:1024 lds
  s_mov_b64 exec, -1
  s_waitcnt lgkmcnt(4)
  s_add_u32 s78, s12, s90
  s_add_u32 m0, s99, 81920
  s_lshl_b32 s78, s78, 4
  buffer_load_dwordx4 v6, s[56:59], s78 offen offset:0 lds
  buffer_load_dwordx4 v7, s[56:59], s78 offen offset:1024 lds
  s_waitcnt lgkmcnt(0)
  s_add_u32 s78, s12, s91
  s_add_u32 m0, s99, 83968
  s_lshl_b32 s78, s78, 4
  buffer_load_dwordx4 v6, s[56:59], s78 offen offset:0 lds
  buffer_load_dwordx4 v7, s[56:59], s78 offen offset:1024 lds
  s_waitcnt vmcnt(20)
  s_barrier
  s_mov_b32 s100, 0x33333333
  s_mov_b32 s101, 0x33333333
  s_mov_b32 s84, 0xcccccccc
  s_mov_b32 s85, 0xcccccccc
  s_add_u32 s76, s72, 6
  s_and_b32 s76, s76, 7
  s_mul_i32 s76, s76, 229376
  s_add_u32 s77, s76, s3
  s_add_u32 m0, s27, 32768
  s_nop 0
  buffer_load_dwordx4 v2, s[44:47], s77 offen offset:0 lds
  buffer_load_dwordx4 v3, s[44:47], s77 offen offset:1024 lds
  s_add_u32 m0, s27, 40960
  s_nop 0
  buffer_load_dwordx4 v4, s[48:51], s77 offen offset:0 lds
  buffer_load_dwordx4 v5, s[48:51], s77 offen offset:1024 lds
  s_add_u32 s76, s72, 6
  s_and_b32 s76, s76, 7
  s_mul_i32 s76, s76, 229376
  s_add_u32 s77, s76, s26
  s_add_u32 m0, s27, 114688
  s_mov_b64 exec, s[100:101]
  buffer_load_dwordx4 v14, s[44:47], s77 offen offset:0 lds
  buffer_load_dwordx4 v15, s[44:47], s77 offen offset:1024 lds
  s_mov_b64 exec, s[84:85]
  buffer_load_dwordx4 v14, s[48:51], s77 offen offset:0 lds
  buffer_load_dwordx4 v15, s[48:51], s77 offen offset:1024 lds
  s_mov_b64 exec, -1
  s_waitcnt vmcnt(22)
  ds_read_b64_tr_b16 v[224:225], v8 offset:0
  ds_read_b64_tr_b16 v[226:227], v8 offset:1024
  ds_read_b64_tr_b16 v[228:229], v9 offset:0
  ds_read_b64_tr_b16 v[230:231], v9 offset:1024
  s_waitcnt vmcnt(20)
  ds_read_b64_tr_b16 v[232:233], v8 offset:2048
  ds_read_b64_tr_b16 v[234:235], v8 offset:3072
  ds_read_b64_tr_b16 v[236:237], v9 offset:2048
  ds_read_b64_tr_b16 v[238:239], v9 offset:3072
  s_add_u32 s78, s12, s92
  s_add_u32 m0, s99, 131072
  s_lshl_b32 s78, s78, 4
  buffer_load_dwordx4 v6, s[56:59], s78 offen offset:0 lds
  buffer_load_dwordx4 v7, s[56:59], s78 offen offset:1024 lds
  s_waitcnt vmcnt(18)
  s_barrier
  s_mov_b32 s100, 0x33333333
  s_mov_b32 s101, 0x33333333
  s_mov_b32 s84, 0xcccccccc
  s_mov_b32 s85, 0xcccccccc
  s_add_u32 s76, s72, 7
  s_and_b32 s76, s76, 7
  s_mul_i32 s76, s76, 229376
  s_add_u32 s77, s76, s3
  s_add_u32 m0, s27, 49152
  s_nop 0
  buffer_load_dwordx4 v2, s[44:47], s77 offen offset:0 lds
  buffer_load_dwordx4 v3, s[44:47], s77 offen offset:1024 lds
  s_add_u32 m0, s27, 57344
  s_nop 0
  buffer_load_dwordx4 v4, s[48:51], s77 offen offset:0 lds
  buffer_load_dwordx4 v5, s[48:51], s77 offen offset:1024 lds
  s_add_u32 s76, s72, 7
  s_and_b32 s76, s76, 7
  s_mul_i32 s76, s76, 229376
  s_add_u32 s77, s76, s26
  s_add_u32 m0, s27, 122880
  s_mov_b64 exec, s[84:85]
  buffer_load_dwordx4 v14, s[44:47], s77 offen offset:0 lds
  buffer_load_dwordx4 v15, s[44:47], s77 offen offset:1024 lds
  s_mov_b64 exec, s[100:101]
  buffer_load_dwordx4 v14, s[48:51], s77 offen offset:0 lds
  buffer_load_dwordx4 v15, s[48:51], s77 offen offset:1024 lds
  s_mov_b64 exec, -1
  s_waitcnt vmcnt(20)
  ds_read_b64_tr_b16 v[240:241], v8 offset:16384
  ds_read_b64_tr_b16 v[242:243], v8 offset:17408
  ds_read_b64_tr_b16 v[244:245], v9 offset:16384
  ds_read_b64_tr_b16 v[246:247], v9 offset:17408
  s_waitcnt vmcnt(18)
  ds_read_b64_tr_b16 v[248:249], v8 offset:18432
  ds_read_b64_tr_b16 v[250:251], v8 offset:19456
  ds_read_b64_tr_b16 v[252:253], v9 offset:18432
  ds_read_b64_tr_b16 v[254:255], v9 offset:19456
  s_add_u32 s78, s12, s93
  s_add_u32 m0, s99, 133120
  s_lshl_b32 s78, s78, 4
  buffer_load_dwordx4 v6, s[56:59], s78 offen offset:0 lds
  buffer_load_dwordx4 v7, s[56:59], s78 offen offset:1024 lds
  s_waitcnt vmcnt(16)
  s_barrier
  s_mov_b32 s100, 0x33333333
  s_mov_b32 s101, 0x33333333
  s_mov_b32 s84, 0xcccccccc
  s_mov_b32 s85, 0xcccccccc
  s_add_u32 s76, s72, 0
  s_and_b32 s76, s76, 7
  s_mul_i32 s76, s76, 229376
  s_add_u32 s77, s76, s26
  s_add_u32 m0, s27, 0
  s_mov_b64 exec, s[100:101]
  buffer_load_dwordx4 v14, s[44:47], s77 offen offset:0 lds
  buffer_load_dwordx4 v15, s[44:47], s77 offen offset:1024 lds
  s_mov_b64 exec, s[84:85]
  buffer_load_dwordx4 v14, s[48:51], s77 offen offset:0 lds
  buffer_load_dwordx4 v15, s[48:51], s77 offen offset:1024 lds
  s_mov_b64 exec, -1
  s_add_u32 s76, s72, 1
  s_and_b32 s76, s76, 7
  s_mul_i32 s76, s76, 229376
  s_add_u32 s77, s76, s26
  s_add_u32 m0, s27, 8192
  s_mov_b64 exec, s[84:85]
  buffer_load_dwordx4 v14, s[44:47], s77 offen offset:0 lds
  buffer_load_dwordx4 v15, s[44:47], s77 offen offset:1024 lds
  s_mov_b64 exec, s[100:101]
  buffer_load_dwordx4 v14, s[48:51], s77 offen offset:0 lds
  buffer_load_dwordx4 v15, s[48:51], s77 offen offset:1024 lds
  s_mov_b64 exec, -1
  s_waitcnt vmcnt(14)
  s_barrier
  s_mov_b32 s100, 0x33333333
  s_mov_b32 s101, 0x33333333
  s_mov_b32 s84, 0xcccccccc
  s_mov_b32 s85, 0xcccccccc
  s_add_u32 s76, s72, 2
  s_and_b32 s76, s76, 7
  s_mul_i32 s76, s76, 229376
  s_add_u32 s77, s76, s26
  s_add_u32 m0, s27, 16384
  s_mov_b64 exec, s[100:101]
  buffer_load_dwordx4 v14, s[44:47], s77 offen offset:0 lds
  buffer_load_dwordx4 v15, s[44:47], s77 offen offset:1024 lds
  s_mov_b64 exec, s[84:85]
  buffer_load_dwordx4 v14, s[48:51], s77 offen offset:0 lds
  buffer_load_dwordx4 v15, s[48:51], s77 offen offset:1024 lds
  s_mov_b64 exec, -1
  s_add_u32 s76, s72, 3
  s_and_b32 s76, s76, 7
  s_mul_i32 s76, s76, 229376
  s_add_u32 s77, s76, s26
  s_add_u32 m0, s27, 24576
  s_mov_b64 exec, s[84:85]
  buffer_load_dwordx4 v14, s[44:47], s77 offen offset:0 lds
  buffer_load_dwordx4 v15, s[44:47], s77 offen offset:1024 lds
  s_mov_b64 exec, s[100:101]
  buffer_load_dwordx4 v14, s[48:51], s77 offen offset:0 lds
  buffer_load_dwordx4 v15, s[48:51], s77 offen offset:1024 lds
  s_mov_b64 exec, -1
  s_waitcnt vmcnt(8)
  s_barrier
  v_and_b32 v4, 31, v0
  v_lshlrev_b32 v4, 10, v4
  v_lshrrev_b32 v5, 5, v0
  v_lshl_add_u32 v4, v5, 4, v4
  s_lshl_b32 s76, s73, 1
  s_lshr_b32 s77, s68, 1
  s_add_u32 s76, s76, s77
  s_lshl_b32 s76, s76, 15
  s_lshl_b32 s77, s74, 7
  s_add_u32 s76, s76, s77
  s_and_b32 s77, s68, 1
  s_lshl_b32 s77, s77, 6
  s_add_u32 s76, s76, s77
  v_add_u32 v4, s76, v4
  s_waitcnt lgkmcnt(12)
  s_add_u32 s78, s13, s90
  s_add_u32 m0, s99, 65536
  s_lshl_b32 s78, s78, 4
  buffer_load_dwordx4 v6, s[56:59], s78 offen offset:0 lds
  buffer_load_dwordx4 v7, s[56:59], s78 offen offset:1024 lds
  s_waitcnt lgkmcnt(8)
  s_add_u32 s78, s13, s91
  s_add_u32 m0, s99, 67584
  s_lshl_b32 s78, s78, 4
  buffer_load_dwordx4 v6, s[56:59], s78 offen offset:0 lds
  buffer_load_dwordx4 v7, s[56:59], s78 offen offset:1024 lds
  s_waitcnt vmcnt(4)
  s_barrier
  v_mov_b32 v5, 158208
  s_add_u32 s78, s4, s90
  buffer_load_dwordx4 v[80:83], v10, s[32:35], s78 offen sc1
  buffer_load_dwordx4 v[84:87], v11, s[32:35], s78 offen sc1
  s_waitcnt vmcnt(4)
  s_add_u32 s78, s4, s91
  buffer_load_dwordx4 v[88:91], v10, s[32:35], s78 offen sc1
  buffer_load_dwordx4 v[92:95], v11, s[32:35], s78 offen sc1
  s_waitcnt vmcnt(4)
  s_add_u32 s78, s4, s92
  buffer_load_dwordx4 v[96:99], v10, s[32:35], s78 offen sc1
  buffer_load_dwordx4 v[100:103], v11, s[32:35], s78 offen sc1
  s_waitcnt vmcnt(4)
  s_add_u32 s78, s4, s93
  buffer_load_dwordx4 v[104:107], v10, s[32:35], s78 offen sc1
  buffer_load_dwordx4 v[108:111], v11, s[32:35], s78 offen sc1
  s_waitcnt lgkmcnt(4)
  s_waitcnt vmcnt(4)
  s_add_u32 s78, s13, s92
  s_add_u32 m0, s99, 81920
  s_lshl_b32 s78, s78, 4
  buffer_load_dwordx4 v6, s[56:59], s78 offen offset:0 lds
  buffer_load_dwordx4 v7, s[56:59], s78 offen offset:1024 lds
  s_waitcnt lgkmcnt(0)
  s_waitcnt vmcnt(4)
  s_add_u32 s78, s13, s93
  s_add_u32 m0, s99, 83968
  s_lshl_b32 s78, s78, 4
  buffer_load_dwordx4 v6, s[56:59], s78 offen offset:0 lds
  buffer_load_dwordx4 v7, s[56:59], s78 offen offset:1024 lds
  s_waitcnt vmcnt(4)
  s_add_u32 s78, s10, s14
  s_add_u32 m0, s99, 32768
  s_lshl_b32 s78, s78, 4
  buffer_load_dwordx4 v6, s[52:55], s78 offen offset:0 lds
  buffer_load_dwordx4 v7, s[52:55], s78 offen offset:1024 lds
  s_waitcnt vmcnt(4)
  s_add_u32 s78, s10, s15
  s_add_u32 m0, s99, 34816
  s_lshl_b32 s78, s78, 4
  buffer_load_dwordx4 v6, s[52:55], s78 offen offset:0 lds
  buffer_load_dwordx4 v7, s[52:55], s78 offen offset:1024 lds
  s_waitcnt vmcnt(4)
  s_add_u32 s78, s11, s14
  s_add_u32 m0, s99, 49152
  s_lshl_b32 s78, s78, 4
  buffer_load_dwordx4 v6, s[52:55], s78 offen offset:0 lds
  buffer_load_dwordx4 v7, s[52:55], s78 offen offset:1024 lds
  s_waitcnt vmcnt(4)
  s_add_u32 s78, s11, s15
  s_add_u32 m0, s99, 51200
  s_lshl_b32 s78, s78, 4
  buffer_load_dwordx4 v6, s[52:55], s78 offen offset:0 lds
  buffer_load_dwordx4 v7, s[52:55], s78 offen offset:1024 lds
  s_mov_b32 s86, 2097152
L_lp_8:
  ds_read_b128 v[12:15], v5 offset:0
  s_waitcnt lgkmcnt(0)
  v_and_b32 v12, v12, v13
  v_and_b32 v14, v14, v15
  v_and_b32 v12, v12, v14
  s_nop 0
  v_readfirstlane_b32 s81, v12
  s_nop 1
  s_cmp_lg_u32 s81, 0
  s_cbranch_scc1 L_lok_9
  s_sleep 1
  s_sub_u32 s86, s86, 1
  s_cbranch_scc0 L_lp_8
L_lok_9:
  s_waitcnt vmcnt(4)
  s_add_u32 s78, s6, s90
  s_add_u32 m0, s99, 0
  s_lshl_b32 s78, s78, 4
  buffer_load_dwordx4 v6, s[52:55], s78 offen offset:0 lds
  buffer_load_dwordx4 v7, s[52:55], s78 offen offset:1024 lds
  s_waitcnt vmcnt(4)
  s_add_u32 s78, s6, s91
  s_add_u32 m0, s99, 2048
  s_lshl_b32 s78, s78, 4
  buffer_load_dwordx4 v6, s[52:55], s78 offen offset:0 lds
  buffer_load_dwordx4 v7, s[52:55], s78 offen offset:1024 lds
  s_mov_b32 s86, 2097152
L_lp_10:
  ds_read_b128 v[12:15], v5 offset:16
  s_waitcnt lgkmcnt(0)
  v_and_b32 v12, v12, v13
  v_and_b32 v14, v14, v15
  v_and_b32 v12, v12, v14
  s_nop 0
  v_readfirstlane_b32 s81, v12
  s_nop 1
  s_cmp_lg_u32 s81, 0
  s_cbranch_scc1 L_lok_11
  s_sleep 1
  s_sub_u32 s86, s86, 1
  s_cbranch_scc0 L_lp_10
L_lok_11:
  s_waitcnt vmcnt(4)
  s_add_u32 s78, s6, s92
  s_add_u32 m0, s99, 16384
  s_lshl_b32 s78, s78, 4
  buffer_load_dwordx4 v6, s[52:55], s78 offen offset:0 lds
  buffer_load_dwordx4 v7, s[52:55], s78 offen offset:1024 lds
  s_waitcnt vmcnt(4)
  s_add_u32 s78, s6, s93
  s_add_u32 m0, s99, 18432
  s_lshl_b32 s78, s78, 4
  buffer_load_dwordx4 v6, s[52:55], s78 offen offset:0 lds
  buffer_load_dwordx4 v7, s[52:55], s78 offen offset:1024 lds
  s_mul_i32 s76, s75, 0x9e3779b1
  s_lshr_b32 s81, s76, 15
  s_xor_b32 s76, s76, s81
  s_and_b32 s76, s76, 0xfffdfffd
  s_or_b32 s76, s76, 0x00010001
  s_mov_b32 s3, 0x00010001
  v_and_b32 v14, 7, v0
  v_lshlrev_b32 v14, 2, v14
  v_bfe_u32 v14, s76, v14, 4
  v_lshl_or_b32 v14, v14, 15, v14
  v_lshrrev_b32 v15, 2, v14
  v_and_b32 v14, s3, v14
  v_and_b32 v15, s3, v15
  v_xor_b32 v15, s3, v15
  v_xor_b32 v80, v80, v14
  v_xor_b32 v82, v82, v15
  v_xor_b32 v84, v84, v14
  v_xor_b32 v86, v86, v15
  v_bitop3_b32 v2, v80, v82, v80 bitop3:0xf3
  v_bitop3_b32 v2, v84, v86, v2 bitop3:0xfb
  v_and_b32 v2, s3, v2
  v_cmp_ne_u32 vcc, 0, v2
  s_nop 0
  s_cmp_lg_u64 vcc, 0
  s_cbranch_scc1 L_slow_12
L_cont_13:
  v_mfma_f32_32x32x16_bf16 v[16:31], v[112:115], v[80:83], 0
  v_xor_b32 v88, v88, v14
  v_xor_b32 v90, v90, v15
  v_xor_b32 v92, v92, v14
  v_xor_b32 v94, v94, v15
  v_mfma_f32_32x32x16_bf16 v[32:47], v[116:119], v[80:83], 0
  v_bitop3_b32 v2, v88, v90, v88 bitop3:0xf3
  v_bitop3_b32 v2, v92, v94, v2 bitop3:0xfb
  v_mfma_f32_32x32x16_bf16 v[48:63], v[112:115], v[84:87], 0
  v_and_b32 v2, s3, v2
  v_cmp_ne_u32 vcc, 0, v2
  v_mfma_f32_32x32x16_bf16 v[64:79], v[116:119], v[84:87], 0
  s_cmp_lg_u64 vcc, 0
  s_cbranch_scc1 L_slow_16
L_cont_17:
  v_mfma_f32_32x32x16_bf16 v[16:31], v[120:123], v[88:91], v[16:31]
  v_xor_b32 v96, v96, v14
  v_xor_b32 v98, v98, v15
  v_xor_b32 v100, v100, v14
  v_xor_b32 v102, v102, v15
  v_mfma_f32_32x32x16_bf16 v[32:47], v[124:127], v[88:91], v[32:47]
  s_waitcnt vmcnt(4)
  s_add_u32 s78, s5, s90
  v_bitop3_b32 v2, v96, v98, v96 bitop3:0xf3
  v_bitop3_b32 v2, v100, v102, v2 bitop3:0xfb
  v_mfma_f32_32x32x16_bf16 v[48:63], v[120:123], v[92:95], v[48:63]
  buffer_load_dwordx4 v[80:83], v10, s[32:35], s78 offen sc1
  buffer_load_dwordx4 v[84:87], v11, s[32:35], s78 offen sc1
  v_and_b32 v2, s3, v2
  v_cmp_ne_u32 vcc, 0, v2
  v_mfma_f32_32x32x16_bf16 v[64:79], v[124:127], v[92:95], v[64:79]
  s_cmp_lg_u64 vcc, 0
  s_cbranch_scc1 L_slow_20
L_cont_21:
  v_mfma_f32_32x32x16_bf16 v[16:31], v[128:131], v[96:99], v[16:31]
  v_xor_b32 v104, v104, v14
  v_xor_b32 v106, v106, v15
  v_xor_b32 v108, v108, v14
  v_xor_b32 v110, v110, v15
  v_mfma_f32_32x32x16_bf16 v[32:47], v[132:135], v[96:99], v[32:47]
  s_waitcnt vmcnt(4)
  s_add_u32 s78, s5, s91
  buffer_load_dwordx4 v[112:115], v10, s[32:35], s78 offen sc1
  v_bitop3_b32 v2, v104, v106, v104 bitop3:0xf3
  v_bitop3_b32 v2, v108, v110, v2 bitop3:0xfb
  v_mfma_f32_32x32x16_bf16 v[48:63], v[128:131], v[100:103], v[48:63]
  buffer_load_dwordx4 v[116:119], v11, s[32:35], s78 offen sc1
  s_waitcnt vmcnt(4)
  s_add_u32 s78, s5, s92
  v_and_b32 v2, s3, v2
  v_cmp_ne_u32 vcc, 0, v2
  v_mfma_f32_32x32x16_bf16 v[64:79], v[132:135], v[100:103], v[64:79]
  buffer_load_dwordx4 v[88:91], v10, s[32:35], s78 offen sc1
  buffer_load_dwordx4 v[92:95], v11, s[32:35], s78 offen sc1
  s_cmp_lg_u64 vcc, 0
  s_cbranch_scc1 L_slow_24
L_cont_25:
  v_mfma_f32_32x32x16_bf16 v[16:31], v[136:139], v[104:107], v[16:31]
  s_waitcnt vmcnt(5)
  v_xor_b32 v80, v80, v14
  v_xor_b32 v82, v82, v15
  s_waitcnt vmcnt(4)
  v_xor_b32 v84, v84, v14
  v_xor_b32 v86, v86, v15
  v_mfma_f32_32x32x16_bf16 v[32:47], v[140:143], v[104:107], v[32:47]
  s_add_u32 s78, s5, s93
  buffer_load_dwordx4 v[120:123], v10, s[32:35], s78 offen sc1
  v_bitop3_b32 v2, v80, v82, v80 bitop3:0xf3
  v_bitop3_b32 v2, v84, v86, v2 bitop3:0xfb
  v_mfma_f32_32x32x16_bf16 v[48:63], v[136:139], v[108:111], v[48:63]
  buffer_load_dwordx4 v[124:127], v11, s[32:35], s78 offen sc1
  s_waitcnt vmcnt(4)
  s_add_u32 s78, s8, s90
  v_and_b32 v2, s3, v2
  v_cmp_ne_u32 vcc, 0, v2
  v_mfma_f32_32x32x16_bf16 v[64:79], v[140:143], v[108:111], v[64:79]
  buffer_load_dwordx4 v[96:99], v10, s[32:35], s78 offen sc1
  buffer_load_dwordx4 v[100:103], v11, s[32:35], s78 offen sc1
  s_cmp_lg_u64 vcc, 0
  s_cbranch_scc1 L_slow_28
L_cont_29:
  v_mfma_f32_32x32x16_bf16 v[16:31], v[144:147], v[80:83], v[16:31]
  v_xor_b32 v112, v112, v14
  v_xor_b32 v114, v114, v15
  v_xor_b32 v116, v116, v14
  v_xor_b32 v118, v118, v15
  v_mfma_f32_32x32x16_bf16 v[32:47], v[148:151], v[80:83], v[32:47]
  s_waitcnt vmcnt(4)
  s_add_u32 s78, s8, s91
  buffer_load_dwordx4 v[128:131], v10, s[32:35], s78 offen sc1
  v_bitop3_b32 v2, v112, v114, v112 bitop3:0xf3
  v_bitop3_b32 v2, v116, v118, v2 bitop3:0xfb
  v_mfma_f32_32x32x16_bf16 v[48:63], v[144:147], v[84:87], v[48:63]
  buffer_load_dwordx4 v[132:135], v11, s[32:35], s78 offen sc1
  s_waitcnt vmcnt(4)
  s_add_u32 s78, s8, s92
  v_and_b32 v2, s3, v2
  v_cmp_ne_u32 vcc, 0, v2
  v_mfma_f32_32x32x16_bf16 v[64:79], v[148:151], v[84:87], v[64:79]
  buffer_load_dwordx4 v[104:107], v10, s[32:35], s78 offen sc1
  buffer_load_dwordx4 v[108:111], v11, s[32:35], s78 offen sc1
  s_cmp_lg_u64 vcc, 0
  s_cbranch_scc1 L_slow_32
L_cont_33:
  v_mfma_f32_32x32x16_bf16 v[16:31], v[152:155], v[112:115], v[16:31]
  v_xor_b32 v88, v88, v14
  v_xor_b32 v90, v90, v15
  v_xor_b32 v92, v92, v14
  v_xor_b32 v94, v94, v15
  v_mfma_f32_32x32x16_bf16 v[32:47], v[156:159], v[112:115], v[32:47]
  s_waitcnt vmcnt(4)
  s_add_u32 s78, s8, s93
  buffer_load_dwordx4 v[136:139], v10, s[32:35], s78 offen sc1
  v_bitop3_b32 v2, v88, v90, v88 bitop3:0xf3
  v_bitop3_b32 v2, v92, v94, v2 bitop3:0xfb
  v_mfma_f32_32x32x16_bf16 v[48:63], v[152:155], v[116:119], v[48:63]
  buffer_load_dwordx4 v[140:143], v11, s[32:35], s78 offen sc1
  s_waitcnt vmcnt(4)
  s_add_u32 s78, s9, s90
  v_and_b32 v2, s3, v2
  v_cmp_ne_u32 vcc, 0, v2
  v_mfma_f32_32x32x16_bf16 v[64:79], v[156:159], v[116:119], v[64:79]
  buffer_load_dwordx4 v[80:83], v10, s[32:35], s78 offen sc1
  buffer_load_dwordx4 v[84:87], v11, s[32:35], s78 offen sc1
  s_cmp_lg_u64 vcc, 0
  s_cbranch_scc1 L_slow_36
L_cont_37:
  v_mfma_f32_32x32x16_bf16 v[16:31], v[160:163], v[88:91], v[16:31]
  v_xor_b32 v120, v120, v14
  v_xor_b32 v122, v122, v15
  v_xor_b32 v124, v124, v14
  v_xor_b32 v126, v126, v15
  v_mfma_f32_32x32x16_bf16 v[32:47], v[164:167], v[88:91], v[32:47]
  s_add_u32 s78, s9, s91
  buffer_load_dwordx4 v[144:147], v10, s[32:35], s78 offen sc1
  buffer_load_dwordx4 v[148:151], v11, s[32:35], s78 offen sc1
  s_add_u32 s78, s9, s92
  buffer_load_dwordx4 v[112:115], v10, s[32:35], s78 offen sc1
  buffer_load_dwordx4 v[116:119], v11, s[32:35], s78 offen sc1
  s_mov_b32 s86, 2097152
L_lp_40:
  ds_read_b128 v[152:155], v5 offset:32
  s_waitcnt lgkmcnt(0)
  v_and_b32 v152, v152, v153
  v_and_b32 v154, v154, v155
  v_and_b32 v152, v152, v154
  s_nop 0
  v_readfirstlane_b32 s81, v152
  s_nop 1
  s_cmp_lg_u32 s81, 0
  s_cbranch_scc1 L_lok_41
  s_sleep 1
  s_sub_u32 s86, s86, 1
  s_cbranch_scc0 L_lp_40
L_lok_41:
  v_bitop3_b32 v2, v120, v122, v120 bitop3:0xf3
  v_bitop3_b32 v2, v124, v126, v2 bitop3:0xfb
  v_mfma_f32_32x32x16_bf16 v[48:63], v[160:163], v[92:95], v[48:63]
  v_and_b32 v2, s3, v2
  v_cmp_ne_u32 vcc, 0, v2
  v_mfma_f32_32x32x16_bf16 v[64:79], v[164:167], v[92:95], v[64:79]
  s_cmp_lg_u64 vcc, 0
  s_cbranch_scc1 L_slow_42
L_cont_43:
  v_mfma_f32_32x32x16_bf16 v[16:31], v[168:171], v[120:123], v[16:31]
  v_xor_b32 v96, v96, v14
  v_xor_b32 v98, v98, v15
  v_xor_b32 v100, v100, v14
  v_xor_b32 v102, v102, v15
  v_mfma_f32_32x32x16_bf16 v[32:47], v[172:175], v[120:123], v[32:47]
  s_add_u32 s78, s9, s93
  buffer_load_dwordx4 v[152:155], v10, s[32:35], s78 offen sc1
  buffer_load_dwordx4 v[156:159], v11, s[32:35], s78 offen sc1
  v_bitop3_b32 v2, v96, v98, v96 bitop3:0xf3
  v_bitop3_b32 v2, v100, v102, v2 bitop3:0xfb
  v_mfma_f32_32x32x16_bf16 v[48:63], v[168:171], v[124:127], v[48:63]
  s_add_u32 s78, s7, s90
  s_add_u32 m0, s99, 98304
  s_lshl_b32 s78, s78, 4
  v_and_b32 v2, s3, v2
  v_cmp_ne_u32 vcc, 0, v2
  v_mfma_f32_32x32x16_bf16 v[64:79], v[172:175], v[124:127], v[64:79]
  buffer_load_dwordx4 v6, s[52:55], s78 offen offset:0 lds
  buffer_load_dwordx4 v7, s[52:55], s78 offen offset:1024 lds
  s_cmp_lg_u64 vcc, 0
  s_cbranch_scc1 L_slow_46
L_cont_47:
  v_mfma_f32_32x32x16_bf16 v[16:31], v[176:179], v[96:99], v[16:31]
  v_xor_b32 v128, v128, v14
  v_xor_b32 v130, v130, v15
  v_xor_b32 v132, v132, v14
  v_xor_b32 v134, v134, v15
  v_mfma_f32_32x32x16_bf16 v[32:47], v[180:183], v[96:99], v[32:47]
  s_add_u32 s78, s12, s90
  s_add_u32 s78, s78, 114688
  buffer_load_dwordx4 v[88:91], v10, s[32:35], s78 offen sc1
  v_bitop3_b32 v2, v128, v130, v128 bitop3:0xf3
  v_bitop3_b32 v2, v132, v134, v2 bitop3:0xfb
  v_mfma_f32_32x32x16_bf16 v[48:63], v[176:179], v[100:103], v[48:63]
  buffer_load_dwordx4 v[92:95], v11, s[32:35], s78 offen sc1
  s_add_u32 s78, s7, s91
  s_add_u32 m0, s99, 100352
  v_and_b32 v2, s3, v2
  v_cmp_ne_u32 vcc, 0, v2
  v_mfma_f32_32x32x16_bf16 v[64:79], v[180:183], v[100:103], v[64:79]
  s_lshl_b32 s78, s78, 4
  buffer_load_dwordx4 v6, s[52:55], s78 offen offset:0 lds
  buffer_load_dwordx4 v7, s[52:55], s78 offen offset:1024 lds
  s_cmp_lg_u64 vcc, 0
  s_cbranch_scc1 L_slow_50
L_cont_51:
  v_mfma_f32_32x32x16_bf16 v[16:31], v[184:187], v[128:131], v[16:31]
  s_waitcnt vmcnt(17)
  v_xor_b32 v104, v104, v14
  v_xor_b32 v106, v106, v15
  s_waitcnt vmcnt(16)
  v_xor_b32 v108, v108, v14
  v_xor_b32 v110, v110, v15
  v_mfma_f32_32x32x16_bf16 v[32:47], v[188:191], v[128:131], v[32:47]
  s_add_u32 s78, s12, s91
  s_add_u32 s78, s78, 114688
  buffer_load_dwordx4 v[160:163], v10, s[32:35], s78 offen sc1
  v_bitop3_b32 v2, v104, v106, v104 bitop3:0xf3
  v_bitop3_b32 v2, v108, v110, v2 bitop3:0xfb
  v_mfma_f32_32x32x16_bf16 v[48:63], v[184:187], v[132:135], v[48:63]
  buffer_load_dwordx4 v[164:167], v11, s[32:35], s78 offen sc1
  s_add_u32 s78, s7, s92
  s_add_u32 m0, s99, 114688
  v_and_b32 v2, s3, v2
  v_cmp_ne_u32 vcc, 0, v2
  v_mfma_f32_32x32x16_bf16 v[64:79], v[188:191], v[132:135], v[64:79]
  s_lshl_b32 s78, s78, 4
  buffer_load_dwordx4 v6, s[52:55], s78 offen offset:0 lds
  buffer_load_dwordx4 v7, s[52:55], s78 offen offset:1024 lds
  s_cmp_lg_u64 vcc, 0
  s_cbranch_scc1 L_slow_54
L_cont_55:
  v_mfma_f32_32x32x16_bf16 v[16:31], v[192:195], v[104:107], v[16:31]
  s_waitcnt vmcnt(19)
  v_xor_b32 v136, v136, v14
  v_xor_b32 v138, v138, v15
  s_waitcnt vmcnt(18)
  v_xor_b32 v140, v140, v14
  v_xor_b32 v142, v142, v15
  v_mfma_f32_32x32x16_bf16 v[32:47], v[196:199], v[104:107], v[32:47]
  s_add_u32 s78, s12, s92
  s_add_u32 s78, s78, 114688
  buffer_load_dwordx4 v[120:123], v10, s[32:35], s78 offen sc1
  v_bitop3_b32 v2, v136, v138, v136 bitop3:0xf3
  v_bitop3_b32 v2, v140, v142, v2 bitop3:0xfb
  v_mfma_f32_32x32x16_bf16 v[48:63], v[192:195], v[108:111], v[48:63]
  buffer_load_dwordx4 v[124:127], v11, s[32:35], s78 offen sc1
  s_add_u32 s78, s7, s93
  s_add_u32 m0, s99, 116736
  v_and_b32 v2, s3, v2
  v_cmp_ne_u32 vcc, 0, v2
  v_mfma_f32_32x32x16_bf16 v[64:79], v[196:199], v[108:111], v[64:79]
  s_lshl_b32 s78, s78, 4
  buffer_load_dwordx4 v6, s[52:55], s78 offen offset:0 lds
  buffer_load_dwordx4 v7, s[52:55], s78 offen offset:1024 lds
  s_cmp_lg_u64 vcc, 0
  s_cbranch_scc1 L_slow_58
L_cont_59:
  v_mfma_f32_32x32x16_bf16 v[16:31], v[200:203], v[136:139], v[16:31]
  s_waitcnt vmcnt(21)
  v_xor_b32 v80, v80, v14
  v_xor_b32 v82, v82, v15
  s_waitcnt vmcnt(20)
  v_xor_b32 v84, v84, v14
  v_xor_b32 v86, v86, v15
  v_mfma_f32_32x32x16_bf16 v[32:47], v[204:207], v[136:139], v[32:47]
  s_add_u32 s78, s12, s93
  s_add_u32 s78, s78, 114688
  v_bitop3_b32 v2, v80, v82, v80 bitop3:0xf3
  v_bitop3_b32 v2, v84, v86, v2 bitop3:0xfb
  v_mfma_f32_32x32x16_bf16 v[48:63], v[200:203], v[140:143], v[48:63]
  buffer_load_dwordx4 v[168:171], v10, s[32:35], s78 offen sc1
  buffer_load_dwordx4 v[172:175], v11, s[32:35], s78 offen sc1
  v_and_b32 v2, s3, v2
  v_cmp_ne_u32 vcc, 0, v2
  v_mfma_f32_32x32x16_bf16 v[64:79], v[204:207], v[140:143], v[64:79]
  s_cmp_lg_u64 vcc, 0
  s_cbranch_scc1 L_slow_62
L_cont_63:
  v_mfma_f32_32x32x16_bf16 v[16:31], v[208:211], v[80:83], v[16:31]
  s_waitcnt vmcnt(21)
  v_xor_b32 v144, v144, v14
  v_xor_b32 v146, v146, v15
  s_waitcnt vmcnt(20)
  v_xor_b32 v148, v148, v14
  v_xor_b32 v150, v150, v15
  v_mfma_f32_32x32x16_bf16 v[32:47], v[212:215], v[80:83], v[32:47]
  s_add_u32 s78, s13, s90
  s_add_u32 s78, s78, 114688
  v_bitop3_b32 v2, v144, v146, v144 bitop3:0xf3
  v_bitop3_b32 v2, v148, v150, v2 bitop3:0xfb
  v_mfma_f32_32x32x16_bf16 v[48:63], v[208:211], v[84:87], v[48:63]
  buffer_load_dwordx4 v[96:99], v10, s[32:35], s78 offen sc1
  buffer_load_dwordx4 v[100:103], v11, s[32:35], s78 offen sc1
  v_and_b32 v2, s3, v2
  v_cmp_ne_u32 vcc, 0, v2
  v_mfma_f32_32x32x16_bf16 v[64:79], v[212:215], v[84:87], v[64:79]
  s_cmp_lg_u64 vcc, 0
  s_cbranch_scc1 L_slow_66
L_cont_67:
  v_mfma_f32_32x32x16_bf16 v[16:31], v[216:219], v[144:147], v[16:31]
  s_waitcnt vmcnt(21)
  v_xor_b32 v112, v112, v14
  v_xor_b32 v114, v114, v15
  s_waitcnt vmcnt(20)
  v_xor_b32 v116, v116, v14
  v_xor_b32 v118, v118, v15
  v_mfma_f32_32x32x16_bf16 v[32:47], v[220:223], v[144:147], v[32:47]
  s_add_u32 s78, s13, s91
  s_add_u32 s78, s78, 114688
  v_bitop3_b32 v2, v112, v114, v112 bitop3:0xf3
  v_bitop3_b32 v2, v116, v118, v2 bitop3:0xfb
  v_mfma_f32_32x32x16_bf16 v[48:63], v[216:219], v[148:151], v[48:63]
  buffer_load_dwordx4 v[176:179], v10, s[32:35], s78 offen sc1
  buffer_load_dwordx4 v[180:183], v11, s[32:35], s78 offen sc1
  v_and_b32 v2, s3, v2
  v_cmp_ne_u32 vcc, 0, v2
  v_mfma_f32_32x32x16_bf16 v[64:79], v[220:223], v[148:151], v[64:79]
  s_cmp_lg_u64 vcc, 0
  s_cbranch_scc1 L_slow_70
L_cont_71:
  v_mfma_f32_32x32x16_bf16 v[16:31], v[224:227], v[112:115], v[16:31]
  s_waitcnt vmcnt(21)
  v_xor_b32 v152, v152, v14
  v_xor_b32 v154, v154, v15
  s_waitcnt vmcnt(20)
  v_xor_b32 v156, v156, v14
  v_xor_b32 v158, v158, v15
  v_mfma_f32_32x32x16_bf16 v[32:47], v[228:231], v[112:115], v[32:47]
  s_add_u32 s78, s13, s92
  s_add_u32 s78, s78, 114688
  v_bitop3_b32 v2, v152, v154, v152 bitop3:0xf3
  v_bitop3_b32 v2, v156, v158, v2 bitop3:0xfb
  v_mfma_f32_32x32x16_bf16 v[48:63], v[224:227], v[116:119], v[48:63]
  buffer_load_dwordx4 v[128:131], v10, s[32:35], s78 offen sc1
  buffer_load_dwordx4 v[132:135], v11, s[32:35], s78 offen sc1
  v_and_b32 v2, s3, v2
  v_cmp_ne_u32 vcc, 0, v2
  v_mfma_f32_32x32x16_bf16 v[64:79], v[228:231], v[116:119], v[64:79]
  s_cmp_lg_u64 vcc, 0
  s_cbranch_scc1 L_slow_74
L_cont_75:
  v_mfma_f32_32x32x16_bf16 v[16:31], v[232:235], v[152:155], v[16:31]
  s_waitcnt vmcnt(19)
  v_xor_b32 v88, v88, v14
  v_xor_b32 v90, v90, v15
  s_waitcnt vmcnt(18)
  v_xor_b32 v92, v92, v14
  v_xor_b32 v94, v94, v15
  v_mfma_f32_32x32x16_bf16 v[32:47], v[236:239], v[152:155], v[32:47]
  v_add_u32 v8, 65536, v8
  v_add_u32 v9, 65536, v9
  ds_read_b64_tr_b16 v[184:185], v8 offset:0
  v_bitop3_b32 v2, v88, v90, v88 bitop3:0xf3
  v_bitop3_b32 v2, v92, v94, v2 bitop3:0xfb
  v_mfma_f32_32x32x16_bf16 v[48:63], v[232:235], v[156:159], v[48:63]
  ds_read_b64_tr_b16 v[186:187], v8 offset:1024
  ds_read_b64_tr_b16 v[188:189], v9 offset:0
  ds_read_b64_tr_b16 v[190:191], v9 offset:1024
  s_add_u32 s78, s13, s93
  v_and_b32 v2, s3, v2
  v_cmp_ne_u32 vcc, 0, v2
  v_mfma_f32_32x32x16_bf16 v[64:79], v[236:239], v[156:159], v[64:79]
  s_add_u32 s78, s78, 114688
  buffer_load_dwordx4 v[104:107], v10, s[32:35], s78 offen sc1
  buffer_load_dwordx4 v[108:111], v11, s[32:35], s78 offen sc1
  s_cmp_lg_u64 vcc, 0
  s_cbranch_scc1 L_slow_78
L_cont_79:
  v_mfma_f32_32x32x16_bf16 v[16:31], v[240:243], v[88:91], v[16:31]
  s_waitcnt vmcnt(17)
  v_xor_b32 v160, v160, v14
  v_xor_b32 v162, v162, v15
  s_waitcnt vmcnt(16)
  v_xor_b32 v164, v164, v14
  v_xor_b32 v166, v166, v15
  v_mfma_f32_32x32x16_bf16 v[32:47], v[244:247], v[88:91], v[32:47]
  ds_read_b64_tr_b16 v[192:193], v8 offset:2048
  ds_read_b64_tr_b16 v[194:195], v8 offset:3072
  v_bitop3_b32 v2, v160, v162, v160 bitop3:0xf3
  v_bitop3_b32 v2, v164, v166, v2 bitop3:0xfb
  v_mfma_f32_32x32x16_bf16 v[48:63], v[240:243], v[92:95], v[48:63]
  ds_read_b64_tr_b16 v[196:197], v9 offset:2048
  ds_read_b64_tr_b16 v[198:199], v9 offset:3072
  s_add_u32 s78, s10, s14
  v_and_b32 v2, s3, v2
  v_cmp_ne_u32 vcc, 0, v2
  v_mfma_f32_32x32x16_bf16 v[64:79], v[244:247], v[92:95], v[64:79]
  buffer_load_dwordx4 v[136:139], v10, s[32:35], s78 offen sc1
  buffer_load_dwordx4 v[140:143], v11, s[32:35], s78 offen sc1
  s_cmp_lg_u64 vcc, 0
  s_cbranch_scc1 L_slow_82
L_cont_83:
  v_mfma_f32_32x32x16_bf16 v[16:31], v[248:251], v[160:163], v[16:31]
  s_waitcnt vmcnt(15)
  v_xor_b32 v120, v120, v14
  v_xor_b32 v122, v122, v15
  s_waitcnt vmcnt(14)
  v_xor_b32 v124, v124, v14
  v_xor_b32 v126, v126, v15
  v_mfma_f32_32x32x16_bf16 v[32:47], v[252:255], v[160:163], v[32:47]
  v_subrev_u32 v8, 65536, v8
  v_subrev_u32 v9, 65536, v9
  ds_read_b64_tr_b16 v[200:201], v8 offset:0
  v_bitop3_b32 v2, v120, v122, v120 bitop3:0xf3
  v_bitop3_b32 v2, v124, v126, v2 bitop3:0xfb
  v_mfma_f32_32x32x16_bf16 v[48:63], v[248:251], v[164:167], v[48:63]
  ds_read_b64_tr_b16 v[202:203], v8 offset:1024
  ds_read_b64_tr_b16 v[204:205], v9 offset:0
  ds_read_b64_tr_b16 v[206:207], v9 offset:1024
  s_add_u32 s78, s10, s15
  v_and_b32 v2, s3, v2
  v_cmp_ne_u32 vcc, 0, v2
  v_mfma_f32_32x32x16_bf16 v[64:79], v[252:255], v[164:167], v[64:79]
  buffer_load_dwordx4 v[80:83], v10, s[32:35], s78 offen sc1
  buffer_load_dwordx4 v[84:87], v11, s[32:35], s78 offen sc1
  s_cmp_lg_u64 vcc, 0
  s_cbranch_scc1 L_slow_86
L_cont_87:
  s_waitcnt lgkmcnt(10)
  v_mfma_f32_32x32x16_bf16 v[16:31], v[184:187], v[120:123], v[16:31]
  s_waitcnt vmcnt(13)
  v_xor_b32 v168, v168, v14
  v_xor_b32 v170, v170, v15
  s_waitcnt vmcnt(12)
  v_xor_b32 v172, v172, v14
  v_xor_b32 v174, v174, v15
  s_waitcnt lgkmcnt(8)
  v_mfma_f32_32x32x16_bf16 v[32:47], v[188:191], v[120:123], v[32:47]
  ds_read_b64_tr_b16 v[208:209], v8 offset:2048
  ds_read_b64_tr_b16 v[210:211], v8 offset:3072
  v_bitop3_b32 v2, v168, v170, v168 bitop3:0xf3
  v_bitop3_b32 v2, v172, v174, v2 bitop3:0xfb
  v_mfma_f32_32x32x16_bf16 v[48:63], v[184:187], v[124:127], v[48:63]
  ds_read_b64_tr_b16 v[212:213], v9 offset:2048
  ds_read_b64_tr_b16 v[214:215], v9 offset:3072
  s_add_u32 s78, s11, s14
  v_and_b32 v2, s3, v2
  v_cmp_ne_u32 vcc, 0, v2
  v_mfma_f32_32x32x16_bf16 v[64:79], v[188:191], v[124:127], v[64:79]
  buffer_load_dwordx4 v[144:147], v10, s[32:35], s78 offen sc1
  buffer_load_dwordx4 v[148:151], v11, s[32:35], s78 offen sc1
  s_cmp_lg_u64 vcc, 0
  s_cbranch_scc1 L_slow_90
L_cont_91:
  s_waitcnt lgkmcnt(10)
  v_mfma_f32_32x32x16_bf16 v[16:31], v[192:195], v[168:171], v[16:31]
  s_waitcnt vmcnt(13)
  v_xor_b32 v96, v96, v14
  v_xor_b32 v98, v98, v15
  s_waitcnt vmcnt(12)
  v_xor_b32 v100, v100, v14
  v_xor_b32 v102, v102, v15
  s_waitcnt lgkmcnt(8)
  v_mfma_f32_32x32x16_bf16 v[32:47], v[196:199], v[168:171], v[32:47]
  ds_read_b64_tr_b16 v[216:217], v8 offset:16384
  ds_read_b64_tr_b16 v[218:219], v8 offset:17408
  v_bitop3_b32 v2, v96, v98, v96 bitop3:0xf3
  v_bitop3_b32 v2, v100, v102, v2 bitop3:0xfb
  v_mfma_f32_32x32x16_bf16 v[48:63], v[192:195], v[172:175], v[48:63]
  ds_read_b64_tr_b16 v[220:221], v9 offset:16384
  ds_read_b64_tr_b16 v[222:223], v9 offset:17408
  s_add_u32 s78, s11, s15
  v_and_b32 v2, s3, v2
  v_cmp_ne_u32 vcc, 0, v2
  v_mfma_f32_32x32x16_bf16 v[64:79], v[196:199], v[172:175], v[64:79]
  buffer_load_dwordx4 v[112:115], v10, s[32:35], s78 offen sc1
  buffer_load_dwordx4 v[116:119], v11, s[32:35], s78 offen sc1
  s_cmp_lg_u64 vcc, 0
  s_cbranch_scc1 L_slow_94
L_cont_95:
  s_waitcnt lgkmcnt(10)
  v_mfma_f32_32x32x16_bf16 v[16:31], v[200:203], v[96:99], v[16:31]
  s_waitcnt vmcnt(13)
  v_xor_b32 v176, v176, v14
  v_xor_b32 v178, v178, v15
  s_waitcnt vmcnt(12)
  v_xor_b32 v180, v180, v14
  v_xor_b32 v182, v182, v15
  s_waitcnt lgkmcnt(8)
  v_mfma_f32_32x32x16_bf16 v[32:47], v[204:207], v[96:99], v[32:47]
  ds_read_b64_tr_b16 v[224:225], v8 offset:18432
  ds_read_b64_tr_b16 v[226:227], v8 offset:19456
  v_bitop3_b32 v2, v176, v178, v176 bitop3:0xf3
  v_bitop3_b32 v2, v180, v182, v2 bitop3:0xfb
  v_mfma_f32_32x32x16_bf16 v[48:63], v[200:203], v[100:103], v[48:63]
  ds_read_b64_tr_b16 v[228:229], v9 offset:18432
  ds_read_b64_tr_b16 v[230:231], v9 offset:19456
  s_add_u32 s78, s6, s90
  v_and_b32 v2, s3, v2
  v_cmp_ne_u32 vcc, 0, v2
  v_mfma_f32_32x32x16_bf16 v[64:79], v[204:207], v[100:103], v[64:79]
  buffer_load_dwordx4 v[152:155], v10, s[32:35], s78 offen sc1
  buffer_load_dwordx4 v[156:159], v11, s[32:35], s78 offen sc1
  s_cmp_lg_u64 vcc, 0
  s_cbranch_scc1 L_slow_98
L_cont_99:
  s_waitcnt lgkmcnt(10)
  v_mfma_f32_32x32x16_bf16 v[16:31], v[208:211], v[176:179], v[16:31]
  s_waitcnt vmcnt(13)
  v_xor_b32 v128, v128, v14
  v_xor_b32 v130, v130, v15
  s_waitcnt vmcnt(12)
  v_xor_b32 v132, v132, v14
  v_xor_b32 v134, v134, v15
  s_waitcnt lgkmcnt(8)
  v_mfma_f32_32x32x16_bf16 v[32:47], v[212:215], v[176:179], v[32:47]
  v_subrev_u32 v8, 65536, v8
  v_subrev_u32 v9, 65536, v9
  ds_read_b64_tr_b16 v[232:233], v8 offset:32768
  v_bitop3_b32 v2, v128, v130, v128 bitop3:0xf3
  v_bitop3_b32 v2, v132, v134, v2 bitop3:0xfb
  v_mfma_f32_32x32x16_bf16 v[48:63], v[208:211], v[180:183], v[48:63]
  ds_read_b64_tr_b16 v[234:235], v8 offset:33792
  ds_read_b64_tr_b16 v[236:237], v9 offset:32768
  ds_read_b64_tr_b16 v[238:239], v9 offset:33792
  s_add_u32 s78, s6, s91
  v_and_b32 v2, s3, v2
  v_cmp_ne_u32 vcc, 0, v2
  v_mfma_f32_32x32x16_bf16 v[64:79], v[212:215], v[180:183], v[64:79]
  buffer_load_dwordx4 v[88:91], v10, s[32:35], s78 offen sc1
  buffer_load_dwordx4 v[92:95], v11, s[32:35], s78 offen sc1
  s_cmp_lg_u64 vcc, 0
  s_cbranch_scc1 L_slow_102
L_cont_103:
  s_waitcnt lgkmcnt(10)
  v_mfma_f32_32x32x16_bf16 v[16:31], v[216:219], v[128:131], v[16:31]
  s_waitcnt vmcnt(13)
  v_xor_b32 v104, v104, v14
  v_xor_b32 v106, v106, v15
  s_waitcnt vmcnt(12)
  v_xor_b32 v108, v108, v14
  v_xor_b32 v110, v110, v15
  s_waitcnt lgkmcnt(8)
  v_mfma_f32_32x32x16_bf16 v[32:47], v[220:223], v[128:131], v[32:47]
  ds_read_b64_tr_b16 v[240:241], v8 offset:34816
  ds_read_b64_tr_b16 v[242:243], v8 offset:35840
  v_bitop3_b32 v2, v104, v106, v104 bitop3:0xf3
  v_bitop3_b32 v2, v108, v110, v2 bitop3:0xfb
  v_mfma_f32_32x32x16_bf16 v[48:63], v[216:219], v[132:135], v[48:63]
  ds_read_b64_tr_b16 v[244:245], v9 offset:34816
  ds_read_b64_tr_b16 v[246:247], v9 offset:35840
  s_add_u32 s78, s6, s92
  v_and_b32 v2, s3, v2
  v_cmp_ne_u32 vcc, 0, v2
  v_mfma_f32_32x32x16_bf16 v[64:79], v[220:223], v[132:135], v[64:79]
  buffer_load_dwordx4 v[160:163], v10, s[32:35], s78 offen sc1
  buffer_load_dwordx4 v[164:167], v11, s[32:35], s78 offen sc1
  s_cmp_lg_u64 vcc, 0
  s_cbranch_scc1 L_slow_106
L_cont_107:
  s_waitcnt lgkmcnt(10)
  v_mfma_f32_32x32x16_bf16 v[16:31], v[224:227], v[104:107], v[16:31]
  s_waitcnt vmcnt(13)
  v_xor_b32 v136, v136, v14
  v_xor_b32 v138, v138, v15
  s_waitcnt vmcnt(12)
  v_xor_b32 v140, v140, v14
  v_xor_b32 v142, v142, v15
  s_waitcnt lgkmcnt(8)
  v_mfma_f32_32x32x16_bf16 v[32:47], v[228:231], v[104:107], v[32:47]
  ds_read_b64_tr_b16 v[248:249], v8 offset:49152
  ds_read_b64_tr_b16 v[250:251], v8 offset:50176
  v_bitop3_b32 v2, v136, v138, v136 bitop3:0xf3
  v_bitop3_b32 v2, v140, v142, v2 bitop3:0xfb
  v_mfma_f32_32x32x16_bf16 v[48:63], v[224:227], v[108:111], v[48:63]
  ds_read_b64_tr_b16 v[252:253], v9 offset:49152
  ds_read_b64_tr_b16 v[254:255], v9 offset:50176
  s_add_u32 s78, s6, s93
  v_and_b32 v2, s3, v2
  v_cmp_ne_u32 vcc, 0, v2
  v_mfma_f32_32x32x16_bf16 v[64:79], v[228:231], v[108:111], v[64:79]
  buffer_load_dwordx4 v[120:123], v10, s[32:35], s78 offen sc1
  buffer_load_dwordx4 v[124:127], v11, s[32:35], s78 offen sc1
  s_cmp_lg_u64 vcc, 0
  s_cbranch_scc1 L_slow_110
L_cont_111:
  s_waitcnt lgkmcnt(10)
  v_mfma_f32_32x32x16_bf16 v[16:31], v[232:235], v[136:139], v[16:31]
  s_waitcnt vmcnt(13)
  v_xor_b32 v80, v80, v14
  v_xor_b32 v82, v82, v15
  s_waitcnt vmcnt(12)
  v_xor_b32 v84, v84, v14
  v_xor_b32 v86, v86, v15
  s_waitcnt lgkmcnt(8)
  v_mfma_f32_32x32x16_bf16 v[32:47], v[236:239], v[136:139], v[32:47]
  ds_read_b64_tr_b16 v[184:185], v8 offset:51200
  ds_read_b64_tr_b16 v[186:187], v8 offset:52224
  v_bitop3_b32 v2, v80, v82, v80 bitop3:0xf3
  v_bitop3_b32 v2, v84, v86, v2 bitop3:0xfb
  v_mfma_f32_32x32x16_bf16 v[48:63], v[232:235], v[140:143], v[48:63]
  ds_read_b64_tr_b16 v[188:189], v9 offset:51200
  ds_read_b64_tr_b16 v[190:191], v9 offset:52224
  s_add_u32 s78, s7, s90
  v_and_b32 v2, s3, v2
  v_cmp_ne_u32 vcc, 0, v2
  v_mfma_f32_32x32x16_bf16 v[64:79], v[236:239], v[140:143], v[64:79]
  buffer_load_dwordx4 v[168:171], v10, s[32:35], s78 offen sc1
  buffer_load_dwordx4 v[172:175], v11, s[32:35], s78 offen sc1
  s_cmp_lg_u64 vcc, 0
  s_cbranch_scc1 L_slow_114
L_cont_115:
  s_waitcnt lgkmcnt(10)
  v_mfma_f32_32x32x16_bf16 v[16:31], v[240:243], v[80:83], v[16:31]
  s_waitcnt vmcnt(13)
  v_xor_b32 v144, v144, v14
  v_xor_b32 v146, v146, v15
  s_waitcnt vmcnt(12)
  v_xor_b32 v148, v148, v14
  v_xor_b32 v150, v150, v15
  s_waitcnt lgkmcnt(8)
  v_mfma_f32_32x32x16_bf16 v[32:47], v[244:247], v[80:83], v[32:47]
  ds_read_b64_tr_b16 v[192:193], v8 offset:0
  ds_read_b64_tr_b16 v[194:195], v8 offset:1024
  v_bitop3_b32 v2, v144, v146, v144 bitop3:0xf3
  v_bitop3_b32 v2, v148, v150, v2 bitop3:0xfb
  v_mfma_f32_32x32x16_bf16 v[48:63], v[240:243], v[84:87], v[48:63]
  ds_read_b64_tr_b16 v[196:197], v9 offset:0
  ds_read_b64_tr_b16 v[198:199], v9 offset:1024
  s_add_u32 s78, s7, s91
  v_and_b32 v2, s3, v2
  v_cmp_ne_u32 vcc, 0, v2
  v_mfma_f32_32x32x16_bf16 v[64:79], v[244:247], v[84:87], v[64:79]
  buffer_load_dwordx4 v[96:99], v10, s[32:35], s78 offen sc1
  buffer_load_dwordx4 v[100:103], v11, s[32:35], s78 offen sc1
  s_cmp_lg_u64 vcc, 0
  s_cbranch_scc1 L_slow_118
L_cont_119:
  s_waitcnt lgkmcnt(10)
  v_mfma_f32_32x32x16_bf16 v[16:31], v[248:251], v[144:147], v[16:31]
  s_waitcnt vmcnt(13)
  v_xor_b32 v112, v112, v14
  v_xor_b32 v114, v114, v15
  s_waitcnt vmcnt(12)
  v_xor_b32 v116, v116, v14
  v_xor_b32 v118, v118, v15
  s_waitcnt lgkmcnt(8)
  v_mfma_f32_32x32x16_bf16 v[32:47], v[252:255], v[144:147], v[32:47]
  ds_read_b64_tr_b16 v[200:201], v8 offset:2048
  ds_read_b64_tr_b16 v[202:203], v8 offset:3072
  v_bitop3_b32 v2, v112, v114, v112 bitop3:0xf3
  v_bitop3_b32 v2, v116, v118, v2 bitop3:0xfb
  v_mfma_f32_32x32x16_bf16 v[48:63], v[248:251], v[148:151], v[48:63]
  ds_read_b64_tr_b16 v[204:205], v9 offset:2048
  ds_read_b64_tr_b16 v[206:207], v9 offset:3072
  s_add_u32 s78, s7, s92
  v_and_b32 v2, s3, v2
  v_cmp_ne_u32 vcc, 0, v2
  v_mfma_f32_32x32x16_bf16 v[64:79], v[252:255], v[148:151], v[64:79]
  buffer_load_dwordx4 v[176:179], v10, s[32:35], s78 offen sc1
  buffer_load_dwordx4 v[180:183], v11, s[32:35], s78 offen sc1
  s_cmp_lg_u64 vcc, 0
  s_cbranch_scc1 L_slow_122
L_cont_123:
  s_waitcnt lgkmcnt(10)
  v_mfma_f32_32x32x16_bf16 v[16:31], v[184:187], v[112:115], v[16:31]
  s_waitcnt vmcnt(13)
  v_xor_b32 v152, v152, v14
  v_xor_b32 v154, v154, v15
  s_waitcnt vmcnt(12)
  v_xor_b32 v156, v156, v14
  v_xor_b32 v158, v158, v15
  s_waitcnt lgkmcnt(8)
  v_mfma_f32_32x32x16_bf16 v[32:47], v[188:191], v[112:115], v[32:47]
  ds_read_b64_tr_b16 v[208:209], v8 offset:16384
  ds_read_b64_tr_b16 v[210:211], v8 offset:17408
  v_bitop3_b32 v2, v152, v154, v152 bitop3:0xf3
  v_bitop3_b32 v2, v156, v158, v2 bitop3:0xfb
  v_mfma_f32_32x32x16_bf16 v[48:63], v[184:187], v[116:119], v[48:63]
  ds_read_b64_tr_b16 v[212:213], v9 offset:16384
  ds_read_b64_tr_b16 v[214:215], v9 offset:17408
  s_add_u32 s78, s7, s93
  v_and_b32 v2, s3, v2
  v_cmp_ne_u32 vcc, 0, v2
  v_mfma_f32_32x32x16_bf16 v[64:79], v[188:191], v[116:119], v[64:79]
  buffer_load_dwordx4 v[128:131], v10, s[32:35], s78 offen sc1
  buffer_load_dwordx4 v[132:135], v11, s[32:35], s78 offen sc1
  s_cmp_lg_u64 vcc, 0
  s_cbranch_scc1 L_slow_126
L_cont_127:
  s_waitcnt lgkmcnt(10)
  v_mfma_f32_32x32x16_bf16 v[16:31], v[192:195], v[152:155], v[16:31]
  s_waitcnt vmcnt(13)
  v_xor_b32 v88, v88, v14
  v_xor_b32 v90, v90, v15
  s_waitcnt vmcnt(12)
  v_xor_b32 v92, v92, v14
  v_xor_b32 v94, v94, v15
  s_waitcnt lgkmcnt(8)
  v_mfma_f32_32x32x16_bf16 v[32:47], v[196:199], v[152:155], v[32:47]
  ds_read_b64_tr_b16 v[216:217], v8 offset:18432
  v_bitop3_b32 v2, v88, v90, v88 bitop3:0xf3
  v_bitop3_b32 v2, v92, v94, v2 bitop3:0xfb
  v_mfma_f32_32x32x16_bf16 v[48:63], v[192:195], v[156:159], v[48:63]
  ds_read_b64_tr_b16 v[218:219], v8 offset:19456
  ds_read_b64_tr_b16 v[220:221], v9 offset:18432
  v_and_b32 v2, s3, v2
  v_cmp_ne_u32 vcc, 0, v2
  v_mfma_f32_32x32x16_bf16 v[64:79], v[196:199], v[156:159], v[64:79]
  ds_read_b64_tr_b16 v[222:223], v9 offset:19456
  s_cmp_lg_u64 vcc, 0
  s_cbranch_scc1 L_slow_130
L_cont_131:
  s_waitcnt lgkmcnt(10)
  v_mfma_f32_32x32x16_bf16 v[16:31], v[200:203], v[88:91], v[16:31]
  s_waitcnt vmcnt(11)
  v_xor_b32 v160, v160, v14
  v_xor_b32 v162, v162, v15
  s_waitcnt vmcnt(10)
  v_xor_b32 v164, v164, v14
  v_xor_b32 v166, v166, v15
  s_waitcnt lgkmcnt(8)
  v_mfma_f32_32x32x16_bf16 v[32:47], v[204:207], v[88:91], v[32:47]
  v_add_u32 v8, 65536, v8
  v_add_u32 v9, 65536, v9
  v_bitop3_b32 v2, v160, v162, v160 bitop3:0xf3
  v_bitop3_b32 v2, v164, v166, v2 bitop3:0xfb
  v_mfma_f32_32x32x16_bf16 v[48:63], v[200:203], v[92:95], v[48:63]
  ds_read_b64_tr_b16 v[104:105], v8 offset:32768
  ds_read_b64_tr_b16 v[106:107], v8 offset:33792
  ds_read_b64_tr_b16 v[108:109], v9 offset:32768
  v_and_b32 v2, s3, v2
  v_cmp_ne_u32 vcc, 0, v2
  v_mfma_f32_32x32x16_bf16 v[64:79], v[204:207], v[92:95], v[64:79]
  ds_read_b64_tr_b16 v[110:111], v9 offset:33792
  s_cmp_lg_u64 vcc, 0
  s_cbranch_scc1 L_slow_134
L_cont_135:
  s_waitcnt lgkmcnt(10)
  v_mfma_f32_32x32x16_bf16 v[16:31], v[208:211], v[160:163], v[16:31]
  s_waitcnt vmcnt(9)
  v_xor_b32 v120, v120, v14
  v_xor_b32 v122, v122, v15
  s_waitcnt vmcnt(8)
  v_xor_b32 v124, v124, v14
  v_xor_b32 v126, v126, v15
  s_waitcnt lgkmcnt(8)
  v_mfma_f32_32x32x16_bf16 v[32:47], v[212:215], v[160:163], v[32:47]
  ds_read_b64_tr_b16 v[224:225], v8 offset:34816
  ds_read_b64_tr_b16 v[226:227], v8 offset:35840
  v_bitop3_b32 v2, v120, v122, v120 bitop3:0xf3
  v_bitop3_b32 v2, v124, v126, v2 bitop3:0xfb
  v_mfma_f32_32x32x16_bf16 v[48:63], v[208:211], v[164:167], v[48:63]
  ds_read_b64_tr_b16 v[228:229], v9 offset:34816
  ds_read_b64_tr_b16 v[230:231], v9 offset:35840
  buffer_load_dwordx4 v[136:139], v4, s[28:31], 0 offen
  v_and_b32 v2, s3, v2
  v_cmp_ne_u32 vcc, 0, v2
  v_mfma_f32_32x32x16_bf16 v[64:79], v[212:215], v[164:167], v[64:79]
  buffer_load_dwordx4 v[140:143], v4, s[28:31], 0 offen offset:32
  s_cmp_lg_u64 vcc, 0
  s_cbranch_scc1 L_slow_138
L_cont_139:
  s_waitcnt lgkmcnt(10)
  v_mfma_f32_32x32x16_bf16 v[16:31], v[216:219], v[120:123], v[16:31]
  s_waitcnt vmcnt(9)
  v_xor_b32 v168, v168, v14
  v_xor_b32 v170, v170, v15
  s_waitcnt vmcnt(8)
  v_xor_b32 v172, v172, v14
  v_xor_b32 v174, v174, v15
  s_waitcnt lgkmcnt(8)
  v_mfma_f32_32x32x16_bf16 v[32:47], v[220:223], v[120:123], v[32:47]
  ds_read_b64_tr_b16 v[232:233], v8 offset:49152
  v_bitop3_b32 v2, v168, v170, v168 bitop3:0xf3
  v_bitop3_b32 v2, v172, v174, v2 bitop3:0xfb
  v_mfma_f32_32x32x16_bf16 v[48:63], v[216:219], v[124:127], v[48:63]
  ds_read_b64_tr_b16 v[234:235], v8 offset:50176
  ds_read_b64_tr_b16 v[236:237], v9 offset:49152
  v_and_b32 v2, s3, v2
  v_cmp_ne_u32 vcc, 0, v2
  v_mfma_f32_32x32x16_bf16 v[64:79], v[220:223], v[124:127], v[64:79]
  ds_read_b64_tr_b16 v[238:239], v9 offset:50176
  s_cmp_lg_u64 vcc, 0
  s_cbranch_scc1 L_slow_142
L_cont_143:
  s_waitcnt lgkmcnt(8)
  v_mfma_f32_32x32x16_bf16 v[32:47], v[108:111], v[168:171], v[32:47]
  ds_read_b64_tr_b16 v[80:81], v8 offset:51200
  ds_read_b64_tr_b16 v[82:83], v8 offset:52224
  ds_read_b64_tr_b16 v[84:85], v9 offset:51200
  ds_read_b64_tr_b16 v[86:87], v9 offset:52224
  s_waitcnt vmcnt(7)
  v_xor_b32 v96, v96, v14
  v_xor_b32 v98, v98, v15
  s_waitcnt vmcnt(6)
  v_xor_b32 v100, v100, v14
  v_xor_b32 v102, v102, v15
  v_bitop3_b32 v2, v96, v98, v96 bitop3:0xf3
  v_bitop3_b32 v2, v100, v102, v2 bitop3:0xfb
  v_and_b32 v2, s3, v2
  v_cmp_ne_u32 vcc, 0, v2
  s_nop 0
  s_cmp_lg_u64 vcc, 0
  s_cbranch_scc1 L_slow_146
L_cont_147:
  s_waitcnt lgkmcnt(8)
  v_mfma_f32_32x32x16_bf16 v[32:47], v[228:231], v[96:99], v[32:47]
  s_waitcnt vmcnt(5)
  v_xor_b32 v176, v176, v14
  v_xor_b32 v178, v178, v15
  s_waitcnt vmcnt(4)
  v_xor_b32 v180, v180, v14
  v_xor_b32 v182, v182, v15
  v_bitop3_b32 v2, v176, v178, v176 bitop3:0xf3
  v_bitop3_b32 v2, v180, v182, v2 bitop3:0xfb
  v_and_b32 v2, s3, v2
  v_cmp_ne_u32 vcc, 0, v2
  s_nop 0
  s_cmp_lg_u64 vcc, 0
  s_cbranch_scc1 L_slow_150
L_cont_151:
  s_waitcnt lgkmcnt(4)
  v_mfma_f32_32x32x16_bf16 v[32:47], v[236:239], v[176:179], v[32:47]
  s_waitcnt vmcnt(3)
  v_xor_b32 v128, v128, v14
  v_xor_b32 v130, v130, v15
  s_waitcnt vmcnt(2)
  v_xor_b32 v132, v132, v14
  v_xor_b32 v134, v134, v15
  v_bitop3_b32 v2, v128, v130, v128 bitop3:0xf3
  v_bitop3_b32 v2, v132, v134, v2 bitop3:0xfb
  v_and_b32 v2, s3, v2
  v_cmp_ne_u32 vcc, 0, v2
  s_nop 0
  s_cmp_lg_u64 vcc, 0
  s_cbranch_scc1 L_slow_154
L_cont_155:
  s_waitcnt lgkmcnt(0)
  v_mfma_f32_32x32x16_bf16 v[32:47], v[84:87], v[128:131], v[32:47]
  s_add_u32 s76, s99, 65536
  v_add_u32 v12, s76, v1
  v_mfma_f32_32x32x16_bf16 v[48:63], v[104:107], v[172:175], v[48:63]
  v_mfma_f32_32x32x16_bf16 v[48:63], v[224:227], v[100:103], v[48:63]
  s_nop 7
  ds_write_b128 v12, v[32:35] offset:16384
  v_mfma_f32_32x32x16_bf16 v[48:63], v[232:235], v[180:183], v[48:63]
  ds_write_b128 v12, v[36:39] offset:17408
  ds_write_b128 v12, v[40:43] offset:18432
  v_mfma_f32_32x32x16_bf16 v[48:63], v[80:83], v[132:135], v[48:63]
  ds_write_b128 v12, v[44:47] offset:19456
  v_mfma_f32_32x32x16_bf16 v[64:79], v[108:111], v[172:175], v[64:79]
  v_mfma_f32_32x32x16_bf16 v[64:79], v[228:231], v[100:103], v[64:79]
  s_nop 8
  ds_write_b128 v12, v[48:51] offset:32768
  v_mfma_f32_32x32x16_bf16 v[64:79], v[236:239], v[180:183], v[64:79]
  ds_write_b128 v12, v[52:55] offset:33792
  ds_write_b128 v12, v[56:59] offset:34816
  v_mfma_f32_32x32x16_bf16 v[64:79], v[84:87], v[132:135], v[64:79]
  ds_write_b128 v12, v[60:63] offset:35840
  v_mfma_f32_32x32x16_bf16 v[16:31], v[104:107], v[168:171], v[16:31]
  v_mfma_f32_32x32x16_bf16 v[16:31], v[224:227], v[96:99], v[16:31]
  s_nop 8
  ds_write_b128 v12, v[64:67] offset:49152
  v_mfma_f32_32x32x16_bf16 v[16:31], v[232:235], v[176:179], v[16:31]
  ds_write_b128 v12, v[68:71] offset:50176
  ds_write_b128 v12, v[72:75] offset:51200
  v_mfma_f32_32x32x16_bf16 v[16:31], v[80:83], v[128:131], v[16:31]
  ds_write_b128 v12, v[76:79] offset:52224
  v_xor_b32 v13, 4096, v12
  v_xor_b32 v14, 8192, v12
  v_xor_b32 v15, 12288, v12
  v_bfe_u32 v6, v0, 4, 1
  v_mul_u32_u24 v6, 16352, v6
  v_sub_u32 v6, v4, v6
  s_waitcnt vmcnt(1)
  v_permlane32_swap_b32 v136, v138
  v_permlane32_swap_b32 v137, v139
  s_waitcnt vmcnt(0)
  v_permlane32_swap_b32 v140, v142
  v_permlane32_swap_b32 v141, v143
  v_lshlrev_b32 v2, 16, v136
  v_and_b32 v3, s87, v136
  v_pk_add_f32 v[16:17], v[16:17], v[2:3]
  v_lshlrev_b32 v2, 16, v137
  v_and_b32 v3, s87, v137
  v_pk_add_f32 v[18:19], v[18:19], v[2:3]
  v_lshlrev_b32 v2, 16, v138
  v_and_b32 v3, s87, v138
  v_pk_add_f32 v[20:21], v[20:21], v[2:3]
  v_lshlrev_b32 v2, 16, v139
  v_and_b32 v3, s87, v139
  v_pk_add_f32 v[22:23], v[22:23], v[2:3]
  v_lshlrev_b32 v2, 16, v140
  v_and_b32 v3, s87, v140
  v_pk_add_f32 v[24:25], v[24:25], v[2:3]
  v_lshlrev_b32 v2, 16, v141
  v_and_b32 v3, s87, v141
  v_pk_add_f32 v[26:27], v[26:27], v[2:3]
  v_lshlrev_b32 v2, 16, v142
  v_and_b32 v3, s87, v142
  v_pk_add_f32 v[28:29], v[28:29], v[2:3]
  v_lshlrev_b32 v2, 16, v143
  v_and_b32 v3, s87, v143
  v_pk_add_f32 v[30:31], v[30:31], v[2:3]
  s_waitcnt lgkmcnt(0)
  s_barrier
  ds_read_b128 v[32:35], v13 offset:16384
  ds_read_b128 v[36:39], v13 offset:17408
  ds_read_b128 v[40:43], v13 offset:18432
  ds_read_b128 v[44:47], v13 offset:19456
  ds_read_b128 v[48:51], v14 offset:32768
  ds_read_b128 v[52:55], v14 offset:33792
  ds_read_b128 v[56:59], v14 offset:34816
  ds_read_b128 v[60:63], v14 offset:35840
  ds_read_b128 v[64:67], v15 offset:49152
  ds_read_b128 v[68:71], v15 offset:50176
  ds_read_b128 v[72:75], v15 offset:51200
  ds_read_b128 v[76:79], v15 offset:52224
  s_waitcnt lgkmcnt(11)
  v_pk_add_f32 v[16:17], v[16:17], v[32:33]
  v_pk_add_f32 v[18:19], v[18:19], v[34:35]
  s_waitcnt lgkmcnt(10)
  v_pk_add_f32 v[20:21], v[20:21], v[36:37]
  v_pk_add_f32 v[22:23], v[22:23], v[38:39]
  s_waitcnt lgkmcnt(9)
  v_pk_add_f32 v[24:25], v[24:25], v[40:41]
  v_pk_add_f32 v[26:27], v[26:27], v[42:43]
  s_waitcnt lgkmcnt(8)
  v_pk_add_f32 v[28:29], v[28:29], v[44:45]
  v_pk_add_f32 v[30:31], v[30:31], v[46:47]
  s_waitcnt lgkmcnt(7)
  v_pk_add_f32 v[16:17], v[16:17], v[48:49]
  v_pk_add_f32 v[18:19], v[18:19], v[50:51]
  s_waitcnt lgkmcnt(6)
  v_pk_add_f32 v[20:21], v[20:21], v[52:53]
  v_pk_add_f32 v[22:23], v[22:23], v[54:55]
  s_waitcnt lgkmcnt(5)
  v_pk_add_f32 v[24:25], v[24:25], v[56:57]
  v_pk_add_f32 v[26:27], v[26:27], v[58:59]
  s_waitcnt lgkmcnt(4)
  v_pk_add_f32 v[28:29], v[28:29], v[60:61]
  v_pk_add_f32 v[30:31], v[30:31], v[62:63]
  s_waitcnt lgkmcnt(3)
  v_pk_add_f32 v[16:17], v[16:17], v[64:65]
  v_pk_add_f32 v[18:19], v[18:19], v[66:67]
  s_waitcnt lgkmcnt(2)
  v_pk_add_f32 v[20:21], v[20:21], v[68:69]
  v_pk_add_f32 v[22:23], v[22:23], v[70:71]
  s_waitcnt lgkmcnt(1)
  v_pk_add_f32 v[24:25], v[24:25], v[72:73]
  v_pk_add_f32 v[26:27], v[26:27], v[74:75]
  s_waitcnt lgkmcnt(0)
  v_pk_add_f32 v[28:29], v[28:29], v[76:77]
  v_pk_add_f32 v[30:31], v[30:31], v[78:79]
  v_cvt_pk_bf16_f32 v16, v16, v17
  v_cvt_pk_bf16_f32 v17, v18, v19
  v_cvt_pk_bf16_f32 v18, v20, v21
  v_cvt_pk_bf16_f32 v19, v22, v23
  v_cvt_pk_bf16_f32 v20, v24, v25
  v_cvt_pk_bf16_f32 v21, v26, v27
  v_cvt_pk_bf16_f32 v22, v28, v29
  v_cvt_pk_bf16_f32 v23, v30, v31
  v_permlane32_swap_b32 v16, v18
  v_permlane32_swap_b32 v17, v19
  v_permlane32_swap_b32 v20, v22
  v_permlane32_swap_b32 v21, v23
  s_nop 0
  v_permlane16_swap_b32 v16, v20
  v_permlane16_swap_b32 v17, v21
  v_permlane16_swap_b32 v18, v22
  v_permlane16_swap_b32 v19, v23
  s_mov_b32 s76, 16384
  buffer_store_dwordx4 v[16:19], v6, s[64:67], 0 offen sc1
  buffer_store_dwordx4 v[20:23], v6, s[64:67], s76 offen sc1
  s_endpgm
L_slow_12:
  s_mov_b32 s86, 65536
L_sp_14:
  s_sleep 1
  s_add_u32 s78, s4, s90
  buffer_load_dwordx4 v[80:83], v10, s[32:35], s78 offen sc1
  buffer_load_dwordx4 v[84:87], v11, s[32:35], s78 offen sc1
  s_waitcnt vmcnt(0)
  v_xor_b32 v80, v80, v14
  v_xor_b32 v82, v82, v15
  v_xor_b32 v84, v84, v14
  v_xor_b32 v86, v86, v15
  v_bitop3_b32 v2, v80, v82, v80 bitop3:0xf3
  v_bitop3_b32 v2, v84, v86, v2 bitop3:0xfb
  v_and_b32 v2, s3, v2
  v_cmp_ne_u32 vcc, 0, v2
  s_nop 1
  s_cmp_lg_u64 vcc, 0
  s_cbranch_scc0 L_sd_15
  s_sub_u32 s86, s86, 1
  s_cbranch_scc0 L_sp_14
L_sd_15:
  s_add_u32 s78, s4, s91
  buffer_load_dwordx4 v[88:91], v10, s[32:35], s78 offen sc1
  buffer_load_dwordx4 v[92:95], v11, s[32:35], s78 offen sc1
  s_add_u32 s78, s4, s92
  buffer_load_dwordx4 v[96:99], v10, s[32:35], s78 offen sc1
  buffer_load_dwordx4 v[100:103], v11, s[32:35], s78 offen sc1
  s_add_u32 s78, s4, s93
  buffer_load_dwordx4 v[104:107], v10, s[32:35], s78 offen sc1
  buffer_load_dwordx4 v[108:111], v11, s[32:35], s78 offen sc1
  s_waitcnt vmcnt(0)
  s_branch L_cont_13
L_slow_16:
  s_mov_b32 s86, 65536
L_sp_18:
  s_sleep 1
  s_add_u32 s78, s4, s91
  buffer_load_dwordx4 v[88:91], v10, s[32:35], s78 offen sc1
  buffer_load_dwordx4 v[92:95], v11, s[32:35], s78 offen sc1
  s_waitcnt vmcnt(0)
  v_xor_b32 v88, v88, v14
  v_xor_b32 v90, v90, v15
  v_xor_b32 v92, v92, v14
  v_xor_b32 v94, v94, v15
  v_bitop3_b32 v2, v88, v90, v88 bitop3:0xf3
  v_bitop3_b32 v2, v92, v94, v2 bitop3:0xfb
  v_and_b32 v2, s3, v2
  v_cmp_ne_u32 vcc, 0, v2
  s_nop 1
  s_cmp_lg_u64 vcc, 0
  s_cbranch_scc0 L_sd_19
  s_sub_u32 s86, s86, 1
  s_cbranch_scc0 L_sp_18
L_sd_19:
  s_add_u32 s78, s4, s92
  buffer_load_dwordx4 v[96:99], v10, s[32:35], s78 offen sc1
  buffer_load_dwordx4 v[100:103], v11, s[32:35], s78 offen sc1
  s_add_u32 s78, s4, s93
  buffer_load_dwordx4 v[104:107], v10, s[32:35], s78 offen sc1
  buffer_load_dwordx4 v[108:111], v11, s[32:35], s78 offen sc1
  s_waitcnt vmcnt(0)
  s_branch L_cont_17
L_slow_20:
  s_mov_b32 s86, 65536
L_sp_22:
  s_sleep 1
  s_add_u32 s78, s4, s92
  buffer_load_dwordx4 v[96:99], v10, s[32:35], s78 offen sc1
  buffer_load_dwordx4 v[100:103], v11, s[32:35], s78 offen sc1
  s_waitcnt vmcnt(0)
  v_xor_b32 v96, v96, v14
  v_xor_b32 v98, v98, v15
  v_xor_b32 v100, v100, v14
  v_xor_b32 v102, v102, v15
  v_bitop3_b32 v2, v96, v98, v96 bitop3:0xf3
  v_bitop3_b32 v2, v100, v102, v2 bitop3:0xfb
  v_and_b32 v2, s3, v2
  v_cmp_ne_u32 vcc, 0, v2
  s_nop 1
  s_cmp_lg_u64 vcc, 0
  s_cbranch_scc0 L_sd_23
  s_sub_u32 s86, s86, 1
  s_cbranch_scc0 L_sp_22
L_sd_23:
  s_add_u32 s78, s4, s93
  buffer_load_dwordx4 v[104:107], v10, s[32:35], s78 offen sc1
  buffer_load_dwordx4 v[108:111], v11, s[32:35], s78 offen sc1
  s_add_u32 s78, s5, s90
  buffer_load_dwordx4 v[80:83], v10, s[32:35], s78 offen sc1
  buffer_load_dwordx4 v[84:87], v11, s[32:35], s78 offen sc1
  s_waitcnt vmcnt(0)
  s_branch L_cont_21
L_slow_24:
  s_mov_b32 s86, 65536
L_sp_26:
  s_sleep 1
  s_add_u32 s78, s4, s93
  buffer_load_dwordx4 v[104:107], v10, s[32:35], s78 offen sc1
  buffer_load_dwordx4 v[108:111], v11, s[32:35], s78 offen sc1
  s_waitcnt vmcnt(0)
  v_xor_b32 v104, v104, v14
  v_xor_b32 v106, v106, v15
  v_xor_b32 v108, v108, v14
  v_xor_b32 v110, v110, v15
  v_bitop3_b32 v2, v104, v106, v104 bitop3:0xf3
  v_bitop3_b32 v2, v108, v110, v2 bitop3:0xfb
  v_and_b32 v2, s3, v2
  v_cmp_ne_u32 vcc, 0, v2
  s_nop 1
  s_cmp_lg_u64 vcc, 0
  s_cbranch_scc0 L_sd_27
  s_sub_u32 s86, s86, 1
  s_cbranch_scc0 L_sp_26
L_sd_27:
  s_add_u32 s78, s5, s90
  buffer_load_dwordx4 v[80:83], v10, s[32:35], s78 offen sc1
  buffer_load_dwordx4 v[84:87], v11, s[32:35], s78 offen sc1
  s_add_u32 s78, s5, s91
  buffer_load_dwordx4 v[112:115], v10, s[32:35], s78 offen sc1
  buffer_load_dwordx4 v[116:119], v11, s[32:35], s78 offen sc1
  s_add_u32 s78, s5, s92
  buffer_load_dwordx4 v[88:91], v10, s[32:35], s78 offen sc1
  buffer_load_dwordx4 v[92:95], v11, s[32:35], s78 offen sc1
  s_waitcnt vmcnt(0)
  s_branch L_cont_25
L_slow_28:
  s_mov_b32 s86, 65536
L_sp_30:
  s_sleep 1
  s_add_u32 s78, s5, s90
  buffer_load_dwordx4 v[80:83], v10, s[32:35], s78 offen sc1
  buffer_load_dwordx4 v[84:87], v11, s[32:35], s78 offen sc1
  s_waitcnt vmcnt(0)
  v_xor_b32 v80, v80, v14
  v_xor_b32 v82, v82, v15
  v_xor_b32 v84, v84, v14
  v_xor_b32 v86, v86, v15
  v_bitop3_b32 v2, v80, v82, v80 bitop3:0xf3
  v_bitop3_b32 v2, v84, v86, v2 bitop3:0xfb
  v_and_b32 v2, s3, v2
  v_cmp_ne_u32 vcc, 0, v2
  s_nop 1
  s_cmp_lg_u64 vcc, 0
  s_cbranch_scc0 L_sd_31
  s_sub_u32 s86, s86, 1
  s_cbranch_scc0 L_sp_30
L_sd_31:
  s_add_u32 s78, s5, s91
  buffer_load_dwordx4 v[112:115], v10, s[32:35], s78 offen sc1
  buffer_load_dwordx4 v[116:119], v11, s[32:35], s78 offen sc1
  s_add_u32 s78, s5, s92
  buffer_load_dwordx4 v[88:91], v10, s[32:35], s78 offen sc1
  buffer_load_dwordx4 v[92:95], v11, s[32:35], s78 offen sc1
  s_add_u32 s78, s5, s93
  buffer_load_dwordx4 v[120:123], v10, s[32:35], s78 offen sc1
  buffer_load_dwordx4 v[124:127], v11, s[32:35], s78 offen sc1
  s_add_u32 s78, s8, s90
  buffer_load_dwordx4 v[96:99], v10, s[32:35], s78 offen sc1
  buffer_load_dwordx4 v[100:103], v11, s[32:35], s78 offen sc1
  s_waitcnt vmcnt(6)
  s_branch L_cont_29
L_slow_32:
  s_mov_b32 s86, 65536
L_sp_34:
  s_sleep 1
  s_add_u32 s78, s5, s91
  buffer_load_dwordx4 v[112:115], v10, s[32:35], s78 offen sc1
  buffer_load_dwordx4 v[116:119], v11, s[32:35], s78 offen sc1
  s_waitcnt vmcnt(0)
  v_xor_b32 v112, v112, v14
  v_xor_b32 v114, v114, v15
  v_xor_b32 v116, v116, v14
  v_xor_b32 v118, v118, v15
  v_bitop3_b32 v2, v112, v114, v112 bitop3:0xf3
  v_bitop3_b32 v2, v116, v118, v2 bitop3:0xfb
  v_and_b32 v2, s3, v2
  v_cmp_ne_u32 vcc, 0, v2
  s_nop 1
  s_cmp_lg_u64 vcc, 0
  s_cbranch_scc0 L_sd_35
  s_sub_u32 s86, s86, 1
  s_cbranch_scc0 L_sp_34
L_sd_35:
  s_add_u32 s78, s5, s92
  buffer_load_dwordx4 v[88:91], v10, s[32:35], s78 offen sc1
  buffer_load_dwordx4 v[92:95], v11, s[32:35], s78 offen sc1
  s_add_u32 s78, s5, s93
  buffer_load_dwordx4 v[120:123], v10, s[32:35], s78 offen sc1
  buffer_load_dwordx4 v[124:127], v11, s[32:35], s78 offen sc1
  s_add_u32 s78, s8, s90
  buffer_load_dwordx4 v[96:99], v10, s[32:35], s78 offen sc1
  buffer_load_dwordx4 v[100:103], v11, s[32:35], s78 offen sc1
  s_add_u32 s78, s8, s91
  buffer_load_dwordx4 v[128:131], v10, s[32:35], s78 offen sc1
  buffer_load_dwordx4 v[132:135], v11, s[32:35], s78 offen sc1
  s_add_u32 s78, s8, s92
  buffer_load_dwordx4 v[104:107], v10, s[32:35], s78 offen sc1
  buffer_load_dwordx4 v[108:111], v11, s[32:35], s78 offen sc1
  s_waitcnt vmcnt(6)
  s_branch L_cont_33
L_slow_36:
  s_mov_b32 s86, 65536
L_sp_38:
  s_sleep 1
  s_add_u32 s78, s5, s92
  buffer_load_dwordx4 v[88:91], v10, s[32:35], s78 offen sc1
  buffer_load_dwordx4 v[92:95], v11, s[32:35], s78 offen sc1
  s_waitcnt vmcnt(0)
  v_xor_b32 v88, v88, v14
  v_xor_b32 v90, v90, v15
  v_xor_b32 v92, v92, v14
  v_xor_b32 v94, v94, v15
  v_bitop3_b32 v2, v88, v90, v88 bitop3:0xf3
  v_bitop3_b32 v2, v92, v94, v2 bitop3:0xfb
  v_and_b32 v2, s3, v2
  v_cmp_ne_u32 vcc, 0, v2
  s_nop 1
  s_cmp_lg_u64 vcc, 0
  s_cbranch_scc0 L_sd_39
  s_sub_u32 s86, s86, 1
  s_cbranch_scc0 L_sp_38
L_sd_39:
  s_add_u32 s78, s5, s93
  buffer_load_dwordx4 v[120:123], v10, s[32:35], s78 offen sc1
  buffer_load_dwordx4 v[124:127], v11, s[32:35], s78 offen sc1
  s_add_u32 s78, s8, s90
  buffer_load_dwordx4 v[96:99], v10, s[32:35], s78 offen sc1
  buffer_load_dwordx4 v[100:103], v11, s[32:35], s78 offen sc1
  s_add_u32 s78, s8, s91
  buffer_load_dwordx4 v[128:131], v10, s[32:35], s78 offen sc1
  buffer_load_dwordx4 v[132:135], v11, s[32:35], s78 offen sc1
  s_add_u32 s78, s8, s92
  buffer_load_dwordx4 v[104:107], v10, s[32:35], s78 offen sc1
  buffer_load_dwordx4 v[108:111], v11, s[32:35], s78 offen sc1
  s_add_u32 s78, s8, s93
  buffer_load_dwordx4 v[136:139], v10, s[32:35], s78 offen sc1
  buffer_load_dwordx4 v[140:143], v11, s[32:35], s78 offen sc1
  s_add_u32 s78, s9, s90
  buffer_load_dwordx4 v[80:83], v10, s[32:35], s78 offen sc1
  buffer_load_dwordx4 v[84:87], v11, s[32:35], s78 offen sc1
  s_waitcnt vmcnt(6)
  s_branch L_cont_37
L_slow_42:
  s_mov_b32 s86, 65536
L_sp_44:
  s_sleep 1
  s_add_u32 s78, s5, s93
  buffer_load_dwordx4 v[120:123], v10, s[32:35], s78 offen sc1
  buffer_load_dwordx4 v[124:127], v11, s[32:35], s78 offen sc1
  s_waitcnt vmcnt(0)
  v_xor_b32 v120, v120, v14
  v_xor_b32 v122, v122, v15
  v_xor_b32 v124, v124, v14
  v_xor_b32 v126, v126, v15
  v_bitop3_b32 v2, v120, v122, v120 bitop3:0xf3
  v_bitop3_b32 v2, v124, v126, v2 bitop3:0xfb
  v_and_b32 v2, s3, v2
  v_cmp_ne_u32 vcc, 0, v2
  s_nop 1
  s_cmp_lg_u64 vcc, 0
  s_cbranch_scc0 L_sd_45
  s_sub_u32 s86, s86, 1
  s_cbranch_scc0 L_sp_44
L_sd_45:
  s_add_u32 s78, s8, s90
  buffer_load_dwordx4 v[96:99], v10, s[32:35], s78 offen sc1
  buffer_load_dwordx4 v[100:103], v11, s[32:35], s78 offen sc1
  s_add_u32 s78, s8, s91
  buffer_load_dwordx4 v[128:131], v10, s[32:35], s78 offen sc1
  buffer_load_dwordx4 v[132:135], v11, s[32:35], s78 offen sc1
  s_add_u32 s78, s8, s92
  buffer_load_dwordx4 v[104:107], v10, s[32:35], s78 offen sc1
  buffer_load_dwordx4 v[108:111], v11, s[32:35], s78 offen sc1
  s_add_u32 s78, s8, s93
  buffer_load_dwordx4 v[136:139], v10, s[32:35], s78 offen sc1
  buffer_load_dwordx4 v[140:143], v11, s[32:35], s78 offen sc1
  s_add_u32 s78, s9, s90
  buffer_load_dwordx4 v[80:83], v10, s[32:35], s78 offen sc1
  buffer_load_dwordx4 v[84:87], v11, s[32:35], s78 offen sc1
  s_add_u32 s78, s9, s91
  buffer_load_dwordx4 v[144:147], v10, s[32:35], s78 offen sc1
  buffer_load_dwordx4 v[148:151], v11, s[32:35], s78 offen sc1
  s_add_u32 s78, s9, s92
  buffer_load_dwordx4 v[112:115], v10, s[32:35], s78 offen sc1
  buffer_load_dwordx4 v[116:119], v11, s[32:35], s78 offen sc1
  s_waitcnt vmcnt(10)
  s_branch L_cont_43
L_slow_46:
  s_mov_b32 s86, 65536
L_sp_48:
  s_sleep 1
  s_add_u32 s78, s8, s90
  buffer_load_dwordx4 v[96:99], v10, s[32:35], s78 offen sc1
  buffer_load_dwordx4 v[100:103], v11, s[32:35], s78 offen sc1
  s_waitcnt vmcnt(0)
  v_xor_b32 v96, v96, v14
  v_xor_b32 v98, v98, v15
  v_xor_b32 v100, v100, v14
  v_xor_b32 v102, v102, v15
  v_bitop3_b32 v2, v96, v98, v96 bitop3:0xf3
  v_bitop3_b32 v2, v100, v102, v2 bitop3:0xfb
  v_and_b32 v2, s3, v2
  v_cmp_ne_u32 vcc, 0, v2
  s_nop 1
  s_cmp_lg_u64 vcc, 0
  s_cbranch_scc0 L_sd_49
  s_sub_u32 s86, s86, 1
  s_cbranch_scc0 L_sp_48
L_sd_49:
  s_add_u32 s78, s8, s91
  buffer_load_dwordx4 v[128:131], v10, s[32:35], s78 offen sc1
  buffer_load_dwordx4 v[132:135], v11, s[32:35], s78 offen sc1
  s_add_u32 s78, s8, s92
  buffer_load_dwordx4 v[104:107], v10, s[32:35], s78 offen sc1
  buffer_load_dwordx4 v[108:111], v11, s[32:35], s78 offen sc1
  s_add_u32 s78, s8, s93
  buffer_load_dwordx4 v[136:139], v10, s[32:35], s78 offen sc1
  buffer_load_dwordx4 v[140:143], v11, s[32:35], s78 offen sc1
  s_add_u32 s78, s9, s90
  buffer_load_dwordx4 v[80:83], v10, s[32:35], s78 offen sc1
  buffer_load_dwordx4 v[84:87], v11, s[32:35], s78 offen sc1
  s_add_u32 s78, s9, s91
  buffer_load_dwordx4 v[144:147], v10, s[32:35], s78 offen sc1
  buffer_load_dwordx4 v[148:151], v11, s[32:35], s78 offen sc1
  s_add_u32 s78, s9, s92
  buffer_load_dwordx4 v[112:115], v10, s[32:35], s78 offen sc1
  buffer_load_dwordx4 v[116:119], v11, s[32:35], s78 offen sc1
  s_add_u32 s78, s9, s93
  buffer_load_dwordx4 v[152:155], v10, s[32:35], s78 offen sc1
  buffer_load_dwordx4 v[156:159], v11, s[32:35], s78 offen sc1
  s_add_u32 s78, s7, s90
  s_add_u32 m0, s99, 98304
  s_lshl_b32 s78, s78, 4
  buffer_load_dwordx4 v6, s[52:55], s78 offen offset:0 lds
  buffer_load_dwordx4 v7, s[52:55], s78 offen offset:1024 lds
  s_waitcnt vmcnt(14)
  s_branch L_cont_47
L_slow_50:
  s_mov_b32 s86, 65536
L_sp_52:
  s_sleep 1
  s_add_u32 s78, s8, s91
  buffer_load_dwordx4 v[128:131], v10, s[32:35], s78 offen sc1
  buffer_load_dwordx4 v[132:135], v11, s[32:35], s78 offen sc1
  s_waitcnt vmcnt(0)
  v_xor_b32 v128, v128, v14
  v_xor_b32 v130, v130, v15
  v_xor_b32 v132, v132, v14
  v_xor_b32 v134, v134, v15
  v_bitop3_b32 v2, v128, v130, v128 bitop3:0xf3
  v_bitop3_b32 v2, v132, v134, v2 bitop3:0xfb
  v_and_b32 v2, s3, v2
  v_cmp_ne_u32 vcc, 0, v2
  s_nop 1
  s_cmp_lg_u64 vcc, 0
  s_cbranch_scc0 L_sd_53
  s_sub_u32 s86, s86, 1
  s_cbranch_scc0 L_sp_52
L_sd_53:
  s_add_u32 s78, s8, s92
  buffer_load_dwordx4 v[104:107], v10, s[32:35], s78 offen sc1
  buffer_load_dwordx4 v[108:111], v11, s[32:35], s78 offen sc1
  s_add_u32 s78, s8, s93
  buffer_load_dwordx4 v[136:139], v10, s[32:35], s78 offen sc1
  buffer_load_dwordx4 v[140:143], v11, s[32:35], s78 offen sc1
  s_add_u32 s78, s9, s90
  buffer_load_dwordx4 v[80:83], v10, s[32:35], s78 offen sc1
  buffer_load_dwordx4 v[84:87], v11, s[32:35], s78 offen sc1
  s_add_u32 s78, s9, s91
  buffer_load_dwordx4 v[144:147], v10, s[32:35], s78 offen sc1
  buffer_load_dwordx4 v[148:151], v11, s[32:35], s78 offen sc1
  s_add_u32 s78, s9, s92
  buffer_load_dwordx4 v[112:115], v10, s[32:35], s78 offen sc1
  buffer_load_dwordx4 v[116:119], v11, s[32:35], s78 offen sc1
  s_add_u32 s78, s9, s93
  buffer_load_dwordx4 v[152:155], v10, s[32:35], s78 offen sc1
  buffer_load_dwordx4 v[156:159], v11, s[32:35], s78 offen sc1
  s_add_u32 s78, s7, s90
  s_add_u32 m0, s99, 98304
  s_lshl_b32 s78, s78, 4
  buffer_load_dwordx4 v6, s[52:55], s78 offen offset:0 lds
  buffer_load_dwordx4 v7, s[52:55], s78 offen offset:1024 lds
  s_add_u32 s78, s12, s90
  s_add_u32 s78, s78, 114688
  buffer_load_dwordx4 v[88:91], v10, s[32:35], s78 offen sc1
  buffer_load_dwordx4 v[92:95], v11, s[32:35], s78 offen sc1
  s_add_u32 s78, s7, s91
  s_add_u32 m0, s99, 100352
  s_lshl_b32 s78, s78, 4
  buffer_load_dwordx4 v6, s[52:55], s78 offen offset:0 lds
  buffer_load_dwordx4 v7, s[52:55], s78 offen offset:1024 lds
  s_waitcnt vmcnt(18)
  s_branch L_cont_51
L_slow_54:
  s_mov_b32 s86, 65536
L_sp_56:
  s_sleep 1
  s_add_u32 s78, s8, s92
  buffer_load_dwordx4 v[104:107], v10, s[32:35], s78 offen sc1
  buffer_load_dwordx4 v[108:111], v11, s[32:35], s78 offen sc1
  s_waitcnt vmcnt(0)
  v_xor_b32 v104, v104, v14
  v_xor_b32 v106, v106, v15
  v_xor_b32 v108, v108, v14
  v_xor_b32 v110, v110, v15
  v_bitop3_b32 v2, v104, v106, v104 bitop3:0xf3
  v_bitop3_b32 v2, v108, v110, v2 bitop3:0xfb
  v_and_b32 v2, s3, v2
  v_cmp_ne_u32 vcc, 0, v2
  s_nop 1
  s_cmp_lg_u64 vcc, 0
  s_cbranch_scc0 L_sd_57
  s_sub_u32 s86, s86, 1
  s_cbranch_scc0 L_sp_56
L_sd_57:
  s_add_u32 s78, s8, s93
  buffer_load_dwordx4 v[136:139], v10, s[32:35], s78 offen sc1
  buffer_load_dwordx4 v[140:143], v11, s[32:35], s78 offen sc1
  s_add_u32 s78, s9, s90
  buffer_load_dwordx4 v[80:83], v10, s[32:35], s78 offen sc1
  buffer_load_dwordx4 v[84:87], v11, s[32:35], s78 offen sc1
  s_add_u32 s78, s9, s91
  buffer_load_dwordx4 v[144:147], v10, s[32:35], s78 offen sc1
  buffer_load_dwordx4 v[148:151], v11, s[32:35], s78 offen sc1
  s_add_u32 s78, s9, s92
  buffer_load_dwordx4 v[112:115], v10, s[32:35], s78 offen sc1
  buffer_load_dwordx4 v[116:119], v11, s[32:35], s78 offen sc1
  s_add_u32 s78, s9, s93
  buffer_load_dwordx4 v[152:155], v10, s[32:35], s78 offen sc1
  buffer_load_dwordx4 v[156:159], v11, s[32:35], s78 offen sc1
  s_add_u32 s78, s7, s90
  s_add_u32 m0, s99, 98304
  s_lshl_b32 s78, s78, 4
  buffer_load_dwordx4 v6, s[52:55], s78 offen offset:0 lds
  buffer_load_dwordx4 v7, s[52:55], s78 offen offset:1024 lds
  s_add_u32 s78, s12, s90
  s_add_u32 s78, s78, 114688
  buffer_load_dwordx4 v[88:91], v10, s[32:35], s78 offen sc1
  buffer_load_dwordx4 v[92:95], v11, s[32:35], s78 offen sc1
  s_add_u32 s78, s7, s91
  s_add_u32 m0, s99, 100352
  s_lshl_b32 s78, s78, 4
  buffer_load_dwordx4 v6, s[52:55], s78 offen offset:0 lds
  buffer_load_dwordx4 v7, s[52:55], s78 offen offset:1024 lds
  s_add_u32 s78, s12, s91
  s_add_u32 s78, s78, 114688
  buffer_load_dwordx4 v[160:163], v10, s[32:35], s78 offen sc1
  buffer_load_dwordx4 v[164:167], v11, s[32:35], s78 offen sc1
  s_add_u32 s78, s7, s92
  s_add_u32 m0, s99, 114688
  s_lshl_b32 s78, s78, 4
  buffer_load_dwordx4 v6, s[52:55], s78 offen offset:0 lds
  buffer_load_dwordx4 v7, s[52:55], s78 offen offset:1024 lds
  s_waitcnt vmcnt(20)
  s_branch L_cont_55
L_slow_58:
  s_mov_b32 s86, 65536
L_sp_60:
  s_sleep 1
  s_add_u32 s78, s8, s93
  buffer_load_dwordx4 v[136:139], v10, s[32:35], s78 offen sc1
  buffer_load_dwordx4 v[140:143], v11, s[32:35], s78 offen sc1
  s_waitcnt vmcnt(0)
  v_xor_b32 v136, v136, v14
  v_xor_b32 v138, v138, v15
  v_xor_b32 v140, v140, v14
  v_xor_b32 v142, v142, v15
  v_bitop3_b32 v2, v136, v138, v136 bitop3:0xf3
  v_bitop3_b32 v2, v140, v142, v2 bitop3:0xfb
  v_and_b32 v2, s3, v2
  v_cmp_ne_u32 vcc, 0, v2
  s_nop 1
  s_cmp_lg_u64 vcc, 0
  s_cbranch_scc0 L_sd_61
  s_sub_u32 s86, s86, 1
  s_cbranch_scc0 L_sp_60
L_sd_61:
  s_add_u32 s78, s9, s90
  buffer_load_dwordx4 v[80:83], v10, s[32:35], s78 offen sc1
  buffer_load_dwordx4 v[84:87], v11, s[32:35], s78 offen sc1
  s_add_u32 s78, s9, s91
  buffer_load_dwordx4 v[144:147], v10, s[32:35], s78 offen sc1
  buffer_load_dwordx4 v[148:151], v11, s[32:35], s78 offen sc1
  s_add_u32 s78, s9, s92
  buffer_load_dwordx4 v[112:115], v10, s[32:35], s78 offen sc1
  buffer_load_dwordx4 v[116:119], v11, s[32:35], s78 offen sc1
  s_add_u32 s78, s9, s93
  buffer_load_dwordx4 v[152:155], v10, s[32:35], s78 offen sc1
  buffer_load_dwordx4 v[156:159], v11, s[32:35], s78 offen sc1
  s_add_u32 s78, s7, s90
  s_add_u32 m0, s99, 98304
  s_lshl_b32 s78, s78, 4
  buffer_load_dwordx4 v6, s[52:55], s78 offen offset:0 lds
  buffer_load_dwordx4 v7, s[52:55], s78 offen offset:1024 lds
  s_add_u32 s78, s12, s90
  s_add_u32 s78, s78, 114688
  buffer_load_dwordx4 v[88:91], v10, s[32:35], s78 offen sc1
  buffer_load_dwordx4 v[92:95], v11, s[32:35], s78 offen sc1
  s_add_u32 s78, s7, s91
  s_add_u32 m0, s99, 100352
  s_lshl_b32 s78, s78, 4
  buffer_load_dwordx4 v6, s[52:55], s78 offen offset:0 lds
  buffer_load_dwordx4 v7, s[52:55], s78 offen offset:1024 lds
  s_add_u32 s78, s12, s91
  s_add_u32 s78, s78, 114688
  buffer_load_dwordx4 v[160:163], v10, s[32:35], s78 offen sc1
  buffer_load_dwordx4 v[164:167], v11, s[32:35], s78 offen sc1
  s_add_u32 s78, s7, s92
  s_add_u32 m0, s99, 114688
  s_lshl_b32 s78, s78, 4
  buffer_load_dwordx4 v6, s[52:55], s78 offen offset:0 lds
  buffer_load_dwordx4 v7, s[52:55], s78 offen offset:1024 lds
  s_add_u32 s78, s12, s92
  s_add_u32 s78, s78, 114688
  buffer_load_dwordx4 v[120:123], v10, s[32:35], s78 offen sc1
  buffer_load_dwordx4 v[124:127], v11, s[32:35], s78 offen sc1
  s_add_u32 s78, s7, s93
  s_add_u32 m0, s99, 116736
  s_lshl_b32 s78, s78, 4
  buffer_load_dwordx4 v6, s[52:55], s78 offen offset:0 lds
  buffer_load_dwordx4 v7, s[52:55], s78 offen offset:1024 lds
  s_waitcnt vmcnt(22)
  s_branch L_cont_59
L_slow_62:
  s_mov_b32 s86, 65536
L_sp_64:
  s_sleep 1
  s_add_u32 s78, s9, s90
  buffer_load_dwordx4 v[80:83], v10, s[32:35], s78 offen sc1
  buffer_load_dwordx4 v[84:87], v11, s[32:35], s78 offen sc1
  s_waitcnt vmcnt(0)
  v_xor_b32 v80, v80, v14
  v_xor_b32 v82, v82, v15
  v_xor_b32 v84, v84, v14
  v_xor_b32 v86, v86, v15
  v_bitop3_b32 v2, v80, v82, v80 bitop3:0xf3
  v_bitop3_b32 v2, v84, v86, v2 bitop3:0xfb
  v_and_b32 v2, s3, v2
  v_cmp_ne_u32 vcc, 0, v2
  s_nop 1
  s_cmp_lg_u64 vcc, 0
  s_cbranch_scc0 L_sd_65
  s_sub_u32 s86, s86, 1
  s_cbranch_scc0 L_sp_64
L_sd_65:
  s_add_u32 s78, s9, s91
  buffer_load_dwordx4 v[144:147], v10, s[32:35], s78 offen sc1
  buffer_load_dwordx4 v[148:151], v11, s[32:35], s78 offen sc1
  s_add_u32 s78, s9, s92
  buffer_load_dwordx4 v[112:115], v10, s[32:35], s78 offen sc1
  buffer_load_dwordx4 v[116:119], v11, s[32:35], s78 offen sc1
  s_add_u32 s78, s9, s93
  buffer_load_dwordx4 v[152:155], v10, s[32:35], s78 offen sc1
  buffer_load_dwordx4 v[156:159], v11, s[32:35], s78 offen sc1
  s_add_u32 s78, s7, s90
  s_add_u32 m0, s99, 98304
  s_lshl_b32 s78, s78, 4
  buffer_load_dwordx4 v6, s[52:55], s78 offen offset:0 lds
  buffer_load_dwordx4 v7, s[52:55], s78 offen offset:1024 lds
  s_add_u32 s78, s12, s90
  s_add_u32 s78, s78, 114688
  buffer_load_dwordx4 v[88:91], v10, s[32:35], s78 offen sc1
  buffer_load_dwordx4 v[92:95], v11, s[32:35], s78 offen sc1
  s_add_u32 s78, s7, s91
  s_add_u32 m0, s99, 100352
  s_lshl_b32 s78, s78, 4
  buffer_load_dwordx4 v6, s[52:55], s78 offen offset:0 lds
  buffer_load_dwordx4 v7, s[52:55], s78 offen offset:1024 lds
  s_add_u32 s78, s12, s91
  s_add_u32 s78, s78, 114688
  buffer_load_dwordx4 v[160:163], v10, s[32:35], s78 offen sc1
  buffer_load_dwordx4 v[164:167], v11, s[32:35], s78 offen sc1
  s_add_u32 s78, s7, s92
  s_add_u32 m0, s99, 114688
  s_lshl_b32 s78, s78, 4
  buffer_load_dwordx4 v6, s[52:55], s78 offen offset:0 lds
  buffer_load_dwordx4 v7, s[52:55], s78 offen offset:1024 lds
  s_add_u32 s78, s12, s92
  s_add_u32 s78, s78, 114688
  buffer_load_dwordx4 v[120:123], v10, s[32:35], s78 offen sc1
  buffer_load_dwordx4 v[124:127], v11, s[32:35], s78 offen sc1
  s_add_u32 s78, s7, s93
  s_add_u32 m0, s99, 116736
  s_lshl_b32 s78, s78, 4
  buffer_load_dwordx4 v6, s[52:55], s78 offen offset:0 lds
  buffer_load_dwordx4 v7, s[52:55], s78 offen offset:1024 lds
  s_add_u32 s78, s12, s93
  s_add_u32 s78, s78, 114688
  buffer_load_dwordx4 v[168:171], v10, s[32:35], s78 offen sc1
  buffer_load_dwordx4 v[172:175], v11, s[32:35], s78 offen sc1
  s_waitcnt vmcnt(22)
  s_branch L_cont_63
L_slow_66:
  s_mov_b32 s86, 65536
L_sp_68:
  s_sleep 1
  s_add_u32 s78, s9, s91
  buffer_load_dwordx4 v[144:147], v10, s[32:35], s78 offen sc1
  buffer_load_dwordx4 v[148:151], v11, s[32:35], s78 offen sc1
  s_waitcnt vmcnt(0)
  v_xor_b32 v144, v144, v14
  v_xor_b32 v146, v146, v15
  v_xor_b32 v148, v148, v14
  v_xor_b32 v150, v150, v15
  v_bitop3_b32 v2, v144, v146, v144 bitop3:0xf3
  v_bitop3_b32 v2, v148, v150, v2 bitop3:0xfb
  v_and_b32 v2, s3, v2
  v_cmp_ne_u32 vcc, 0, v2
  s_nop 1
  s_cmp_lg_u64 vcc, 0
  s_cbranch_scc0 L_sd_69
  s_sub_u32 s86, s86, 1
  s_cbranch_scc0 L_sp_68
L_sd_69:
  s_add_u32 s78, s9, s92
  buffer_load_dwordx4 v[112:115], v10, s[32:35], s78 offen sc1
  buffer_load_dwordx4 v[116:119], v11, s[32:35], s78 offen sc1
  s_add_u32 s78, s9, s93
  buffer_load_dwordx4 v[152:155], v10, s[32:35], s78 offen sc1
  buffer_load_dwordx4 v[156:159], v11, s[32:35], s78 offen sc1
  s_add_u32 s78, s7, s90
  s_add_u32 m0, s99, 98304
  s_lshl_b32 s78, s78, 4
  buffer_load_dwordx4 v6, s[52:55], s78 offen offset:0 lds
  buffer_load_dwordx4 v7, s[52:55], s78 offen offset:1024 lds
  s_add_u32 s78, s12, s90
  s_add_u32 s78, s78, 114688
  buffer_load_dwordx4 v[88:91], v10, s[32:35], s78 offen sc1
  buffer_load_dwordx4 v[92:95], v11, s[32:35], s78 offen sc1
  s_add_u32 s78, s7, s91
  s_add_u32 m0, s99, 100352
  s_lshl_b32 s78, s78, 4
  buffer_load_dwordx4 v6, s[52:55], s78 offen offset:0 lds
  buffer_load_dwordx4 v7, s[52:55], s78 offen offset:1024 lds
  s_add_u32 s78, s12, s91
  s_add_u32 s78, s78, 114688
  buffer_load_dwordx4 v[160:163], v10, s[32:35], s78 offen sc1
  buffer_load_dwordx4 v[164:167], v11, s[32:35], s78 offen sc1
  s_add_u32 s78, s7, s92
  s_add_u32 m0, s99, 114688
  s_lshl_b32 s78, s78, 4
  buffer_load_dwordx4 v6, s[52:55], s78 offen offset:0 lds
  buffer_load_dwordx4 v7, s[52:55], s78 offen offset:1024 lds
  s_add_u32 s78, s12, s92
  s_add_u32 s78, s78, 114688
  buffer_load_dwordx4 v[120:123], v10, s[32:35], s78 offen sc1
  buffer_load_dwordx4 v[124:127], v11, s[32:35], s78 offen sc1
  s_add_u32 s78, s7, s93
  s_add_u32 m0, s99, 116736
  s_lshl_b32 s78, s78, 4
  buffer_load_dwordx4 v6, s[52:55], s78 offen offset:0 lds
  buffer_load_dwordx4 v7, s[52:55], s78 offen offset:1024 lds
  s_add_u32 s78, s12, s93
  s_add_u32 s78, s78, 114688
  buffer_load_dwordx4 v[168:171], v10, s[32:35], s78 offen sc1
  buffer_load_dwordx4 v[172:175], v11, s[32:35], s78 offen sc1
  s_add_u32 s78, s13, s90
  s_add_u32 s78, s78, 114688
  buffer_load_dwordx4 v[96:99], v10, s[32:35], s78 offen sc1
  buffer_load_dwordx4 v[100:103], v11, s[32:35], s78 offen sc1
  s_waitcnt vmcnt(22)
  s_branch L_cont_67
L_slow_70:
  s_mov_b32 s86, 65536
L_sp_72:
  s_sleep 1
  s_add_u32 s78, s9, s92
  buffer_load_dwordx4 v[112:115], v10, s[32:35], s78 offen sc1
  buffer_load_dwordx4 v[116:119], v11, s[32:35], s78 offen sc1
  s_waitcnt vmcnt(0)
  v_xor_b32 v112, v112, v14
  v_xor_b32 v114, v114, v15
  v_xor_b32 v116, v116, v14
  v_xor_b32 v118, v118, v15
  v_bitop3_b32 v2, v112, v114, v112 bitop3:0xf3
  v_bitop3_b32 v2, v116, v118, v2 bitop3:0xfb
  v_and_b32 v2, s3, v2
  v_cmp_ne_u32 vcc, 0, v2
  s_nop 1
  s_cmp_lg_u64 vcc, 0
  s_cbranch_scc0 L_sd_73
  s_sub_u32 s86, s86, 1
  s_cbranch_scc0 L_sp_72
L_sd_73:
  s_add_u32 s78, s9, s93
  buffer_load_dwordx4 v[152:155], v10, s[32:35], s78 offen sc1
  buffer_load_dwordx4 v[156:159], v11, s[32:35], s78 offen sc1
  s_add_u32 s78, s7, s90
  s_add_u32 m0, s99, 98304
  s_lshl_b32 s78, s78, 4
  buffer_load_dwordx4 v6, s[52:55], s78 offen offset:0 lds
  buffer_load_dwordx4 v7, s[52:55], s78 offen offset:1024 lds
  s_add_u32 s78, s12, s90
  s_add_u32 s78, s78, 114688
  buffer_load_dwordx4 v[88:91], v10, s[32:35], s78 offen sc1
  buffer_load_dwordx4 v[92:95], v11, s[32:35], s78 offen sc1
  s_add_u32 s78, s7, s91
  s_add_u32 m0, s99, 100352
  s_lshl_b32 s78, s78, 4
  buffer_load_dwordx4 v6, s[52:55], s78 offen offset:0 lds
  buffer_load_dwordx4 v7, s[52:55], s78 offen offset:1024 lds
  s_add_u32 s78, s12, s91
  s_add_u32 s78, s78, 114688
  buffer_load_dwordx4 v[160:163], v10, s[32:35], s78 offen sc1
  buffer_load_dwordx4 v[164:167], v11, s[32:35], s78 offen sc1
  s_add_u32 s78, s7, s92
  s_add_u32 m0, s99, 114688
  s_lshl_b32 s78, s78, 4
  buffer_load_dwordx4 v6, s[52:55], s78 offen offset:0 lds
  buffer_load_dwordx4 v7, s[52:55], s78 offen offset:1024 lds
  s_add_u32 s78, s12, s92
  s_add_u32 s78, s78, 114688
  buffer_load_dwordx4 v[120:123], v10, s[32:35], s78 offen sc1
  buffer_load_dwordx4 v[124:127], v11, s[32:35], s78 offen sc1
  s_add_u32 s78, s7, s93
  s_add_u32 m0, s99, 116736
  s_lshl_b32 s78, s78, 4
  buffer_load_dwordx4 v6, s[52:55], s78 offen offset:0 lds
  buffer_load_dwordx4 v7, s[52:55], s78 offen offset:1024 lds
  s_add_u32 s78, s12, s93
  s_add_u32 s78, s78, 114688
  buffer_load_dwordx4 v[168:171], v10, s[32:35], s78 offen sc1
  buffer_load_dwordx4 v[172:175], v11, s[32:35], s78 offen sc1
  s_add_u32 s78, s13, s90
  s_add_u32 s78, s78, 114688
  buffer_load_dwordx4 v[96:99], v10, s[32:35], s78 offen sc1
  buffer_load_dwordx4 v[100:103], v11, s[32:35], s78 offen sc1
  s_add_u32 s78, s13, s91
  s_add_u32 s78, s78, 114688
  buffer_load_dwordx4 v[176:179], v10, s[32:35], s78 offen sc1
  buffer_load_dwordx4 v[180:183], v11, s[32:35], s78 offen sc1
  s_waitcnt vmcnt(22)
  s_branch L_cont_71
L_slow_74:
  s_mov_b32 s86, 65536
L_sp_76:
  s_sleep 1
  s_add_u32 s78, s9, s93
  buffer_load_dwordx4 v[152:155], v10, s[32:35], s78 offen sc1
  buffer_load_dwordx4 v[156:159], v11, s[32:35], s78 offen sc1
  s_waitcnt vmcnt(0)
  v_xor_b32 v152, v152, v14
  v_xor_b32 v154, v154, v15
  v_xor_b32 v156, v156, v14
  v_xor_b32 v158, v158, v15
  v_bitop3_b32 v2, v152, v154, v152 bitop3:0xf3
  v_bitop3_b32 v2, v156, v158, v2 bitop3:0xfb
  v_and_b32 v2, s3, v2
  v_cmp_ne_u32 vcc, 0, v2
  s_nop 1
  s_cmp_lg_u64 vcc, 0
  s_cbranch_scc0 L_sd_77
  s_sub_u32 s86, s86, 1
  s_cbranch_scc0 L_sp_76
L_sd_77:
  s_add_u32 s78, s7, s90
  s_add_u32 m0, s99, 98304
  s_lshl_b32 s78, s78, 4
  buffer_load_dwordx4 v6, s[52:55], s78 offen offset:0 lds
  buffer_load_dwordx4 v7, s[52:55], s78 offen offset:1024 lds
  s_add_u32 s78, s12, s90
  s_add_u32 s78, s78, 114688
  buffer_load_dwordx4 v[88:91], v10, s[32:35], s78 offen sc1
  buffer_load_dwordx4 v[92:95], v11, s[32:35], s78 offen sc1
  s_add_u32 s78, s7, s91
  s_add_u32 m0, s99, 100352
  s_lshl_b32 s78, s78, 4
  buffer_load_dwordx4 v6, s[52:55], s78 offen offset:0 lds
  buffer_load_dwordx4 v7, s[52:55], s78 offen offset:1024 lds
  s_add_u32 s78, s12, s91
  s_add_u32 s78, s78, 114688
  buffer_load_dwordx4 v[160:163], v10, s[32:35], s78 offen sc1
  buffer_load_dwordx4 v[164:167], v11, s[32:35], s78 offen sc1
  s_add_u32 s78, s7, s92
  s_add_u32 m0, s99, 114688
  s_lshl_b32 s78, s78, 4
  buffer_load_dwordx4 v6, s[52:55], s78 offen offset:0 lds
  buffer_load_dwordx4 v7, s[52:55], s78 offen offset:1024 lds
  s_add_u32 s78, s12, s92
  s_add_u32 s78, s78, 114688
  buffer_load_dwordx4 v[120:123], v10, s[32:35], s78 offen sc1
  buffer_load_dwordx4 v[124:127], v11, s[32:35], s78 offen sc1
  s_add_u32 s78, s7, s93
  s_add_u32 m0, s99, 116736
  s_lshl_b32 s78, s78, 4
  buffer_load_dwordx4 v6, s[52:55], s78 offen offset:0 lds
  buffer_load_dwordx4 v7, s[52:55], s78 offen offset:1024 lds
  s_add_u32 s78, s12, s93
  s_add_u32 s78, s78, 114688
  buffer_load_dwordx4 v[168:171], v10, s[32:35], s78 offen sc1
  buffer_load_dwordx4 v[172:175], v11, s[32:35], s78 offen sc1
  s_add_u32 s78, s13, s90
  s_add_u32 s78, s78, 114688
  buffer_load_dwordx4 v[96:99], v10, s[32:35], s78 offen sc1
  buffer_load_dwordx4 v[100:103], v11, s[32:35], s78 offen sc1
  s_add_u32 s78, s13, s91
  s_add_u32 s78, s78, 114688
  buffer_load_dwordx4 v[176:179], v10, s[32:35], s78 offen sc1
  buffer_load_dwordx4 v[180:183], v11, s[32:35], s78 offen sc1
  s_add_u32 s78, s13, s92
  s_add_u32 s78, s78, 114688
  buffer_load_dwordx4 v[128:131], v10, s[32:35], s78 offen sc1
  buffer_load_dwordx4 v[132:135], v11, s[32:35], s78 offen sc1
  s_waitcnt vmcnt(22)
  s_branch L_cont_75
L_slow_78:
  s_mov_b32 s86, 65536
L_sp_80:
  s_sleep 1
  s_add_u32 s78, s12, s90
  s_add_u32 s78, s78, 114688
  buffer_load_dwordx4 v[88:91], v10, s[32:35], s78 offen sc1
  buffer_load_dwordx4 v[92:95], v11, s[32:35], s78 offen sc1
  s_waitcnt vmcnt(0)
  v_xor_b32 v88, v88, v14
  v_xor_b32 v90, v90, v15
  v_xor_b32 v92, v92, v14
  v_xor_b32 v94, v94, v15
  v_bitop3_b32 v2, v88, v90, v88 bitop3:0xf3
  v_bitop3_b32 v2, v92, v94, v2 bitop3:0xfb
  v_and_b32 v2, s3, v2
  v_cmp_ne_u32 vcc, 0, v2
  s_nop 1
  s_cmp_lg_u64 vcc, 0
  s_cbranch_scc0 L_sd_81
  s_sub_u32 s86, s86, 1
  s_cbranch_scc0 L_sp_80
L_sd_81:
  s_add_u32 s78, s7, s91
  s_add_u32 m0, s99, 100352
  s_lshl_b32 s78, s78, 4
  buffer_load_dwordx4 v6, s[52:55], s78 offen offset:0 lds
  buffer_load_dwordx4 v7, s[52:55], s78 offen offset:1024 lds
  s_add_u32 s78, s12, s91
  s_add_u32 s78, s78, 114688
  buffer_load_dwordx4 v[160:163], v10, s[32:35], s78 offen sc1
  buffer_load_dwordx4 v[164:167], v11, s[32:35], s78 offen sc1
  s_add_u32 s78, s7, s92
  s_add_u32 m0, s99, 114688
  s_lshl_b32 s78, s78, 4
  buffer_load_dwordx4 v6, s[52:55], s78 offen offset:0 lds
  buffer_load_dwordx4 v7, s[52:55], s78 offen offset:1024 lds
  s_add_u32 s78, s12, s92
  s_add_u32 s78, s78, 114688
  buffer_load_dwordx4 v[120:123], v10, s[32:35], s78 offen sc1
  buffer_load_dwordx4 v[124:127], v11, s[32:35], s78 offen sc1
  s_add_u32 s78, s7, s93
  s_add_u32 m0, s99, 116736
  s_lshl_b32 s78, s78, 4
  buffer_load_dwordx4 v6, s[52:55], s78 offen offset:0 lds
  buffer_load_dwordx4 v7, s[52:55], s78 offen offset:1024 lds
  s_add_u32 s78, s12, s93
  s_add_u32 s78, s78, 114688
  buffer_load_dwordx4 v[168:171], v10, s[32:35], s78 offen sc1
  buffer_load_dwordx4 v[172:175], v11, s[32:35], s78 offen sc1
  s_add_u32 s78, s13, s90
  s_add_u32 s78, s78, 114688
  buffer_load_dwordx4 v[96:99], v10, s[32:35], s78 offen sc1
  buffer_load_dwordx4 v[100:103], v11, s[32:35], s78 offen sc1
  s_add_u32 s78, s13, s91
  s_add_u32 s78, s78, 114688
  buffer_load_dwordx4 v[176:179], v10, s[32:35], s78 offen sc1
  buffer_load_dwordx4 v[180:183], v11, s[32:35], s78 offen sc1
  s_add_u32 s78, s13, s92
  s_add_u32 s78, s78, 114688
  buffer_load_dwordx4 v[128:131], v10, s[32:35], s78 offen sc1
  buffer_load_dwordx4 v[132:135], v11, s[32:35], s78 offen sc1
  s_add_u32 s78, s13, s93
  s_add_u32 s78, s78, 114688
  buffer_load_dwordx4 v[104:107], v10, s[32:35], s78 offen sc1
  buffer_load_dwordx4 v[108:111], v11, s[32:35], s78 offen sc1
  s_waitcnt vmcnt(20)
  s_branch L_cont_79
L_slow_82:
  s_mov_b32 s86, 65536
L_sp_84:
  s_sleep 1
  s_add_u32 s78, s12, s91
  s_add_u32 s78, s78, 114688
  buffer_load_dwordx4 v[160:163], v10, s[32:35], s78 offen sc1
  buffer_load_dwordx4 v[164:167], v11, s[32:35], s78 offen sc1
  s_waitcnt vmcnt(0)
  v_xor_b32 v160, v160, v14
  v_xor_b32 v162, v162, v15
  v_xor_b32 v164, v164, v14
  v_xor_b32 v166, v166, v15
  v_bitop3_b32 v2, v160, v162, v160 bitop3:0xf3
  v_bitop3_b32 v2, v164, v166, v2 bitop3:0xfb
  v_and_b32 v2, s3, v2
  v_cmp_ne_u32 vcc, 0, v2
  s_nop 1
  s_cmp_lg_u64 vcc, 0
  s_cbranch_scc0 L_sd_85
  s_sub_u32 s86, s86, 1
  s_cbranch_scc0 L_sp_84
L_sd_85:
  s_add_u32 s78, s7, s92
  s_add_u32 m0, s99, 114688
  s_lshl_b32 s78, s78, 4
  buffer_load_dwordx4 v6, s[52:55], s78 offen offset:0 lds
  buffer_load_dwordx4 v7, s[52:55], s78 offen offset:1024 lds
  s_add_u32 s78, s12, s92
  s_add_u32 s78, s78, 114688
  buffer_load_dwordx4 v[120:123], v10, s[32:35], s78 offen sc1
  buffer_load_dwordx4 v[124:127], v11, s[32:35], s78 offen sc1
  s_add_u32 s78, s7, s93
  s_add_u32 m0, s99, 116736
  s_lshl_b32 s78, s78, 4
  buffer_load_dwordx4 v6, s[52:55], s78 offen offset:0 lds
  buffer_load_dwordx4 v7, s[52:55], s78 offen offset:1024 lds
  s_add_u32 s78, s12, s93
  s_add_u32 s78, s78, 114688
  buffer_load_dwordx4 v[168:171], v10, s[32:35], s78 offen sc1
  buffer_load_dwordx4 v[172:175], v11, s[32:35], s78 offen sc1
  s_add_u32 s78, s13, s90
  s_add_u32 s78, s78, 114688
  buffer_load_dwordx4 v[96:99], v10, s[32:35], s78 offen sc1
  buffer_load_dwordx4 v[100:103], v11, s[32:35], s78 offen sc1
  s_add_u32 s78, s13, s91
  s_add_u32 s78, s78, 114688
  buffer_load_dwordx4 v[176:179], v10, s[32:35], s78 offen sc1
  buffer_load_dwordx4 v[180:183], v11, s[32:35], s78 offen sc1
  s_add_u32 s78, s13, s92
  s_add_u32 s78, s78, 114688
  buffer_load_dwordx4 v[128:131], v10, s[32:35], s78 offen sc1
  buffer_load_dwordx4 v[132:135], v11, s[32:35], s78 offen sc1
  s_add_u32 s78, s13, s93
  s_add_u32 s78, s78, 114688
  buffer_load_dwordx4 v[104:107], v10, s[32:35], s78 offen sc1
  buffer_load_dwordx4 v[108:111], v11, s[32:35], s78 offen sc1
  s_add_u32 s78, s10, s14
  buffer_load_dwordx4 v[136:139], v10, s[32:35], s78 offen sc1
  buffer_load_dwordx4 v[140:143], v11, s[32:35], s78 offen sc1
  s_waitcnt vmcnt(18)
  s_branch L_cont_83
L_slow_86:
  s_mov_b32 s86, 65536
L_sp_88:
  s_sleep 1
  s_add_u32 s78, s12, s92
  s_add_u32 s78, s78, 114688
  buffer_load_dwordx4 v[120:123], v10, s[32:35], s78 offen sc1
  buffer_load_dwordx4 v[124:127], v11, s[32:35], s78 offen sc1
  s_waitcnt vmcnt(0)
  v_xor_b32 v120, v120, v14
  v_xor_b32 v122, v122, v15
  v_xor_b32 v124, v124, v14
  v_xor_b32 v126, v126, v15
  v_bitop3_b32 v2, v120, v122, v120 bitop3:0xf3
  v_bitop3_b32 v2, v124, v126, v2 bitop3:0xfb
  v_and_b32 v2, s3, v2
  v_cmp_ne_u32 vcc, 0, v2
  s_nop 1
  s_cmp_lg_u64 vcc, 0
  s_cbranch_scc0 L_sd_89
  s_sub_u32 s86, s86, 1
  s_cbranch_scc0 L_sp_88
L_sd_89:
  s_add_u32 s78, s7, s93
  s_add_u32 m0, s99, 116736
  s_lshl_b32 s78, s78, 4
  buffer_load_dwordx4 v6, s[52:55], s78 offen offset:0 lds
  buffer_load_dwordx4 v7, s[52:55], s78 offen offset:1024 lds
  s_add_u32 s78, s12, s93
  s_add_u32 s78, s78, 114688
  buffer_load_dwordx4 v[168:171], v10, s[32:35], s78 offen sc1
  buffer_load_dwordx4 v[172:175], v11, s[32:35], s78 offen sc1
  s_add_u32 s78, s13, s90
  s_add_u32 s78, s78, 114688
  buffer_load_dwordx4 v[96:99], v10, s[32:35], s78 offen sc1
  buffer_load_dwordx4 v[100:103], v11, s[32:35], s78 offen sc1
  s_add_u32 s78, s13, s91
  s_add_u32 s78, s78, 114688
  buffer_load_dwordx4 v[176:179], v10, s[32:35], s78 offen sc1
  buffer_load_dwordx4 v[180:183], v11, s[32:35], s78 offen sc1
  s_add_u32 s78, s13, s92
  s_add_u32 s78, s78, 114688
  buffer_load_dwordx4 v[128:131], v10, s[32:35], s78 offen sc1
  buffer_load_dwordx4 v[132:135], v11, s[32:35], s78 offen sc1
  s_add_u32 s78, s13, s93
  s_add_u32 s78, s78, 114688
  buffer_load_dwordx4 v[104:107], v10, s[32:35], s78 offen sc1
  buffer_load_dwordx4 v[108:111], v11, s[32:35], s78 offen sc1
  s_add_u32 s78, s10, s14
  buffer_load_dwordx4 v[136:139], v10, s[32:35], s78 offen sc1
  buffer_load_dwordx4 v[140:143], v11, s[32:35], s78 offen sc1
  s_add_u32 s78, s10, s15
  buffer_load_dwordx4 v[80:83], v10, s[32:35], s78 offen sc1
  buffer_load_dwordx4 v[84:87], v11, s[32:35], s78 offen sc1
  s_waitcnt vmcnt(16)
  s_branch L_cont_87
L_slow_90:
  s_mov_b32 s86, 65536
L_sp_92:
  s_sleep 1
  s_add_u32 s78, s12, s93
  s_add_u32 s78, s78, 114688
  buffer_load_dwordx4 v[168:171], v10, s[32:35], s78 offen sc1
  buffer_load_dwordx4 v[172:175], v11, s[32:35], s78 offen sc1
  s_waitcnt vmcnt(0)
  v_xor_b32 v168, v168, v14
  v_xor_b32 v170, v170, v15
  v_xor_b32 v172, v172, v14
  v_xor_b32 v174, v174, v15
  v_bitop3_b32 v2, v168, v170, v168 bitop3:0xf3
  v_bitop3_b32 v2, v172, v174, v2 bitop3:0xfb
  v_and_b32 v2, s3, v2
  v_cmp_ne_u32 vcc, 0, v2
  s_nop 1
  s_cmp_lg_u64 vcc, 0
  s_cbranch_scc0 L_sd_93
  s_sub_u32 s86, s86, 1
  s_cbranch_scc0 L_sp_92
L_sd_93:
  s_add_u32 s78, s13, s90
  s_add_u32 s78, s78, 114688
  buffer_load_dwordx4 v[96:99], v10, s[32:35], s78 offen sc1
  buffer_load_dwordx4 v[100:103], v11, s[32:35], s78 offen sc1
  s_add_u32 s78, s13, s91
  s_add_u32 s78, s78, 114688
  buffer_load_dwordx4 v[176:179], v10, s[32:35], s78 offen sc1
  buffer_load_dwordx4 v[180:183], v11, s[32:35], s78 offen sc1
  s_add_u32 s78, s13, s92
  s_add_u32 s78, s78, 114688
  buffer_load_dwordx4 v[128:131], v10, s[32:35], s78 offen sc1
  buffer_load_dwordx4 v[132:135], v11, s[32:35], s78 offen sc1
  s_add_u32 s78, s13, s93
  s_add_u32 s78, s78, 114688
  buffer_load_dwordx4 v[104:107], v10, s[32:35], s78 offen sc1
  buffer_load_dwordx4 v[108:111], v11, s[32:35], s78 offen sc1
  s_add_u32 s78, s10, s14
  buffer_load_dwordx4 v[136:139], v10, s[32:35], s78 offen sc1
  buffer_load_dwordx4 v[140:143], v11, s[32:35], s78 offen sc1
  s_add_u32 s78, s10, s15
  buffer_load_dwordx4 v[80:83], v10, s[32:35], s78 offen sc1
  buffer_load_dwordx4 v[84:87], v11, s[32:35], s78 offen sc1
  s_add_u32 s78, s11, s14
  buffer_load_dwordx4 v[144:147], v10, s[32:35], s78 offen sc1
  buffer_load_dwordx4 v[148:151], v11, s[32:35], s78 offen sc1
  s_waitcnt vmcnt(14)
  s_branch L_cont_91
L_slow_94:
  s_mov_b32 s86, 65536
L_sp_96:
  s_sleep 1
  s_add_u32 s78, s13, s90
  s_add_u32 s78, s78, 114688
  buffer_load_dwordx4 v[96:99], v10, s[32:35], s78 offen sc1
  buffer_load_dwordx4 v[100:103], v11, s[32:35], s78 offen sc1
  s_waitcnt vmcnt(0)
  v_xor_b32 v96, v96, v14
  v_xor_b32 v98, v98, v15
  v_xor_b32 v100, v100, v14
  v_xor_b32 v102, v102, v15
  v_bitop3_b32 v2, v96, v98, v96 bitop3:0xf3
  v_bitop3_b32 v2, v100, v102, v2 bitop3:0xfb
  v_and_b32 v2, s3, v2
  v_cmp_ne_u32 vcc, 0, v2
  s_nop 1
  s_cmp_lg_u64 vcc, 0
  s_cbranch_scc0 L_sd_97
  s_sub_u32 s86, s86, 1
  s_cbranch_scc0 L_sp_96
L_sd_97:
  s_add_u32 s78, s13, s91
  s_add_u32 s78, s78, 114688
  buffer_load_dwordx4 v[176:179], v10, s[32:35], s78 offen sc1
  buffer_load_dwordx4 v[180:183], v11, s[32:35], s78 offen sc1
  s_add_u32 s78, s13, s92
  s_add_u32 s78, s78, 114688
  buffer_load_dwordx4 v[128:131], v10, s[32:35], s78 offen sc1
  buffer_load_dwordx4 v[132:135], v11, s[32:35], s78 offen sc1
  s_add_u32 s78, s13, s93
  s_add_u32 s78, s78, 114688
  buffer_load_dwordx4 v[104:107], v10, s[32:35], s78 offen sc1
  buffer_load_dwordx4 v[108:111], v11, s[32:35], s78 offen sc1
  s_add_u32 s78, s10, s14
  buffer_load_dwordx4 v[136:139], v10, s[32:35], s78 offen sc1
  buffer_load_dwordx4 v[140:143], v11, s[32:35], s78 offen sc1
  s_add_u32 s78, s10, s15
  buffer_load_dwordx4 v[80:83], v10, s[32:35], s78 offen sc1
  buffer_load_dwordx4 v[84:87], v11, s[32:35], s78 offen sc1
  s_add_u32 s78, s11, s14
  buffer_load_dwordx4 v[144:147], v10, s[32:35], s78 offen sc1
  buffer_load_dwordx4 v[148:151], v11, s[32:35], s78 offen sc1
  s_add_u32 s78, s11, s15
  buffer_load_dwordx4 v[112:115], v10, s[32:35], s78 offen sc1
  buffer_load_dwordx4 v[116:119], v11, s[32:35], s78 offen sc1
  s_waitcnt vmcnt(14)
  s_branch L_cont_95
L_slow_98:
  s_mov_b32 s86, 65536
L_sp_100:
  s_sleep 1
  s_add_u32 s78, s13, s91
  s_add_u32 s78, s78, 114688
  buffer_load_dwordx4 v[176:179], v10, s[32:35], s78 offen sc1
  buffer_load_dwordx4 v[180:183], v11, s[32:35], s78 offen sc1
  s_waitcnt vmcnt(0)
  v_xor_b32 v176, v176, v14
  v_xor_b32 v178, v178, v15
  v_xor_b32 v180, v180, v14
  v_xor_b32 v182, v182, v15
  v_bitop3_b32 v2, v176, v178, v176 bitop3:0xf3
  v_bitop3_b32 v2, v180, v182, v2 bitop3:0xfb
  v_and_b32 v2, s3, v2
  v_cmp_ne_u32 vcc, 0, v2
  s_nop 1
  s_cmp_lg_u64 vcc, 0
  s_cbranch_scc0 L_sd_101
  s_sub_u32 s86, s86, 1
  s_cbranch_scc0 L_sp_100
L_sd_101:
  s_add_u32 s78, s13, s92
  s_add_u32 s78, s78, 114688
  buffer_load_dwordx4 v[128:131], v10, s[32:35], s78 offen sc1
  buffer_load_dwordx4 v[132:135], v11, s[32:35], s78 offen sc1
  s_add_u32 s78, s13, s93
  s_add_u32 s78, s78, 114688
  buffer_load_dwordx4 v[104:107], v10, s[32:35], s78 offen sc1
  buffer_load_dwordx4 v[108:111], v11, s[32:35], s78 offen sc1
  s_add_u32 s78, s10, s14
  buffer_load_dwordx4 v[136:139], v10, s[32:35], s78 offen sc1
  buffer_load_dwordx4 v[140:143], v11, s[32:35], s78 offen sc1
  s_add_u32 s78, s10, s15
  buffer_load_dwordx4 v[80:83], v10, s[32:35], s78 offen sc1
  buffer_load_dwordx4 v[84:87], v11, s[32:35], s78 offen sc1
  s_add_u32 s78, s11, s14
  buffer_load_dwordx4 v[144:147], v10, s[32:35], s78 offen sc1
  buffer_load_dwordx4 v[148:151], v11, s[32:35], s78 offen sc1
  s_add_u32 s78, s11, s15
  buffer_load_dwordx4 v[112:115], v10, s[32:35], s78 offen sc1
  buffer_load_dwordx4 v[116:119], v11, s[32:35], s78 offen sc1
  s_add_u32 s78, s6, s90
  buffer_load_dwordx4 v[152:155], v10, s[32:35], s78 offen sc1
  buffer_load_dwordx4 v[156:159], v11, s[32:35], s78 offen sc1
  s_waitcnt vmcnt(14)
  s_branch L_cont_99
L_slow_102:
  s_mov_b32 s86, 65536
L_sp_104:
  s_sleep 1
  s_add_u32 s78, s13, s92
  s_add_u32 s78, s78, 114688
  buffer_load_dwordx4 v[128:131], v10, s[32:35], s78 offen sc1
  buffer_load_dwordx4 v[132:135], v11, s[32:35], s78 offen sc1
  s_waitcnt vmcnt(0)
  v_xor_b32 v128, v128, v14
  v_xor_b32 v130, v130, v15
  v_xor_b32 v132, v132, v14
  v_xor_b32 v134, v134, v15
  v_bitop3_b32 v2, v128, v130, v128 bitop3:0xf3
  v_bitop3_b32 v2, v132, v134, v2 bitop3:0xfb
  v_and_b32 v2, s3, v2
  v_cmp_ne_u32 vcc, 0, v2
  s_nop 1
  s_cmp_lg_u64 vcc, 0
  s_cbranch_scc0 L_sd_105
  s_sub_u32 s86, s86, 1
  s_cbranch_scc0 L_sp_104
L_sd_105:
  s_add_u32 s78, s13, s93
  s_add_u32 s78, s78, 114688
  buffer_load_dwordx4 v[104:107], v10, s[32:35], s78 offen sc1
  buffer_load_dwordx4 v[108:111], v11, s[32:35], s78 offen sc1
  s_add_u32 s78, s10, s14
  buffer_load_dwordx4 v[136:139], v10, s[32:35], s78 offen sc1
  buffer_load_dwordx4 v[140:143], v11, s[32:35], s78 offen sc1
  s_add_u32 s78, s10, s15
  buffer_load_dwordx4 v[80:83], v10, s[32:35], s78 offen sc1
  buffer_load_dwordx4 v[84:87], v11, s[32:35], s78 offen sc1
  s_add_u32 s78, s11, s14
  buffer_load_dwordx4 v[144:147], v10, s[32:35], s78 offen sc1
  buffer_load_dwordx4 v[148:151], v11, s[32:35], s78 offen sc1
  s_add_u32 s78, s11, s15
  buffer_load_dwordx4 v[112:115], v10, s[32:35], s78 offen sc1
  buffer_load_dwordx4 v[116:119], v11, s[32:35], s78 offen sc1
  s_add_u32 s78, s6, s90
  buffer_load_dwordx4 v[152:155], v10, s[32:35], s78 offen sc1
  buffer_load_dwordx4 v[156:159], v11, s[32:35], s78 offen sc1
  s_add_u32 s78, s6, s91
  buffer_load_dwordx4 v[88:91], v10, s[32:35], s78 offen sc1
  buffer_load_dwordx4 v[92:95], v11, s[32:35], s78 offen sc1
  s_waitcnt vmcnt(14)
  s_branch L_cont_103
L_slow_106:
  s_mov_b32 s86, 65536
L_sp_108:
  s_sleep 1
  s_add_u32 s78, s13, s93
  s_add_u32 s78, s78, 114688
  buffer_load_dwordx4 v[104:107], v10, s[32:35], s78 offen sc1
  buffer_load_dwordx4 v[108:111], v11, s[32:35], s78 offen sc1
  s_waitcnt vmcnt(0)
  v_xor_b32 v104, v104, v14
  v_xor_b32 v106, v106, v15
  v_xor_b32 v108, v108, v14
  v_xor_b32 v110, v110, v15
  v_bitop3_b32 v2, v104, v106, v104 bitop3:0xf3
  v_bitop3_b32 v2, v108, v110, v2 bitop3:0xfb
  v_and_b32 v2, s3, v2
  v_cmp_ne_u32 vcc, 0, v2
  s_nop 1
  s_cmp_lg_u64 vcc, 0
  s_cbranch_scc0 L_sd_109
  s_sub_u32 s86, s86, 1
  s_cbranch_scc0 L_sp_108
L_sd_109:
  s_add_u32 s78, s10, s14
  buffer_load_dwordx4 v[136:139], v10, s[32:35], s78 offen sc1
  buffer_load_dwordx4 v[140:143], v11, s[32:35], s78 offen sc1
  s_add_u32 s78, s10, s15
  buffer_load_dwordx4 v[80:83], v10, s[32:35], s78 offen sc1
  buffer_load_dwordx4 v[84:87], v11, s[32:35], s78 offen sc1
  s_add_u32 s78, s11, s14
  buffer_load_dwordx4 v[144:147], v10, s[32:35], s78 offen sc1
  buffer_load_dwordx4 v[148:151], v11, s[32:35], s78 offen sc1
  s_add_u32 s78, s11, s15
  buffer_load_dwordx4 v[112:115], v10, s[32:35], s78 offen sc1
  buffer_load_dwordx4 v[116:119], v11, s[32:35], s78 offen sc1
  s_add_u32 s78, s6, s90
  buffer_load_dwordx4 v[152:155], v10, s[32:35], s78 offen sc1
  buffer_load_dwordx4 v[156:159], v11, s[32:35], s78 offen sc1
  s_add_u32 s78, s6, s91
  buffer_load_dwordx4 v[88:91], v10, s[32:35], s78 offen sc1
  buffer_load_dwordx4 v[92:95], v11, s[32:35], s78 offen sc1
  s_add_u32 s78, s6, s92
  buffer_load_dwordx4 v[160:163], v10, s[32:35], s78 offen sc1
  buffer_load_dwordx4 v[164:167], v11, s[32:35], s78 offen sc1
  s_waitcnt vmcnt(14)
  s_branch L_cont_107
L_slow_110:
  s_mov_b32 s86, 65536
L_sp_112:
  s_sleep 1
  s_add_u32 s78, s10, s14
  buffer_load_dwordx4 v[136:139], v10, s[32:35], s78 offen sc1
  buffer_load_dwordx4 v[140:143], v11, s[32:35], s78 offen sc1
  s_waitcnt vmcnt(0)
  v_xor_b32 v136, v136, v14
  v_xor_b32 v138, v138, v15
  v_xor_b32 v140, v140, v14
  v_xor_b32 v142, v142, v15
  v_bitop3_b32 v2, v136, v138, v136 bitop3:0xf3
  v_bitop3_b32 v2, v140, v142, v2 bitop3:0xfb
  v_and_b32 v2, s3, v2
  v_cmp_ne_u32 vcc, 0, v2
  s_nop 1
  s_cmp_lg_u64 vcc, 0
  s_cbranch_scc0 L_sd_113
  s_sub_u32 s86, s86, 1
  s_cbranch_scc0 L_sp_112
L_sd_113:
  s_add_u32 s78, s10, s15
  buffer_load_dwordx4 v[80:83], v10, s[32:35], s78 offen sc1
  buffer_load_dwordx4 v[84:87], v11, s[32:35], s78 offen sc1
  s_add_u32 s78, s11, s14
  buffer_load_dwordx4 v[144:147], v10, s[32:35], s78 offen sc1
  buffer_load_dwordx4 v[148:151], v11, s[32:35], s78 offen sc1
  s_add_u32 s78, s11, s15
  buffer_load_dwordx4 v[112:115], v10, s[32:35], s78 offen sc1
  buffer_load_dwordx4 v[116:119], v11, s[32:35], s78 offen sc1
  s_add_u32 s78, s6, s90
  buffer_load_dwordx4 v[152:155], v10, s[32:35], s78 offen sc1
  buffer_load_dwordx4 v[156:159], v11, s[32:35], s78 offen sc1
  s_add_u32 s78, s6, s91
  buffer_load_dwordx4 v[88:91], v10, s[32:35], s78 offen sc1
  buffer_load_dwordx4 v[92:95], v11, s[32:35], s78 offen sc1
  s_add_u32 s78, s6, s92
  buffer_load_dwordx4 v[160:163], v10, s[32:35], s78 offen sc1
  buffer_load_dwordx4 v[164:167], v11, s[32:35], s78 offen sc1
  s_add_u32 s78, s6, s93
  buffer_load_dwordx4 v[120:123], v10, s[32:35], s78 offen sc1
  buffer_load_dwordx4 v[124:127], v11, s[32:35], s78 offen sc1
  s_waitcnt vmcnt(14)
  s_branch L_cont_111
L_slow_114:
  s_mov_b32 s86, 65536
L_sp_116:
  s_sleep 1
  s_add_u32 s78, s10, s15
  buffer_load_dwordx4 v[80:83], v10, s[32:35], s78 offen sc1
  buffer_load_dwordx4 v[84:87], v11, s[32:35], s78 offen sc1
  s_waitcnt vmcnt(0)
  v_xor_b32 v80, v80, v14
  v_xor_b32 v82, v82, v15
  v_xor_b32 v84, v84, v14
  v_xor_b32 v86, v86, v15
  v_bitop3_b32 v2, v80, v82, v80 bitop3:0xf3
  v_bitop3_b32 v2, v84, v86, v2 bitop3:0xfb
  v_and_b32 v2, s3, v2
  v_cmp_ne_u32 vcc, 0, v2
  s_nop 1
  s_cmp_lg_u64 vcc, 0
  s_cbranch_scc0 L_sd_117
  s_sub_u32 s86, s86, 1
  s_cbranch_scc0 L_sp_116
L_sd_117:
  s_add_u32 s78, s11, s14
  buffer_load_dwordx4 v[144:147], v10, s[32:35], s78 offen sc1
  buffer_load_dwordx4 v[148:151], v11, s[32:35], s78 offen sc1
  s_add_u32 s78, s11, s15
  buffer_load_dwordx4 v[112:115], v10, s[32:35], s78 offen sc1
  buffer_load_dwordx4 v[116:119], v11, s[32:35], s78 offen sc1
  s_add_u32 s78, s6, s90
  buffer_load_dwordx4 v[152:155], v10, s[32:35], s78 offen sc1
  buffer_load_dwordx4 v[156:159], v11, s[32:35], s78 offen sc1
  s_add_u32 s78, s6, s91
  buffer_load_dwordx4 v[88:91], v10, s[32:35], s78 offen sc1
  buffer_load_dwordx4 v[92:95], v11, s[32:35], s78 offen sc1
  s_add_u32 s78, s6, s92
  buffer_load_dwordx4 v[160:163], v10, s[32:35], s78 offen sc1
  buffer_load_dwordx4 v[164:167], v11, s[32:35], s78 offen sc1
  s_add_u32 s78, s6, s93
  buffer_load_dwordx4 v[120:123], v10, s[32:35], s78 offen sc1
  buffer_load_dwordx4 v[124:127], v11, s[32:35], s78 offen sc1
  s_add_u32 s78, s7, s90
  buffer_load_dwordx4 v[168:171], v10, s[32:35], s78 offen sc1
  buffer_load_dwordx4 v[172:175], v11, s[32:35], s78 offen sc1
  s_waitcnt vmcnt(14)
  s_branch L_cont_115
L_slow_118:
  s_mov_b32 s86, 65536
L_sp_120:
  s_sleep 1
  s_add_u32 s78, s11, s14
  buffer_load_dwordx4 v[144:147], v10, s[32:35], s78 offen sc1
  buffer_load_dwordx4 v[148:151], v11, s[32:35], s78 offen sc1
  s_waitcnt vmcnt(0)
  v_xor_b32 v144, v144, v14
  v_xor_b32 v146, v146, v15
  v_xor_b32 v148, v148, v14
  v_xor_b32 v150, v150, v15
  v_bitop3_b32 v2, v144, v146, v144 bitop3:0xf3
  v_bitop3_b32 v2, v148, v150, v2 bitop3:0xfb
  v_and_b32 v2, s3, v2
  v_cmp_ne_u32 vcc, 0, v2
  s_nop 1
  s_cmp_lg_u64 vcc, 0
  s_cbranch_scc0 L_sd_121
  s_sub_u32 s86, s86, 1
  s_cbranch_scc0 L_sp_120
L_sd_121:
  s_add_u32 s78, s11, s15
  buffer_load_dwordx4 v[112:115], v10, s[32:35], s78 offen sc1
  buffer_load_dwordx4 v[116:119], v11, s[32:35], s78 offen sc1
  s_add_u32 s78, s6, s90
  buffer_load_dwordx4 v[152:155], v10, s[32:35], s78 offen sc1
  buffer_load_dwordx4 v[156:159], v11, s[32:35], s78 offen sc1
  s_add_u32 s78, s6, s91
  buffer_load_dwordx4 v[88:91], v10, s[32:35], s78 offen sc1
  buffer_load_dwordx4 v[92:95], v11, s[32:35], s78 offen sc1
  s_add_u32 s78, s6, s92
  buffer_load_dwordx4 v[160:163], v10, s[32:35], s78 offen sc1
  buffer_load_dwordx4 v[164:167], v11, s[32:35], s78 offen sc1
  s_add_u32 s78, s6, s93
  buffer_load_dwordx4 v[120:123], v10, s[32:35], s78 offen sc1
  buffer_load_dwordx4 v[124:127], v11, s[32:35], s78 offen sc1
  s_add_u32 s78, s7, s90
  buffer_load_dwordx4 v[168:171], v10, s[32:35], s78 offen sc1
  buffer_load_dwordx4 v[172:175], v11, s[32:35], s78 offen sc1
  s_add_u32 s78, s7, s91
  buffer_load_dwordx4 v[96:99], v10, s[32:35], s78 offen sc1
  buffer_load_dwordx4 v[100:103], v11, s[32:35], s78 offen sc1
  s_waitcnt vmcnt(14)
  s_branch L_cont_119
L_slow_122:
  s_mov_b32 s86, 65536
L_sp_124:
  s_sleep 1
  s_add_u32 s78, s11, s15
  buffer_load_dwordx4 v[112:115], v10, s[32:35], s78 offen sc1
  buffer_load_dwordx4 v[116:119], v11, s[32:35], s78 offen sc1
  s_waitcnt vmcnt(0)
  v_xor_b32 v112, v112, v14
  v_xor_b32 v114, v114, v15
  v_xor_b32 v116, v116, v14
  v_xor_b32 v118, v118, v15
  v_bitop3_b32 v2, v112, v114, v112 bitop3:0xf3
  v_bitop3_b32 v2, v116, v118, v2 bitop3:0xfb
  v_and_b32 v2, s3, v2
  v_cmp_ne_u32 vcc, 0, v2
  s_nop 1
  s_cmp_lg_u64 vcc, 0
  s_cbranch_scc0 L_sd_125
  s_sub_u32 s86, s86, 1
  s_cbranch_scc0 L_sp_124
L_sd_125:
  s_add_u32 s78, s6, s90
  buffer_load_dwordx4 v[152:155], v10, s[32:35], s78 offen sc1
  buffer_load_dwordx4 v[156:159], v11, s[32:35], s78 offen sc1
  s_add_u32 s78, s6, s91
  buffer_load_dwordx4 v[88:91], v10, s[32:35], s78 offen sc1
  buffer_load_dwordx4 v[92:95], v11, s[32:35], s78 offen sc1
  s_add_u32 s78, s6, s92
  buffer_load_dwordx4 v[160:163], v10, s[32:35], s78 offen sc1
  buffer_load_dwordx4 v[164:167], v11, s[32:35], s78 offen sc1
  s_add_u32 s78, s6, s93
  buffer_load_dwordx4 v[120:123], v10, s[32:35], s78 offen sc1
  buffer_load_dwordx4 v[124:127], v11, s[32:35], s78 offen sc1
  s_add_u32 s78, s7, s90
  buffer_load_dwordx4 v[168:171], v10, s[32:35], s78 offen sc1
  buffer_load_dwordx4 v[172:175], v11, s[32:35], s78 offen sc1
  s_add_u32 s78, s7, s91
  buffer_load_dwordx4 v[96:99], v10, s[32:35], s78 offen sc1
  buffer_load_dwordx4 v[100:103], v11, s[32:35], s78 offen sc1
  s_add_u32 s78, s7, s92
  buffer_load_dwordx4 v[176:179], v10, s[32:35], s78 offen sc1
  buffer_load_dwordx4 v[180:183], v11, s[32:35], s78 offen sc1
  s_waitcnt vmcnt(14)
  s_branch L_cont_123
L_slow_126:
  s_mov_b32 s86, 65536
L_sp_128:
  s_sleep 1
  s_add_u32 s78, s6, s90
  buffer_load_dwordx4 v[152:155], v10, s[32:35], s78 offen sc1
  buffer_load_dwordx4 v[156:159], v11, s[32:35], s78 offen sc1
  s_waitcnt vmcnt(0)
  v_xor_b32 v152, v152, v14
  v_xor_b32 v154, v154, v15
  v_xor_b32 v156, v156, v14
  v_xor_b32 v158, v158, v15
  v_bitop3_b32 v2, v152, v154, v152 bitop3:0xf3
  v_bitop3_b32 v2, v156, v158, v2 bitop3:0xfb
  v_and_b32 v2, s3, v2
  v_cmp_ne_u32 vcc, 0, v2
  s_nop 1
  s_cmp_lg_u64 vcc, 0
  s_cbranch_scc0 L_sd_129
  s_sub_u32 s86, s86, 1
  s_cbranch_scc0 L_sp_128
L_sd_129:
  s_add_u32 s78, s6, s91
  buffer_load_dwordx4 v[88:91], v10, s[32:35], s78 offen sc1
  buffer_load_dwordx4 v[92:95], v11, s[32:35], s78 offen sc1
  s_add_u32 s78, s6, s92
  buffer_load_dwordx4 v[160:163], v10, s[32:35], s78 offen sc1
  buffer_load_dwordx4 v[164:167], v11, s[32:35], s78 offen sc1
  s_add_u32 s78, s6, s93
  buffer_load_dwordx4 v[120:123], v10, s[32:35], s78 offen sc1
  buffer_load_dwordx4 v[124:127], v11, s[32:35], s78 offen sc1
  s_add_u32 s78, s7, s90
  buffer_load_dwordx4 v[168:171], v10, s[32:35], s78 offen sc1
  buffer_load_dwordx4 v[172:175], v11, s[32:35], s78 offen sc1
  s_add_u32 s78, s7, s91
  buffer_load_dwordx4 v[96:99], v10, s[32:35], s78 offen sc1
  buffer_load_dwordx4 v[100:103], v11, s[32:35], s78 offen sc1
  s_add_u32 s78, s7, s92
  buffer_load_dwordx4 v[176:179], v10, s[32:35], s78 offen sc1
  buffer_load_dwordx4 v[180:183], v11, s[32:35], s78 offen sc1
  s_add_u32 s78, s7, s93
  buffer_load_dwordx4 v[128:131], v10, s[32:35], s78 offen sc1
  buffer_load_dwordx4 v[132:135], v11, s[32:35], s78 offen sc1
  s_waitcnt vmcnt(14)
  s_branch L_cont_127
L_slow_130:
  s_mov_b32 s86, 65536
L_sp_132:
  s_sleep 1
  s_add_u32 s78, s6, s91
  buffer_load_dwordx4 v[88:91], v10, s[32:35], s78 offen sc1
  buffer_load_dwordx4 v[92:95], v11, s[32:35], s78 offen sc1
  s_waitcnt vmcnt(0)
  v_xor_b32 v88, v88, v14
  v_xor_b32 v90, v90, v15
  v_xor_b32 v92, v92, v14
  v_xor_b32 v94, v94, v15
  v_bitop3_b32 v2, v88, v90, v88 bitop3:0xf3
  v_bitop3_b32 v2, v92, v94, v2 bitop3:0xfb
  v_and_b32 v2, s3, v2
  v_cmp_ne_u32 vcc, 0, v2
  s_nop 1
  s_cmp_lg_u64 vcc, 0
  s_cbranch_scc0 L_sd_133
  s_sub_u32 s86, s86, 1
  s_cbranch_scc0 L_sp_132
L_sd_133:
  s_add_u32 s78, s6, s92
  buffer_load_dwordx4 v[160:163], v10, s[32:35], s78 offen sc1
  buffer_load_dwordx4 v[164:167], v11, s[32:35], s78 offen sc1
  s_add_u32 s78, s6, s93
  buffer_load_dwordx4 v[120:123], v10, s[32:35], s78 offen sc1
  buffer_load_dwordx4 v[124:127], v11, s[32:35], s78 offen sc1
  s_add_u32 s78, s7, s90
  buffer_load_dwordx4 v[168:171], v10, s[32:35], s78 offen sc1
  buffer_load_dwordx4 v[172:175], v11, s[32:35], s78 offen sc1
  s_add_u32 s78, s7, s91
  buffer_load_dwordx4 v[96:99], v10, s[32:35], s78 offen sc1
  buffer_load_dwordx4 v[100:103], v11, s[32:35], s78 offen sc1
  s_add_u32 s78, s7, s92
  buffer_load_dwordx4 v[176:179], v10, s[32:35], s78 offen sc1
  buffer_load_dwordx4 v[180:183], v11, s[32:35], s78 offen sc1
  s_add_u32 s78, s7, s93
  buffer_load_dwordx4 v[128:131], v10, s[32:35], s78 offen sc1
  buffer_load_dwordx4 v[132:135], v11, s[32:35], s78 offen sc1
  s_waitcnt vmcnt(12)
  s_branch L_cont_131
L_slow_134:
  s_mov_b32 s86, 65536
L_sp_136:
  s_sleep 1
  s_add_u32 s78, s6, s92
  buffer_load_dwordx4 v[160:163], v10, s[32:35], s78 offen sc1
  buffer_load_dwordx4 v[164:167], v11, s[32:35], s78 offen sc1
  s_waitcnt vmcnt(0)
  v_xor_b32 v160, v160, v14
  v_xor_b32 v162, v162, v15
  v_xor_b32 v164, v164, v14
  v_xor_b32 v166, v166, v15
  v_bitop3_b32 v2, v160, v162, v160 bitop3:0xf3
  v_bitop3_b32 v2, v164, v166, v2 bitop3:0xfb
  v_and_b32 v2, s3, v2
  v_cmp_ne_u32 vcc, 0, v2
  s_nop 1
  s_cmp_lg_u64 vcc, 0
  s_cbranch_scc0 L_sd_137
  s_sub_u32 s86, s86, 1
  s_cbranch_scc0 L_sp_136
L_sd_137:
  s_add_u32 s78, s6, s93
  buffer_load_dwordx4 v[120:123], v10, s[32:35], s78 offen sc1
  buffer_load_dwordx4 v[124:127], v11, s[32:35], s78 offen sc1
  s_add_u32 s78, s7, s90
  buffer_load_dwordx4 v[168:171], v10, s[32:35], s78 offen sc1
  buffer_load_dwordx4 v[172:175], v11, s[32:35], s78 offen sc1
  s_add_u32 s78, s7, s91
  buffer_load_dwordx4 v[96:99], v10, s[32:35], s78 offen sc1
  buffer_load_dwordx4 v[100:103], v11, s[32:35], s78 offen sc1
  s_add_u32 s78, s7, s92
  buffer_load_dwordx4 v[176:179], v10, s[32:35], s78 offen sc1
  buffer_load_dwordx4 v[180:183], v11, s[32:35], s78 offen sc1
  s_add_u32 s78, s7, s93
  buffer_load_dwordx4 v[128:131], v10, s[32:35], s78 offen sc1
  buffer_load_dwordx4 v[132:135], v11, s[32:35], s78 offen sc1
  s_waitcnt vmcnt(10)
  s_branch L_cont_135
L_slow_138:
  s_mov_b32 s86, 65536
L_sp_140:
  s_sleep 1
  s_add_u32 s78, s6, s93
  buffer_load_dwordx4 v[120:123], v10, s[32:35], s78 offen sc1
  buffer_load_dwordx4 v[124:127], v11, s[32:35], s78 offen sc1
  s_waitcnt vmcnt(0)
  v_xor_b32 v120, v120, v14
  v_xor_b32 v122, v122, v15
  v_xor_b32 v124, v124, v14
  v_xor_b32 v126, v126, v15
  v_bitop3_b32 v2, v120, v122, v120 bitop3:0xf3
  v_bitop3_b32 v2, v124, v126, v2 bitop3:0xfb
  v_and_b32 v2, s3, v2
  v_cmp_ne_u32 vcc, 0, v2
  s_nop 1
  s_cmp_lg_u64 vcc, 0
  s_cbranch_scc0 L_sd_141
  s_sub_u32 s86, s86, 1
  s_cbranch_scc0 L_sp_140
L_sd_141:
  s_add_u32 s78, s7, s90
  buffer_load_dwordx4 v[168:171], v10, s[32:35], s78 offen sc1
  buffer_load_dwordx4 v[172:175], v11, s[32:35], s78 offen sc1
  s_add_u32 s78, s7, s91
  buffer_load_dwordx4 v[96:99], v10, s[32:35], s78 offen sc1
  buffer_load_dwordx4 v[100:103], v11, s[32:35], s78 offen sc1
  s_add_u32 s78, s7, s92
  buffer_load_dwordx4 v[176:179], v10, s[32:35], s78 offen sc1
  buffer_load_dwordx4 v[180:183], v11, s[32:35], s78 offen sc1
  s_add_u32 s78, s7, s93
  buffer_load_dwordx4 v[128:131], v10, s[32:35], s78 offen sc1
  buffer_load_dwordx4 v[132:135], v11, s[32:35], s78 offen sc1
  buffer_load_dwordx4 v[136:139], v4, s[28:31], 0 offen
  buffer_load_dwordx4 v[140:143], v4, s[28:31], 0 offen offset:32
  s_waitcnt vmcnt(10)
  s_branch L_cont_139
L_slow_142:
  s_mov_b32 s86, 65536
L_sp_144:
  s_sleep 1
  s_add_u32 s78, s7, s90
  buffer_load_dwordx4 v[168:171], v10, s[32:35], s78 offen sc1
  buffer_load_dwordx4 v[172:175], v11, s[32:35], s78 offen sc1
  s_waitcnt vmcnt(0)
  v_xor_b32 v168, v168, v14
  v_xor_b32 v170, v170, v15
  v_xor_b32 v172, v172, v14
  v_xor_b32 v174, v174, v15
  v_bitop3_b32 v2, v168, v170, v168 bitop3:0xf3
  v_bitop3_b32 v2, v172, v174, v2 bitop3:0xfb
  v_and_b32 v2, s3, v2
  v_cmp_ne_u32 vcc, 0, v2
  s_nop 1
  s_cmp_lg_u64 vcc, 0
  s_cbranch_scc0 L_sd_145
  s_sub_u32 s86, s86, 1
  s_cbranch_scc0 L_sp_144
L_sd_145:
  s_add_u32 s78, s7, s91
  buffer_load_dwordx4 v[96:99], v10, s[32:35], s78 offen sc1
  buffer_load_dwordx4 v[100:103], v11, s[32:35], s78 offen sc1
  s_add_u32 s78, s7, s92
  buffer_load_dwordx4 v[176:179], v10, s[32:35], s78 offen sc1
  buffer_load_dwordx4 v[180:183], v11, s[32:35], s78 offen sc1
  s_add_u32 s78, s7, s93
  buffer_load_dwordx4 v[128:131], v10, s[32:35], s78 offen sc1
  buffer_load_dwordx4 v[132:135], v11, s[32:35], s78 offen sc1
  buffer_load_dwordx4 v[136:139], v4, s[28:31], 0 offen
  buffer_load_dwordx4 v[140:143], v4, s[28:31], 0 offen offset:32
  s_waitcnt vmcnt(8)
  s_branch L_cont_143
L_slow_146:
  s_mov_b32 s86, 65536
L_sp_148:
  s_sleep 1
  s_add_u32 s78, s7, s91
  buffer_load_dwordx4 v[96:99], v10, s[32:35], s78 offen sc1
  buffer_load_dwordx4 v[100:103], v11, s[32:35], s78 offen sc1
  s_waitcnt vmcnt(0)
  v_xor_b32 v96, v96, v14
  v_xor_b32 v98, v98, v15
  v_xor_b32 v100, v100, v14
  v_xor_b32 v102, v102, v15
  v_bitop3_b32 v2, v96, v98, v96 bitop3:0xf3
  v_bitop3_b32 v2, v100, v102, v2 bitop3:0xfb
  v_and_b32 v2, s3, v2
  v_cmp_ne_u32 vcc, 0, v2
  s_nop 1
  s_cmp_lg_u64 vcc, 0
  s_cbranch_scc0 L_sd_149
  s_sub_u32 s86, s86, 1
  s_cbranch_scc0 L_sp_148
L_sd_149:
  s_add_u32 s78, s7, s92
  buffer_load_dwordx4 v[176:179], v10, s[32:35], s78 offen sc1
  buffer_load_dwordx4 v[180:183], v11, s[32:35], s78 offen sc1
  s_add_u32 s78, s7, s93
  buffer_load_dwordx4 v[128:131], v10, s[32:35], s78 offen sc1
  buffer_load_dwordx4 v[132:135], v11, s[32:35], s78 offen sc1
  buffer_load_dwordx4 v[136:139], v4, s[28:31], 0 offen
  buffer_load_dwordx4 v[140:143], v4, s[28:31], 0 offen offset:32
  s_waitcnt vmcnt(6)
  s_branch L_cont_147
L_slow_150:
  s_mov_b32 s86, 65536
L_sp_152:
  s_sleep 1
  s_add_u32 s78, s7, s92
  buffer_load_dwordx4 v[176:179], v10, s[32:35], s78 offen sc1
  buffer_load_dwordx4 v[180:183], v11, s[32:35], s78 offen sc1
  s_waitcnt vmcnt(0)
  v_xor_b32 v176, v176, v14
  v_xor_b32 v178, v178, v15
  v_xor_b32 v180, v180, v14
  v_xor_b32 v182, v182, v15
  v_bitop3_b32 v2, v176, v178, v176 bitop3:0xf3
  v_bitop3_b32 v2, v180, v182, v2 bitop3:0xfb
  v_and_b32 v2, s3, v2
  v_cmp_ne_u32 vcc, 0, v2
  s_nop 1
  s_cmp_lg_u64 vcc, 0
  s_cbranch_scc0 L_sd_153
  s_sub_u32 s86, s86, 1
  s_cbranch_scc0 L_sp_152
L_sd_153:
  s_add_u32 s78, s7, s93
  buffer_load_dwordx4 v[128:131], v10, s[32:35], s78 offen sc1
  buffer_load_dwordx4 v[132:135], v11, s[32:35], s78 offen sc1
  buffer_load_dwordx4 v[136:139], v4, s[28:31], 0 offen
  buffer_load_dwordx4 v[140:143], v4, s[28:31], 0 offen offset:32
  s_waitcnt vmcnt(4)
  s_branch L_cont_151
L_slow_154:
  s_mov_b32 s86, 65536
L_sp_156:
  s_sleep 1
  s_add_u32 s78, s7, s93
  buffer_load_dwordx4 v[128:131], v10, s[32:35], s78 offen sc1
  buffer_load_dwordx4 v[132:135], v11, s[32:35], s78 offen sc1
  s_waitcnt vmcnt(0)
  v_xor_b32 v128, v128, v14
  v_xor_b32 v130, v130, v15
  v_xor_b32 v132, v132, v14
  v_xor_b32 v134, v134, v15
  v_bitop3_b32 v2, v128, v130, v128 bitop3:0xf3
  v_bitop3_b32 v2, v132, v134, v2 bitop3:0xfb
  v_and_b32 v2, s3, v2
  v_cmp_ne_u32 vcc, 0, v2
  s_nop 1
  s_cmp_lg_u64 vcc, 0
  s_cbranch_scc0 L_sd_157
  s_sub_u32 s86, s86, 1
  s_cbranch_scc0 L_sp_156
L_sd_157:
  buffer_load_dwordx4 v[136:139], v4, s[28:31], 0 offen
  buffer_load_dwordx4 v[140:143], v4, s[28:31], 0 offen offset:32
  s_waitcnt vmcnt(2)
  s_branch L_cont_155
L_p2t2:
  s_lshl_b32 s27, s68, 11
  s_mov_b32 s60, s8
  s_mov_b32 s61, s9
  s_mov_b32 s62, 0x4000
  s_mov_b32 s63, 0x20000
  s_mov_b32 s32, s24
  s_mov_b32 s33, s25
  s_mov_b32 s34, 0x1000000
  s_mov_b32 s35, 0x20000
  s_mov_b32 s36, s22
  s_mov_b32 s37, s23
  s_mov_b32 s38, 0x100
  s_mov_b32 s39, 0x20000
  s_mov_b32 s52, s18
  s_mov_b32 s53, s19
  s_mov_b32 s54, 0x1c0000
  s_mov_b32 s55, 0x20000
  s_mov_b32 s56, s10
  s_mov_b32 s57, s11
  s_mov_b32 s58, 0x80000
  s_mov_b32 s59, 0x20000
  s_mov_b32 s64, s20
  s_mov_b32 s65, s21
  s_mov_b32 s66, 0x200000
  s_mov_b32 s67, 0x20000
  s_mov_b32 s24, 0x3fb8aa3b
  s_lshl_b32 s88, s68, 1
  s_add_u32 s88, s88, s74
  s_add_u32 s89, s88, 1
  s_and_b32 s88, s88, 7
  s_and_b32 s89, s89, 7
  s_lshr_b32 s76, s74, 1
  s_add_u32 s76, s76, s73
  s_add_u32 s90, s76, 0
  s_and_b32 s90, s90, 3
  s_add_u32 s91, s76, 1
  s_and_b32 s91, s91, 3
  s_add_u32 s92, s76, 2
  s_and_b32 s92, s92, 3
  s_add_u32 s93, s76, 3
  s_and_b32 s93, s93, 3
  s_mul_i32 s81, s73, 294912
  s_lshl_b32 s76, s74, 7
  v_lshl_add_u32 v6, v12, 10, v13
  v_add_u32 v6, s76, v6
  v_add_u32 v7, 7168, v6
  v_lshrrev_b32 v14, 5, v0
  v_lshlrev_b32 v14, 9, v14
  v_bfe_u32 v15, v0, 2, 2
  v_lshl_add_u32 v14, v15, 7, v14
  v_bfe_u32 v15, v0, 3, 1
  v_lshl_add_u32 v14, v15, 6, v14
  v_bfe_u32 v15, v0, 4, 1
  v_lshl_add_u32 v14, v15, 5, v14
  v_and_b32 v15, 3, v0
  v_lshl_add_u32 v14, v15, 3, v14
  s_and_b32 s76, s68, 1
  s_lshl_b32 s76, s76, 6
  v_xor_b32 v14, s76, v14
  s_lshl_b32 s76, s68, 12
  s_add_u32 s76, s76, 65536
  v_add_u32 v8, s76, v14
  v_xor_b32 v9, 64, v8
  s_lshr_b32 s76, s68, 1
  s_mul_i32 s77, s76, 147456
  s_sub_u32 s78, 147456, s77
  s_add_u32 s77, s77, s81
  s_add_u32 s78, s78, s81
  v_add_u32 v10, s77, v1
  v_add_u32 v11, s78, v1
  s_lshl_b32 s4, s88, 13
  s_add_u32 s6, s4, 4096
  s_lshl_b32 s12, s88, 12
  s_mul_i32 s76, s88, 6144
  s_and_b32 s77, s88, 1
  s_lshl_b32 s78, s77, 11
  s_add_u32 s8, s76, s78
  s_add_u32 s8, s8, 65536
  s_lshl_b32 s78, s77, 12
  s_sub_u32 s10, s76, s78
  s_add_u32 s10, s10, 69632
  s_lshl_b32 s5, s89, 13
  s_add_u32 s7, s5, 4096
  s_lshl_b32 s13, s89, 12
  s_mul_i32 s76, s89, 6144
  s_and_b32 s77, s89, 1
  s_lshl_b32 s78, s77, 11
  s_add_u32 s9, s76, s78
  s_add_u32 s9, s9, 65536
  s_lshl_b32 s78, s77, 12
  s_sub_u32 s11, s76, s78
  s_add_u32 s11, s11, 69632
  s_lshl_b32 s90, s90, 10
  s_lshl_b32 s91, s91, 10
  s_lshl_b32 s92, s92, 10
  s_lshl_b32 s93, s93, 10
  s_and_b32 s14, s90, 1024
  s_and_b32 s15, s91, 1024
  s_lshl_b32 s99, s68, 12
  v_mov_b32 v16, 0
  v_mov_b32 v17, 0
  v_mov_b32 v18, 0
  v_mov_b32 v19, 0
  v_mov_b32 v20, 0
  v_mov_b32 v21, 0
  v_mov_b32 v22, 0
  v_mov_b32 v23, 0
  v_add_u32 v14, s27, v1
  v_add_u32 v14, 149504, v14
  ds_write_b128 v14, v[16:19]
  ds_write_b128 v14, v[16:19] offset:1024
  v_add_u32 v14, 157696, v1
  ds_write_b128 v14, v[20:23]
  s_lshl_b32 s76, s69, 2
  s_add_u32 s76, s76, s68
  s_mul_i32 s94, s76, 147456
  s_lshl_b32 s77, s70, 12
  s_add_u32 s94, s94, s77
  s_add_u32 s94, s94, 114688
  s_lshl_b32 s95, s76, 5
  s_add_u32 s95, s95, s70
  s_lshl_b32 s95, s95, 7
  s_add_u32 s95, s95, 11536384
  s_or_b32 s76, s2, s68
  s_cmp_lg_u32 s76, 0
  s_cbranch_scc1 L_nn_158
  s_memrealtime s[100:101]
  s_waitcnt lgkmcnt(0)
  s_or_b32 s76, s100, 1
  v_mov_b32 v240, s76
  v_mov_b32 v241, 0
  v_lshlrev_b32 v242, 26, v0
  buffer_atomic_cmpswap v[240:241], v242, s[36:39], 0 offen sc1
  s_nop 1
L_nn_158:
  s_lshl_b32 s77, s70, 11
  s_mov_b32 m0, 147456
  s_nop 0
  buffer_load_dwordx4 v1, s[60:63], s77 offen lds
  buffer_load_dwordx4 v1, s[60:63], s77 offen offset:1024 lds
  s_lshl_b32 s76, s68, 4
  v_add_u32 v14, s76, v12
  v_mul_u32_u24 v14, 3072, v14
  v_add_u32 v2, v14, v13
  v_xor_b32 v15, 32, v13
  v_add_u32 v4, v14, v15
  v_add_u32 v3, 23552, v2
  v_add_u32 v5, 23552, v4
  s_lshl_b32 s3, s70, 7
  s_add_u32 s76, s72, 0
  s_and_b32 s76, s76, 7
  s_mul_i32 s76, s76, 196608
  s_add_u32 s77, s76, s3
  s_add_u32 m0, s27, 0
  s_nop 0
  buffer_load_dwordx4 v2, s[40:43], s77 offen offset:0 lds
  buffer_load_dwordx4 v3, s[40:43], s77 offen offset:1024 lds
  s_add_u32 s76, s72, 1
  s_and_b32 s76, s76, 7
  s_mul_i32 s76, s76, 196608
  s_add_u32 s77, s76, s3
  s_add_u32 m0, s27, 8192
  s_nop 0
  buffer_load_dwordx4 v4, s[40:43], s77 offen offset:0 lds
  buffer_load_dwordx4 v5, s[40:43], s77 offen offset:1024 lds
  s_add_u32 s76, s72, 2
  s_and_b32 s76, s76, 7
  s_mul_i32 s76, s76, 196608
  s_add_u32 s77, s76, s3
  s_add_u32 m0, s27, 16384
  s_nop 0
  buffer_load_dwordx4 v2, s[40:43], s77 offen offset:0 lds
  buffer_load_dwordx4 v3, s[40:43], s77 offen offset:1024 lds
  s_add_u32 s76, s72, 3
  s_and_b32 s76, s76, 7
  s_mul_i32 s76, s76, 196608
  s_add_u32 s77, s76, s3
  s_add_u32 m0, s27, 24576
  s_nop 0
  buffer_load_dwordx4 v4, s[40:43], s77 offen offset:0 lds
  buffer_load_dwordx4 v5, s[40:43], s77 offen offset:1024 lds
  s_waitcnt lgkmcnt(0)
  s_waitcnt vmcnt(4)
  s_barrier
  s_add_u32 s76, s72, 4
  s_and_b32 s76, s76, 7
  s_mul_i32 s76, s76, 196608
  s_add_u32 s77, s76, s3
  s_add_u32 m0, s27, 32768
  s_nop 0
  buffer_load_dwordx4 v2, s[40:43], s77 offen offset:0 lds
  buffer_load_dwordx4 v3, s[40:43], s77 offen offset:1024 lds
  s_add_u32 s76, s72, 5
  s_and_b32 s76, s76, 7
  s_mul_i32 s76, s76, 196608
  s_add_u32 s77, s76, s3
  s_add_u32 m0, s27, 40960
  s_nop 0
  buffer_load_dwordx4 v4, s[40:43], s77 offen offset:0 lds
  buffer_load_dwordx4 v5, s[40:43], s77 offen offset:1024 lds
  s_add_u32 s76, s72, 6
  s_and_b32 s76, s76, 7
  s_mul_i32 s76, s76, 196608
  s_add_u32 s77, s76, s3
  s_add_u32 m0, s27, 49152
  s_nop 0
  buffer_load_dwordx4 v2, s[40:43], s77 offen offset:0 lds
  buffer_load_dwordx4 v3, s[40:43], s77 offen offset:1024 lds
  s_add_u32 s76, s72, 7
  s_and_b32 s76, s76, 7
  s_mul_i32 s76, s76, 196608
  s_add_u32 s77, s76, s3
  s_add_u32 m0, s27, 57344
  s_nop 0
  buffer_load_dwordx4 v4, s[40:43], s77 offen offset:0 lds
  buffer_load_dwordx4 v5, s[40:43], s77 offen offset:1024 lds
  s_lshl_b32 s76, s2, 2
  s_add_u32 s76, s76, s68
  s_mul_i32 s77, s76, 1792
  s_lshl_b32 s78, s76, 9
  s_mul_i32 s79, s76, 1536
  v_lshlrev_b32 v14, 5, v0
  v_lshlrev_b32 v15, 3, v0
  buffer_load_dword v234, v14, s[52:55], s77 offen
  buffer_load_dword v235, v15, s[56:59], s78 offen
  s_waitcnt vmcnt(10)
  s_barrier
  buffer_load_dword v110, off, s[36:39], 0 sc1
  v_and_b32 v14, 1, v0
  v_lshlrev_b32 v14, 9, v14
  v_lshrrev_b32 v15, 5, v0
  v_lshl_add_u32 v14, v15, 7, v14
  v_bfe_u32 v15, v0, 2, 2
  v_lshl_add_u32 v14, v15, 5, v14
  v_bfe_u32 v15, v0, 4, 1
  v_lshl_add_u32 v14, v15, 4, v14
  v_bfe_u32 v15, v0, 1, 1
  v_lshl_add_u32 v14, v15, 3, v14
  v_add_u32 v14, 147456, v14
  ds_read_b64_tr_b16 v[32:33], v14 offset:0
  ds_read_b64_tr_b16 v[34:35], v14 offset:256
  ds_read_b64_tr_b16 v[36:37], v14 offset:1024
  ds_read_b64_tr_b16 v[38:39], v14 offset:1280
  s_mov_b32 s82, 0x0f0f0f0f
  s_mov_b32 s83, 0x0f0f0f0f
  s_waitcnt lgkmcnt(3)
  v_cndmask_b32 v16, 0, v32, s[82:83]
  v_cndmask_b32 v20, v32, 0, s[82:83]
  v_cndmask_b32 v17, 0, v33, s[82:83]
  v_cndmask_b32 v21, v33, 0, s[82:83]
  s_waitcnt lgkmcnt(2)
  v_cndmask_b32 v18, 0, v34, s[82:83]
  v_cndmask_b32 v22, v34, 0, s[82:83]
  v_cndmask_b32 v19, 0, v35, s[82:83]
  v_cndmask_b32 v23, v35, 0, s[82:83]
  s_waitcnt lgkmcnt(1)
  v_cndmask_b32 v24, 0, v36, s[82:83]
  v_cndmask_b32 v28, v36, 0, s[82:83]
  v_cndmask_b32 v25, 0, v37, s[82:83]
  v_cndmask_b32 v29, v37, 0, s[82:83]
  s_waitcnt lgkmcnt(0)
  v_cndmask_b32 v26, 0, v38, s[82:83]
  v_cndmask_b32 v30, v38, 0, s[82:83]
  v_cndmask_b32 v27, 0, v39, s[82:83]
  v_cndmask_b32 v31, v39, 0, s[82:83]
  s_lshl_b32 s76, s2, 2
  s_add_u32 s76, s76, s68
  s_mul_i32 s77, s76, 1792
  s_lshl_b32 s78, s76, 9
  s_mul_i32 s79, s76, 1536
  v_lshlrev_b32 v14, 5, v0
  v_lshlrev_b32 v15, 3, v0
  buffer_load_dword v232, v14, s[44:47], s77 offen
  buffer_load_dword v233, v14, s[48:51], s77 offen
  s_waitcnt vmcnt(9)
  s_barrier
  s_lshl_b32 s76, s68, 4
  v_add_u32 v14, s76, v12
  v_mul_u32_u24 v14, 3584, v14
  v_add_u32 v2, v14, v13
  v_xor_b32 v15, 32, v13
  v_add_u32 v4, v14, v15
  v_add_u32 v3, 27648, v2
  v_add_u32 v5, 27648, v4
  s_lshl_b32 s3, s70, 8
  s_add_u32 s76, s72, 0
  s_and_b32 s76, s76, 7
  s_mul_i32 s76, s76, 229376
  s_add_u32 s77, s76, s3
  s_add_u32 m0, s27, 0
  s_nop 0
  buffer_load_dwordx4 v2, s[44:47], s77 offen offset:0 lds
  buffer_load_dwordx4 v3, s[44:47], s77 offen offset:1024 lds
  s_add_u32 m0, s27, 8192
  s_nop 0
  buffer_load_dwordx4 v4, s[48:51], s77 offen offset:0 lds
  buffer_load_dwordx4 v5, s[48:51], s77 offen offset:1024 lds
  s_add_u32 s78, s4, s90
  s_add_u32 m0, s99, 131072
  s_lshl_b32 s78, s78, 4
  buffer_load_dwordx4 v6, s[52:55], s78 offen offset:0 lds
  buffer_load_dwordx4 v7, s[52:55], s78 offen offset:1024 lds
  s_add_u32 s78, s4, s91
  s_add_u32 m0, s99, 133120
  s_lshl_b32 s78, s78, 4
  buffer_load_dwordx4 v6, s[52:55], s78 offen offset:0 lds
  buffer_load_dwordx4 v7, s[52:55], s78 offen offset:1024 lds
  s_waitcnt vmcnt(13)
  s_barrier
  s_mov_b32 s86, 65536
  s_waitcnt vmcnt(10)
  v_readfirstlane_b32 s75, v110
L_np_159:
  s_nop 0
  s_cmp_lg_u32 s75, 0
  s_cbranch_scc1 L_nok_160
  s_sleep 1
  buffer_load_dword v110, off, s[36:39], 0 sc1
  s_waitcnt vmcnt(0)
  v_readfirstlane_b32 s75, v110
  s_sub_u32 s86, s86, 1
  s_cbranch_scc0 L_np_159
L_nok_160:
  s_nop 1
  s_add_u32 s76, s72, 1
  s_and_b32 s76, s76, 7
  s_mul_i32 s76, s76, 229376
  s_add_u32 s77, s76, s3
  s_add_u32 m0, s27, 16384
  s_nop 0
  buffer_load_dwordx4 v2, s[44:47], s77 offen offset:0 lds
  buffer_load_dwordx4 v3, s[44:47], s77 offen offset:1024 lds
  s_add_u32 m0, s27, 24576
  s_nop 0
  buffer_load_dwordx4 v4, s[48:51], s77 offen offset:0 lds
  buffer_load_dwordx4 v5, s[48:51], s77 offen offset:1024 lds
  s_add_u32 s78, s4, s92
  s_add_u32 m0, s99, 65536
  s_lshl_b32 s78, s78, 4
  buffer_load_dwordx4 v6, s[52:55], s78 offen offset:0 lds
  buffer_load_dwordx4 v7, s[52:55], s78 offen offset:1024 lds
  s_add_u32 s78, s4, s93
  s_add_u32 m0, s99, 67584
  s_lshl_b32 s78, s78, 4
  buffer_load_dwordx4 v6, s[52:55], s78 offen offset:0 lds
  buffer_load_dwordx4 v7, s[52:55], s78 offen offset:1024 lds
  s_waitcnt vmcnt(12)
  s_barrier
  s_add_u32 s76, s72, 2
  s_and_b32 s76, s76, 7
  s_mul_i32 s76, s76, 229376
  s_add_u32 s77, s76, s3
  s_add_u32 m0, s27, 32768
  s_nop 0
  buffer_load_dwordx4 v2, s[44:47], s77 offen offset:0 lds
  buffer_load_dwordx4 v3, s[44:47], s77 offen offset:1024 lds
  s_add_u32 m0, s27, 40960
  s_nop 0
  buffer_load_dwordx4 v4, s[48:51], s77 offen offset:0 lds
  buffer_load_dwordx4 v5, s[48:51], s77 offen offset:1024 lds
  v_add_u32 v8, 65536, v8
  v_add_u32 v9, 65536, v9
  s_waitcnt vmcnt(14)
  ds_read_b64_tr_b16 v[112:113], v8 offset:0
  ds_read_b64_tr_b16 v[114:115], v8 offset:1024
  ds_read_b64_tr_b16 v[116:117], v9 offset:0
  ds_read_b64_tr_b16 v[118:119], v9 offset:1024
  s_waitcnt vmcnt(12)
  ds_read_b64_tr_b16 v[120:121], v8 offset:2048
  ds_read_b64_tr_b16 v[122:123], v8 offset:3072
  ds_read_b64_tr_b16 v[124:125], v9 offset:2048
  ds_read_b64_tr_b16 v[126:127], v9 offset:3072
  s_waitcnt lgkmcnt(4)
  s_add_u32 s78, s5, s90
  s_add_u32 m0, s99, 131072
  s_lshl_b32 s78, s78, 4
  buffer_load_dwordx4 v6, s[52:55], s78 offen offset:0 lds
  buffer_load_dwordx4 v7, s[52:55], s78 offen offset:1024 lds
  s_waitcnt lgkmcnt(0)
  s_add_u32 s78, s5, s91
  s_add_u32 m0, s99, 133120
  s_lshl_b32 s78, s78, 4
  buffer_load_dwordx4 v6, s[52:55], s78 offen offset:0 lds
  buffer_load_dwordx4 v7, s[52:55], s78 offen offset:1024 lds
  s_waitcnt vmcnt(12)
  s_barrier
  s_add_u32 s76, s72, 3
  s_and_b32 s76, s76, 7
  s_mul_i32 s76, s76, 229376
  s_add_u32 s77, s76, s3
  s_add_u32 m0, s27, 49152
  s_nop 0
  buffer_load_dwordx4 v2, s[44:47], s77 offen offset:0 lds
  buffer_load_dwordx4 v3, s[44:47], s77 offen offset:1024 lds
  s_add_u32 m0, s27, 57344
  s_nop 0
  buffer_load_dwordx4 v4, s[48:51], s77 offen offset:0 lds
  buffer_load_dwordx4 v5, s[48:51], s77 offen offset:1024 lds
  v_subrev_u32 v8, 65536, v8
  v_subrev_u32 v9, 65536, v9
  s_waitcnt vmcnt(14)
  ds_read_b64_tr_b16 v[128:129], v8 offset:0
  ds_read_b64_tr_b16 v[130:131], v8 offset:1024
  ds_read_b64_tr_b16 v[132:133], v9 offset:0
  ds_read_b64_tr_b16 v[134:135], v9 offset:1024
  s_waitcnt vmcnt(12)
  ds_read_b64_tr_b16 v[136:137], v8 offset:2048
  ds_read_b64_tr_b16 v[138:139], v8 offset:3072
  ds_read_b64_tr_b16 v[140:141], v9 offset:2048
  ds_read_b64_tr_b16 v[142:143], v9 offset:3072
  s_waitcnt lgkmcnt(4)
  s_add_u32 s78, s5, s92
  s_add_u32 m0, s99, 65536
  s_lshl_b32 s78, s78, 4
  buffer_load_dwordx4 v6, s[52:55], s78 offen offset:0 lds
  buffer_load_dwordx4 v7, s[52:55], s78 offen offset:1024 lds
  s_waitcnt lgkmcnt(0)
  s_add_u32 s78, s5, s93
  s_add_u32 m0, s99, 67584
  s_lshl_b32 s78, s78, 4
  buffer_load_dwordx4 v6, s[52:55], s78 offen offset:0 lds
  buffer_load_dwordx4 v7, s[52:55], s78 offen offset:1024 lds
  s_waitcnt vmcnt(12)
  s_barrier
  s_add_u32 s76, s99, 114688
  v_add_u32 v14, s76, v1
  ds_read_b128 v[32:35], v14 offset:0
  ds_read_b128 v[36:39], v14 offset:1024
  ds_read_b128 v[40:43], v14 offset:2048
  ds_read_b128 v[44:47], v14 offset:3072
  s_add_u32 s76, s72, 4
  s_and_b32 s76, s76, 7
  s_mul_i32 s76, s76, 229376
  s_add_u32 s77, s76, s3
  s_add_u32 m0, s27, 0
  s_nop 0
  buffer_load_dwordx4 v2, s[44:47], s77 offen offset:0 lds
  buffer_load_dwordx4 v3, s[44:47], s77 offen offset:1024 lds
  s_add_u32 m0, s27, 8192
  s_nop 0
  buffer_load_dwordx4 v4, s[48:51], s77 offen offset:0 lds
  buffer_load_dwordx4 v5, s[48:51], s77 offen offset:1024 lds
  s_setprio 2
  s_waitcnt lgkmcnt(3)
  v_mfma_f32_32x32x16_bf16 v[48:63], v[16:19], v[32:35], 0
  s_waitcnt lgkmcnt(2)
  v_mfma_f32_32x32x16_bf16 v[48:63], v[20:23], v[36:39], v[48:63]
  s_waitcnt lgkmcnt(1)
  v_mfma_f32_32x32x16_bf16 v[64:79], v[24:27], v[40:43], 0
  s_waitcnt lgkmcnt(0)
  v_mfma_f32_32x32x16_bf16 v[64:79], v[28:31], v[44:47], v[64:79]
  s_setprio 0
  s_nop 6
  v_max3_f32 v32, v48, v49, v50
  v_min3_f32 v33, v48, v49, v50
  v_max3_f32 v32, v32, v51, v52
  v_min3_f32 v33, v33, v51, v52
  v_max3_f32 v32, v32, v53, v54
  v_min3_f32 v33, v33, v53, v54
  v_max3_f32 v32, v32, v55, v56
  v_min3_f32 v33, v33, v55, v56
  v_max3_f32 v32, v32, v57, v58
  v_min3_f32 v33, v33, v57, v58
  v_max3_f32 v32, v32, v59, v60
  v_min3_f32 v33, v33, v59, v60
  v_max3_f32 v32, v32, v61, v62
  v_min3_f32 v33, v33, v61, v62
  v_max_f32 v32, v32, v63
  v_min_f32 v33, v33, v63
  v_mul_f32 v32, s24, v32
  v_mul_f32 v33, s24, v33
  v_fma_f32 v16, v48, s24, -v32
  v_fma_f32 v48, -v48, s24, v33
  v_fma_f32 v17, v49, s24, -v32
  v_fma_f32 v49, -v49, s24, v33
  v_fma_f32 v18, v50, s24, -v32
  v_fma_f32 v50, -v50, s24, v33
  v_fma_f32 v19, v51, s24, -v32
  v_fma_f32 v51, -v51, s24, v33
  v_fma_f32 v20, v52, s24, -v32
  v_fma_f32 v52, -v52, s24, v33
  v_fma_f32 v21, v53, s24, -v32
  v_fma_f32 v53, -v53, s24, v33
  v_fma_f32 v22, v54, s24, -v32
  v_fma_f32 v54, -v54, s24, v33
  v_fma_f32 v23, v55, s24, -v32
  v_fma_f32 v55, -v55, s24, v33
  v_fma_f32 v24, v56, s24, -v32
  v_fma_f32 v56, -v56, s24, v33
  v_add_u32 v8, 65536, v8
  v_add_u32 v9, 65536, v9
  s_waitcnt vmcnt(14)
  ds_read_b64_tr_b16 v[144:145], v8 offset:0
  ds_read_b64_tr_b16 v[146:147], v8 offset:1024
  ds_read_b64_tr_b16 v[148:149], v9 offset:0
  ds_read_b64_tr_b16 v[150:151], v9 offset:1024
  s_waitcnt vmcnt(12)
  ds_read_b64_tr_b16 v[152:153], v8 offset:2048
  ds_read_b64_tr_b16 v[154:155], v8 offset:3072
  ds_read_b64_tr_b16 v[156:157], v9 offset:2048
  ds_read_b64_tr_b16 v[158:159], v9 offset:3072
  s_add_u32 s78, s8, s90
  s_add_u32 m0, s99, 81920
  s_lshl_b32 s78, s78, 4
  buffer_load_dwordx4 v6, s[52:55], s78 offen offset:0 lds
  buffer_load_dwordx4 v7, s[52:55], s78 offen offset:1024 lds
  s_add_u32 s78, s8, s91
  s_add_u32 m0, s99, 83968
  s_lshl_b32 s78, s78, 4
  buffer_load_dwordx4 v6, s[52:55], s78 offen offset:0 lds
  buffer_load_dwordx4 v7, s[52:55], s78 offen offset:1024 lds
  s_waitcnt vmcnt(12)
  s_barrier
  s_add_u32 s76, s72, 5
  s_and_b32 s76, s76, 7
  s_mul_i32 s76, s76, 229376
  s_add_u32 s77, s76, s3
  s_add_u32 m0, s27, 16384
  s_nop 0
  buffer_load_dwordx4 v2, s[44:47], s77 offen offset:0 lds
  buffer_load_dwordx4 v3, s[44:47], s77 offen offset:1024 lds
  s_add_u32 m0, s27, 24576
  s_nop 0
  buffer_load_dwordx4 v4, s[48:51], s77 offen offset:0 lds
  buffer_load_dwordx4 v5, s[48:51], s77 offen offset:1024 lds
  v_fma_f32 v25, v57, s24, -v32
  v_fma_f32 v57, -v57, s24, v33
  v_fma_f32 v26, v58, s24, -v32
  v_fma_f32 v58, -v58, s24, v33
  v_fma_f32 v27, v59, s24, -v32
  v_fma_f32 v59, -v59, s24, v33
  v_fma_f32 v28, v60, s24, -v32
  v_fma_f32 v60, -v60, s24, v33
  v_fma_f32 v29, v61, s24, -v32
  v_fma_f32 v61, -v61, s24, v33
  v_fma_f32 v30, v62, s24, -v32
  v_fma_f32 v62, -v62, s24, v33
  v_fma_f32 v31, v63, s24, -v32
  v_fma_f32 v63, -v63, s24, v33
  v_exp_f32 v16, v16
  v_exp_f32 v48, v48
  v_exp_f32 v17, v17
  v_exp_f32 v49, v49
  v_exp_f32 v18, v18
  v_exp_f32 v50, v50
  v_exp_f32 v19, v19
  v_exp_f32 v51, v51
  v_exp_f32 v20, v20
  v_exp_f32 v52, v52
  v_exp_f32 v21, v21
  v_subrev_u32 v8, 65536, v8
  v_subrev_u32 v9, 65536, v9
  s_waitcnt vmcnt(14)
  ds_read_b64_tr_b16 v[160:161], v8 offset:0
  ds_read_b64_tr_b16 v[162:163], v8 offset:1024
  ds_read_b64_tr_b16 v[164:165], v9 offset:0
  ds_read_b64_tr_b16 v[166:167], v9 offset:1024
  s_waitcnt vmcnt(12)
  ds_read_b64_tr_b16 v[168:169], v8 offset:2048
  ds_read_b64_tr_b16 v[170:171], v8 offset:3072
  ds_read_b64_tr_b16 v[172:173], v9 offset:2048
  ds_read_b64_tr_b16 v[174:175], v9 offset:3072
  s_waitcnt lgkmcnt(4)
  s_add_u32 s78, s8, s92
  s_add_u32 m0, s99, 65536
  s_lshl_b32 s78, s78, 4
  buffer_load_dwordx4 v6, s[52:55], s78 offen offset:0 lds
  buffer_load_dwordx4 v7, s[52:55], s78 offen offset:1024 lds
  s_waitcnt lgkmcnt(0)
  s_add_u32 s78, s8, s93
  s_add_u32 m0, s99, 67584
  s_lshl_b32 s78, s78, 4
  buffer_load_dwordx4 v6, s[52:55], s78 offen offset:0 lds
  buffer_load_dwordx4 v7, s[52:55], s78 offen offset:1024 lds
  s_waitcnt vmcnt(12)
  s_barrier
  s_add_u32 s76, s72, 6
  s_and_b32 s76, s76, 7
  s_mul_i32 s76, s76, 229376
  s_add_u32 s77, s76, s3
  s_add_u32 m0, s27, 32768
  s_nop 0
  buffer_load_dwordx4 v2, s[44:47], s77 offen offset:0 lds
  buffer_load_dwordx4 v3, s[44:47], s77 offen offset:1024 lds
  s_add_u32 m0, s27, 40960
  s_nop 0
  buffer_load_dwordx4 v4, s[48:51], s77 offen offset:0 lds
  buffer_load_dwordx4 v5, s[48:51], s77 offen offset:1024 lds
  v_exp_f32 v53, v53
  v_exp_f32 v22, v22
  v_exp_f32 v54, v54
  v_exp_f32 v23, v23
  v_exp_f32 v55, v55
  v_exp_f32 v24, v24
  v_exp_f32 v56, v56
  v_exp_f32 v25, v25
  v_exp_f32 v57, v57
  v_exp_f32 v26, v26
  v_exp_f32 v58, v58
  v_exp_f32 v27, v27
  v_exp_f32 v59, v59
  v_exp_f32 v28, v28
  v_exp_f32 v60, v60
  v_exp_f32 v29, v29
  v_exp_f32 v61, v61
  v_exp_f32 v30, v30
  s_waitcnt vmcnt(14)
  ds_read_b64_tr_b16 v[176:177], v8 offset:16384
  ds_read_b64_tr_b16 v[178:179], v8 offset:17408
  ds_read_b64_tr_b16 v[180:181], v9 offset:16384
  ds_read_b64_tr_b16 v[182:183], v9 offset:17408
  s_waitcnt vmcnt(12)
  ds_read_b64_tr_b16 v[184:185], v8 offset:18432
  ds_read_b64_tr_b16 v[186:187], v8 offset:19456
  ds_read_b64_tr_b16 v[188:189], v9 offset:18432
  ds_read_b64_tr_b16 v[190:191], v9 offset:19456
  s_waitcnt lgkmcnt(4)
  s_add_u32 s78, s9, s90
  s_add_u32 m0, s99, 81920
  s_lshl_b32 s78, s78, 4
  buffer_load_dwordx4 v6, s[52:55], s78 offen offset:0 lds
  buffer_load_dwordx4 v7, s[52:55], s78 offen offset:1024 lds
  s_waitcnt lgkmcnt(0)
  s_add_u32 s78, s9, s91
  s_add_u32 m0, s99, 83968
  s_lshl_b32 s78, s78, 4
  buffer_load_dwordx4 v6, s[52:55], s78 offen offset:0 lds
  buffer_load_dwordx4 v7, s[52:55], s78 offen offset:1024 lds
  s_waitcnt vmcnt(12)
  s_barrier
  s_add_u32 s76, s72, 7
  s_and_b32 s76, s76, 7
  s_mul_i32 s76, s76, 229376
  s_add_u32 s77, s76, s3
  s_add_u32 m0, s27, 49152
  s_nop 0
  buffer_load_dwordx4 v2, s[44:47], s77 offen offset:0 lds
  buffer_load_dwordx4 v3, s[44:47], s77 offen offset:1024 lds
  s_add_u32 m0, s27, 57344
  s_nop 0
  buffer_load_dwordx4 v4, s[48:51], s77 offen offset:0 lds
  buffer_load_dwordx4 v5, s[48:51], s77 offen offset:1024 lds
  v_exp_f32 v62, v62
  v_exp_f32 v31, v31
  v_exp_f32 v63, v63
  v_add_f32 v34, v16, v17
  v_add_f32 v35, v48, v49
  v_add_f32 v34, v34, v18
  v_add_f32 v35, v35, v50
  v_add_f32 v34, v34, v19
  v_add_f32 v35, v35, v51
  v_add_f32 v34, v34, v20
  v_add_f32 v35, v35, v52
  v_add_f32 v34, v34, v21
  v_add_f32 v35, v35, v53
  v_add_f32 v34, v34, v22
  v_add_f32 v35, v35, v54
  v_add_f32 v34, v34, v23
  v_add_f32 v35, v35, v55
  v_add_f32 v34, v34, v24
  v_add_f32 v35, v35, v56
  v_add_f32 v34, v34, v25
  v_add_f32 v35, v35, v57
  v_add_f32 v34, v34, v26
  v_add_f32 v35, v35, v58
  v_add_f32 v34, v34, v27
  v_add_f32 v35, v35, v59
  v_add_f32 v34, v34, v28
  v_add_f32 v35, v35, v60
  v_add_f32 v34, v34, v29
  v_add_f32 v35, v35, v61
  v_add_f32 v34, v34, v30
  v_add_f32 v35, v35, v62
  v_add_f32 v34, v34, v31
  s_waitcnt vmcnt(14)
  ds_read_b64_tr_b16 v[192:193], v8 offset:0
  ds_read_b64_tr_b16 v[194:195], v8 offset:1024
  ds_read_b64_tr_b16 v[196:197], v9 offset:0
  ds_read_b64_tr_b16 v[198:199], v9 offset:1024
  s_waitcnt vmcnt(12)
  ds_read_b64_tr_b16 v[200:201], v8 offset:2048
  ds_read_b64_tr_b16 v[202:203], v8 offset:3072
  ds_read_b64_tr_b16 v[204:205], v9 offset:2048
  ds_read_b64_tr_b16 v[206:207], v9 offset:3072
  s_waitcnt lgkmcnt(4)
  s_add_u32 s78, s9, s92
  s_add_u32 m0, s99, 65536
  s_lshl_b32 s78, s78, 4
  buffer_load_dwordx4 v6, s[52:55], s78 offen offset:0 lds
  buffer_load_dwordx4 v7, s[52:55], s78 offen offset:1024 lds
  s_waitcnt lgkmcnt(0)
  s_add_u32 s78, s9, s93
  s_add_u32 m0, s99, 67584
  s_lshl_b32 s78, s78, 4
  buffer_load_dwordx4 v6, s[52:55], s78 offen offset:0 lds
  buffer_load_dwordx4 v7, s[52:55], s78 offen offset:1024 lds
  s_waitcnt vmcnt(12)
  s_barrier
  s_add_u32 s3, s3, 128
  s_add_u32 s76, s72, 0
  s_and_b32 s76, s76, 7
  s_mul_i32 s76, s76, 229376
  s_add_u32 s77, s76, s3
  s_add_u32 m0, s27, 0
  s_nop 0
  buffer_load_dwordx4 v2, s[44:47], s77 offen offset:0 lds
  buffer_load_dwordx4 v3, s[44:47], s77 offen offset:1024 lds
  s_add_u32 m0, s27, 8192
  s_nop 0
  buffer_load_dwordx4 v4, s[48:51], s77 offen offset:0 lds
  buffer_load_dwordx4 v5, s[48:51], s77 offen offset:1024 lds
  v_add_f32 v35, v35, v63
  v_rcp_f32 v34, v34
  v_rcp_f32 v35, v35
  v_mul_f32 v16, v16, v34
  v_mul_f32 v48, v48, v35
  v_mul_f32 v17, v17, v34
  v_mul_f32 v49, v49, v35
  v_mul_f32 v18, v18, v34
  v_mul_f32 v50, v50, v35
  v_mul_f32 v19, v19, v34
  v_mul_f32 v51, v51, v35
  v_mul_f32 v20, v20, v34
  v_mul_f32 v52, v52, v35
  v_mul_f32 v21, v21, v34
  v_mul_f32 v53, v53, v35
  v_mul_f32 v22, v22, v34
  v_mul_f32 v54, v54, v35
  v_mul_f32 v23, v23, v34
  v_mul_f32 v55, v55, v35
  v_mul_f32 v24, v24, v34
  v_mul_f32 v56, v56, v35
  v_mul_f32 v25, v25, v34
  v_mul_f32 v57, v57, v35
  v_mul_f32 v26, v26, v34
  v_mul_f32 v58, v58, v35
  v_mul_f32 v27, v27, v34
  v_mul_f32 v59, v59, v35
  v_mul_f32 v28, v28, v34
  v_mul_f32 v60, v60, v35
  v_mul_f32 v29, v29, v34
  v_mul_f32 v61, v61, v35
  v_mul_f32 v30, v30, v34
  v_mul_f32 v62, v62, v35
  v_mul_f32 v31, v31, v34
  s_waitcnt vmcnt(14)
  ds_read_b64_tr_b16 v[208:209], v8 offset:16384
  ds_read_b64_tr_b16 v[210:211], v8 offset:17408
  ds_read_b64_tr_b16 v[212:213], v9 offset:16384
  ds_read_b64_tr_b16 v[214:215], v9 offset:17408
  s_waitcnt vmcnt(12)
  ds_read_b64_tr_b16 v[216:217], v8 offset:18432
  ds_read_b64_tr_b16 v[218:219], v8 offset:19456
  ds_read_b64_tr_b16 v[220:221], v9 offset:18432
  ds_read_b64_tr_b16 v[222:223], v9 offset:19456
  s_waitcnt lgkmcnt(4)
  s_add_u32 s78, s12, s90
  s_add_u32 m0, s99, 81920
  s_lshl_b32 s78, s78, 4
  buffer_load_dwordx4 v6, s[56:59], s78 offen offset:0 lds
  buffer_load_dwordx4 v7, s[56:59], s78 offen offset:1024 lds
  s_waitcnt lgkmcnt(0)
  s_add_u32 s78, s12, s91
  s_add_u32 m0, s99, 83968
  s_lshl_b32 s78, s78, 4
  buffer_load_dwordx4 v6, s[56:59], s78 offen offset:0 lds
  buffer_load_dwordx4 v7, s[56:59], s78 offen offset:1024 lds
  s_waitcnt vmcnt(12)
  s_barrier
  s_add_u32 s76, s72, 1
  s_and_b32 s76, s76, 7
  s_mul_i32 s76, s76, 229376
  s_add_u32 s77, s76, s3
  s_add_u32 m0, s27, 16384
  s_nop 0
  buffer_load_dwordx4 v2, s[44:47], s77 offen offset:0 lds
  buffer_load_dwordx4 v3, s[44:47], s77 offen offset:1024 lds
  s_add_u32 m0, s27, 24576
  s_nop 0
  buffer_load_dwordx4 v4, s[48:51], s77 offen offset:0 lds
  buffer_load_dwordx4 v5, s[48:51], s77 offen offset:1024 lds
  v_mul_f32 v63, v63, v35
  v_cvt_pk_bf16_f32 v80, v16, v17
  v_cvt_pk_bf16_f32 v88, v48, v49
  v_cvt_pk_bf16_f32 v81, v18, v19
  v_cvt_pk_bf16_f32 v89, v50, v51
  v_cvt_pk_bf16_f32 v82, v20, v21
  v_cvt_pk_bf16_f32 v90, v52, v53
  v_cvt_pk_bf16_f32 v83, v22, v23
  v_cvt_pk_bf16_f32 v91, v54, v55
  v_cvt_pk_bf16_f32 v84, v24, v25
  v_cvt_pk_bf16_f32 v92, v56, v57
  v_cvt_pk_bf16_f32 v85, v26, v27
  v_cvt_pk_bf16_f32 v93, v58, v59
  v_cvt_pk_bf16_f32 v86, v28, v29
  v_cvt_pk_bf16_f32 v94, v60, v61
  v_cvt_pk_bf16_f32 v87, v30, v31
  v_cvt_pk_bf16_f32 v95, v62, v63
  v_max3_f32 v32, v64, v65, v66
  v_min3_f32 v33, v64, v65, v66
  v_max3_f32 v32, v32, v67, v68
  v_min3_f32 v33, v33, v67, v68
  v_max3_f32 v32, v32, v69, v70
  v_min3_f32 v33, v33, v69, v70
  v_max3_f32 v32, v32, v71, v72
  v_min3_f32 v33, v33, v71, v72
  v_max3_f32 v32, v32, v73, v74
  v_min3_f32 v33, v33, v73, v74
  v_max3_f32 v32, v32, v75, v76
  v_min3_f32 v33, v33, v75, v76
  v_max3_f32 v32, v32, v77, v78
  v_min3_f32 v33, v33, v77, v78
  v_max_f32 v32, v32, v79
  v_min_f32 v33, v33, v79
  v_mul_f32 v32, s24, v32
  v_mul_f32 v33, s24, v33
  s_waitcnt vmcnt(14)
  ds_read_b64_tr_b16 v[224:225], v8 offset:0
  ds_read_b64_tr_b16 v[226:227], v8 offset:1024
  ds_read_b64_tr_b16 v[228:229], v9 offset:0
  ds_read_b64_tr_b16 v[230:231], v9 offset:1024
  s_add_u32 s78, s12, s92
  s_add_u32 m0, s99, 131072
  s_lshl_b32 s78, s78, 4
  buffer_load_dwordx4 v6, s[56:59], s78 offen offset:0 lds
  buffer_load_dwordx4 v7, s[56:59], s78 offen offset:1024 lds
  s_waitcnt vmcnt(10)
  s_barrier
  s_add_u32 s76, s72, 2
  s_and_b32 s76, s76, 7
  s_mul_i32 s76, s76, 229376
  s_add_u32 s77, s76, s3
  s_add_u32 m0, s27, 32768
  s_nop 0
  buffer_load_dwordx4 v2, s[44:47], s77 offen offset:0 lds
  buffer_load_dwordx4 v3, s[44:47], s77 offen offset:1024 lds
  s_add_u32 m0, s27, 40960
  s_nop 0
  buffer_load_dwordx4 v4, s[48:51], s77 offen offset:0 lds
  buffer_load_dwordx4 v5, s[48:51], s77 offen offset:1024 lds
  v_fma_f32 v16, v64, s24, -v32
  v_fma_f32 v64, -v64, s24, v33
  v_fma_f32 v17, v65, s24, -v32
  v_fma_f32 v65, -v65, s24, v33
  v_fma_f32 v18, v66, s24, -v32
  v_fma_f32 v66, -v66, s24, v33
  v_fma_f32 v19, v67, s24, -v32
  v_fma_f32 v67, -v67, s24, v33
  v_fma_f32 v20, v68, s24, -v32
  v_fma_f32 v68, -v68, s24, v33
  v_fma_f32 v21, v69, s24, -v32
  v_fma_f32 v69, -v69, s24, v33
  v_fma_f32 v22, v70, s24, -v32
  v_fma_f32 v70, -v70, s24, v33
  v_fma_f32 v23, v71, s24, -v32
  v_fma_f32 v71, -v71, s24, v33
  v_fma_f32 v24, v72, s24, -v32
  v_fma_f32 v72, -v72, s24, v33
  v_fma_f32 v25, v73, s24, -v32
  v_fma_f32 v73, -v73, s24, v33
  v_fma_f32 v26, v74, s24, -v32
  v_fma_f32 v74, -v74, s24, v33
  v_fma_f32 v27, v75, s24, -v32
  v_fma_f32 v75, -v75, s24, v33
  v_fma_f32 v28, v76, s24, -v32
  v_fma_f32 v76, -v76, s24, v33
  v_fma_f32 v29, v77, s24, -v32
  v_fma_f32 v77, -v77, s24, v33
  v_fma_f32 v30, v78, s24, -v32
  v_fma_f32 v78, -v78, s24, v33
  v_fma_f32 v31, v79, s24, -v32
  v_fma_f32 v79, -v79, s24, v33
  v_exp_f32 v16, v16
  v_exp_f32 v64, v64
  s_add_u32 s78, s12, s93
  s_add_u32 m0, s99, 133120
  s_lshl_b32 s78, s78, 4
  buffer_load_dwordx4 v6, s[56:59], s78 offen offset:0 lds
  buffer_load_dwordx4 v7, s[56:59], s78 offen offset:1024 lds
  s_waitcnt vmcnt(8)
  s_barrier
  s_add_u32 s76, s72, 3
  s_and_b32 s76, s76, 7
  s_mul_i32 s76, s76, 229376
  s_add_u32 s77, s76, s3
  s_add_u32 m0, s27, 49152
  s_nop 0
  buffer_load_dwordx4 v2, s[44:47], s77 offen offset:0 lds
  buffer_load_dwordx4 v3, s[44:47], s77 offen offset:1024 lds
  s_add_u32 m0, s27, 57344
  s_nop 0
  buffer_load_dwordx4 v4, s[48:51], s77 offen offset:0 lds
  buffer_load_dwordx4 v5, s[48:51], s77 offen offset:1024 lds
  s_add_u32 s76, s72, 6
  s_and_b32 s76, s76, 7
  s_mul_i32 s76, s76, 229376
  s_add_u32 s77, s76, s3
  s_add_u32 m0, s27, 98304
  s_nop 0
  buffer_load_dwordx4 v2, s[44:47], s77 offen offset:0 lds
  buffer_load_dwordx4 v3, s[44:47], s77 offen offset:1024 lds
  s_add_u32 m0, s27, 106496
  s_nop 0
  buffer_load_dwordx4 v4, s[48:51], s77 offen offset:0 lds
  buffer_load_dwordx4 v5, s[48:51], s77 offen offset:1024 lds
  v_exp_f32 v17, v17
  v_exp_f32 v65, v65
  v_exp_f32 v18, v18
  v_exp_f32 v66, v66
  v_exp_f32 v19, v19
  v_exp_f32 v67, v67
  v_exp_f32 v20, v20
  v_exp_f32 v68, v68
  v_exp_f32 v21, v21
  v_exp_f32 v69, v69
  v_exp_f32 v22, v22
  v_exp_f32 v70, v70
  v_exp_f32 v23, v23
  v_exp_f32 v71, v71
  v_exp_f32 v24, v24
  v_exp_f32 v72, v72
  v_exp_f32 v25, v25
  v_exp_f32 v73, v73
  s_waitcnt vmcnt(10)
  s_barrier
  s_add_u32 s76, s72, 4
  s_and_b32 s76, s76, 7
  s_mul_i32 s76, s76, 229376
  s_add_u32 s77, s76, s3
  s_add_u32 m0, s27, 0
  s_nop 0
  buffer_load_dwordx4 v2, s[44:47], s77 offen offset:0 lds
  buffer_load_dwordx4 v3, s[44:47], s77 offen offset:1024 lds
  s_add_u32 m0, s27, 8192
  s_nop 0
  buffer_load_dwordx4 v4, s[48:51], s77 offen offset:0 lds
  buffer_load_dwordx4 v5, s[48:51], s77 offen offset:1024 lds
  s_add_u32 s76, s72, 7
  s_and_b32 s76, s76, 7
  s_mul_i32 s76, s76, 229376
  s_add_u32 s77, s76, s3
  s_add_u32 m0, s27, 114688
  s_nop 0
  buffer_load_dwordx4 v2, s[44:47], s77 offen offset:0 lds
  buffer_load_dwordx4 v3, s[44:47], s77 offen offset:1024 lds
  s_add_u32 m0, s27, 122880
  s_nop 0
  buffer_load_dwordx4 v4, s[48:51], s77 offen offset:0 lds
  buffer_load_dwordx4 v5, s[48:51], s77 offen offset:1024 lds
  v_exp_f32 v26, v26
  v_exp_f32 v74, v74
  v_exp_f32 v27, v27
  v_exp_f32 v75, v75
  v_exp_f32 v28, v28
  v_exp_f32 v76, v76
  v_exp_f32 v29, v29
  v_exp_f32 v77, v77
  v_exp_f32 v30, v30
  v_exp_f32 v78, v78
  v_exp_f32 v31, v31
  v_exp_f32 v79, v79
  v_add_f32 v34, v16, v17
  v_add_f32 v35, v64, v65
  v_add_f32 v34, v34, v18
  v_add_f32 v35, v35, v66
  v_add_f32 v34, v34, v19
  v_add_f32 v35, v35, v67
  v_add_f32 v34, v34, v20
  v_add_f32 v35, v35, v68
  v_add_f32 v34, v34, v21
  v_add_f32 v35, v35, v69
  v_add_f32 v34, v34, v22
  s_waitcnt vmcnt(12)
  s_barrier
  s_add_u32 s76, s72, 5
  s_and_b32 s76, s76, 7
  s_mul_i32 s76, s76, 229376
  s_add_u32 s77, s76, s3
  s_add_u32 m0, s27, 16384
  s_nop 0
  buffer_load_dwordx4 v2, s[44:47], s77 offen offset:0 lds
  buffer_load_dwordx4 v3, s[44:47], s77 offen offset:1024 lds
  s_add_u32 m0, s27, 24576
  s_nop 0
  buffer_load_dwordx4 v4, s[48:51], s77 offen offset:0 lds
  buffer_load_dwordx4 v5, s[48:51], s77 offen offset:1024 lds
  v_add_f32 v35, v35, v70
  v_add_f32 v34, v34, v23
  v_add_f32 v35, v35, v71
  v_add_f32 v34, v34, v24
  v_add_f32 v35, v35, v72
  v_add_f32 v34, v34, v25
  v_add_f32 v35, v35, v73
  v_add_f32 v34, v34, v26
  v_add_f32 v35, v35, v74
  v_add_f32 v34, v34, v27
  v_add_f32 v35, v35, v75
  v_add_f32 v34, v34, v28
  v_add_f32 v35, v35, v76
  v_add_f32 v34, v34, v29
  v_add_f32 v35, v35, v77
  v_add_f32 v34, v34, v30
  v_add_f32 v35, v35, v78
  v_add_f32 v34, v34, v31
  v_add_f32 v35, v35, v79
  v_rcp_f32 v34, v34
  v_rcp_f32 v35, v35
  v_mul_f32 v16, v16, v34
  v_mul_f32 v64, v64, v35
  v_mul_f32 v17, v17, v34
  v_mul_f32 v65, v65, v35
  v_mul_f32 v18, v18, v34
  v_mul_f32 v66, v66, v35
  v_mul_f32 v19, v19, v34
  v_mul_f32 v67, v67, v35
  v_mul_f32 v20, v20, v34
  v_mul_f32 v68, v68, v35
  v_mul_f32 v21, v21, v34
  v_mul_f32 v69, v69, v35
  v_mul_f32 v22, v22, v34
  s_waitcnt lgkmcnt(0)
  s_add_u32 s78, s13, s90
  s_add_u32 m0, s99, 65536
  s_lshl_b32 s78, s78, 4
  buffer_load_dwordx4 v6, s[56:59], s78 offen offset:0 lds
  buffer_load_dwordx4 v7, s[56:59], s78 offen offset:1024 lds
  s_waitcnt vmcnt(10)
  s_barrier
  v_and_b32 v4, 31, v0
  v_lshlrev_b32 v4, 10, v4
  v_lshrrev_b32 v5, 5, v0
  v_lshl_add_u32 v4, v5, 4, v4
  s_lshl_b32 s76, s73, 1
  s_lshr_b32 s77, s68, 1
  s_add_u32 s76, s76, s77
  s_lshl_b32 s76, s76, 15
  s_lshl_b32 s77, s74, 7
  s_add_u32 s76, s76, s77
  s_and_b32 s77, s68, 1
  s_lshl_b32 s77, s77, 6
  s_add_u32 s76, s76, s77
  v_add_u32 v4, s76, v4
  s_mul_i32 s76, s75, 0x9e3779b1
  s_lshr_b32 s81, s76, 15
  s_xor_b32 s76, s76, s81
  s_and_b32 s76, s76, 0xfffdfffd
  s_or_b32 s76, s76, 0x00010001
  s_mov_b32 s3, 0x00010001
  v_and_b32 v2, 7, v0
  v_lshlrev_b32 v2, 2, v2
  v_bfe_u32 v2, s76, v2, 4
  v_lshl_or_b32 v2, v2, 15, v2
  v_lshrrev_b32 v3, 2, v2
  v_mul_f32 v70, v70, v35
  v_mul_f32 v23, v23, v34
  v_mul_f32 v71, v71, v35
  v_mul_f32 v24, v24, v34
  v_mul_f32 v72, v72, v35
  v_mul_f32 v25, v25, v34
  v_mul_f32 v73, v73, v35
  v_mul_f32 v26, v26, v34
  v_mul_f32 v74, v74, v35
  v_mul_f32 v27, v27, v34
  v_mul_f32 v75, v75, v35
  v_mul_f32 v28, v28, v34
  v_mul_f32 v76, v76, v35
  v_mul_f32 v29, v29, v34
  v_mul_f32 v77, v77, v35
  v_mul_f32 v30, v30, v34
  v_mul_f32 v78, v78, v35
  v_mul_f32 v31, v31, v34
  v_mul_f32 v79, v79, v35
  v_cvt_pk_bf16_f32 v96, v16, v17
  v_cvt_pk_bf16_f32 v104, v64, v65
  v_cvt_pk_bf16_f32 v97, v18, v19
  v_cvt_pk_bf16_f32 v105, v66, v67
  v_cvt_pk_bf16_f32 v98, v20, v21
  v_cvt_pk_bf16_f32 v106, v68, v69
  v_cvt_pk_bf16_f32 v99, v22, v23
  v_cvt_pk_bf16_f32 v107, v70, v71
  v_cvt_pk_bf16_f32 v100, v24, v25
  v_cvt_pk_bf16_f32 v108, v72, v73
  v_cvt_pk_bf16_f32 v101, v26, v27
  v_cvt_pk_bf16_f32 v109, v74, v75
  v_cvt_pk_bf16_f32 v102, v28, v29
  v_cvt_pk_bf16_f32 v110, v76, v77
  v_cvt_pk_bf16_f32 v103, v30, v31
  v_cvt_pk_bf16_f32 v111, v78, v79
  v_and_b32 v15, 15, v0
  v_lshlrev_b32 v15, 9, v15
  v_lshrrev_b32 v14, 4, v0
  v_lshl_add_u32 v15, v14, 26, v15
  s_lshl_b32 s26, s70, 6
  s_add_u32 s26, s26, s68
  s_mul_i32 s84, s26, 1152
  s_add_u32 s84, s84, 10485760
  s_mul_i32 s85, s69, 4608
  s_lshl_b32 s26, s26, 7
  s_add_u32 s26, s26, 12058624
  buffer_load_dword v14, v15, s[32:35], s26 offen sc1
  v_and_b32 v12, 31, v0
  v_lshrrev_b32 v13, 5, v0
  v_lshlrev_b32 v13, 3, v13
  v_sub_u32 v12, v12, v13
  v_and_b32 v13, 1, v12
  v_lshlrev_b32 v13, 4, v13
  s_movk_i32 s76, 0x3f80
  v_lshlrev_b32 v13, v13, s76
  v_lshrrev_b32 v12, 1, v12
  v_cmp_eq_u32 vcc, 0, v12
  s_nop 1
  v_cndmask_b32 v248, 0, v13, vcc
  v_cmp_eq_u32 vcc, 1, v12
  s_nop 1
  v_cndmask_b32 v249, 0, v13, vcc
  v_cmp_eq_u32 vcc, 2, v12
  s_nop 1
  v_cndmask_b32 v250, 0, v13, vcc
  v_cmp_eq_u32 vcc, 3, v12
  s_nop 1
  v_cndmask_b32 v251, 0, v13, vcc
  s_waitcnt vmcnt(3)
  s_barrier
  v_mov_b32 v5, 158208
  s_setprio 2
  s_mov_b32 s82, 0xffff
  s_mov_b32 s83, 0
  s_mov_b32 s86, 65536
  s_add_u32 s81, s75, 1
  s_waitcnt vmcnt(0)
  v_subrev_u32 v14, s81, v14
L_poll_161:
  v_cmp_lt_u32 vcc, 0, v14
  s_nop 1
  s_and_b64 vcc, vcc, s[82:83]
  s_cbranch_scc0 L_ok_162
  s_sleep 1
  buffer_load_dword v14, v15, s[32:35], s26 offen sc1
  s_waitcnt vmcnt(0)
  v_subrev_u32 v14, s81, v14
  s_sub_u32 s86, s86, 1
  s_cbranch_scc0 L_poll_161
L_ok_162:
  v_lshrrev_b32 v15, 2, v0
  v_mul_u32_u24 v15, 4608, v15
  v_and_b32 v13, 3, v0
  v_lshl_add_u32 v15, v13, 4, v15
  s_add_u32 s79, s84, s85
  buffer_load_dwordx4 v[16:19], v1, s[32:35], s79 offen sc1
  s_add_u32 s85, s85, 4608
  s_cmp_eq_u32 s85, 73728
  s_cselect_b32 s85, 0, s85
  s_add_u32 s79, s84, s85
  buffer_load_dwordx4 v[20:23], v1, s[32:35], s79 offen sc1
  s_add_u32 s85, s85, 4608
  s_cmp_eq_u32 s85, 73728
  s_cselect_b32 s85, 0, s85
  buffer_load_dwordx4 v[252:255], v15, s[32:35], s84 offen offset:1024 sc1
  s_add_u32 s79, s84, s85
  buffer_load_dwordx4 v[24:27], v1, s[32:35], s79 offen sc1
  s_add_u32 s85, s85, 4608
  s_cmp_eq_u32 s85, 73728
  s_cselect_b32 s85, 0, s85
  s_add_u32 s79, s84, s85
  buffer_load_dwordx4 v[28:31], v1, s[32:35], s79 offen sc1
  s_add_u32 s85, s85, 4608
  s_cmp_eq_u32 s85, 73728
  s_cselect_b32 s85, 0, s85
  s_add_u32 s79, s84, s85
  buffer_load_dwordx4 v[32:35], v1, s[32:35], s79 offen sc1
  s_add_u32 s85, s85, 4608
  s_cmp_eq_u32 s85, 73728
  s_cselect_b32 s85, 0, s85
  s_add_u32 s79, s84, s85
  buffer_load_dwordx4 v[36:39], v1, s[32:35], s79 offen sc1
  s_add_u32 s85, s85, 4608
  s_cmp_eq_u32 s85, 73728
  s_cselect_b32 s85, 0, s85
  s_add_u32 s79, s84, s85
  buffer_load_dwordx4 v[40:43], v1, s[32:35], s79 offen sc1
  s_add_u32 s85, s85, 4608
  s_cmp_eq_u32 s85, 73728
  s_cselect_b32 s85, 0, s85
  s_add_u32 s79, s84, s85
  buffer_load_dwordx4 v[44:47], v1, s[32:35], s79 offen sc1
  s_add_u32 s85, s85, 4608
  s_cmp_eq_u32 s85, 73728
  s_cselect_b32 s85, 0, s85
  s_add_u32 s79, s84, s85
  buffer_load_dwordx4 v[48:51], v1, s[32:35], s79 offen sc1
  s_add_u32 s85, s85, 4608
  s_cmp_eq_u32 s85, 73728
  s_cselect_b32 s85, 0, s85
  s_add_u32 s79, s84, s85
  buffer_load_dwordx4 v[52:55], v1, s[32:35], s79 offen sc1
  s_add_u32 s85, s85, 4608
  s_cmp_eq_u32 s85, 73728
  s_cselect_b32 s85, 0, s85
  s_add_u32 s79, s84, s85
  buffer_load_dwordx4 v[56:59], v1, s[32:35], s79 offen sc1
  s_add_u32 s85, s85, 4608
  s_cmp_eq_u32 s85, 73728
  s_cselect_b32 s85, 0, s85
  s_add_u32 s79, s84, s85
  buffer_load_dwordx4 v[60:63], v1, s[32:35], s79 offen sc1
  s_add_u32 s85, s85, 4608
  s_cmp_eq_u32 s85, 73728
  s_cselect_b32 s85, 0, s85
  s_add_u32 s79, s84, s85
  buffer_load_dwordx4 v[64:67], v1, s[32:35], s79 offen sc1
  s_add_u32 s85, s85, 4608
  s_cmp_eq_u32 s85, 73728
  s_cselect_b32 s85, 0, s85
  s_add_u32 s79, s84, s85
  buffer_load_dwordx4 v[68:71], v1, s[32:35], s79 offen sc1
  s_add_u32 s85, s85, 4608
  s_cmp_eq_u32 s85, 73728
  s_cselect_b32 s85, 0, s85
  s_add_u32 s79, s84, s85
  buffer_load_dwordx4 v[72:75], v1, s[32:35], s79 offen sc1
  s_add_u32 s85, s85, 4608
  s_cmp_eq_u32 s85, 73728
  s_cselect_b32 s85, 0, s85
  s_add_u32 s79, s84, s85
  buffer_load_dwordx4 v[76:79], v1, s[32:35], s79 offen sc1
  s_add_u32 s85, s85, 4608
  s_cmp_eq_u32 s85, 73728
  s_cselect_b32 s85, 0, s85
  v_lshlrev_b32 v13, 4, v13
  v_bfe_u32 v15, v0, 4, 1
  v_lshl_add_u32 v13, v15, 2, v13
  v_lshrrev_b32 v14, 5, v0
  v_lshl_add_u32 v13, v14, 1, v13
  s_lshl_b32 s76, s68, 6
  s_add_u32 s76, s76, 157696
  v_add_u32 v13, s76, v13
  v_and_b32 v12, 15, v0
  v_lshlrev_b32 v12, 4, v12
  v_lshl_add_u32 v12, v14, 3, v12
  v_lshl_add_u32 v12, v15, 11, v12
  s_lshr_b32 s76, s68, 1
  s_lshl_b32 s76, s76, 12
  s_and_b32 s77, s68, 1
  s_mul_i32 s77, s77, 768
  s_add_u32 s76, s76, s77
  s_add_u32 s76, s76, 149504
  v_add_u32 v12, s76, v12
  s_setprio 2
  s_waitcnt vmcnt(16)
  v_mfma_f32_32x32x16_bf16 v[232:247], v[248:251], v[16:19], 0
  s_waitcnt vmcnt(15)
  v_mfma_f32_32x32x16_bf16 v[232:247], v[248:251], v[20:23], v[232:247]
  s_waitcnt vmcnt(13)
  v_mfma_f32_32x32x16_bf16 v[232:247], v[248:251], v[24:27], v[232:247]
  v_lshlrev_b32 v16, 16, v252
  v_and_b32 v17, s87, v252
  v_lshlrev_b32 v18, 16, v253
  s_waitcnt vmcnt(12)
  v_mfma_f32_32x32x16_bf16 v[232:247], v[248:251], v[28:31], v[232:247]
  v_and_b32 v19, s87, v253
  v_lshlrev_b32 v20, 16, v254
  v_and_b32 v21, s87, v254
  s_waitcnt vmcnt(11)
  v_mfma_f32_32x32x16_bf16 v[232:247], v[248:251], v[32:35], v[232:247]
  v_lshlrev_b32 v22, 16, v255
  v_and_b32 v23, s87, v255
  v_add_f32_dpp v16, v16, v16 row_ror:4 row_mask:0xf bank_mask:0xf
  s_waitcnt vmcnt(10)
  v_mfma_f32_32x32x16_bf16 v[232:247], v[248:251], v[36:39], v[232:247]
  v_add_f32_dpp v17, v17, v17 row_ror:4 row_mask:0xf bank_mask:0xf
  v_add_f32_dpp v18, v18, v18 row_ror:4 row_mask:0xf bank_mask:0xf
  v_add_f32_dpp v19, v19, v19 row_ror:4 row_mask:0xf bank_mask:0xf
  s_waitcnt vmcnt(9)
  v_mfma_f32_32x32x16_bf16 v[232:247], v[248:251], v[40:43], v[232:247]
  v_add_f32_dpp v20, v20, v20 row_ror:4 row_mask:0xf bank_mask:0xf
  v_add_f32_dpp v21, v21, v21 row_ror:4 row_mask:0xf bank_mask:0xf
  v_add_f32_dpp v22, v22, v22 row_ror:4 row_mask:0xf bank_mask:0xf
  s_waitcnt vmcnt(8)
  v_mfma_f32_32x32x16_bf16 v[232:247], v[248:251], v[44:47], v[232:247]
  v_add_f32_dpp v23, v23, v23 row_ror:4 row_mask:0xf bank_mask:0xf
  v_add_f32_dpp v16, v16, v16 row_ror:8 row_mask:0xf bank_mask:0xf
  v_add_f32_dpp v17, v17, v17 row_ror:8 row_mask:0xf bank_mask:0xf
  s_waitcnt vmcnt(7)
  v_mfma_f32_32x32x16_bf16 v[232:247], v[248:251], v[48:51], v[232:247]
  s_add_u32 s78, s10, s14
  s_add_u32 m0, s99, 32768
  s_lshl_b32 s78, s78, 4
  buffer_load_dwordx4 v6, s[52:55], s78 offen offset:0 lds
  buffer_load_dwordx4 v7, s[52:55], s78 offen offset:1024 lds
  v_add_f32_dpp v18, v18, v18 row_ror:8 row_mask:0xf bank_mask:0xf
  v_add_f32_dpp v19, v19, v19 row_ror:8 row_mask:0xf bank_mask:0xf
  v_add_f32_dpp v20, v20, v20 row_ror:8 row_mask:0xf bank_mask:0xf
  s_waitcnt vmcnt(8)
  v_mfma_f32_32x32x16_bf16 v[232:247], v[248:251], v[52:55], v[232:247]
  v_add_f32_dpp v21, v21, v21 row_ror:8 row_mask:0xf bank_mask:0xf
  v_add_f32_dpp v22, v22, v22 row_ror:8 row_mask:0xf bank_mask:0xf
  v_add_f32_dpp v23, v23, v23 row_ror:8 row_mask:0xf bank_mask:0xf
  s_waitcnt vmcnt(7)
  v_mfma_f32_32x32x16_bf16 v[232:247], v[248:251], v[56:59], v[232:247]
  s_add_u32 s78, s10, s15
  s_add_u32 m0, s99, 34816
  s_lshl_b32 s78, s78, 4
  buffer_load_dwordx4 v6, s[52:55], s78 offen offset:0 lds
  buffer_load_dwordx4 v7, s[52:55], s78 offen offset:1024 lds
  v_permlane32_swap_b32 v16, v17
  v_permlane32_swap_b32 v18, v19
  v_permlane32_swap_b32 v20, v21
  s_waitcnt vmcnt(8)
  v_mfma_f32_32x32x16_bf16 v[232:247], v[248:251], v[60:63], v[232:247]
  v_permlane32_swap_b32 v22, v23
  v_add_f32 v16, v16, v17
  v_add_f32 v18, v18, v19
  s_waitcnt vmcnt(7)
  v_mfma_f32_32x32x16_bf16 v[232:247], v[248:251], v[64:67], v[232:247]
  s_add_u32 s78, s11, s14
  s_add_u32 m0, s99, 49152
  s_lshl_b32 s78, s78, 4
  buffer_load_dwordx4 v6, s[52:55], s78 offen offset:0 lds
  buffer_load_dwordx4 v7, s[52:55], s78 offen offset:1024 lds
  v_add_f32 v20, v20, v21
  v_add_f32 v22, v22, v23
  v_permlane16_swap_b32 v16, v18
  s_waitcnt vmcnt(8)
  v_mfma_f32_32x32x16_bf16 v[232:247], v[248:251], v[68:71], v[232:247]
  v_permlane16_swap_b32 v20, v22
  v_add_f32 v16, v16, v18
  v_add_f32 v20, v20, v22
  s_waitcnt vmcnt(7)
  v_mfma_f32_32x32x16_bf16 v[232:247], v[248:251], v[72:75], v[232:247]
  s_add_u32 s78, s11, s15
  s_add_u32 m0, s99, 51200
  s_lshl_b32 s78, s78, 4
  buffer_load_dwordx4 v6, s[52:55], s78 offen offset:0 lds
  buffer_load_dwordx4 v7, s[52:55], s78 offen offset:1024 lds
  v_cvt_pk_bf16_f32 v16, v16, v20
  s_waitcnt vmcnt(8)
  v_mfma_f32_32x32x16_bf16 v[232:247], v[248:251], v[76:79], v[232:247]
  ds_write_b16 v13, v16
  ds_write_b16_d16_hi v13, v16 offset:8
  s_nop 9
  v_cvt_pk_bf16_f32 v232, v232, v233
  v_cvt_pk_bf16_f32 v233, v234, v235
  v_cvt_pk_bf16_f32 v234, v236, v237
  v_cvt_pk_bf16_f32 v235, v238, v239
  ds_write_b64 v12, v[232:233]
  ds_write_b64 v12, v[234:235] offset:1024
  s_lshl_b32 s76, s68, 2
  v_add_u32 v14, s76, v5
  v_mov_b32 v15, 1
  s_waitcnt lgkmcnt(0)
  ds_write_b32 v14, v15 offset:48
  ds_read_b64_tr_b16 v[232:233], v8 offset:2048
  ds_read_b64_tr_b16 v[234:235], v8 offset:3072
  ds_read_b64_tr_b16 v[236:237], v9 offset:2048
  ds_read_b64_tr_b16 v[238:239], v9 offset:3072
  ds_read_b64_tr_b16 v[240:241], v8 offset:16384
  ds_read_b64_tr_b16 v[242:243], v8 offset:17408
  ds_read_b64_tr_b16 v[244:245], v9 offset:16384
  ds_read_b64_tr_b16 v[246:247], v9 offset:17408
  ds_read_b64_tr_b16 v[248:249], v8 offset:18432
  ds_read_b64_tr_b16 v[250:251], v8 offset:19456
  ds_read_b64_tr_b16 v[252:253], v9 offset:18432
  ds_read_b64_tr_b16 v[254:255], v9 offset:19456
  s_mov_b32 s86, 2097152
  s_waitcnt lgkmcnt(0)
L_lp_163:
  ds_read_b128 v[12:15], v5 offset:48
  s_waitcnt lgkmcnt(0)
  v_and_b32 v12, v12, v13
  v_and_b32 v14, v14, v15
  v_and_b32 v12, v12, v14
  s_nop 0
  v_readfirstlane_b32 s81, v12
  s_nop 1
  s_cmp_lg_u32 s81, 0
  s_cbranch_scc1 L_lok_164
  s_sleep 1
  s_sub_u32 s86, s86, 1
  s_cbranch_scc0 L_lp_163
L_lok_164:
  s_mov_b32 s86, 2097152
L_lp_165:
  ds_read_b128 v[12:15], v5 offset:16
  s_waitcnt lgkmcnt(0)
  v_and_b32 v12, v12, v13
  v_and_b32 v14, v14, v15
  v_and_b32 v12, v12, v14
  s_nop 0
  v_readfirstlane_b32 s81, v12
  s_nop 1
  s_cmp_lg_u32 s81, 0
  s_cbranch_scc1 L_lok_166
  s_sleep 1
  s_sub_u32 s86, s86, 1
  s_cbranch_scc0 L_lp_165
L_lok_166:
  v_add_u32 v12, 149504, v1
  v_lshrrev_b32 v13, 5, v0
  v_lshlrev_b32 v13, 6, v13
  v_add_u32 v13, 157696, v13
  v_mov_b32 v14, 157952
  s_mov_b32 s82, 0x0000ffff
  s_mov_b32 s83, 0xffff0000
  v_cndmask_b32 v13, v14, v13, s[82:83]
  s_setprio 2
  ds_read_b128 v[16:19], v13 offset:0
  ds_read_b128 v[20:23], v13 offset:16
  ds_read_b128 v[24:27], v13 offset:32
  ds_read_b128 v[28:31], v13 offset:48
  ds_read_b128 v[32:35], v12 offset:0
  ds_read_b128 v[36:39], v12 offset:1024
  ds_read_b128 v[40:43], v12 offset:2048
  ds_read_b128 v[44:47], v12 offset:3072
  s_waitcnt lgkmcnt(7)
  v_mfma_f32_32x32x16_bf16 v[48:63], v[16:19], v[80:83], 0
  ds_read_b128 v[16:19], v13 offset:128
  s_waitcnt lgkmcnt(7)
  v_mfma_f32_32x32x16_bf16 v[48:63], v[20:23], v[84:87], v[48:63]
  ds_read_b128 v[20:23], v13 offset:144
  s_waitcnt lgkmcnt(7)
  v_mfma_f32_32x32x16_bf16 v[48:63], v[24:27], v[88:91], v[48:63]
  ds_read_b128 v[24:27], v13 offset:160
  s_waitcnt lgkmcnt(7)
  v_mfma_f32_32x32x16_bf16 v[48:63], v[28:31], v[92:95], v[48:63]
  ds_read_b128 v[28:31], v13 offset:176
  s_waitcnt lgkmcnt(7)
  v_mfma_f32_32x32x16_bf16 v[64:79], v[32:35], v[80:83], 0
  ds_read_b128 v[32:35], v12 offset:4096
  s_waitcnt lgkmcnt(7)
  v_mfma_f32_32x32x16_bf16 v[64:79], v[36:39], v[84:87], v[64:79]
  ds_read_b128 v[36:39], v12 offset:5120
  s_waitcnt lgkmcnt(7)
  v_mfma_f32_32x32x16_bf16 v[64:79], v[40:43], v[88:91], v[64:79]
  ds_read_b128 v[40:43], v12 offset:6144
  s_waitcnt lgkmcnt(7)
  v_mfma_f32_32x32x16_bf16 v[64:79], v[44:47], v[92:95], v[64:79]
  ds_read_b128 v[44:47], v12 offset:7168
  s_waitcnt lgkmcnt(7)
  v_mfma_f32_32x32x16_bf16 v[80:95], v[16:19], v[96:99], 0
  v_add_f32 v48, 0x358637bd, v48
  v_add_f32 v56, 0x358637bd, v56
  v_rcp_f32 v48, v48
  v_rcp_f32 v56, v56
  s_waitcnt lgkmcnt(6)
  v_mfma_f32_32x32x16_bf16 v[80:95], v[20:23], v[100:103], v[80:95]
  s_waitcnt lgkmcnt(5)
  v_mfma_f32_32x32x16_bf16 v[80:95], v[24:27], v[104:107], v[80:95]
  s_nop 0
  v_mul_f32 v64, v64, v48
  v_mul_f32 v65, v65, v48
  v_mul_f32 v66, v66, v48
  v_mul_f32 v67, v67, v48
  v_mul_f32 v68, v68, v48
  s_waitcnt lgkmcnt(4)
  v_mfma_f32_32x32x16_bf16 v[80:95], v[28:31], v[108:111], v[80:95]
  v_mul_f32 v69, v69, v48
  v_mul_f32 v70, v70, v48
  v_mul_f32 v71, v71, v48
  v_mul_f32 v72, v72, v56
  v_mul_f32 v73, v73, v56
  s_waitcnt lgkmcnt(3)
  v_mfma_f32_32x32x16_bf16 v[16:31], v[32:35], v[96:99], 0
  v_mul_f32 v74, v74, v56
  v_mul_f32 v75, v75, v56
  v_mul_f32 v76, v76, v56
  v_mul_f32 v77, v77, v56
  v_mul_f32 v78, v78, v56
  s_waitcnt lgkmcnt(2)
  v_mfma_f32_32x32x16_bf16 v[16:31], v[36:39], v[100:103], v[16:31]
  v_mul_f32 v79, v79, v56
  v_cvt_pk_bf16_f32 v64, v64, v65
  v_cvt_pk_bf16_f32 v65, v66, v67
  v_cvt_pk_bf16_f32 v66, v68, v69
  v_cvt_pk_bf16_f32 v67, v70, v71
  s_waitcnt lgkmcnt(1)
  v_mfma_f32_32x32x16_bf16 v[16:31], v[40:43], v[104:107], v[16:31]
  v_cvt_pk_bf16_f32 v68, v72, v73
  v_cvt_pk_bf16_f32 v69, v74, v75
  v_cvt_pk_bf16_f32 v70, v76, v77
  v_cvt_pk_bf16_f32 v71, v78, v79
  v_bfi_b32 v64, s3, v2, v64
  s_waitcnt lgkmcnt(0)
  v_mfma_f32_32x32x16_bf16 v[16:31], v[44:47], v[108:111], v[16:31]
  v_bfi_b32 v66, s3, v3, v66
  v_bfi_b32 v68, s3, v2, v68
  v_bfi_b32 v70, s3, v3, v70
  buffer_store_dwordx4 v[64:67], v1, s[32:35], s94 offen offset:0 sc1
  buffer_store_dwordx4 v[68:71], v1, s[32:35], s94 offen offset:1024 sc1
  s_add_u32 s78, s4, s90
  buffer_load_dwordx4 v[96:99], v10, s[32:35], s78 offen sc1
  buffer_load_dwordx4 v[100:103], v11, s[32:35], s78 offen sc1
  s_add_u32 s78, s4, s91
  buffer_load_dwordx4 v[104:107], v10, s[32:35], s78 offen sc1
  buffer_load_dwordx4 v[108:111], v11, s[32:35], s78 offen sc1
  v_add_f32 v80, 0x358637bd, v80
  v_add_f32 v88, 0x358637bd, v88
  v_rcp_f32 v80, v80
  v_rcp_f32 v88, v88
  v_mul_f32 v16, v16, v80
  v_mul_f32 v17, v17, v80
  v_mul_f32 v18, v18, v80
  v_mul_f32 v19, v19, v80
  v_mul_f32 v20, v20, v80
  v_mul_f32 v21, v21, v80
  v_mul_f32 v22, v22, v80
  v_mul_f32 v23, v23, v80
  v_mul_f32 v24, v24, v88
  v_mul_f32 v25, v25, v88
  v_mul_f32 v26, v26, v88
  v_mul_f32 v27, v27, v88
  v_mul_f32 v28, v28, v88
  v_mul_f32 v29, v29, v88
  v_mul_f32 v30, v30, v88
  v_mul_f32 v31, v31, v88
  v_cvt_pk_bf16_f32 v16, v16, v17
  v_cvt_pk_bf16_f32 v17, v18, v19
  v_cvt_pk_bf16_f32 v18, v20, v21
  v_cvt_pk_bf16_f32 v19, v22, v23
  v_cvt_pk_bf16_f32 v20, v24, v25
  v_cvt_pk_bf16_f32 v21, v26, v27
  v_cvt_pk_bf16_f32 v22, v28, v29
  v_cvt_pk_bf16_f32 v23, v30, v31
  v_bfi_b32 v16, s3, v2, v16
  v_bfi_b32 v18, s3, v3, v18
  v_bfi_b32 v20, s3, v2, v20
  v_bfi_b32 v22, s3, v3, v22
  buffer_store_dwordx4 v[16:19], v1, s[32:35], s94 offen offset:2048 sc1
  buffer_store_dwordx4 v[20:23], v1, s[32:35], s94 offen offset:3072 sc1
  s_add_u32 s78, s4, s92
  buffer_load_dwordx4 v[80:83], v10, s[32:35], s78 offen sc1
  buffer_load_dwordx4 v[84:87], v11, s[32:35], s78 offen sc1
  s_add_u32 s78, s4, s93
  buffer_load_dwordx4 v[88:91], v10, s[32:35], s78 offen sc1
  buffer_load_dwordx4 v[92:95], v11, s[32:35], s78 offen sc1
  s_setprio 0
  s_add_u32 s78, s13, s91
  s_add_u32 m0, s99, 67584
  s_lshl_b32 s78, s78, 4
  buffer_load_dwordx4 v6, s[56:59], s78 offen offset:0 lds
  buffer_load_dwordx4 v7, s[56:59], s78 offen offset:1024 lds
  s_add_u32 s78, s13, s92
  s_add_u32 m0, s99, 81920
  s_lshl_b32 s78, s78, 4
  buffer_load_dwordx4 v6, s[56:59], s78 offen offset:0 lds
  buffer_load_dwordx4 v7, s[56:59], s78 offen offset:1024 lds
  s_add_u32 s78, s13, s93
  s_add_u32 m0, s99, 83968
  s_lshl_b32 s78, s78, 4
  buffer_load_dwordx4 v6, s[56:59], s78 offen offset:0 lds
  buffer_load_dwordx4 v7, s[56:59], s78 offen offset:1024 lds
  s_waitcnt vmcnt(4)
  s_add_u32 s78, s6, s90
  s_add_u32 m0, s99, 0
  s_lshl_b32 s78, s78, 4
  buffer_load_dwordx4 v6, s[52:55], s78 offen offset:0 lds
  buffer_load_dwordx4 v7, s[52:55], s78 offen offset:1024 lds
  s_waitcnt vmcnt(4)
  s_add_u32 s78, s6, s91
  s_add_u32 m0, s99, 2048
  s_lshl_b32 s78, s78, 4
  buffer_load_dwordx4 v6, s[52:55], s78 offen offset:0 lds
  buffer_load_dwordx4 v7, s[52:55], s78 offen offset:1024 lds
  s_mul_i32 s76, s75, 0x9e3779b1
  s_lshr_b32 s81, s76, 15
  s_xor_b32 s76, s76, s81
  s_and_b32 s76, s76, 0xfffdfffd
  s_or_b32 s76, s76, 0x00010001
  s_mov_b32 s3, 0x00010001
  v_and_b32 v14, 7, v0
  v_lshlrev_b32 v14, 2, v14
  v_bfe_u32 v14, s76, v14, 4
  v_lshl_or_b32 v14, v14, 15, v14
  v_lshrrev_b32 v15, 2, v14
  v_and_b32 v14, s3, v14
  v_and_b32 v15, s3, v15
  v_xor_b32 v15, s3, v15
  v_xor_b32 v96, v96, v14
  v_xor_b32 v98, v98, v15
  v_xor_b32 v100, v100, v14
  v_xor_b32 v102, v102, v15
  v_bitop3_b32 v2, v96, v98, v96 bitop3:0xf3
  v_bitop3_b32 v2, v100, v102, v2 bitop3:0xfb
  v_and_b32 v2, s3, v2
  v_cmp_ne_u32 vcc, 0, v2
  s_nop 0
  s_cmp_lg_u64 vcc, 0
  s_cbranch_scc1 L_slow_167
L_cont_168:
  v_mfma_f32_32x32x16_bf16 v[16:31], v[112:115], v[96:99], 0
  v_xor_b32 v104, v104, v14
  v_xor_b32 v106, v106, v15
  v_xor_b32 v108, v108, v14
  v_xor_b32 v110, v110, v15
  v_mfma_f32_32x32x16_bf16 v[32:47], v[116:119], v[96:99], 0
  v_bitop3_b32 v2, v104, v106, v104 bitop3:0xf3
  v_bitop3_b32 v2, v108, v110, v2 bitop3:0xfb
  v_mfma_f32_32x32x16_bf16 v[48:63], v[112:115], v[100:103], 0
  v_and_b32 v2, s3, v2
  v_cmp_ne_u32 vcc, 0, v2
  v_mfma_f32_32x32x16_bf16 v[64:79], v[116:119], v[100:103], 0
  s_cmp_lg_u64 vcc, 0
  s_cbranch_scc1 L_slow_171
L_cont_172:
  v_mfma_f32_32x32x16_bf16 v[16:31], v[120:123], v[104:107], v[16:31]
  v_xor_b32 v80, v80, v14
  v_xor_b32 v82, v82, v15
  v_xor_b32 v84, v84, v14
  v_xor_b32 v86, v86, v15
  v_mfma_f32_32x32x16_bf16 v[32:47], v[124:127], v[104:107], v[32:47]
  s_waitcnt vmcnt(4)
  s_add_u32 s78, s5, s90
  buffer_load_dwordx4 v[96:99], v10, s[32:35], s78 offen sc1
  buffer_load_dwordx4 v[100:103], v11, s[32:35], s78 offen sc1
  v_bitop3_b32 v2, v80, v82, v80 bitop3:0xf3
  v_bitop3_b32 v2, v84, v86, v2 bitop3:0xfb
  v_mfma_f32_32x32x16_bf16 v[48:63], v[120:123], v[108:111], v[48:63]
  s_waitcnt vmcnt(4)
  s_add_u32 s78, s6, s92
  s_add_u32 m0, s99, 16384
  s_lshl_b32 s78, s78, 4
  v_and_b32 v2, s3, v2
  v_cmp_ne_u32 vcc, 0, v2
  v_mfma_f32_32x32x16_bf16 v[64:79], v[124:127], v[108:111], v[64:79]
  buffer_load_dwordx4 v6, s[52:55], s78 offen offset:0 lds
  buffer_load_dwordx4 v7, s[52:55], s78 offen offset:1024 lds
  s_cmp_lg_u64 vcc, 0
  s_cbranch_scc1 L_slow_175
L_cont_176:
  v_mfma_f32_32x32x16_bf16 v[16:31], v[128:131], v[80:83], v[16:31]
  v_xor_b32 v88, v88, v14
  v_xor_b32 v90, v90, v15
  v_xor_b32 v92, v92, v14
  v_xor_b32 v94, v94, v15
  v_mfma_f32_32x32x16_bf16 v[32:47], v[132:135], v[80:83], v[32:47]
  s_waitcnt vmcnt(4)
  s_add_u32 s78, s5, s91
  buffer_load_dwordx4 v[112:115], v10, s[32:35], s78 offen sc1
  buffer_load_dwordx4 v[116:119], v11, s[32:35], s78 offen sc1
  s_waitcnt vmcnt(4)
  v_bitop3_b32 v2, v88, v90, v88 bitop3:0xf3
  v_bitop3_b32 v2, v92, v94, v2 bitop3:0xfb
  v_mfma_f32_32x32x16_bf16 v[48:63], v[128:131], v[84:87], v[48:63]
  s_add_u32 s78, s5, s92
  buffer_load_dwordx4 v[104:107], v10, s[32:35], s78 offen sc1
  buffer_load_dwordx4 v[108:111], v11, s[32:35], s78 offen sc1
  s_waitcnt vmcnt(4)
  s_add_u32 s78, s6, s93
  v_and_b32 v2, s3, v2
  v_cmp_ne_u32 vcc, 0, v2
  v_mfma_f32_32x32x16_bf16 v[64:79], v[132:135], v[84:87], v[64:79]
  s_add_u32 m0, s99, 18432
  s_lshl_b32 s78, s78, 4
  buffer_load_dwordx4 v6, s[52:55], s78 offen offset:0 lds
  buffer_load_dwordx4 v7, s[52:55], s78 offen offset:1024 lds
  s_cmp_lg_u64 vcc, 0
  s_cbranch_scc1 L_slow_179
L_cont_180:
  v_mfma_f32_32x32x16_bf16 v[16:31], v[136:139], v[88:91], v[16:31]
  v_xor_b32 v96, v96, v14
  v_xor_b32 v98, v98, v15
  v_xor_b32 v100, v100, v14
  v_xor_b32 v102, v102, v15
  v_mfma_f32_32x32x16_bf16 v[32:47], v[140:143], v[88:91], v[32:47]
  s_waitcnt vmcnt(4)
  s_add_u32 s78, s5, s93
  buffer_load_dwordx4 v[120:123], v10, s[32:35], s78 offen sc1
  v_bitop3_b32 v2, v96, v98, v96 bitop3:0xf3
  v_bitop3_b32 v2, v100, v102, v2 bitop3:0xfb
  v_mfma_f32_32x32x16_bf16 v[48:63], v[136:139], v[92:95], v[48:63]
  buffer_load_dwordx4 v[124:127], v11, s[32:35], s78 offen sc1
  s_waitcnt vmcnt(4)
  s_add_u32 s78, s8, s90
  v_and_b32 v2, s3, v2
  v_cmp_ne_u32 vcc, 0, v2
  v_mfma_f32_32x32x16_bf16 v[64:79], v[140:143], v[92:95], v[64:79]
  buffer_load_dwordx4 v[80:83], v10, s[32:35], s78 offen sc1
  buffer_load_dwordx4 v[84:87], v11, s[32:35], s78 offen sc1
  s_cmp_lg_u64 vcc, 0
  s_cbranch_scc1 L_slow_183
L_cont_184:
  v_mfma_f32_32x32x16_bf16 v[16:31], v[144:147], v[96:99], v[16:31]
  v_xor_b32 v112, v112, v14
  v_xor_b32 v114, v114, v15
  v_xor_b32 v116, v116, v14
  v_xor_b32 v118, v118, v15
  v_mfma_f32_32x32x16_bf16 v[32:47], v[148:151], v[96:99], v[32:47]
  s_waitcnt vmcnt(4)
  s_add_u32 s78, s8, s91
  buffer_load_dwordx4 v[128:131], v10, s[32:35], s78 offen sc1
  v_bitop3_b32 v2, v112, v114, v112 bitop3:0xf3
  v_bitop3_b32 v2, v116, v118, v2 bitop3:0xfb
  v_mfma_f32_32x32x16_bf16 v[48:63], v[144:147], v[100:103], v[48:63]
  buffer_load_dwordx4 v[132:135], v11, s[32:35], s78 offen sc1
  s_waitcnt vmcnt(4)
  s_add_u32 s78, s8, s92
  v_and_b32 v2, s3, v2
  v_cmp_ne_u32 vcc, 0, v2
  v_mfma_f32_32x32x16_bf16 v[64:79], v[148:151], v[100:103], v[64:79]
  buffer_load_dwordx4 v[88:91], v10, s[32:35], s78 offen sc1
  buffer_load_dwordx4 v[92:95], v11, s[32:35], s78 offen sc1
  s_cmp_lg_u64 vcc, 0
  s_cbranch_scc1 L_slow_187
L_cont_188:
  v_mfma_f32_32x32x16_bf16 v[16:31], v[152:155], v[112:115], v[16:31]
  v_xor_b32 v104, v104, v14
  v_xor_b32 v106, v106, v15
  v_xor_b32 v108, v108, v14
  v_xor_b32 v110, v110, v15
  v_mfma_f32_32x32x16_bf16 v[32:47], v[156:159], v[112:115], v[32:47]
  s_waitcnt vmcnt(4)
  s_add_u32 s78, s8, s93
  buffer_load_dwordx4 v[136:139], v10, s[32:35], s78 offen sc1
  v_bitop3_b32 v2, v104, v106, v104 bitop3:0xf3
  v_bitop3_b32 v2, v108, v110, v2 bitop3:0xfb
  v_mfma_f32_32x32x16_bf16 v[48:63], v[152:155], v[116:119], v[48:63]
  buffer_load_dwordx4 v[140:143], v11, s[32:35], s78 offen sc1
  s_waitcnt vmcnt(4)
  s_add_u32 s78, s9, s90
  v_and_b32 v2, s3, v2
  v_cmp_ne_u32 vcc, 0, v2
  v_mfma_f32_32x32x16_bf16 v[64:79], v[156:159], v[116:119], v[64:79]
  buffer_load_dwordx4 v[96:99], v10, s[32:35], s78 offen sc1
  buffer_load_dwordx4 v[100:103], v11, s[32:35], s78 offen sc1
  s_cmp_lg_u64 vcc, 0
  s_cbranch_scc1 L_slow_191
L_cont_192:
  v_mfma_f32_32x32x16_bf16 v[16:31], v[160:163], v[104:107], v[16:31]
  v_xor_b32 v120, v120, v14
  v_xor_b32 v122, v122, v15
  v_xor_b32 v124, v124, v14
  v_xor_b32 v126, v126, v15
  v_mfma_f32_32x32x16_bf16 v[32:47], v[164:167], v[104:107], v[32:47]
  s_add_u32 s78, s9, s91
  buffer_load_dwordx4 v[144:147], v10, s[32:35], s78 offen sc1
  buffer_load_dwordx4 v[148:151], v11, s[32:35], s78 offen sc1
  s_add_u32 s78, s9, s92
  buffer_load_dwordx4 v[112:115], v10, s[32:35], s78 offen sc1
  buffer_load_dwordx4 v[116:119], v11, s[32:35], s78 offen sc1
  s_mov_b32 s86, 2097152
L_lp_195:
  ds_read_b128 v[152:155], v5 offset:32
  s_waitcnt lgkmcnt(0)
  v_and_b32 v152, v152, v153
  v_and_b32 v154, v154, v155
  v_and_b32 v152, v152, v154
  s_nop 0
  v_readfirstlane_b32 s81, v152
  s_nop 1
  s_cmp_lg_u32 s81, 0
  s_cbranch_scc1 L_lok_196
  s_sleep 1
  s_sub_u32 s86, s86, 1
  s_cbranch_scc0 L_lp_195
L_lok_196:
  v_bitop3_b32 v2, v120, v122, v120 bitop3:0xf3
  v_bitop3_b32 v2, v124, v126, v2 bitop3:0xfb
  v_mfma_f32_32x32x16_bf16 v[48:63], v[160:163], v[108:111], v[48:63]
  v_and_b32 v2, s3, v2
  v_cmp_ne_u32 vcc, 0, v2
  v_mfma_f32_32x32x16_bf16 v[64:79], v[164:167], v[108:111], v[64:79]
  s_cmp_lg_u64 vcc, 0
  s_cbranch_scc1 L_slow_197
L_cont_198:
  v_mfma_f32_32x32x16_bf16 v[16:31], v[168:171], v[120:123], v[16:31]
  v_xor_b32 v80, v80, v14
  v_xor_b32 v82, v82, v15
  v_xor_b32 v84, v84, v14
  v_xor_b32 v86, v86, v15
  v_mfma_f32_32x32x16_bf16 v[32:47], v[172:175], v[120:123], v[32:47]
  s_add_u32 s78, s9, s93
  buffer_load_dwordx4 v[152:155], v10, s[32:35], s78 offen sc1
  buffer_load_dwordx4 v[156:159], v11, s[32:35], s78 offen sc1
  v_bitop3_b32 v2, v80, v82, v80 bitop3:0xf3
  v_bitop3_b32 v2, v84, v86, v2 bitop3:0xfb
  v_mfma_f32_32x32x16_bf16 v[48:63], v[168:171], v[124:127], v[48:63]
  s_add_u32 s78, s7, s90
  s_add_u32 m0, s99, 98304
  s_lshl_b32 s78, s78, 4
  v_and_b32 v2, s3, v2
  v_cmp_ne_u32 vcc, 0, v2
  v_mfma_f32_32x32x16_bf16 v[64:79], v[172:175], v[124:127], v[64:79]
  buffer_load_dwordx4 v6, s[52:55], s78 offen offset:0 lds
  buffer_load_dwordx4 v7, s[52:55], s78 offen offset:1024 lds
  s_cmp_lg_u64 vcc, 0
  s_cbranch_scc1 L_slow_201
L_cont_202:
  v_mfma_f32_32x32x16_bf16 v[16:31], v[176:179], v[80:83], v[16:31]
  v_xor_b32 v128, v128, v14
  v_xor_b32 v130, v130, v15
  v_xor_b32 v132, v132, v14
  v_xor_b32 v134, v134, v15
  v_mfma_f32_32x32x16_bf16 v[32:47], v[180:183], v[80:83], v[32:47]
  s_add_u32 s78, s12, s90
  s_add_u32 s78, s78, 114688
  buffer_load_dwordx4 v[104:107], v10, s[32:35], s78 offen sc1
  v_bitop3_b32 v2, v128, v130, v128 bitop3:0xf3
  v_bitop3_b32 v2, v132, v134, v2 bitop3:0xfb
  v_mfma_f32_32x32x16_bf16 v[48:63], v[176:179], v[84:87], v[48:63]
  buffer_load_dwordx4 v[108:111], v11, s[32:35], s78 offen sc1
  s_add_u32 s78, s7, s91
  s_add_u32 m0, s99, 100352
  v_and_b32 v2, s3, v2
  v_cmp_ne_u32 vcc, 0, v2
  v_mfma_f32_32x32x16_bf16 v[64:79], v[180:183], v[84:87], v[64:79]
  s_lshl_b32 s78, s78, 4
  buffer_load_dwordx4 v6, s[52:55], s78 offen offset:0 lds
  buffer_load_dwordx4 v7, s[52:55], s78 offen offset:1024 lds
  s_cmp_lg_u64 vcc, 0
  s_cbranch_scc1 L_slow_205
L_cont_206:
  v_mfma_f32_32x32x16_bf16 v[16:31], v[184:187], v[128:131], v[16:31]
  s_waitcnt vmcnt(17)
  v_xor_b32 v88, v88, v14
  v_xor_b32 v90, v90, v15
  s_waitcnt vmcnt(16)
  v_xor_b32 v92, v92, v14
  v_xor_b32 v94, v94, v15
  v_mfma_f32_32x32x16_bf16 v[32:47], v[188:191], v[128:131], v[32:47]
  s_add_u32 s78, s12, s91
  s_add_u32 s78, s78, 114688
  buffer_load_dwordx4 v[160:163], v10, s[32:35], s78 offen sc1
  v_bitop3_b32 v2, v88, v90, v88 bitop3:0xf3
  v_bitop3_b32 v2, v92, v94, v2 bitop3:0xfb
  v_mfma_f32_32x32x16_bf16 v[48:63], v[184:187], v[132:135], v[48:63]
  buffer_load_dwordx4 v[164:167], v11, s[32:35], s78 offen sc1
  s_add_u32 s78, s7, s92
  s_add_u32 m0, s99, 114688
  v_and_b32 v2, s3, v2
  v_cmp_ne_u32 vcc, 0, v2
  v_mfma_f32_32x32x16_bf16 v[64:79], v[188:191], v[132:135], v[64:79]
  s_lshl_b32 s78, s78, 4
  buffer_load_dwordx4 v6, s[52:55], s78 offen offset:0 lds
  buffer_load_dwordx4 v7, s[52:55], s78 offen offset:1024 lds
  s_cmp_lg_u64 vcc, 0
  s_cbranch_scc1 L_slow_209
L_cont_210:
  v_mfma_f32_32x32x16_bf16 v[16:31], v[192:195], v[88:91], v[16:31]
  s_waitcnt vmcnt(19)
  v_xor_b32 v136, v136, v14
  v_xor_b32 v138, v138, v15
  s_waitcnt vmcnt(18)
  v_xor_b32 v140, v140, v14
  v_xor_b32 v142, v142, v15
  v_mfma_f32_32x32x16_bf16 v[32:47], v[196:199], v[88:91], v[32:47]
  s_add_u32 s78, s12, s92
  s_add_u32 s78, s78, 114688
  buffer_load_dwordx4 v[120:123], v10, s[32:35], s78 offen sc1
  v_bitop3_b32 v2, v136, v138, v136 bitop3:0xf3
  v_bitop3_b32 v2, v140, v142, v2 bitop3:0xfb
  v_mfma_f32_32x32x16_bf16 v[48:63], v[192:195], v[92:95], v[48:63]
  buffer_load_dwordx4 v[124:127], v11, s[32:35], s78 offen sc1
  s_add_u32 s78, s7, s93
  s_add_u32 m0, s99, 116736
  v_and_b32 v2, s3, v2
  v_cmp_ne_u32 vcc, 0, v2
  v_mfma_f32_32x32x16_bf16 v[64:79], v[196:199], v[92:95], v[64:79]
  s_lshl_b32 s78, s78, 4
  buffer_load_dwordx4 v6, s[52:55], s78 offen offset:0 lds
  buffer_load_dwordx4 v7, s[52:55], s78 offen offset:1024 lds
  s_cmp_lg_u64 vcc, 0
  s_cbranch_scc1 L_slow_213
L_cont_214:
  v_mfma_f32_32x32x16_bf16 v[16:31], v[200:203], v[136:139], v[16:31]
  s_waitcnt vmcnt(21)
  v_xor_b32 v96, v96, v14
  v_xor_b32 v98, v98, v15
  s_waitcnt vmcnt(20)
  v_xor_b32 v100, v100, v14
  v_xor_b32 v102, v102, v15
  v_mfma_f32_32x32x16_bf16 v[32:47], v[204:207], v[136:139], v[32:47]
  s_add_u32 s78, s12, s93
  s_add_u32 s78, s78, 114688
  v_bitop3_b32 v2, v96, v98, v96 bitop3:0xf3
  v_bitop3_b32 v2, v100, v102, v2 bitop3:0xfb
  v_mfma_f32_32x32x16_bf16 v[48:63], v[200:203], v[140:143], v[48:63]
  buffer_load_dwordx4 v[168:171], v10, s[32:35], s78 offen sc1
  buffer_load_dwordx4 v[172:175], v11, s[32:35], s78 offen sc1
  v_and_b32 v2, s3, v2
  v_cmp_ne_u32 vcc, 0, v2
  v_mfma_f32_32x32x16_bf16 v[64:79], v[204:207], v[140:143], v[64:79]
  s_cmp_lg_u64 vcc, 0
  s_cbranch_scc1 L_slow_217
L_cont_218:
  v_mfma_f32_32x32x16_bf16 v[16:31], v[208:211], v[96:99], v[16:31]
  s_waitcnt vmcnt(21)
  v_xor_b32 v144, v144, v14
  v_xor_b32 v146, v146, v15
  s_waitcnt vmcnt(20)
  v_xor_b32 v148, v148, v14
  v_xor_b32 v150, v150, v15
  v_mfma_f32_32x32x16_bf16 v[32:47], v[212:215], v[96:99], v[32:47]
  s_add_u32 s78, s13, s90
  s_add_u32 s78, s78, 114688
  v_bitop3_b32 v2, v144, v146, v144 bitop3:0xf3
  v_bitop3_b32 v2, v148, v150, v2 bitop3:0xfb
  v_mfma_f32_32x32x16_bf16 v[48:63], v[208:211], v[100:103], v[48:63]
  buffer_load_dwordx4 v[80:83], v10, s[32:35], s78 offen sc1
  buffer_load_dwordx4 v[84:87], v11, s[32:35], s78 offen sc1
  v_and_b32 v2, s3, v2
  v_cmp_ne_u32 vcc, 0, v2
  v_mfma_f32_32x32x16_bf16 v[64:79], v[212:215], v[100:103], v[64:79]
  s_cmp_lg_u64 vcc, 0
  s_cbranch_scc1 L_slow_221
L_cont_222:
  v_mfma_f32_32x32x16_bf16 v[16:31], v[216:219], v[144:147], v[16:31]
  s_waitcnt vmcnt(21)
  v_xor_b32 v112, v112, v14
  v_xor_b32 v114, v114, v15
  s_waitcnt vmcnt(20)
  v_xor_b32 v116, v116, v14
  v_xor_b32 v118, v118, v15
  v_mfma_f32_32x32x16_bf16 v[32:47], v[220:223], v[144:147], v[32:47]
  s_add_u32 s78, s13, s91
  s_add_u32 s78, s78, 114688
  v_bitop3_b32 v2, v112, v114, v112 bitop3:0xf3
  v_bitop3_b32 v2, v116, v118, v2 bitop3:0xfb
  v_mfma_f32_32x32x16_bf16 v[48:63], v[216:219], v[148:151], v[48:63]
  buffer_load_dwordx4 v[176:179], v10, s[32:35], s78 offen sc1
  buffer_load_dwordx4 v[180:183], v11, s[32:35], s78 offen sc1
  v_and_b32 v2, s3, v2
  v_cmp_ne_u32 vcc, 0, v2
  v_mfma_f32_32x32x16_bf16 v[64:79], v[220:223], v[148:151], v[64:79]
  s_cmp_lg_u64 vcc, 0
  s_cbranch_scc1 L_slow_225
L_cont_226:
  v_mfma_f32_32x32x16_bf16 v[16:31], v[224:227], v[112:115], v[16:31]
  s_waitcnt vmcnt(21)
  v_xor_b32 v152, v152, v14
  v_xor_b32 v154, v154, v15
  s_waitcnt vmcnt(20)
  v_xor_b32 v156, v156, v14
  v_xor_b32 v158, v158, v15
  v_mfma_f32_32x32x16_bf16 v[32:47], v[228:231], v[112:115], v[32:47]
  s_add_u32 s78, s13, s92
  s_add_u32 s78, s78, 114688
  v_bitop3_b32 v2, v152, v154, v152 bitop3:0xf3
  v_bitop3_b32 v2, v156, v158, v2 bitop3:0xfb
  v_mfma_f32_32x32x16_bf16 v[48:63], v[224:227], v[116:119], v[48:63]
  buffer_load_dwordx4 v[128:131], v10, s[32:35], s78 offen sc1
  buffer_load_dwordx4 v[132:135], v11, s[32:35], s78 offen sc1
  v_and_b32 v2, s3, v2
  v_cmp_ne_u32 vcc, 0, v2
  v_mfma_f32_32x32x16_bf16 v[64:79], v[228:231], v[116:119], v[64:79]
  s_cmp_lg_u64 vcc, 0
  s_cbranch_scc1 L_slow_229
L_cont_230:
  v_mfma_f32_32x32x16_bf16 v[16:31], v[232:235], v[152:155], v[16:31]
  s_waitcnt vmcnt(19)
  v_xor_b32 v104, v104, v14
  v_xor_b32 v106, v106, v15
  s_waitcnt vmcnt(18)
  v_xor_b32 v108, v108, v14
  v_xor_b32 v110, v110, v15
  v_mfma_f32_32x32x16_bf16 v[32:47], v[236:239], v[152:155], v[32:47]
  v_add_u32 v8, 65536, v8
  v_add_u32 v9, 65536, v9
  ds_read_b64_tr_b16 v[184:185], v8 offset:0
  v_bitop3_b32 v2, v104, v106, v104 bitop3:0xf3
  v_bitop3_b32 v2, v108, v110, v2 bitop3:0xfb
  v_mfma_f32_32x32x16_bf16 v[48:63], v[232:235], v[156:159], v[48:63]
  ds_read_b64_tr_b16 v[186:187], v8 offset:1024
  ds_read_b64_tr_b16 v[188:189], v9 offset:0
  ds_read_b64_tr_b16 v[190:191], v9 offset:1024
  s_add_u32 s78, s13, s93
  v_and_b32 v2, s3, v2
  v_cmp_ne_u32 vcc, 0, v2
  v_mfma_f32_32x32x16_bf16 v[64:79], v[236:239], v[156:159], v[64:79]
  s_add_u32 s78, s78, 114688
  buffer_load_dwordx4 v[88:91], v10, s[32:35], s78 offen sc1
  buffer_load_dwordx4 v[92:95], v11, s[32:35], s78 offen sc1
  s_cmp_lg_u64 vcc, 0
  s_cbranch_scc1 L_slow_233
L_cont_234:
  v_mfma_f32_32x32x16_bf16 v[16:31], v[240:243], v[104:107], v[16:31]
  s_waitcnt vmcnt(17)
  v_xor_b32 v160, v160, v14
  v_xor_b32 v162, v162, v15
  s_waitcnt vmcnt(16)
  v_xor_b32 v164, v164, v14
  v_xor_b32 v166, v166, v15
  v_mfma_f32_32x32x16_bf16 v[32:47], v[244:247], v[104:107], v[32:47]
  ds_read_b64_tr_b16 v[192:193], v8 offset:2048
  ds_read_b64_tr_b16 v[194:195], v8 offset:3072
  v_bitop3_b32 v2, v160, v162, v160 bitop3:0xf3
  v_bitop3_b32 v2, v164, v166, v2 bitop3:0xfb
  v_mfma_f32_32x32x16_bf16 v[48:63], v[240:243], v[108:111], v[48:63]
  ds_read_b64_tr_b16 v[196:197], v9 offset:2048
  ds_read_b64_tr_b16 v[198:199], v9 offset:3072
  s_add_u32 s78, s10, s14
  v_and_b32 v2, s3, v2
  v_cmp_ne_u32 vcc, 0, v2
  v_mfma_f32_32x32x16_bf16 v[64:79], v[244:247], v[108:111], v[64:79]
  buffer_load_dwordx4 v[136:139], v10, s[32:35], s78 offen sc1
  buffer_load_dwordx4 v[140:143], v11, s[32:35], s78 offen sc1
  s_cmp_lg_u64 vcc, 0
  s_cbranch_scc1 L_slow_237
L_cont_238:
  v_mfma_f32_32x32x16_bf16 v[16:31], v[248:251], v[160:163], v[16:31]
  s_waitcnt vmcnt(15)
  v_xor_b32 v120, v120, v14
  v_xor_b32 v122, v122, v15
  s_waitcnt vmcnt(14)
  v_xor_b32 v124, v124, v14
  v_xor_b32 v126, v126, v15
  v_mfma_f32_32x32x16_bf16 v[32:47], v[252:255], v[160:163], v[32:47]
  v_subrev_u32 v8, 65536, v8
  v_subrev_u32 v9, 65536, v9
  ds_read_b64_tr_b16 v[200:201], v8 offset:0
  v_bitop3_b32 v2, v120, v122, v120 bitop3:0xf3
  v_bitop3_b32 v2, v124, v126, v2 bitop3:0xfb
  v_mfma_f32_32x32x16_bf16 v[48:63], v[248:251], v[164:167], v[48:63]
  ds_read_b64_tr_b16 v[202:203], v8 offset:1024
  ds_read_b64_tr_b16 v[204:205], v9 offset:0
  ds_read_b64_tr_b16 v[206:207], v9 offset:1024
  s_add_u32 s78, s10, s15
  v_and_b32 v2, s3, v2
  v_cmp_ne_u32 vcc, 0, v2
  v_mfma_f32_32x32x16_bf16 v[64:79], v[252:255], v[164:167], v[64:79]
  buffer_load_dwordx4 v[96:99], v10, s[32:35], s78 offen sc1
  buffer_load_dwordx4 v[100:103], v11, s[32:35], s78 offen sc1
  s_cmp_lg_u64 vcc, 0
  s_cbranch_scc1 L_slow_241
L_cont_242:
  s_waitcnt lgkmcnt(10)
  v_mfma_f32_32x32x16_bf16 v[16:31], v[184:187], v[120:123], v[16:31]
  s_waitcnt vmcnt(13)
  v_xor_b32 v168, v168, v14
  v_xor_b32 v170, v170, v15
  s_waitcnt vmcnt(12)
  v_xor_b32 v172, v172, v14
  v_xor_b32 v174, v174, v15
  s_waitcnt lgkmcnt(8)
  v_mfma_f32_32x32x16_bf16 v[32:47], v[188:191], v[120:123], v[32:47]
  ds_read_b64_tr_b16 v[208:209], v8 offset:2048
  ds_read_b64_tr_b16 v[210:211], v8 offset:3072
  v_bitop3_b32 v2, v168, v170, v168 bitop3:0xf3
  v_bitop3_b32 v2, v172, v174, v2 bitop3:0xfb
  v_mfma_f32_32x32x16_bf16 v[48:63], v[184:187], v[124:127], v[48:63]
  ds_read_b64_tr_b16 v[212:213], v9 offset:2048
  ds_read_b64_tr_b16 v[214:215], v9 offset:3072
  s_add_u32 s78, s11, s14
  v_and_b32 v2, s3, v2
  v_cmp_ne_u32 vcc, 0, v2
  v_mfma_f32_32x32x16_bf16 v[64:79], v[188:191], v[124:127], v[64:79]
  buffer_load_dwordx4 v[144:147], v10, s[32:35], s78 offen sc1
  buffer_load_dwordx4 v[148:151], v11, s[32:35], s78 offen sc1
  s_cmp_lg_u64 vcc, 0
  s_cbranch_scc1 L_slow_245
L_cont_246:
  s_waitcnt lgkmcnt(10)
  v_mfma_f32_32x32x16_bf16 v[16:31], v[192:195], v[168:171], v[16:31]
  s_waitcnt vmcnt(13)
  v_xor_b32 v80, v80, v14
  v_xor_b32 v82, v82, v15
  s_waitcnt vmcnt(12)
  v_xor_b32 v84, v84, v14
  v_xor_b32 v86, v86, v15
  s_waitcnt lgkmcnt(8)
  v_mfma_f32_32x32x16_bf16 v[32:47], v[196:199], v[168:171], v[32:47]
  ds_read_b64_tr_b16 v[216:217], v8 offset:16384
  ds_read_b64_tr_b16 v[218:219], v8 offset:17408
  v_bitop3_b32 v2, v80, v82, v80 bitop3:0xf3
  v_bitop3_b32 v2, v84, v86, v2 bitop3:0xfb
  v_mfma_f32_32x32x16_bf16 v[48:63], v[192:195], v[172:175], v[48:63]
  ds_read_b64_tr_b16 v[220:221], v9 offset:16384
  ds_read_b64_tr_b16 v[222:223], v9 offset:17408
  s_add_u32 s78, s11, s15
  v_and_b32 v2, s3, v2
  v_cmp_ne_u32 vcc, 0, v2
  v_mfma_f32_32x32x16_bf16 v[64:79], v[196:199], v[172:175], v[64:79]
  buffer_load_dwordx4 v[112:115], v10, s[32:35], s78 offen sc1
  buffer_load_dwordx4 v[116:119], v11, s[32:35], s78 offen sc1
  s_cmp_lg_u64 vcc, 0
  s_cbranch_scc1 L_slow_249
L_cont_250:
  s_waitcnt lgkmcnt(10)
  v_mfma_f32_32x32x16_bf16 v[16:31], v[200:203], v[80:83], v[16:31]
  s_waitcnt vmcnt(13)
  v_xor_b32 v176, v176, v14
  v_xor_b32 v178, v178, v15
  s_waitcnt vmcnt(12)
  v_xor_b32 v180, v180, v14
  v_xor_b32 v182, v182, v15
  s_waitcnt lgkmcnt(8)
  v_mfma_f32_32x32x16_bf16 v[32:47], v[204:207], v[80:83], v[32:47]
  ds_read_b64_tr_b16 v[224:225], v8 offset:18432
  ds_read_b64_tr_b16 v[226:227], v8 offset:19456
  v_bitop3_b32 v2, v176, v178, v176 bitop3:0xf3
  v_bitop3_b32 v2, v180, v182, v2 bitop3:0xfb
  v_mfma_f32_32x32x16_bf16 v[48:63], v[200:203], v[84:87], v[48:63]
  ds_read_b64_tr_b16 v[228:229], v9 offset:18432
  ds_read_b64_tr_b16 v[230:231], v9 offset:19456
  s_add_u32 s78, s6, s90
  v_and_b32 v2, s3, v2
  v_cmp_ne_u32 vcc, 0, v2
  v_mfma_f32_32x32x16_bf16 v[64:79], v[204:207], v[84:87], v[64:79]
  buffer_load_dwordx4 v[152:155], v10, s[32:35], s78 offen sc1
  buffer_load_dwordx4 v[156:159], v11, s[32:35], s78 offen sc1
  s_cmp_lg_u64 vcc, 0
  s_cbranch_scc1 L_slow_253
L_cont_254:
  s_waitcnt lgkmcnt(10)
  v_mfma_f32_32x32x16_bf16 v[16:31], v[208:211], v[176:179], v[16:31]
  s_waitcnt vmcnt(13)
  v_xor_b32 v128, v128, v14
  v_xor_b32 v130, v130, v15
  s_waitcnt vmcnt(12)
  v_xor_b32 v132, v132, v14
  v_xor_b32 v134, v134, v15
  s_waitcnt lgkmcnt(8)
  v_mfma_f32_32x32x16_bf16 v[32:47], v[212:215], v[176:179], v[32:47]
  v_subrev_u32 v8, 65536, v8
  v_subrev_u32 v9, 65536, v9
  ds_read_b64_tr_b16 v[232:233], v8 offset:32768
  v_bitop3_b32 v2, v128, v130, v128 bitop3:0xf3
  v_bitop3_b32 v2, v132, v134, v2 bitop3:0xfb
  v_mfma_f32_32x32x16_bf16 v[48:63], v[208:211], v[180:183], v[48:63]
  ds_read_b64_tr_b16 v[234:235], v8 offset:33792
  ds_read_b64_tr_b16 v[236:237], v9 offset:32768
  ds_read_b64_tr_b16 v[238:239], v9 offset:33792
  s_add_u32 s78, s6, s91
  v_and_b32 v2, s3, v2
  v_cmp_ne_u32 vcc, 0, v2
  v_mfma_f32_32x32x16_bf16 v[64:79], v[212:215], v[180:183], v[64:79]
  buffer_load_dwordx4 v[104:107], v10, s[32:35], s78 offen sc1
  buffer_load_dwordx4 v[108:111], v11, s[32:35], s78 offen sc1
  s_cmp_lg_u64 vcc, 0
  s_cbranch_scc1 L_slow_257
L_cont_258:
  s_waitcnt lgkmcnt(10)
  v_mfma_f32_32x32x16_bf16 v[16:31], v[216:219], v[128:131], v[16:31]
  s_waitcnt vmcnt(13)
  v_xor_b32 v88, v88, v14
  v_xor_b32 v90, v90, v15
  s_waitcnt vmcnt(12)
  v_xor_b32 v92, v92, v14
  v_xor_b32 v94, v94, v15
  s_waitcnt lgkmcnt(8)
  v_mfma_f32_32x32x16_bf16 v[32:47], v[220:223], v[128:131], v[32:47]
  ds_read_b64_tr_b16 v[240:241], v8 offset:34816
  ds_read_b64_tr_b16 v[242:243], v8 offset:35840
  v_bitop3_b32 v2, v88, v90, v88 bitop3:0xf3
  v_bitop3_b32 v2, v92, v94, v2 bitop3:0xfb
  v_mfma_f32_32x32x16_bf16 v[48:63], v[216:219], v[132:135], v[48:63]
  ds_read_b64_tr_b16 v[244:245], v9 offset:34816
  ds_read_b64_tr_b16 v[246:247], v9 offset:35840
  s_add_u32 s78, s6, s92
  v_and_b32 v2, s3, v2
  v_cmp_ne_u32 vcc, 0, v2
  v_mfma_f32_32x32x16_bf16 v[64:79], v[220:223], v[132:135], v[64:79]
  buffer_load_dwordx4 v[160:163], v10, s[32:35], s78 offen sc1
  buffer_load_dwordx4 v[164:167], v11, s[32:35], s78 offen sc1
  s_cmp_lg_u64 vcc, 0
  s_cbranch_scc1 L_slow_261
L_cont_262:
  s_waitcnt lgkmcnt(10)
  v_mfma_f32_32x32x16_bf16 v[16:31], v[224:227], v[88:91], v[16:31]
  s_waitcnt vmcnt(13)
  v_xor_b32 v136, v136, v14
  v_xor_b32 v138, v138, v15
  s_waitcnt vmcnt(12)
  v_xor_b32 v140, v140, v14
  v_xor_b32 v142, v142, v15
  s_waitcnt lgkmcnt(8)
  v_mfma_f32_32x32x16_bf16 v[32:47], v[228:231], v[88:91], v[32:47]
  ds_read_b64_tr_b16 v[248:249], v8 offset:49152
  ds_read_b64_tr_b16 v[250:251], v8 offset:50176
  v_bitop3_b32 v2, v136, v138, v136 bitop3:0xf3
  v_bitop3_b32 v2, v140, v142, v2 bitop3:0xfb
  v_mfma_f32_32x32x16_bf16 v[48:63], v[224:227], v[92:95], v[48:63]
  ds_read_b64_tr_b16 v[252:253], v9 offset:49152
  ds_read_b64_tr_b16 v[254:255], v9 offset:50176
  s_add_u32 s78, s6, s93
  v_and_b32 v2, s3, v2
  v_cmp_ne_u32 vcc, 0, v2
  v_mfma_f32_32x32x16_bf16 v[64:79], v[228:231], v[92:95], v[64:79]
  buffer_load_dwordx4 v[120:123], v10, s[32:35], s78 offen sc1
  buffer_load_dwordx4 v[124:127], v11, s[32:35], s78 offen sc1
  s_cmp_lg_u64 vcc, 0
  s_cbranch_scc1 L_slow_265
L_cont_266:
  s_waitcnt lgkmcnt(10)
  v_mfma_f32_32x32x16_bf16 v[16:31], v[232:235], v[136:139], v[16:31]
  s_waitcnt vmcnt(13)
  v_xor_b32 v96, v96, v14
  v_xor_b32 v98, v98, v15
  s_waitcnt vmcnt(12)
  v_xor_b32 v100, v100, v14
  v_xor_b32 v102, v102, v15
  s_waitcnt lgkmcnt(8)
  v_mfma_f32_32x32x16_bf16 v[32:47], v[236:239], v[136:139], v[32:47]
  ds_read_b64_tr_b16 v[184:185], v8 offset:51200
  ds_read_b64_tr_b16 v[186:187], v8 offset:52224
  v_bitop3_b32 v2, v96, v98, v96 bitop3:0xf3
  v_bitop3_b32 v2, v100, v102, v2 bitop3:0xfb
  v_mfma_f32_32x32x16_bf16 v[48:63], v[232:235], v[140:143], v[48:63]
  ds_read_b64_tr_b16 v[188:189], v9 offset:51200
  ds_read_b64_tr_b16 v[190:191], v9 offset:52224
  s_add_u32 s78, s7, s90
  v_and_b32 v2, s3, v2
  v_cmp_ne_u32 vcc, 0, v2
  v_mfma_f32_32x32x16_bf16 v[64:79], v[236:239], v[140:143], v[64:79]
  buffer_load_dwordx4 v[168:171], v10, s[32:35], s78 offen sc1
  buffer_load_dwordx4 v[172:175], v11, s[32:35], s78 offen sc1
  s_cmp_lg_u64 vcc, 0
  s_cbranch_scc1 L_slow_269
L_cont_270:
  s_waitcnt lgkmcnt(10)
  v_mfma_f32_32x32x16_bf16 v[16:31], v[240:243], v[96:99], v[16:31]
  s_waitcnt vmcnt(13)
  v_xor_b32 v144, v144, v14
  v_xor_b32 v146, v146, v15
  s_waitcnt vmcnt(12)
  v_xor_b32 v148, v148, v14
  v_xor_b32 v150, v150, v15
  s_waitcnt lgkmcnt(8)
  v_mfma_f32_32x32x16_bf16 v[32:47], v[244:247], v[96:99], v[32:47]
  ds_read_b64_tr_b16 v[192:193], v8 offset:0
  ds_read_b64_tr_b16 v[194:195], v8 offset:1024
  v_bitop3_b32 v2, v144, v146, v144 bitop3:0xf3
  v_bitop3_b32 v2, v148, v150, v2 bitop3:0xfb
  v_mfma_f32_32x32x16_bf16 v[48:63], v[240:243], v[100:103], v[48:63]
  ds_read_b64_tr_b16 v[196:197], v9 offset:0
  ds_read_b64_tr_b16 v[198:199], v9 offset:1024
  s_add_u32 s78, s7, s91
  v_and_b32 v2, s3, v2
  v_cmp_ne_u32 vcc, 0, v2
  v_mfma_f32_32x32x16_bf16 v[64:79], v[244:247], v[100:103], v[64:79]
  buffer_load_dwordx4 v[80:83], v10, s[32:35], s78 offen sc1
  buffer_load_dwordx4 v[84:87], v11, s[32:35], s78 offen sc1
  s_cmp_lg_u64 vcc, 0
  s_cbranch_scc1 L_slow_273
L_cont_274:
  s_waitcnt lgkmcnt(10)
  v_mfma_f32_32x32x16_bf16 v[16:31], v[248:251], v[144:147], v[16:31]
  s_waitcnt vmcnt(13)
  v_xor_b32 v112, v112, v14
  v_xor_b32 v114, v114, v15
  s_waitcnt vmcnt(12)
  v_xor_b32 v116, v116, v14
  v_xor_b32 v118, v118, v15
  s_waitcnt lgkmcnt(8)
  v_mfma_f32_32x32x16_bf16 v[32:47], v[252:255], v[144:147], v[32:47]
  ds_read_b64_tr_b16 v[200:201], v8 offset:2048
  ds_read_b64_tr_b16 v[202:203], v8 offset:3072
  v_bitop3_b32 v2, v112, v114, v112 bitop3:0xf3
  v_bitop3_b32 v2, v116, v118, v2 bitop3:0xfb
  v_mfma_f32_32x32x16_bf16 v[48:63], v[248:251], v[148:151], v[48:63]
  ds_read_b64_tr_b16 v[204:205], v9 offset:2048
  ds_read_b64_tr_b16 v[206:207], v9 offset:3072
  s_add_u32 s78, s7, s92
  v_and_b32 v2, s3, v2
  v_cmp_ne_u32 vcc, 0, v2
  v_mfma_f32_32x32x16_bf16 v[64:79], v[252:255], v[148:151], v[64:79]
  buffer_load_dwordx4 v[176:179], v10, s[32:35], s78 offen sc1
  buffer_load_dwordx4 v[180:183], v11, s[32:35], s78 offen sc1
  s_cmp_lg_u64 vcc, 0
  s_cbranch_scc1 L_slow_277
L_cont_278:
  s_waitcnt lgkmcnt(10)
  v_mfma_f32_32x32x16_bf16 v[16:31], v[184:187], v[112:115], v[16:31]
  s_waitcnt vmcnt(13)
  v_xor_b32 v152, v152, v14
  v_xor_b32 v154, v154, v15
  s_waitcnt vmcnt(12)
  v_xor_b32 v156, v156, v14
  v_xor_b32 v158, v158, v15
  s_waitcnt lgkmcnt(8)
  v_mfma_f32_32x32x16_bf16 v[32:47], v[188:191], v[112:115], v[32:47]
  ds_read_b64_tr_b16 v[208:209], v8 offset:16384
  ds_read_b64_tr_b16 v[210:211], v8 offset:17408
  v_bitop3_b32 v2, v152, v154, v152 bitop3:0xf3
  v_bitop3_b32 v2, v156, v158, v2 bitop3:0xfb
  v_mfma_f32_32x32x16_bf16 v[48:63], v[184:187], v[116:119], v[48:63]
  ds_read_b64_tr_b16 v[212:213], v9 offset:16384
  ds_read_b64_tr_b16 v[214:215], v9 offset:17408
  s_add_u32 s78, s7, s93
  v_and_b32 v2, s3, v2
  v_cmp_ne_u32 vcc, 0, v2
  v_mfma_f32_32x32x16_bf16 v[64:79], v[188:191], v[116:119], v[64:79]
  buffer_load_dwordx4 v[128:131], v10, s[32:35], s78 offen sc1
  buffer_load_dwordx4 v[132:135], v11, s[32:35], s78 offen sc1
  s_cmp_lg_u64 vcc, 0
  s_cbranch_scc1 L_slow_281
L_cont_282:
  s_waitcnt lgkmcnt(10)
  v_mfma_f32_32x32x16_bf16 v[16:31], v[192:195], v[152:155], v[16:31]
  s_waitcnt vmcnt(13)
  v_xor_b32 v104, v104, v14
  v_xor_b32 v106, v106, v15
  s_waitcnt vmcnt(12)
  v_xor_b32 v108, v108, v14
  v_xor_b32 v110, v110, v15
  s_waitcnt lgkmcnt(8)
  v_mfma_f32_32x32x16_bf16 v[32:47], v[196:199], v[152:155], v[32:47]
  ds_read_b64_tr_b16 v[216:217], v8 offset:18432
  v_bitop3_b32 v2, v104, v106, v104 bitop3:0xf3
  v_bitop3_b32 v2, v108, v110, v2 bitop3:0xfb
  v_mfma_f32_32x32x16_bf16 v[48:63], v[192:195], v[156:159], v[48:63]
  ds_read_b64_tr_b16 v[218:219], v8 offset:19456
  ds_read_b64_tr_b16 v[220:221], v9 offset:18432
  v_and_b32 v2, s3, v2
  v_cmp_ne_u32 vcc, 0, v2
  v_mfma_f32_32x32x16_bf16 v[64:79], v[196:199], v[156:159], v[64:79]
  ds_read_b64_tr_b16 v[222:223], v9 offset:19456
  s_cmp_lg_u64 vcc, 0
  s_cbranch_scc1 L_slow_285
L_cont_286:
  s_waitcnt lgkmcnt(10)
  v_mfma_f32_32x32x16_bf16 v[16:31], v[200:203], v[104:107], v[16:31]
  s_waitcnt vmcnt(11)
  v_xor_b32 v160, v160, v14
  v_xor_b32 v162, v162, v15
  s_waitcnt vmcnt(10)
  v_xor_b32 v164, v164, v14
  v_xor_b32 v166, v166, v15
  s_waitcnt lgkmcnt(8)
  v_mfma_f32_32x32x16_bf16 v[32:47], v[204:207], v[104:107], v[32:47]
  v_add_u32 v8, 65536, v8
  v_add_u32 v9, 65536, v9
  v_bitop3_b32 v2, v160, v162, v160 bitop3:0xf3
  v_bitop3_b32 v2, v164, v166, v2 bitop3:0xfb
  v_mfma_f32_32x32x16_bf16 v[48:63], v[200:203], v[108:111], v[48:63]
  ds_read_b64_tr_b16 v[88:89], v8 offset:32768
  ds_read_b64_tr_b16 v[90:91], v8 offset:33792
  ds_read_b64_tr_b16 v[92:93], v9 offset:32768
  v_and_b32 v2, s3, v2
  v_cmp_ne_u32 vcc, 0, v2
  v_mfma_f32_32x32x16_bf16 v[64:79], v[204:207], v[108:111], v[64:79]
  ds_read_b64_tr_b16 v[94:95], v9 offset:33792
  s_cmp_lg_u64 vcc, 0
  s_cbranch_scc1 L_slow_289
L_cont_290:
  s_waitcnt lgkmcnt(10)
  v_mfma_f32_32x32x16_bf16 v[16:31], v[208:211], v[160:163], v[16:31]
  s_waitcnt vmcnt(9)
  v_xor_b32 v120, v120, v14
  v_xor_b32 v122, v122, v15
  s_waitcnt vmcnt(8)
  v_xor_b32 v124, v124, v14
  v_xor_b32 v126, v126, v15
  s_waitcnt lgkmcnt(8)
  v_mfma_f32_32x32x16_bf16 v[32:47], v[212:215], v[160:163], v[32:47]
  ds_read_b64_tr_b16 v[224:225], v8 offset:34816
  ds_read_b64_tr_b16 v[226:227], v8 offset:35840
  v_bitop3_b32 v2, v120, v122, v120 bitop3:0xf3
  v_bitop3_b32 v2, v124, v126, v2 bitop3:0xfb
  v_mfma_f32_32x32x16_bf16 v[48:63], v[208:211], v[164:167], v[48:63]
  ds_read_b64_tr_b16 v[228:229], v9 offset:34816
  ds_read_b64_tr_b16 v[230:231], v9 offset:35840
  buffer_load_dwordx4 v[136:139], v4, s[28:31], 0 offen
  v_and_b32 v2, s3, v2
  v_cmp_ne_u32 vcc, 0, v2
  v_mfma_f32_32x32x16_bf16 v[64:79], v[212:215], v[164:167], v[64:79]
  buffer_load_dwordx4 v[140:143], v4, s[28:31], 0 offen offset:32
  s_cmp_lg_u64 vcc, 0
  s_cbranch_scc1 L_slow_293
L_cont_294:
  s_waitcnt lgkmcnt(10)
  v_mfma_f32_32x32x16_bf16 v[16:31], v[216:219], v[120:123], v[16:31]
  s_waitcnt vmcnt(9)
  v_xor_b32 v168, v168, v14
  v_xor_b32 v170, v170, v15
  s_waitcnt vmcnt(8)
  v_xor_b32 v172, v172, v14
  v_xor_b32 v174, v174, v15
  s_waitcnt lgkmcnt(8)
  v_mfma_f32_32x32x16_bf16 v[32:47], v[220:223], v[120:123], v[32:47]
  ds_read_b64_tr_b16 v[232:233], v8 offset:49152
  v_bitop3_b32 v2, v168, v170, v168 bitop3:0xf3
  v_bitop3_b32 v2, v172, v174, v2 bitop3:0xfb
  v_mfma_f32_32x32x16_bf16 v[48:63], v[216:219], v[124:127], v[48:63]
  ds_read_b64_tr_b16 v[234:235], v8 offset:50176
  ds_read_b64_tr_b16 v[236:237], v9 offset:49152
  v_and_b32 v2, s3, v2
  v_cmp_ne_u32 vcc, 0, v2
  v_mfma_f32_32x32x16_bf16 v[64:79], v[220:223], v[124:127], v[64:79]
  ds_read_b64_tr_b16 v[238:239], v9 offset:50176
  s_cmp_lg_u64 vcc, 0
  s_cbranch_scc1 L_slow_297
L_cont_298:
  s_waitcnt lgkmcnt(8)
  v_mfma_f32_32x32x16_bf16 v[32:47], v[92:95], v[168:171], v[32:47]
  ds_read_b64_tr_b16 v[96:97], v8 offset:51200
  ds_read_b64_tr_b16 v[98:99], v8 offset:52224
  ds_read_b64_tr_b16 v[100:101], v9 offset:51200
  ds_read_b64_tr_b16 v[102:103], v9 offset:52224
  s_waitcnt vmcnt(7)
  v_xor_b32 v80, v80, v14
  v_xor_b32 v82, v82, v15
  s_waitcnt vmcnt(6)
  v_xor_b32 v84, v84, v14
  v_xor_b32 v86, v86, v15
  v_bitop3_b32 v2, v80, v82, v80 bitop3:0xf3
  v_bitop3_b32 v2, v84, v86, v2 bitop3:0xfb
  v_and_b32 v2, s3, v2
  v_cmp_ne_u32 vcc, 0, v2
  s_nop 0
  s_cmp_lg_u64 vcc, 0
  s_cbranch_scc1 L_slow_301
L_cont_302:
  s_waitcnt lgkmcnt(8)
  v_mfma_f32_32x32x16_bf16 v[32:47], v[228:231], v[80:83], v[32:47]
  s_waitcnt vmcnt(5)
  v_xor_b32 v176, v176, v14
  v_xor_b32 v178, v178, v15
  s_waitcnt vmcnt(4)
  v_xor_b32 v180, v180, v14
  v_xor_b32 v182, v182, v15
  v_bitop3_b32 v2, v176, v178, v176 bitop3:0xf3
  v_bitop3_b32 v2, v180, v182, v2 bitop3:0xfb
  v_and_b32 v2, s3, v2
  v_cmp_ne_u32 vcc, 0, v2
  s_nop 0
  s_cmp_lg_u64 vcc, 0
  s_cbranch_scc1 L_slow_305
L_cont_306:
  s_waitcnt lgkmcnt(4)
  v_mfma_f32_32x32x16_bf16 v[32:47], v[236:239], v[176:179], v[32:47]
  s_waitcnt vmcnt(3)
  v_xor_b32 v128, v128, v14
  v_xor_b32 v130, v130, v15
  s_waitcnt vmcnt(2)
  v_xor_b32 v132, v132, v14
  v_xor_b32 v134, v134, v15
  v_bitop3_b32 v2, v128, v130, v128 bitop3:0xf3
  v_bitop3_b32 v2, v132, v134, v2 bitop3:0xfb
  v_and_b32 v2, s3, v2
  v_cmp_ne_u32 vcc, 0, v2
  s_nop 0
  s_cmp_lg_u64 vcc, 0
  s_cbranch_scc1 L_slow_309
L_cont_310:
  s_waitcnt lgkmcnt(0)
  v_mfma_f32_32x32x16_bf16 v[32:47], v[100:103], v[128:131], v[32:47]
  s_add_u32 s76, s99, 65536
  v_add_u32 v12, s76, v1
  v_mfma_f32_32x32x16_bf16 v[48:63], v[88:91], v[172:175], v[48:63]
  v_mfma_f32_32x32x16_bf16 v[48:63], v[224:227], v[84:87], v[48:63]
  s_nop 7
  ds_write_b128 v12, v[32:35] offset:16384
  v_mfma_f32_32x32x16_bf16 v[48:63], v[232:235], v[180:183], v[48:63]
  ds_write_b128 v12, v[36:39] offset:17408
  ds_write_b128 v12, v[40:43] offset:18432
  v_mfma_f32_32x32x16_bf16 v[48:63], v[96:99], v[132:135], v[48:63]
  ds_write_b128 v12, v[44:47] offset:19456
  v_mfma_f32_32x32x16_bf16 v[64:79], v[92:95], v[172:175], v[64:79]
  v_mfma_f32_32x32x16_bf16 v[64:79], v[228:231], v[84:87], v[64:79]
  s_nop 8
  ds_write_b128 v12, v[48:51] offset:32768
  v_mfma_f32_32x32x16_bf16 v[64:79], v[236:239], v[180:183], v[64:79]
  ds_write_b128 v12, v[52:55] offset:33792
  ds_write_b128 v12, v[56:59] offset:34816
  v_mfma_f32_32x32x16_bf16 v[64:79], v[100:103], v[132:135], v[64:79]
  ds_write_b128 v12, v[60:63] offset:35840
  v_mfma_f32_32x32x16_bf16 v[16:31], v[88:91], v[168:171], v[16:31]
  v_mfma_f32_32x32x16_bf16 v[16:31], v[224:227], v[80:83], v[16:31]
  s_nop 8
  ds_write_b128 v12, v[64:67] offset:49152
  v_mfma_f32_32x32x16_bf16 v[16:31], v[232:235], v[176:179], v[16:31]
  ds_write_b128 v12, v[68:71] offset:50176
  ds_write_b128 v12, v[72:75] offset:51200
  v_mfma_f32_32x32x16_bf16 v[16:31], v[96:99], v[128:131], v[16:31]
  ds_write_b128 v12, v[76:79] offset:52224
  v_xor_b32 v13, 4096, v12
  v_xor_b32 v14, 8192, v12
  v_xor_b32 v15, 12288, v12
  v_bfe_u32 v6, v0, 4, 1
  v_mul_u32_u24 v6, 16352, v6
  v_sub_u32 v6, v4, v6
  s_waitcnt vmcnt(1)
  v_permlane32_swap_b32 v136, v138
  v_permlane32_swap_b32 v137, v139
  s_waitcnt vmcnt(0)
  v_permlane32_swap_b32 v140, v142
  v_permlane32_swap_b32 v141, v143
  v_lshlrev_b32 v2, 16, v136
  v_and_b32 v3, s87, v136
  v_pk_add_f32 v[16:17], v[16:17], v[2:3]
  v_lshlrev_b32 v2, 16, v137
  v_and_b32 v3, s87, v137
  v_pk_add_f32 v[18:19], v[18:19], v[2:3]
  v_lshlrev_b32 v2, 16, v138
  v_and_b32 v3, s87, v138
  v_pk_add_f32 v[20:21], v[20:21], v[2:3]
  v_lshlrev_b32 v2, 16, v139
  v_and_b32 v3, s87, v139
  v_pk_add_f32 v[22:23], v[22:23], v[2:3]
  v_lshlrev_b32 v2, 16, v140
  v_and_b32 v3, s87, v140
  v_pk_add_f32 v[24:25], v[24:25], v[2:3]
  v_lshlrev_b32 v2, 16, v141
  v_and_b32 v3, s87, v141
  v_pk_add_f32 v[26:27], v[26:27], v[2:3]
  v_lshlrev_b32 v2, 16, v142
  v_and_b32 v3, s87, v142
  v_pk_add_f32 v[28:29], v[28:29], v[2:3]
  v_lshlrev_b32 v2, 16, v143
  v_and_b32 v3, s87, v143
  v_pk_add_f32 v[30:31], v[30:31], v[2:3]
  s_waitcnt lgkmcnt(0)
  s_barrier
  ds_read_b128 v[32:35], v13 offset:16384
  ds_read_b128 v[36:39], v13 offset:17408
  ds_read_b128 v[40:43], v13 offset:18432
  ds_read_b128 v[44:47], v13 offset:19456
  ds_read_b128 v[48:51], v14 offset:32768
  ds_read_b128 v[52:55], v14 offset:33792
  ds_read_b128 v[56:59], v14 offset:34816
  ds_read_b128 v[60:63], v14 offset:35840
  ds_read_b128 v[64:67], v15 offset:49152
  ds_read_b128 v[68:71], v15 offset:50176
  ds_read_b128 v[72:75], v15 offset:51200
  ds_read_b128 v[76:79], v15 offset:52224
  s_waitcnt lgkmcnt(11)
  v_pk_add_f32 v[16:17], v[16:17], v[32:33]
  v_pk_add_f32 v[18:19], v[18:19], v[34:35]
  s_waitcnt lgkmcnt(10)
  v_pk_add_f32 v[20:21], v[20:21], v[36:37]
  v_pk_add_f32 v[22:23], v[22:23], v[38:39]
  s_waitcnt lgkmcnt(9)
  v_pk_add_f32 v[24:25], v[24:25], v[40:41]
  v_pk_add_f32 v[26:27], v[26:27], v[42:43]
  s_waitcnt lgkmcnt(8)
  v_pk_add_f32 v[28:29], v[28:29], v[44:45]
  v_pk_add_f32 v[30:31], v[30:31], v[46:47]
  s_waitcnt lgkmcnt(7)
  v_pk_add_f32 v[16:17], v[16:17], v[48:49]
  v_pk_add_f32 v[18:19], v[18:19], v[50:51]
  s_waitcnt lgkmcnt(6)
  v_pk_add_f32 v[20:21], v[20:21], v[52:53]
  v_pk_add_f32 v[22:23], v[22:23], v[54:55]
  s_waitcnt lgkmcnt(5)
  v_pk_add_f32 v[24:25], v[24:25], v[56:57]
  v_pk_add_f32 v[26:27], v[26:27], v[58:59]
  s_waitcnt lgkmcnt(4)
  v_pk_add_f32 v[28:29], v[28:29], v[60:61]
  v_pk_add_f32 v[30:31], v[30:31], v[62:63]
  s_waitcnt lgkmcnt(3)
  v_pk_add_f32 v[16:17], v[16:17], v[64:65]
  v_pk_add_f32 v[18:19], v[18:19], v[66:67]
  s_waitcnt lgkmcnt(2)
  v_pk_add_f32 v[20:21], v[20:21], v[68:69]
  v_pk_add_f32 v[22:23], v[22:23], v[70:71]
  s_waitcnt lgkmcnt(1)
  v_pk_add_f32 v[24:25], v[24:25], v[72:73]
  v_pk_add_f32 v[26:27], v[26:27], v[74:75]
  s_waitcnt lgkmcnt(0)
  v_pk_add_f32 v[28:29], v[28:29], v[76:77]
  v_pk_add_f32 v[30:31], v[30:31], v[78:79]
  v_cvt_pk_bf16_f32 v16, v16, v17
  v_cvt_pk_bf16_f32 v17, v18, v19
  v_cvt_pk_bf16_f32 v18, v20, v21
  v_cvt_pk_bf16_f32 v19, v22, v23
  v_cvt_pk_bf16_f32 v20, v24, v25
  v_cvt_pk_bf16_f32 v21, v26, v27
  v_cvt_pk_bf16_f32 v22, v28, v29
  v_cvt_pk_bf16_f32 v23, v30, v31
  v_permlane32_swap_b32 v16, v18
  v_permlane32_swap_b32 v17, v19
  v_permlane32_swap_b32 v20, v22
  v_permlane32_swap_b32 v21, v23
  s_nop 0
  v_permlane16_swap_b32 v16, v20
  v_permlane16_swap_b32 v17, v21
  v_permlane16_swap_b32 v18, v22
  v_permlane16_swap_b32 v19, v23
  s_mov_b32 s76, 16384
  buffer_store_dwordx4 v[16:19], v6, s[64:67], 0 offen sc1
  buffer_store_dwordx4 v[20:23], v6, s[64:67], s76 offen sc1
  s_endpgm
L_slow_167:
  s_mov_b32 s86, 65536
L_sp_169:
  s_sleep 1
  s_add_u32 s78, s4, s90
  buffer_load_dwordx4 v[96:99], v10, s[32:35], s78 offen sc1
  buffer_load_dwordx4 v[100:103], v11, s[32:35], s78 offen sc1
  s_waitcnt vmcnt(0)
  v_xor_b32 v96, v96, v14
  v_xor_b32 v98, v98, v15
  v_xor_b32 v100, v100, v14
  v_xor_b32 v102, v102, v15
  v_bitop3_b32 v2, v96, v98, v96 bitop3:0xf3
  v_bitop3_b32 v2, v100, v102, v2 bitop3:0xfb
  v_and_b32 v2, s3, v2
  v_cmp_ne_u32 vcc, 0, v2
  s_nop 1
  s_cmp_lg_u64 vcc, 0
  s_cbranch_scc0 L_sd_170
  s_sub_u32 s86, s86, 1
  s_cbranch_scc0 L_sp_169
L_sd_170:
  s_add_u32 s78, s4, s91
  buffer_load_dwordx4 v[104:107], v10, s[32:35], s78 offen sc1
  buffer_load_dwordx4 v[108:111], v11, s[32:35], s78 offen sc1
  s_add_u32 s78, s4, s92
  buffer_load_dwordx4 v[80:83], v10, s[32:35], s78 offen sc1
  buffer_load_dwordx4 v[84:87], v11, s[32:35], s78 offen sc1
  s_add_u32 s78, s4, s93
  buffer_load_dwordx4 v[88:91], v10, s[32:35], s78 offen sc1
  buffer_load_dwordx4 v[92:95], v11, s[32:35], s78 offen sc1
  s_waitcnt vmcnt(0)
  s_branch L_cont_168
L_slow_171:
  s_mov_b32 s86, 65536
L_sp_173:
  s_sleep 1
  s_add_u32 s78, s4, s91
  buffer_load_dwordx4 v[104:107], v10, s[32:35], s78 offen sc1
  buffer_load_dwordx4 v[108:111], v11, s[32:35], s78 offen sc1
  s_waitcnt vmcnt(0)
  v_xor_b32 v104, v104, v14
  v_xor_b32 v106, v106, v15
  v_xor_b32 v108, v108, v14
  v_xor_b32 v110, v110, v15
  v_bitop3_b32 v2, v104, v106, v104 bitop3:0xf3
  v_bitop3_b32 v2, v108, v110, v2 bitop3:0xfb
  v_and_b32 v2, s3, v2
  v_cmp_ne_u32 vcc, 0, v2
  s_nop 1
  s_cmp_lg_u64 vcc, 0
  s_cbranch_scc0 L_sd_174
  s_sub_u32 s86, s86, 1
  s_cbranch_scc0 L_sp_173
L_sd_174:
  s_add_u32 s78, s4, s92
  buffer_load_dwordx4 v[80:83], v10, s[32:35], s78 offen sc1
  buffer_load_dwordx4 v[84:87], v11, s[32:35], s78 offen sc1
  s_add_u32 s78, s4, s93
  buffer_load_dwordx4 v[88:91], v10, s[32:35], s78 offen sc1
  buffer_load_dwordx4 v[92:95], v11, s[32:35], s78 offen sc1
  s_waitcnt vmcnt(0)
  s_branch L_cont_172
L_slow_175:
  s_mov_b32 s86, 65536
L_sp_177:
  s_sleep 1
  s_add_u32 s78, s4, s92
  buffer_load_dwordx4 v[80:83], v10, s[32:35], s78 offen sc1
  buffer_load_dwordx4 v[84:87], v11, s[32:35], s78 offen sc1
  s_waitcnt vmcnt(0)
  v_xor_b32 v80, v80, v14
  v_xor_b32 v82, v82, v15
  v_xor_b32 v84, v84, v14
  v_xor_b32 v86, v86, v15
  v_bitop3_b32 v2, v80, v82, v80 bitop3:0xf3
  v_bitop3_b32 v2, v84, v86, v2 bitop3:0xfb
  v_and_b32 v2, s3, v2
  v_cmp_ne_u32 vcc, 0, v2
  s_nop 1
  s_cmp_lg_u64 vcc, 0
  s_cbranch_scc0 L_sd_178
  s_sub_u32 s86, s86, 1
  s_cbranch_scc0 L_sp_177
L_sd_178:
  s_add_u32 s78, s4, s93
  buffer_load_dwordx4 v[88:91], v10, s[32:35], s78 offen sc1
  buffer_load_dwordx4 v[92:95], v11, s[32:35], s78 offen sc1
  s_add_u32 s78, s5, s90
  buffer_load_dwordx4 v[96:99], v10, s[32:35], s78 offen sc1
  buffer_load_dwordx4 v[100:103], v11, s[32:35], s78 offen sc1
  s_waitcnt vmcnt(0)
  s_branch L_cont_176
L_slow_179:
  s_mov_b32 s86, 65536
L_sp_181:
  s_sleep 1
  s_add_u32 s78, s4, s93
  buffer_load_dwordx4 v[88:91], v10, s[32:35], s78 offen sc1
  buffer_load_dwordx4 v[92:95], v11, s[32:35], s78 offen sc1
  s_waitcnt vmcnt(0)
  v_xor_b32 v88, v88, v14
  v_xor_b32 v90, v90, v15
  v_xor_b32 v92, v92, v14
  v_xor_b32 v94, v94, v15
  v_bitop3_b32 v2, v88, v90, v88 bitop3:0xf3
  v_bitop3_b32 v2, v92, v94, v2 bitop3:0xfb
  v_and_b32 v2, s3, v2
  v_cmp_ne_u32 vcc, 0, v2
  s_nop 1
  s_cmp_lg_u64 vcc, 0
  s_cbranch_scc0 L_sd_182
  s_sub_u32 s86, s86, 1
  s_cbranch_scc0 L_sp_181
L_sd_182:
  s_add_u32 s78, s5, s90
  buffer_load_dwordx4 v[96:99], v10, s[32:35], s78 offen sc1
  buffer_load_dwordx4 v[100:103], v11, s[32:35], s78 offen sc1
  s_add_u32 s78, s5, s91
  buffer_load_dwordx4 v[112:115], v10, s[32:35], s78 offen sc1
  buffer_load_dwordx4 v[116:119], v11, s[32:35], s78 offen sc1
  s_add_u32 s78, s5, s92
  buffer_load_dwordx4 v[104:107], v10, s[32:35], s78 offen sc1
  buffer_load_dwordx4 v[108:111], v11, s[32:35], s78 offen sc1
  s_waitcnt vmcnt(0)
  s_branch L_cont_180
L_slow_183:
  s_mov_b32 s86, 65536
L_sp_185:
  s_sleep 1
  s_add_u32 s78, s5, s90
  buffer_load_dwordx4 v[96:99], v10, s[32:35], s78 offen sc1
  buffer_load_dwordx4 v[100:103], v11, s[32:35], s78 offen sc1
  s_waitcnt vmcnt(0)
  v_xor_b32 v96, v96, v14
  v_xor_b32 v98, v98, v15
  v_xor_b32 v100, v100, v14
  v_xor_b32 v102, v102, v15
  v_bitop3_b32 v2, v96, v98, v96 bitop3:0xf3
  v_bitop3_b32 v2, v100, v102, v2 bitop3:0xfb
  v_and_b32 v2, s3, v2
  v_cmp_ne_u32 vcc, 0, v2
  s_nop 1
  s_cmp_lg_u64 vcc, 0
  s_cbranch_scc0 L_sd_186
  s_sub_u32 s86, s86, 1
  s_cbranch_scc0 L_sp_185
L_sd_186:
  s_add_u32 s78, s6, s92
  s_add_u32 m0, s99, 16384
  s_lshl_b32 s78, s78, 4
  buffer_load_dwordx4 v6, s[52:55], s78 offen offset:0 lds
  buffer_load_dwordx4 v7, s[52:55], s78 offen offset:1024 lds
  s_add_u32 s78, s5, s91
  buffer_load_dwordx4 v[112:115], v10, s[32:35], s78 offen sc1
  buffer_load_dwordx4 v[116:119], v11, s[32:35], s78 offen sc1
  s_add_u32 s78, s5, s92
  buffer_load_dwordx4 v[104:107], v10, s[32:35], s78 offen sc1
  buffer_load_dwordx4 v[108:111], v11, s[32:35], s78 offen sc1
  s_add_u32 s78, s6, s93
  s_add_u32 m0, s99, 18432
  s_lshl_b32 s78, s78, 4
  buffer_load_dwordx4 v6, s[52:55], s78 offen offset:0 lds
  buffer_load_dwordx4 v7, s[52:55], s78 offen offset:1024 lds
  s_add_u32 s78, s5, s93
  buffer_load_dwordx4 v[120:123], v10, s[32:35], s78 offen sc1
  buffer_load_dwordx4 v[124:127], v11, s[32:35], s78 offen sc1
  s_add_u32 s78, s8, s90
  buffer_load_dwordx4 v[80:83], v10, s[32:35], s78 offen sc1
  buffer_load_dwordx4 v[84:87], v11, s[32:35], s78 offen sc1
  s_waitcnt vmcnt(6)
  s_branch L_cont_184
L_slow_187:
  s_mov_b32 s86, 65536
L_sp_189:
  s_sleep 1
  s_add_u32 s78, s5, s91
  buffer_load_dwordx4 v[112:115], v10, s[32:35], s78 offen sc1
  buffer_load_dwordx4 v[116:119], v11, s[32:35], s78 offen sc1
  s_waitcnt vmcnt(0)
  v_xor_b32 v112, v112, v14
  v_xor_b32 v114, v114, v15
  v_xor_b32 v116, v116, v14
  v_xor_b32 v118, v118, v15
  v_bitop3_b32 v2, v112, v114, v112 bitop3:0xf3
  v_bitop3_b32 v2, v116, v118, v2 bitop3:0xfb
  v_and_b32 v2, s3, v2
  v_cmp_ne_u32 vcc, 0, v2
  s_nop 1
  s_cmp_lg_u64 vcc, 0
  s_cbranch_scc0 L_sd_190
  s_sub_u32 s86, s86, 1
  s_cbranch_scc0 L_sp_189
L_sd_190:
  s_add_u32 s78, s5, s92
  buffer_load_dwordx4 v[104:107], v10, s[32:35], s78 offen sc1
  buffer_load_dwordx4 v[108:111], v11, s[32:35], s78 offen sc1
  s_add_u32 s78, s6, s93
  s_add_u32 m0, s99, 18432
  s_lshl_b32 s78, s78, 4
  buffer_load_dwordx4 v6, s[52:55], s78 offen offset:0 lds
  buffer_load_dwordx4 v7, s[52:55], s78 offen offset:1024 lds
  s_add_u32 s78, s5, s93
  buffer_load_dwordx4 v[120:123], v10, s[32:35], s78 offen sc1
  buffer_load_dwordx4 v[124:127], v11, s[32:35], s78 offen sc1
  s_add_u32 s78, s8, s90
  buffer_load_dwordx4 v[80:83], v10, s[32:35], s78 offen sc1
  buffer_load_dwordx4 v[84:87], v11, s[32:35], s78 offen sc1
  s_add_u32 s78, s8, s91
  buffer_load_dwordx4 v[128:131], v10, s[32:35], s78 offen sc1
  buffer_load_dwordx4 v[132:135], v11, s[32:35], s78 offen sc1
  s_add_u32 s78, s8, s92
  buffer_load_dwordx4 v[88:91], v10, s[32:35], s78 offen sc1
  buffer_load_dwordx4 v[92:95], v11, s[32:35], s78 offen sc1
  s_waitcnt vmcnt(6)
  s_branch L_cont_188
L_slow_191:
  s_mov_b32 s86, 65536
L_sp_193:
  s_sleep 1
  s_add_u32 s78, s5, s92
  buffer_load_dwordx4 v[104:107], v10, s[32:35], s78 offen sc1
  buffer_load_dwordx4 v[108:111], v11, s[32:35], s78 offen sc1
  s_waitcnt vmcnt(0)
  v_xor_b32 v104, v104, v14
  v_xor_b32 v106, v106, v15
  v_xor_b32 v108, v108, v14
  v_xor_b32 v110, v110, v15
  v_bitop3_b32 v2, v104, v106, v104 bitop3:0xf3
  v_bitop3_b32 v2, v108, v110, v2 bitop3:0xfb
  v_and_b32 v2, s3, v2
  v_cmp_ne_u32 vcc, 0, v2
  s_nop 1
  s_cmp_lg_u64 vcc, 0
  s_cbranch_scc0 L_sd_194
  s_sub_u32 s86, s86, 1
  s_cbranch_scc0 L_sp_193
L_sd_194:
  s_add_u32 s78, s6, s93
  s_add_u32 m0, s99, 18432
  s_lshl_b32 s78, s78, 4
  buffer_load_dwordx4 v6, s[52:55], s78 offen offset:0 lds
  buffer_load_dwordx4 v7, s[52:55], s78 offen offset:1024 lds
  s_add_u32 s78, s5, s93
  buffer_load_dwordx4 v[120:123], v10, s[32:35], s78 offen sc1
  buffer_load_dwordx4 v[124:127], v11, s[32:35], s78 offen sc1
  s_add_u32 s78, s8, s90
  buffer_load_dwordx4 v[80:83], v10, s[32:35], s78 offen sc1
  buffer_load_dwordx4 v[84:87], v11, s[32:35], s78 offen sc1
  s_add_u32 s78, s8, s91
  buffer_load_dwordx4 v[128:131], v10, s[32:35], s78 offen sc1
  buffer_load_dwordx4 v[132:135], v11, s[32:35], s78 offen sc1
  s_add_u32 s78, s8, s92
  buffer_load_dwordx4 v[88:91], v10, s[32:35], s78 offen sc1
  buffer_load_dwordx4 v[92:95], v11, s[32:35], s78 offen sc1
  s_add_u32 s78, s8, s93
  buffer_load_dwordx4 v[136:139], v10, s[32:35], s78 offen sc1
  buffer_load_dwordx4 v[140:143], v11, s[32:35], s78 offen sc1
  s_add_u32 s78, s9, s90
  buffer_load_dwordx4 v[96:99], v10, s[32:35], s78 offen sc1
  buffer_load_dwordx4 v[100:103], v11, s[32:35], s78 offen sc1
  s_waitcnt vmcnt(6)
  s_branch L_cont_192
L_slow_197:
  s_mov_b32 s86, 65536
L_sp_199:
  s_sleep 1
  s_add_u32 s78, s5, s93
  buffer_load_dwordx4 v[120:123], v10, s[32:35], s78 offen sc1
  buffer_load_dwordx4 v[124:127], v11, s[32:35], s78 offen sc1
  s_waitcnt vmcnt(0)
  v_xor_b32 v120, v120, v14
  v_xor_b32 v122, v122, v15
  v_xor_b32 v124, v124, v14
  v_xor_b32 v126, v126, v15
  v_bitop3_b32 v2, v120, v122, v120 bitop3:0xf3
  v_bitop3_b32 v2, v124, v126, v2 bitop3:0xfb
  v_and_b32 v2, s3, v2
  v_cmp_ne_u32 vcc, 0, v2
  s_nop 1
  s_cmp_lg_u64 vcc, 0
  s_cbranch_scc0 L_sd_200
  s_sub_u32 s86, s86, 1
  s_cbranch_scc0 L_sp_199
L_sd_200:
  s_add_u32 s78, s8, s90
  buffer_load_dwordx4 v[80:83], v10, s[32:35], s78 offen sc1
  buffer_load_dwordx4 v[84:87], v11, s[32:35], s78 offen sc1
  s_add_u32 s78, s8, s91
  buffer_load_dwordx4 v[128:131], v10, s[32:35], s78 offen sc1
  buffer_load_dwordx4 v[132:135], v11, s[32:35], s78 offen sc1
  s_add_u32 s78, s8, s92
  buffer_load_dwordx4 v[88:91], v10, s[32:35], s78 offen sc1
  buffer_load_dwordx4 v[92:95], v11, s[32:35], s78 offen sc1
  s_add_u32 s78, s8, s93
  buffer_load_dwordx4 v[136:139], v10, s[32:35], s78 offen sc1
  buffer_load_dwordx4 v[140:143], v11, s[32:35], s78 offen sc1
  s_add_u32 s78, s9, s90
  buffer_load_dwordx4 v[96:99], v10, s[32:35], s78 offen sc1
  buffer_load_dwordx4 v[100:103], v11, s[32:35], s78 offen sc1
  s_add_u32 s78, s9, s91
  buffer_load_dwordx4 v[144:147], v10, s[32:35], s78 offen sc1
  buffer_load_dwordx4 v[148:151], v11, s[32:35], s78 offen sc1
  s_add_u32 s78, s9, s92
  buffer_load_dwordx4 v[112:115], v10, s[32:35], s78 offen sc1
  buffer_load_dwordx4 v[116:119], v11, s[32:35], s78 offen sc1
  s_waitcnt vmcnt(10)
  s_branch L_cont_198
L_slow_201:
  s_mov_b32 s86, 65536
L_sp_203:
  s_sleep 1
  s_add_u32 s78, s8, s90
  buffer_load_dwordx4 v[80:83], v10, s[32:35], s78 offen sc1
  buffer_load_dwordx4 v[84:87], v11, s[32:35], s78 offen sc1
  s_waitcnt vmcnt(0)
  v_xor_b32 v80, v80, v14
  v_xor_b32 v82, v82, v15
  v_xor_b32 v84, v84, v14
  v_xor_b32 v86, v86, v15
  v_bitop3_b32 v2, v80, v82, v80 bitop3:0xf3
  v_bitop3_b32 v2, v84, v86, v2 bitop3:0xfb
  v_and_b32 v2, s3, v2
  v_cmp_ne_u32 vcc, 0, v2
  s_nop 1
  s_cmp_lg_u64 vcc, 0
  s_cbranch_scc0 L_sd_204
  s_sub_u32 s86, s86, 1
  s_cbranch_scc0 L_sp_203
L_sd_204:
  s_add_u32 s78, s8, s91
  buffer_load_dwordx4 v[128:131], v10, s[32:35], s78 offen sc1
  buffer_load_dwordx4 v[132:135], v11, s[32:35], s78 offen sc1
  s_add_u32 s78, s8, s92
  buffer_load_dwordx4 v[88:91], v10, s[32:35], s78 offen sc1
  buffer_load_dwordx4 v[92:95], v11, s[32:35], s78 offen sc1
  s_add_u32 s78, s8, s93
  buffer_load_dwordx4 v[136:139], v10, s[32:35], s78 offen sc1
  buffer_load_dwordx4 v[140:143], v11, s[32:35], s78 offen sc1
  s_add_u32 s78, s9, s90
  buffer_load_dwordx4 v[96:99], v10, s[32:35], s78 offen sc1
  buffer_load_dwordx4 v[100:103], v11, s[32:35], s78 offen sc1
  s_add_u32 s78, s9, s91
  buffer_load_dwordx4 v[144:147], v10, s[32:35], s78 offen sc1
  buffer_load_dwordx4 v[148:151], v11, s[32:35], s78 offen sc1
  s_add_u32 s78, s9, s92
  buffer_load_dwordx4 v[112:115], v10, s[32:35], s78 offen sc1
  buffer_load_dwordx4 v[116:119], v11, s[32:35], s78 offen sc1
  s_add_u32 s78, s9, s93
  buffer_load_dwordx4 v[152:155], v10, s[32:35], s78 offen sc1
  buffer_load_dwordx4 v[156:159], v11, s[32:35], s78 offen sc1
  s_add_u32 s78, s7, s90
  s_add_u32 m0, s99, 98304
  s_lshl_b32 s78, s78, 4
  buffer_load_dwordx4 v6, s[52:55], s78 offen offset:0 lds
  buffer_load_dwordx4 v7, s[52:55], s78 offen offset:1024 lds
  s_waitcnt vmcnt(14)
  s_branch L_cont_202
L_slow_205:
  s_mov_b32 s86, 65536
L_sp_207:
  s_sleep 1
  s_add_u32 s78, s8, s91
  buffer_load_dwordx4 v[128:131], v10, s[32:35], s78 offen sc1
  buffer_load_dwordx4 v[132:135], v11, s[32:35], s78 offen sc1
  s_waitcnt vmcnt(0)
  v_xor_b32 v128, v128, v14
  v_xor_b32 v130, v130, v15
  v_xor_b32 v132, v132, v14
  v_xor_b32 v134, v134, v15
  v_bitop3_b32 v2, v128, v130, v128 bitop3:0xf3
  v_bitop3_b32 v2, v132, v134, v2 bitop3:0xfb
  v_and_b32 v2, s3, v2
  v_cmp_ne_u32 vcc, 0, v2
  s_nop 1
  s_cmp_lg_u64 vcc, 0
  s_cbranch_scc0 L_sd_208
  s_sub_u32 s86, s86, 1
  s_cbranch_scc0 L_sp_207
L_sd_208:
  s_add_u32 s78, s8, s92
  buffer_load_dwordx4 v[88:91], v10, s[32:35], s78 offen sc1
  buffer_load_dwordx4 v[92:95], v11, s[32:35], s78 offen sc1
  s_add_u32 s78, s8, s93
  buffer_load_dwordx4 v[136:139], v10, s[32:35], s78 offen sc1
  buffer_load_dwordx4 v[140:143], v11, s[32:35], s78 offen sc1
  s_add_u32 s78, s9, s90
  buffer_load_dwordx4 v[96:99], v10, s[32:35], s78 offen sc1
  buffer_load_dwordx4 v[100:103], v11, s[32:35], s78 offen sc1
  s_add_u32 s78, s9, s91
  buffer_load_dwordx4 v[144:147], v10, s[32:35], s78 offen sc1
  buffer_load_dwordx4 v[148:151], v11, s[32:35], s78 offen sc1
  s_add_u32 s78, s9, s92
  buffer_load_dwordx4 v[112:115], v10, s[32:35], s78 offen sc1
  buffer_load_dwordx4 v[116:119], v11, s[32:35], s78 offen sc1
  s_add_u32 s78, s9, s93
  buffer_load_dwordx4 v[152:155], v10, s[32:35], s78 offen sc1
  buffer_load_dwordx4 v[156:159], v11, s[32:35], s78 offen sc1
  s_add_u32 s78, s7, s90
  s_add_u32 m0, s99, 98304
  s_lshl_b32 s78, s78, 4
  buffer_load_dwordx4 v6, s[52:55], s78 offen offset:0 lds
  buffer_load_dwordx4 v7, s[52:55], s78 offen offset:1024 lds
  s_add_u32 s78, s12, s90
  s_add_u32 s78, s78, 114688
  buffer_load_dwordx4 v[104:107], v10, s[32:35], s78 offen sc1
  buffer_load_dwordx4 v[108:111], v11, s[32:35], s78 offen sc1
  s_add_u32 s78, s7, s91
  s_add_u32 m0, s99, 100352
  s_lshl_b32 s78, s78, 4
  buffer_load_dwordx4 v6, s[52:55], s78 offen offset:0 lds
  buffer_load_dwordx4 v7, s[52:55], s78 offen offset:1024 lds
  s_waitcnt vmcnt(18)
  s_branch L_cont_206
L_slow_209:
  s_mov_b32 s86, 65536
L_sp_211:
  s_sleep 1
  s_add_u32 s78, s8, s92
  buffer_load_dwordx4 v[88:91], v10, s[32:35], s78 offen sc1
  buffer_load_dwordx4 v[92:95], v11, s[32:35], s78 offen sc1
  s_waitcnt vmcnt(0)
  v_xor_b32 v88, v88, v14
  v_xor_b32 v90, v90, v15
  v_xor_b32 v92, v92, v14
  v_xor_b32 v94, v94, v15
  v_bitop3_b32 v2, v88, v90, v88 bitop3:0xf3
  v_bitop3_b32 v2, v92, v94, v2 bitop3:0xfb
  v_and_b32 v2, s3, v2
  v_cmp_ne_u32 vcc, 0, v2
  s_nop 1
  s_cmp_lg_u64 vcc, 0
  s_cbranch_scc0 L_sd_212
  s_sub_u32 s86, s86, 1
  s_cbranch_scc0 L_sp_211
L_sd_212:
  s_add_u32 s78, s8, s93
  buffer_load_dwordx4 v[136:139], v10, s[32:35], s78 offen sc1
  buffer_load_dwordx4 v[140:143], v11, s[32:35], s78 offen sc1
  s_add_u32 s78, s9, s90
  buffer_load_dwordx4 v[96:99], v10, s[32:35], s78 offen sc1
  buffer_load_dwordx4 v[100:103], v11, s[32:35], s78 offen sc1
  s_add_u32 s78, s9, s91
  buffer_load_dwordx4 v[144:147], v10, s[32:35], s78 offen sc1
  buffer_load_dwordx4 v[148:151], v11, s[32:35], s78 offen sc1
  s_add_u32 s78, s9, s92
  buffer_load_dwordx4 v[112:115], v10, s[32:35], s78 offen sc1
  buffer_load_dwordx4 v[116:119], v11, s[32:35], s78 offen sc1
  s_add_u32 s78, s9, s93
  buffer_load_dwordx4 v[152:155], v10, s[32:35], s78 offen sc1
  buffer_load_dwordx4 v[156:159], v11, s[32:35], s78 offen sc1
  s_add_u32 s78, s7, s90
  s_add_u32 m0, s99, 98304
  s_lshl_b32 s78, s78, 4
  buffer_load_dwordx4 v6, s[52:55], s78 offen offset:0 lds
  buffer_load_dwordx4 v7, s[52:55], s78 offen offset:1024 lds
  s_add_u32 s78, s12, s90
  s_add_u32 s78, s78, 114688
  buffer_load_dwordx4 v[104:107], v10, s[32:35], s78 offen sc1
  buffer_load_dwordx4 v[108:111], v11, s[32:35], s78 offen sc1
  s_add_u32 s78, s7, s91
  s_add_u32 m0, s99, 100352
  s_lshl_b32 s78, s78, 4
  buffer_load_dwordx4 v6, s[52:55], s78 offen offset:0 lds
  buffer_load_dwordx4 v7, s[52:55], s78 offen offset:1024 lds
  s_add_u32 s78, s12, s91
  s_add_u32 s78, s78, 114688
  buffer_load_dwordx4 v[160:163], v10, s[32:35], s78 offen sc1
  buffer_load_dwordx4 v[164:167], v11, s[32:35], s78 offen sc1
  s_add_u32 s78, s7, s92
  s_add_u32 m0, s99, 114688
  s_lshl_b32 s78, s78, 4
  buffer_load_dwordx4 v6, s[52:55], s78 offen offset:0 lds
  buffer_load_dwordx4 v7, s[52:55], s78 offen offset:1024 lds
  s_waitcnt vmcnt(20)
  s_branch L_cont_210
L_slow_213:
  s_mov_b32 s86, 65536
L_sp_215:
  s_sleep 1
  s_add_u32 s78, s8, s93
  buffer_load_dwordx4 v[136:139], v10, s[32:35], s78 offen sc1
  buffer_load_dwordx4 v[140:143], v11, s[32:35], s78 offen sc1
  s_waitcnt vmcnt(0)
  v_xor_b32 v136, v136, v14
  v_xor_b32 v138, v138, v15
  v_xor_b32 v140, v140, v14
  v_xor_b32 v142, v142, v15
  v_bitop3_b32 v2, v136, v138, v136 bitop3:0xf3
  v_bitop3_b32 v2, v140, v142, v2 bitop3:0xfb
  v_and_b32 v2, s3, v2
  v_cmp_ne_u32 vcc, 0, v2
  s_nop 1
  s_cmp_lg_u64 vcc, 0
  s_cbranch_scc0 L_sd_216
  s_sub_u32 s86, s86, 1
  s_cbranch_scc0 L_sp_215
L_sd_216:
  s_add_u32 s78, s9, s90
  buffer_load_dwordx4 v[96:99], v10, s[32:35], s78 offen sc1
  buffer_load_dwordx4 v[100:103], v11, s[32:35], s78 offen sc1
  s_add_u32 s78, s9, s91
  buffer_load_dwordx4 v[144:147], v10, s[32:35], s78 offen sc1
  buffer_load_dwordx4 v[148:151], v11, s[32:35], s78 offen sc1
  s_add_u32 s78, s9, s92
  buffer_load_dwordx4 v[112:115], v10, s[32:35], s78 offen sc1
  buffer_load_dwordx4 v[116:119], v11, s[32:35], s78 offen sc1
  s_add_u32 s78, s9, s93
  buffer_load_dwordx4 v[152:155], v10, s[32:35], s78 offen sc1
  buffer_load_dwordx4 v[156:159], v11, s[32:35], s78 offen sc1
  s_add_u32 s78, s7, s90
  s_add_u32 m0, s99, 98304
  s_lshl_b32 s78, s78, 4
  buffer_load_dwordx4 v6, s[52:55], s78 offen offset:0 lds
  buffer_load_dwordx4 v7, s[52:55], s78 offen offset:1024 lds
  s_add_u32 s78, s12, s90
  s_add_u32 s78, s78, 114688
  buffer_load_dwordx4 v[104:107], v10, s[32:35], s78 offen sc1
  buffer_load_dwordx4 v[108:111], v11, s[32:35], s78 offen sc1
  s_add_u32 s78, s7, s91
  s_add_u32 m0, s99, 100352
  s_lshl_b32 s78, s78, 4
  buffer_load_dwordx4 v6, s[52:55], s78 offen offset:0 lds
  buffer_load_dwordx4 v7, s[52:55], s78 offen offset:1024 lds
  s_add_u32 s78, s12, s91
  s_add_u32 s78, s78, 114688
  buffer_load_dwordx4 v[160:163], v10, s[32:35], s78 offen sc1
  buffer_load_dwordx4 v[164:167], v11, s[32:35], s78 offen sc1
  s_add_u32 s78, s7, s92
  s_add_u32 m0, s99, 114688
  s_lshl_b32 s78, s78, 4
  buffer_load_dwordx4 v6, s[52:55], s78 offen offset:0 lds
  buffer_load_dwordx4 v7, s[52:55], s78 offen offset:1024 lds
  s_add_u32 s78, s12, s92
  s_add_u32 s78, s78, 114688
  buffer_load_dwordx4 v[120:123], v10, s[32:35], s78 offen sc1
  buffer_load_dwordx4 v[124:127], v11, s[32:35], s78 offen sc1
  s_add_u32 s78, s7, s93
  s_add_u32 m0, s99, 116736
  s_lshl_b32 s78, s78, 4
  buffer_load_dwordx4 v6, s[52:55], s78 offen offset:0 lds
  buffer_load_dwordx4 v7, s[52:55], s78 offen offset:1024 lds
  s_waitcnt vmcnt(22)
  s_branch L_cont_214
L_slow_217:
  s_mov_b32 s86, 65536
L_sp_219:
  s_sleep 1
  s_add_u32 s78, s9, s90
  buffer_load_dwordx4 v[96:99], v10, s[32:35], s78 offen sc1
  buffer_load_dwordx4 v[100:103], v11, s[32:35], s78 offen sc1
  s_waitcnt vmcnt(0)
  v_xor_b32 v96, v96, v14
  v_xor_b32 v98, v98, v15
  v_xor_b32 v100, v100, v14
  v_xor_b32 v102, v102, v15
  v_bitop3_b32 v2, v96, v98, v96 bitop3:0xf3
  v_bitop3_b32 v2, v100, v102, v2 bitop3:0xfb
  v_and_b32 v2, s3, v2
  v_cmp_ne_u32 vcc, 0, v2
  s_nop 1
  s_cmp_lg_u64 vcc, 0
  s_cbranch_scc0 L_sd_220
  s_sub_u32 s86, s86, 1
  s_cbranch_scc0 L_sp_219
L_sd_220:
  s_add_u32 s78, s9, s91
  buffer_load_dwordx4 v[144:147], v10, s[32:35], s78 offen sc1
  buffer_load_dwordx4 v[148:151], v11, s[32:35], s78 offen sc1
  s_add_u32 s78, s9, s92
  buffer_load_dwordx4 v[112:115], v10, s[32:35], s78 offen sc1
  buffer_load_dwordx4 v[116:119], v11, s[32:35], s78 offen sc1
  s_add_u32 s78, s9, s93
  buffer_load_dwordx4 v[152:155], v10, s[32:35], s78 offen sc1
  buffer_load_dwordx4 v[156:159], v11, s[32:35], s78 offen sc1
  s_add_u32 s78, s7, s90
  s_add_u32 m0, s99, 98304
  s_lshl_b32 s78, s78, 4
  buffer_load_dwordx4 v6, s[52:55], s78 offen offset:0 lds
  buffer_load_dwordx4 v7, s[52:55], s78 offen offset:1024 lds
  s_add_u32 s78, s12, s90
  s_add_u32 s78, s78, 114688
  buffer_load_dwordx4 v[104:107], v10, s[32:35], s78 offen sc1
  buffer_load_dwordx4 v[108:111], v11, s[32:35], s78 offen sc1
  s_add_u32 s78, s7, s91
  s_add_u32 m0, s99, 100352
  s_lshl_b32 s78, s78, 4
  buffer_load_dwordx4 v6, s[52:55], s78 offen offset:0 lds
  buffer_load_dwordx4 v7, s[52:55], s78 offen offset:1024 lds
  s_add_u32 s78, s12, s91
  s_add_u32 s78, s78, 114688
  buffer_load_dwordx4 v[160:163], v10, s[32:35], s78 offen sc1
  buffer_load_dwordx4 v[164:167], v11, s[32:35], s78 offen sc1
  s_add_u32 s78, s7, s92
  s_add_u32 m0, s99, 114688
  s_lshl_b32 s78, s78, 4
  buffer_load_dwordx4 v6, s[52:55], s78 offen offset:0 lds
  buffer_load_dwordx4 v7, s[52:55], s78 offen offset:1024 lds
  s_add_u32 s78, s12, s92
  s_add_u32 s78, s78, 114688
  buffer_load_dwordx4 v[120:123], v10, s[32:35], s78 offen sc1
  buffer_load_dwordx4 v[124:127], v11, s[32:35], s78 offen sc1
  s_add_u32 s78, s7, s93
  s_add_u32 m0, s99, 116736
  s_lshl_b32 s78, s78, 4
  buffer_load_dwordx4 v6, s[52:55], s78 offen offset:0 lds
  buffer_load_dwordx4 v7, s[52:55], s78 offen offset:1024 lds
  s_add_u32 s78, s12, s93
  s_add_u32 s78, s78, 114688
  buffer_load_dwordx4 v[168:171], v10, s[32:35], s78 offen sc1
  buffer_load_dwordx4 v[172:175], v11, s[32:35], s78 offen sc1
  s_waitcnt vmcnt(22)
  s_branch L_cont_218
L_slow_221:
  s_mov_b32 s86, 65536
L_sp_223:
  s_sleep 1
  s_add_u32 s78, s9, s91
  buffer_load_dwordx4 v[144:147], v10, s[32:35], s78 offen sc1
  buffer_load_dwordx4 v[148:151], v11, s[32:35], s78 offen sc1
  s_waitcnt vmcnt(0)
  v_xor_b32 v144, v144, v14
  v_xor_b32 v146, v146, v15
  v_xor_b32 v148, v148, v14
  v_xor_b32 v150, v150, v15
  v_bitop3_b32 v2, v144, v146, v144 bitop3:0xf3
  v_bitop3_b32 v2, v148, v150, v2 bitop3:0xfb
  v_and_b32 v2, s3, v2
  v_cmp_ne_u32 vcc, 0, v2
  s_nop 1
  s_cmp_lg_u64 vcc, 0
  s_cbranch_scc0 L_sd_224
  s_sub_u32 s86, s86, 1
  s_cbranch_scc0 L_sp_223
L_sd_224:
  s_add_u32 s78, s9, s92
  buffer_load_dwordx4 v[112:115], v10, s[32:35], s78 offen sc1
  buffer_load_dwordx4 v[116:119], v11, s[32:35], s78 offen sc1
  s_add_u32 s78, s9, s93
  buffer_load_dwordx4 v[152:155], v10, s[32:35], s78 offen sc1
  buffer_load_dwordx4 v[156:159], v11, s[32:35], s78 offen sc1
  s_add_u32 s78, s7, s90
  s_add_u32 m0, s99, 98304
  s_lshl_b32 s78, s78, 4
  buffer_load_dwordx4 v6, s[52:55], s78 offen offset:0 lds
  buffer_load_dwordx4 v7, s[52:55], s78 offen offset:1024 lds
  s_add_u32 s78, s12, s90
  s_add_u32 s78, s78, 114688
  buffer_load_dwordx4 v[104:107], v10, s[32:35], s78 offen sc1
  buffer_load_dwordx4 v[108:111], v11, s[32:35], s78 offen sc1
  s_add_u32 s78, s7, s91
  s_add_u32 m0, s99, 100352
  s_lshl_b32 s78, s78, 4
  buffer_load_dwordx4 v6, s[52:55], s78 offen offset:0 lds
  buffer_load_dwordx4 v7, s[52:55], s78 offen offset:1024 lds
  s_add_u32 s78, s12, s91
  s_add_u32 s78, s78, 114688
  buffer_load_dwordx4 v[160:163], v10, s[32:35], s78 offen sc1
  buffer_load_dwordx4 v[164:167], v11, s[32:35], s78 offen sc1
  s_add_u32 s78, s7, s92
  s_add_u32 m0, s99, 114688
  s_lshl_b32 s78, s78, 4
  buffer_load_dwordx4 v6, s[52:55], s78 offen offset:0 lds
  buffer_load_dwordx4 v7, s[52:55], s78 offen offset:1024 lds
  s_add_u32 s78, s12, s92
  s_add_u32 s78, s78, 114688
  buffer_load_dwordx4 v[120:123], v10, s[32:35], s78 offen sc1
  buffer_load_dwordx4 v[124:127], v11, s[32:35], s78 offen sc1
  s_add_u32 s78, s7, s93
  s_add_u32 m0, s99, 116736
  s_lshl_b32 s78, s78, 4
  buffer_load_dwordx4 v6, s[52:55], s78 offen offset:0 lds
  buffer_load_dwordx4 v7, s[52:55], s78 offen offset:1024 lds
  s_add_u32 s78, s12, s93
  s_add_u32 s78, s78, 114688
  buffer_load_dwordx4 v[168:171], v10, s[32:35], s78 offen sc1
  buffer_load_dwordx4 v[172:175], v11, s[32:35], s78 offen sc1
  s_add_u32 s78, s13, s90
  s_add_u32 s78, s78, 114688
  buffer_load_dwordx4 v[80:83], v10, s[32:35], s78 offen sc1
  buffer_load_dwordx4 v[84:87], v11, s[32:35], s78 offen sc1
  s_waitcnt vmcnt(22)
  s_branch L_cont_222
L_slow_225:
  s_mov_b32 s86, 65536
L_sp_227:
  s_sleep 1
  s_add_u32 s78, s9, s92
  buffer_load_dwordx4 v[112:115], v10, s[32:35], s78 offen sc1
  buffer_load_dwordx4 v[116:119], v11, s[32:35], s78 offen sc1
  s_waitcnt vmcnt(0)
  v_xor_b32 v112, v112, v14
  v_xor_b32 v114, v114, v15
  v_xor_b32 v116, v116, v14
  v_xor_b32 v118, v118, v15
  v_bitop3_b32 v2, v112, v114, v112 bitop3:0xf3
  v_bitop3_b32 v2, v116, v118, v2 bitop3:0xfb
  v_and_b32 v2, s3, v2
  v_cmp_ne_u32 vcc, 0, v2
  s_nop 1
  s_cmp_lg_u64 vcc, 0
  s_cbranch_scc0 L_sd_228
  s_sub_u32 s86, s86, 1
  s_cbranch_scc0 L_sp_227
L_sd_228:
  s_add_u32 s78, s9, s93
  buffer_load_dwordx4 v[152:155], v10, s[32:35], s78 offen sc1
  buffer_load_dwordx4 v[156:159], v11, s[32:35], s78 offen sc1
  s_add_u32 s78, s7, s90
  s_add_u32 m0, s99, 98304
  s_lshl_b32 s78, s78, 4
  buffer_load_dwordx4 v6, s[52:55], s78 offen offset:0 lds
  buffer_load_dwordx4 v7, s[52:55], s78 offen offset:1024 lds
  s_add_u32 s78, s12, s90
  s_add_u32 s78, s78, 114688
  buffer_load_dwordx4 v[104:107], v10, s[32:35], s78 offen sc1
  buffer_load_dwordx4 v[108:111], v11, s[32:35], s78 offen sc1
  s_add_u32 s78, s7, s91
  s_add_u32 m0, s99, 100352
  s_lshl_b32 s78, s78, 4
  buffer_load_dwordx4 v6, s[52:55], s78 offen offset:0 lds
  buffer_load_dwordx4 v7, s[52:55], s78 offen offset:1024 lds
  s_add_u32 s78, s12, s91
  s_add_u32 s78, s78, 114688
  buffer_load_dwordx4 v[160:163], v10, s[32:35], s78 offen sc1
  buffer_load_dwordx4 v[164:167], v11, s[32:35], s78 offen sc1
  s_add_u32 s78, s7, s92
  s_add_u32 m0, s99, 114688
  s_lshl_b32 s78, s78, 4
  buffer_load_dwordx4 v6, s[52:55], s78 offen offset:0 lds
  buffer_load_dwordx4 v7, s[52:55], s78 offen offset:1024 lds
  s_add_u32 s78, s12, s92
  s_add_u32 s78, s78, 114688
  buffer_load_dwordx4 v[120:123], v10, s[32:35], s78 offen sc1
  buffer_load_dwordx4 v[124:127], v11, s[32:35], s78 offen sc1
  s_add_u32 s78, s7, s93
  s_add_u32 m0, s99, 116736
  s_lshl_b32 s78, s78, 4
  buffer_load_dwordx4 v6, s[52:55], s78 offen offset:0 lds
  buffer_load_dwordx4 v7, s[52:55], s78 offen offset:1024 lds
  s_add_u32 s78, s12, s93
  s_add_u32 s78, s78, 114688
  buffer_load_dwordx4 v[168:171], v10, s[32:35], s78 offen sc1
  buffer_load_dwordx4 v[172:175], v11, s[32:35], s78 offen sc1
  s_add_u32 s78, s13, s90
  s_add_u32 s78, s78, 114688
  buffer_load_dwordx4 v[80:83], v10, s[32:35], s78 offen sc1
  buffer_load_dwordx4 v[84:87], v11, s[32:35], s78 offen sc1
  s_add_u32 s78, s13, s91
  s_add_u32 s78, s78, 114688
  buffer_load_dwordx4 v[176:179], v10, s[32:35], s78 offen sc1
  buffer_load_dwordx4 v[180:183], v11, s[32:35], s78 offen sc1
  s_waitcnt vmcnt(22)
  s_branch L_cont_226
L_slow_229:
  s_mov_b32 s86, 65536
L_sp_231:
  s_sleep 1
  s_add_u32 s78, s9, s93
  buffer_load_dwordx4 v[152:155], v10, s[32:35], s78 offen sc1
  buffer_load_dwordx4 v[156:159], v11, s[32:35], s78 offen sc1
  s_waitcnt vmcnt(0)
  v_xor_b32 v152, v152, v14
  v_xor_b32 v154, v154, v15
  v_xor_b32 v156, v156, v14
  v_xor_b32 v158, v158, v15
  v_bitop3_b32 v2, v152, v154, v152 bitop3:0xf3
  v_bitop3_b32 v2, v156, v158, v2 bitop3:0xfb
  v_and_b32 v2, s3, v2
  v_cmp_ne_u32 vcc, 0, v2
  s_nop 1
  s_cmp_lg_u64 vcc, 0
  s_cbranch_scc0 L_sd_232
  s_sub_u32 s86, s86, 1
  s_cbranch_scc0 L_sp_231
L_sd_232:
  s_add_u32 s78, s7, s90
  s_add_u32 m0, s99, 98304
  s_lshl_b32 s78, s78, 4
  buffer_load_dwordx4 v6, s[52:55], s78 offen offset:0 lds
  buffer_load_dwordx4 v7, s[52:55], s78 offen offset:1024 lds
  s_add_u32 s78, s12, s90
  s_add_u32 s78, s78, 114688
  buffer_load_dwordx4 v[104:107], v10, s[32:35], s78 offen sc1
  buffer_load_dwordx4 v[108:111], v11, s[32:35], s78 offen sc1
  s_add_u32 s78, s7, s91
  s_add_u32 m0, s99, 100352
  s_lshl_b32 s78, s78, 4
  buffer_load_dwordx4 v6, s[52:55], s78 offen offset:0 lds
  buffer_load_dwordx4 v7, s[52:55], s78 offen offset:1024 lds
  s_add_u32 s78, s12, s91
  s_add_u32 s78, s78, 114688
  buffer_load_dwordx4 v[160:163], v10, s[32:35], s78 offen sc1
  buffer_load_dwordx4 v[164:167], v11, s[32:35], s78 offen sc1
  s_add_u32 s78, s7, s92
  s_add_u32 m0, s99, 114688
  s_lshl_b32 s78, s78, 4
  buffer_load_dwordx4 v6, s[52:55], s78 offen offset:0 lds
  buffer_load_dwordx4 v7, s[52:55], s78 offen offset:1024 lds
  s_add_u32 s78, s12, s92
  s_add_u32 s78, s78, 114688
  buffer_load_dwordx4 v[120:123], v10, s[32:35], s78 offen sc1
  buffer_load_dwordx4 v[124:127], v11, s[32:35], s78 offen sc1
  s_add_u32 s78, s7, s93
  s_add_u32 m0, s99, 116736
  s_lshl_b32 s78, s78, 4
  buffer_load_dwordx4 v6, s[52:55], s78 offen offset:0 lds
  buffer_load_dwordx4 v7, s[52:55], s78 offen offset:1024 lds
  s_add_u32 s78, s12, s93
  s_add_u32 s78, s78, 114688
  buffer_load_dwordx4 v[168:171], v10, s[32:35], s78 offen sc1
  buffer_load_dwordx4 v[172:175], v11, s[32:35], s78 offen sc1
  s_add_u32 s78, s13, s90
  s_add_u32 s78, s78, 114688
  buffer_load_dwordx4 v[80:83], v10, s[32:35], s78 offen sc1
  buffer_load_dwordx4 v[84:87], v11, s[32:35], s78 offen sc1
  s_add_u32 s78, s13, s91
  s_add_u32 s78, s78, 114688
  buffer_load_dwordx4 v[176:179], v10, s[32:35], s78 offen sc1
  buffer_load_dwordx4 v[180:183], v11, s[32:35], s78 offen sc1
  s_add_u32 s78, s13, s92
  s_add_u32 s78, s78, 114688
  buffer_load_dwordx4 v[128:131], v10, s[32:35], s78 offen sc1
  buffer_load_dwordx4 v[132:135], v11, s[32:35], s78 offen sc1
  s_waitcnt vmcnt(22)
  s_branch L_cont_230
L_slow_233:
  s_mov_b32 s86, 65536
L_sp_235:
  s_sleep 1
  s_add_u32 s78, s12, s90
  s_add_u32 s78, s78, 114688
  buffer_load_dwordx4 v[104:107], v10, s[32:35], s78 offen sc1
  buffer_load_dwordx4 v[108:111], v11, s[32:35], s78 offen sc1
  s_waitcnt vmcnt(0)
  v_xor_b32 v104, v104, v14
  v_xor_b32 v106, v106, v15
  v_xor_b32 v108, v108, v14
  v_xor_b32 v110, v110, v15
  v_bitop3_b32 v2, v104, v106, v104 bitop3:0xf3
  v_bitop3_b32 v2, v108, v110, v2 bitop3:0xfb
  v_and_b32 v2, s3, v2
  v_cmp_ne_u32 vcc, 0, v2
  s_nop 1
  s_cmp_lg_u64 vcc, 0
  s_cbranch_scc0 L_sd_236
  s_sub_u32 s86, s86, 1
  s_cbranch_scc0 L_sp_235
L_sd_236:
  s_add_u32 s78, s7, s91
  s_add_u32 m0, s99, 100352
  s_lshl_b32 s78, s78, 4
  buffer_load_dwordx4 v6, s[52:55], s78 offen offset:0 lds
  buffer_load_dwordx4 v7, s[52:55], s78 offen offset:1024 lds
  s_add_u32 s78, s12, s91
  s_add_u32 s78, s78, 114688
  buffer_load_dwordx4 v[160:163], v10, s[32:35], s78 offen sc1
  buffer_load_dwordx4 v[164:167], v11, s[32:35], s78 offen sc1
  s_add_u32 s78, s7, s92
  s_add_u32 m0, s99, 114688
  s_lshl_b32 s78, s78, 4
  buffer_load_dwordx4 v6, s[52:55], s78 offen offset:0 lds
  buffer_load_dwordx4 v7, s[52:55], s78 offen offset:1024 lds
  s_add_u32 s78, s12, s92
  s_add_u32 s78, s78, 114688
  buffer_load_dwordx4 v[120:123], v10, s[32:35], s78 offen sc1
  buffer_load_dwordx4 v[124:127], v11, s[32:35], s78 offen sc1
  s_add_u32 s78, s7, s93
  s_add_u32 m0, s99, 116736
  s_lshl_b32 s78, s78, 4
  buffer_load_dwordx4 v6, s[52:55], s78 offen offset:0 lds
  buffer_load_dwordx4 v7, s[52:55], s78 offen offset:1024 lds
  s_add_u32 s78, s12, s93
  s_add_u32 s78, s78, 114688
  buffer_load_dwordx4 v[168:171], v10, s[32:35], s78 offen sc1
  buffer_load_dwordx4 v[172:175], v11, s[32:35], s78 offen sc1
  s_add_u32 s78, s13, s90
  s_add_u32 s78, s78, 114688
  buffer_load_dwordx4 v[80:83], v10, s[32:35], s78 offen sc1
  buffer_load_dwordx4 v[84:87], v11, s[32:35], s78 offen sc1
  s_add_u32 s78, s13, s91
  s_add_u32 s78, s78, 114688
  buffer_load_dwordx4 v[176:179], v10, s[32:35], s78 offen sc1
  buffer_load_dwordx4 v[180:183], v11, s[32:35], s78 offen sc1
  s_add_u32 s78, s13, s92
  s_add_u32 s78, s78, 114688
  buffer_load_dwordx4 v[128:131], v10, s[32:35], s78 offen sc1
  buffer_load_dwordx4 v[132:135], v11, s[32:35], s78 offen sc1
  s_add_u32 s78, s13, s93
  s_add_u32 s78, s78, 114688
  buffer_load_dwordx4 v[88:91], v10, s[32:35], s78 offen sc1
  buffer_load_dwordx4 v[92:95], v11, s[32:35], s78 offen sc1
  s_waitcnt vmcnt(20)
  s_branch L_cont_234
L_slow_237:
  s_mov_b32 s86, 65536
L_sp_239:
  s_sleep 1
  s_add_u32 s78, s12, s91
  s_add_u32 s78, s78, 114688
  buffer_load_dwordx4 v[160:163], v10, s[32:35], s78 offen sc1
  buffer_load_dwordx4 v[164:167], v11, s[32:35], s78 offen sc1
  s_waitcnt vmcnt(0)
  v_xor_b32 v160, v160, v14
  v_xor_b32 v162, v162, v15
  v_xor_b32 v164, v164, v14
  v_xor_b32 v166, v166, v15
  v_bitop3_b32 v2, v160, v162, v160 bitop3:0xf3
  v_bitop3_b32 v2, v164, v166, v2 bitop3:0xfb
  v_and_b32 v2, s3, v2
  v_cmp_ne_u32 vcc, 0, v2
  s_nop 1
  s_cmp_lg_u64 vcc, 0
  s_cbranch_scc0 L_sd_240
  s_sub_u32 s86, s86, 1
  s_cbranch_scc0 L_sp_239
L_sd_240:
  s_add_u32 s78, s7, s92
  s_add_u32 m0, s99, 114688
  s_lshl_b32 s78, s78, 4
  buffer_load_dwordx4 v6, s[52:55], s78 offen offset:0 lds
  buffer_load_dwordx4 v7, s[52:55], s78 offen offset:1024 lds
  s_add_u32 s78, s12, s92
  s_add_u32 s78, s78, 114688
  buffer_load_dwordx4 v[120:123], v10, s[32:35], s78 offen sc1
  buffer_load_dwordx4 v[124:127], v11, s[32:35], s78 offen sc1
  s_add_u32 s78, s7, s93
  s_add_u32 m0, s99, 116736
  s_lshl_b32 s78, s78, 4
  buffer_load_dwordx4 v6, s[52:55], s78 offen offset:0 lds
  buffer_load_dwordx4 v7, s[52:55], s78 offen offset:1024 lds
  s_add_u32 s78, s12, s93
  s_add_u32 s78, s78, 114688
  buffer_load_dwordx4 v[168:171], v10, s[32:35], s78 offen sc1
  buffer_load_dwordx4 v[172:175], v11, s[32:35], s78 offen sc1
  s_add_u32 s78, s13, s90
  s_add_u32 s78, s78, 114688
  buffer_load_dwordx4 v[80:83], v10, s[32:35], s78 offen sc1
  buffer_load_dwordx4 v[84:87], v11, s[32:35], s78 offen sc1
  s_add_u32 s78, s13, s91
  s_add_u32 s78, s78, 114688
  buffer_load_dwordx4 v[176:179], v10, s[32:35], s78 offen sc1
  buffer_load_dwordx4 v[180:183], v11, s[32:35], s78 offen sc1
  s_add_u32 s78, s13, s92
  s_add_u32 s78, s78, 114688
  buffer_load_dwordx4 v[128:131], v10, s[32:35], s78 offen sc1
  buffer_load_dwordx4 v[132:135], v11, s[32:35], s78 offen sc1
  s_add_u32 s78, s13, s93
  s_add_u32 s78, s78, 114688
  buffer_load_dwordx4 v[88:91], v10, s[32:35], s78 offen sc1
  buffer_load_dwordx4 v[92:95], v11, s[32:35], s78 offen sc1
  s_add_u32 s78, s10, s14
  buffer_load_dwordx4 v[136:139], v10, s[32:35], s78 offen sc1
  buffer_load_dwordx4 v[140:143], v11, s[32:35], s78 offen sc1
  s_waitcnt vmcnt(18)
  s_branch L_cont_238
L_slow_241:
  s_mov_b32 s86, 65536
L_sp_243:
  s_sleep 1
  s_add_u32 s78, s12, s92
  s_add_u32 s78, s78, 114688
  buffer_load_dwordx4 v[120:123], v10, s[32:35], s78 offen sc1
  buffer_load_dwordx4 v[124:127], v11, s[32:35], s78 offen sc1
  s_waitcnt vmcnt(0)
  v_xor_b32 v120, v120, v14
  v_xor_b32 v122, v122, v15
  v_xor_b32 v124, v124, v14
  v_xor_b32 v126, v126, v15
  v_bitop3_b32 v2, v120, v122, v120 bitop3:0xf3
  v_bitop3_b32 v2, v124, v126, v2 bitop3:0xfb
  v_and_b32 v2, s3, v2
  v_cmp_ne_u32 vcc, 0, v2
  s_nop 1
  s_cmp_lg_u64 vcc, 0
  s_cbranch_scc0 L_sd_244
  s_sub_u32 s86, s86, 1
  s_cbranch_scc0 L_sp_243
L_sd_244:
  s_add_u32 s78, s7, s93
  s_add_u32 m0, s99, 116736
  s_lshl_b32 s78, s78, 4
  buffer_load_dwordx4 v6, s[52:55], s78 offen offset:0 lds
  buffer_load_dwordx4 v7, s[52:55], s78 offen offset:1024 lds
  s_add_u32 s78, s12, s93
  s_add_u32 s78, s78, 114688
  buffer_load_dwordx4 v[168:171], v10, s[32:35], s78 offen sc1
  buffer_load_dwordx4 v[172:175], v11, s[32:35], s78 offen sc1
  s_add_u32 s78, s13, s90
  s_add_u32 s78, s78, 114688
  buffer_load_dwordx4 v[80:83], v10, s[32:35], s78 offen sc1
  buffer_load_dwordx4 v[84:87], v11, s[32:35], s78 offen sc1
  s_add_u32 s78, s13, s91
  s_add_u32 s78, s78, 114688
  buffer_load_dwordx4 v[176:179], v10, s[32:35], s78 offen sc1
  buffer_load_dwordx4 v[180:183], v11, s[32:35], s78 offen sc1
  s_add_u32 s78, s13, s92
  s_add_u32 s78, s78, 114688
  buffer_load_dwordx4 v[128:131], v10, s[32:35], s78 offen sc1
  buffer_load_dwordx4 v[132:135], v11, s[32:35], s78 offen sc1
  s_add_u32 s78, s13, s93
  s_add_u32 s78, s78, 114688
  buffer_load_dwordx4 v[88:91], v10, s[32:35], s78 offen sc1
  buffer_load_dwordx4 v[92:95], v11, s[32:35], s78 offen sc1
  s_add_u32 s78, s10, s14
  buffer_load_dwordx4 v[136:139], v10, s[32:35], s78 offen sc1
  buffer_load_dwordx4 v[140:143], v11, s[32:35], s78 offen sc1
  s_add_u32 s78, s10, s15
  buffer_load_dwordx4 v[96:99], v10, s[32:35], s78 offen sc1
  buffer_load_dwordx4 v[100:103], v11, s[32:35], s78 offen sc1
  s_waitcnt vmcnt(16)
  s_branch L_cont_242
L_slow_245:
  s_mov_b32 s86, 65536
L_sp_247:
  s_sleep 1
  s_add_u32 s78, s12, s93
  s_add_u32 s78, s78, 114688
  buffer_load_dwordx4 v[168:171], v10, s[32:35], s78 offen sc1
  buffer_load_dwordx4 v[172:175], v11, s[32:35], s78 offen sc1
  s_waitcnt vmcnt(0)
  v_xor_b32 v168, v168, v14
  v_xor_b32 v170, v170, v15
  v_xor_b32 v172, v172, v14
  v_xor_b32 v174, v174, v15
  v_bitop3_b32 v2, v168, v170, v168 bitop3:0xf3
  v_bitop3_b32 v2, v172, v174, v2 bitop3:0xfb
  v_and_b32 v2, s3, v2
  v_cmp_ne_u32 vcc, 0, v2
  s_nop 1
  s_cmp_lg_u64 vcc, 0
  s_cbranch_scc0 L_sd_248
  s_sub_u32 s86, s86, 1
  s_cbranch_scc0 L_sp_247
L_sd_248:
  s_add_u32 s78, s13, s90
  s_add_u32 s78, s78, 114688
  buffer_load_dwordx4 v[80:83], v10, s[32:35], s78 offen sc1
  buffer_load_dwordx4 v[84:87], v11, s[32:35], s78 offen sc1
  s_add_u32 s78, s13, s91
  s_add_u32 s78, s78, 114688
  buffer_load_dwordx4 v[176:179], v10, s[32:35], s78 offen sc1
  buffer_load_dwordx4 v[180:183], v11, s[32:35], s78 offen sc1
  s_add_u32 s78, s13, s92
  s_add_u32 s78, s78, 114688
  buffer_load_dwordx4 v[128:131], v10, s[32:35], s78 offen sc1
  buffer_load_dwordx4 v[132:135], v11, s[32:35], s78 offen sc1
  s_add_u32 s78, s13, s93
  s_add_u32 s78, s78, 114688
  buffer_load_dwordx4 v[88:91], v10, s[32:35], s78 offen sc1
  buffer_load_dwordx4 v[92:95], v11, s[32:35], s78 offen sc1
  s_add_u32 s78, s10, s14
  buffer_load_dwordx4 v[136:139], v10, s[32:35], s78 offen sc1
  buffer_load_dwordx4 v[140:143], v11, s[32:35], s78 offen sc1
  s_add_u32 s78, s10, s15
  buffer_load_dwordx4 v[96:99], v10, s[32:35], s78 offen sc1
  buffer_load_dwordx4 v[100:103], v11, s[32:35], s78 offen sc1
  s_add_u32 s78, s11, s14
  buffer_load_dwordx4 v[144:147], v10, s[32:35], s78 offen sc1
  buffer_load_dwordx4 v[148:151], v11, s[32:35], s78 offen sc1
  s_waitcnt vmcnt(14)
  s_branch L_cont_246
L_slow_249:
  s_mov_b32 s86, 65536
L_sp_251:
  s_sleep 1
  s_add_u32 s78, s13, s90
  s_add_u32 s78, s78, 114688
  buffer_load_dwordx4 v[80:83], v10, s[32:35], s78 offen sc1
  buffer_load_dwordx4 v[84:87], v11, s[32:35], s78 offen sc1
  s_waitcnt vmcnt(0)
  v_xor_b32 v80, v80, v14
  v_xor_b32 v82, v82, v15
  v_xor_b32 v84, v84, v14
  v_xor_b32 v86, v86, v15
  v_bitop3_b32 v2, v80, v82, v80 bitop3:0xf3
  v_bitop3_b32 v2, v84, v86, v2 bitop3:0xfb
  v_and_b32 v2, s3, v2
  v_cmp_ne_u32 vcc, 0, v2
  s_nop 1
  s_cmp_lg_u64 vcc, 0
  s_cbranch_scc0 L_sd_252
  s_sub_u32 s86, s86, 1
  s_cbranch_scc0 L_sp_251
L_sd_252:
  s_add_u32 s78, s13, s91
  s_add_u32 s78, s78, 114688
  buffer_load_dwordx4 v[176:179], v10, s[32:35], s78 offen sc1
  buffer_load_dwordx4 v[180:183], v11, s[32:35], s78 offen sc1
  s_add_u32 s78, s13, s92
  s_add_u32 s78, s78, 114688
  buffer_load_dwordx4 v[128:131], v10, s[32:35], s78 offen sc1
  buffer_load_dwordx4 v[132:135], v11, s[32:35], s78 offen sc1
  s_add_u32 s78, s13, s93
  s_add_u32 s78, s78, 114688
  buffer_load_dwordx4 v[88:91], v10, s[32:35], s78 offen sc1
  buffer_load_dwordx4 v[92:95], v11, s[32:35], s78 offen sc1
  s_add_u32 s78, s10, s14
  buffer_load_dwordx4 v[136:139], v10, s[32:35], s78 offen sc1
  buffer_load_dwordx4 v[140:143], v11, s[32:35], s78 offen sc1
  s_add_u32 s78, s10, s15
  buffer_load_dwordx4 v[96:99], v10, s[32:35], s78 offen sc1
  buffer_load_dwordx4 v[100:103], v11, s[32:35], s78 offen sc1
  s_add_u32 s78, s11, s14
  buffer_load_dwordx4 v[144:147], v10, s[32:35], s78 offen sc1
  buffer_load_dwordx4 v[148:151], v11, s[32:35], s78 offen sc1
  s_add_u32 s78, s11, s15
  buffer_load_dwordx4 v[112:115], v10, s[32:35], s78 offen sc1
  buffer_load_dwordx4 v[116:119], v11, s[32:35], s78 offen sc1
  s_waitcnt vmcnt(14)
  s_branch L_cont_250
L_slow_253:
  s_mov_b32 s86, 65536
L_sp_255:
  s_sleep 1
  s_add_u32 s78, s13, s91
  s_add_u32 s78, s78, 114688
  buffer_load_dwordx4 v[176:179], v10, s[32:35], s78 offen sc1
  buffer_load_dwordx4 v[180:183], v11, s[32:35], s78 offen sc1
  s_waitcnt vmcnt(0)
  v_xor_b32 v176, v176, v14
  v_xor_b32 v178, v178, v15
  v_xor_b32 v180, v180, v14
  v_xor_b32 v182, v182, v15
  v_bitop3_b32 v2, v176, v178, v176 bitop3:0xf3
  v_bitop3_b32 v2, v180, v182, v2 bitop3:0xfb
  v_and_b32 v2, s3, v2
  v_cmp_ne_u32 vcc, 0, v2
  s_nop 1
  s_cmp_lg_u64 vcc, 0
  s_cbranch_scc0 L_sd_256
  s_sub_u32 s86, s86, 1
  s_cbranch_scc0 L_sp_255
L_sd_256:
  s_add_u32 s78, s13, s92
  s_add_u32 s78, s78, 114688
  buffer_load_dwordx4 v[128:131], v10, s[32:35], s78 offen sc1
  buffer_load_dwordx4 v[132:135], v11, s[32:35], s78 offen sc1
  s_add_u32 s78, s13, s93
  s_add_u32 s78, s78, 114688
  buffer_load_dwordx4 v[88:91], v10, s[32:35], s78 offen sc1
  buffer_load_dwordx4 v[92:95], v11, s[32:35], s78 offen sc1
  s_add_u32 s78, s10, s14
  buffer_load_dwordx4 v[136:139], v10, s[32:35], s78 offen sc1
  buffer_load_dwordx4 v[140:143], v11, s[32:35], s78 offen sc1
  s_add_u32 s78, s10, s15
  buffer_load_dwordx4 v[96:99], v10, s[32:35], s78 offen sc1
  buffer_load_dwordx4 v[100:103], v11, s[32:35], s78 offen sc1
  s_add_u32 s78, s11, s14
  buffer_load_dwordx4 v[144:147], v10, s[32:35], s78 offen sc1
  buffer_load_dwordx4 v[148:151], v11, s[32:35], s78 offen sc1
  s_add_u32 s78, s11, s15
  buffer_load_dwordx4 v[112:115], v10, s[32:35], s78 offen sc1
  buffer_load_dwordx4 v[116:119], v11, s[32:35], s78 offen sc1
  s_add_u32 s78, s6, s90
  buffer_load_dwordx4 v[152:155], v10, s[32:35], s78 offen sc1
  buffer_load_dwordx4 v[156:159], v11, s[32:35], s78 offen sc1
  s_waitcnt vmcnt(14)
  s_branch L_cont_254
L_slow_257:
  s_mov_b32 s86, 65536
L_sp_259:
  s_sleep 1
  s_add_u32 s78, s13, s92
  s_add_u32 s78, s78, 114688
  buffer_load_dwordx4 v[128:131], v10, s[32:35], s78 offen sc1
  buffer_load_dwordx4 v[132:135], v11, s[32:35], s78 offen sc1
  s_waitcnt vmcnt(0)
  v_xor_b32 v128, v128, v14
  v_xor_b32 v130, v130, v15
  v_xor_b32 v132, v132, v14
  v_xor_b32 v134, v134, v15
  v_bitop3_b32 v2, v128, v130, v128 bitop3:0xf3
  v_bitop3_b32 v2, v132, v134, v2 bitop3:0xfb
  v_and_b32 v2, s3, v2
  v_cmp_ne_u32 vcc, 0, v2
  s_nop 1
  s_cmp_lg_u64 vcc, 0
  s_cbranch_scc0 L_sd_260
  s_sub_u32 s86, s86, 1
  s_cbranch_scc0 L_sp_259
L_sd_260:
  s_add_u32 s78, s13, s93
  s_add_u32 s78, s78, 114688
  buffer_load_dwordx4 v[88:91], v10, s[32:35], s78 offen sc1
  buffer_load_dwordx4 v[92:95], v11, s[32:35], s78 offen sc1
  s_add_u32 s78, s10, s14
  buffer_load_dwordx4 v[136:139], v10, s[32:35], s78 offen sc1
  buffer_load_dwordx4 v[140:143], v11, s[32:35], s78 offen sc1
  s_add_u32 s78, s10, s15
  buffer_load_dwordx4 v[96:99], v10, s[32:35], s78 offen sc1
  buffer_load_dwordx4 v[100:103], v11, s[32:35], s78 offen sc1
  s_add_u32 s78, s11, s14
  buffer_load_dwordx4 v[144:147], v10, s[32:35], s78 offen sc1
  buffer_load_dwordx4 v[148:151], v11, s[32:35], s78 offen sc1
  s_add_u32 s78, s11, s15
  buffer_load_dwordx4 v[112:115], v10, s[32:35], s78 offen sc1
  buffer_load_dwordx4 v[116:119], v11, s[32:35], s78 offen sc1
  s_add_u32 s78, s6, s90
  buffer_load_dwordx4 v[152:155], v10, s[32:35], s78 offen sc1
  buffer_load_dwordx4 v[156:159], v11, s[32:35], s78 offen sc1
  s_add_u32 s78, s6, s91
  buffer_load_dwordx4 v[104:107], v10, s[32:35], s78 offen sc1
  buffer_load_dwordx4 v[108:111], v11, s[32:35], s78 offen sc1
  s_waitcnt vmcnt(14)
  s_branch L_cont_258
L_slow_261:
  s_mov_b32 s86, 65536
L_sp_263:
  s_sleep 1
  s_add_u32 s78, s13, s93
  s_add_u32 s78, s78, 114688
  buffer_load_dwordx4 v[88:91], v10, s[32:35], s78 offen sc1
  buffer_load_dwordx4 v[92:95], v11, s[32:35], s78 offen sc1
  s_waitcnt vmcnt(0)
  v_xor_b32 v88, v88, v14
  v_xor_b32 v90, v90, v15
  v_xor_b32 v92, v92, v14
  v_xor_b32 v94, v94, v15
  v_bitop3_b32 v2, v88, v90, v88 bitop3:0xf3
  v_bitop3_b32 v2, v92, v94, v2 bitop3:0xfb
  v_and_b32 v2, s3, v2
  v_cmp_ne_u32 vcc, 0, v2
  s_nop 1
  s_cmp_lg_u64 vcc, 0
  s_cbranch_scc0 L_sd_264
  s_sub_u32 s86, s86, 1
  s_cbranch_scc0 L_sp_263
L_sd_264:
  s_add_u32 s78, s10, s14
  buffer_load_dwordx4 v[136:139], v10, s[32:35], s78 offen sc1
  buffer_load_dwordx4 v[140:143], v11, s[32:35], s78 offen sc1
  s_add_u32 s78, s10, s15
  buffer_load_dwordx4 v[96:99], v10, s[32:35], s78 offen sc1
  buffer_load_dwordx4 v[100:103], v11, s[32:35], s78 offen sc1
  s_add_u32 s78, s11, s14
  buffer_load_dwordx4 v[144:147], v10, s[32:35], s78 offen sc1
  buffer_load_dwordx4 v[148:151], v11, s[32:35], s78 offen sc1
  s_add_u32 s78, s11, s15
  buffer_load_dwordx4 v[112:115], v10, s[32:35], s78 offen sc1
  buffer_load_dwordx4 v[116:119], v11, s[32:35], s78 offen sc1
  s_add_u32 s78, s6, s90
  buffer_load_dwordx4 v[152:155], v10, s[32:35], s78 offen sc1
  buffer_load_dwordx4 v[156:159], v11, s[32:35], s78 offen sc1
  s_add_u32 s78, s6, s91
  buffer_load_dwordx4 v[104:107], v10, s[32:35], s78 offen sc1
  buffer_load_dwordx4 v[108:111], v11, s[32:35], s78 offen sc1
  s_add_u32 s78, s6, s92
  buffer_load_dwordx4 v[160:163], v10, s[32:35], s78 offen sc1
  buffer_load_dwordx4 v[164:167], v11, s[32:35], s78 offen sc1
  s_waitcnt vmcnt(14)
  s_branch L_cont_262
L_slow_265:
  s_mov_b32 s86, 65536
L_sp_267:
  s_sleep 1
  s_add_u32 s78, s10, s14
  buffer_load_dwordx4 v[136:139], v10, s[32:35], s78 offen sc1
  buffer_load_dwordx4 v[140:143], v11, s[32:35], s78 offen sc1
  s_waitcnt vmcnt(0)
  v_xor_b32 v136, v136, v14
  v_xor_b32 v138, v138, v15
  v_xor_b32 v140, v140, v14
  v_xor_b32 v142, v142, v15
  v_bitop3_b32 v2, v136, v138, v136 bitop3:0xf3
  v_bitop3_b32 v2, v140, v142, v2 bitop3:0xfb
  v_and_b32 v2, s3, v2
  v_cmp_ne_u32 vcc, 0, v2
  s_nop 1
  s_cmp_lg_u64 vcc, 0
  s_cbranch_scc0 L_sd_268
  s_sub_u32 s86, s86, 1
  s_cbranch_scc0 L_sp_267
L_sd_268:
  s_add_u32 s78, s10, s15
  buffer_load_dwordx4 v[96:99], v10, s[32:35], s78 offen sc1
  buffer_load_dwordx4 v[100:103], v11, s[32:35], s78 offen sc1
  s_add_u32 s78, s11, s14
  buffer_load_dwordx4 v[144:147], v10, s[32:35], s78 offen sc1
  buffer_load_dwordx4 v[148:151], v11, s[32:35], s78 offen sc1
  s_add_u32 s78, s11, s15
  buffer_load_dwordx4 v[112:115], v10, s[32:35], s78 offen sc1
  buffer_load_dwordx4 v[116:119], v11, s[32:35], s78 offen sc1
  s_add_u32 s78, s6, s90
  buffer_load_dwordx4 v[152:155], v10, s[32:35], s78 offen sc1
  buffer_load_dwordx4 v[156:159], v11, s[32:35], s78 offen sc1
  s_add_u32 s78, s6, s91
  buffer_load_dwordx4 v[104:107], v10, s[32:35], s78 offen sc1
  buffer_load_dwordx4 v[108:111], v11, s[32:35], s78 offen sc1
  s_add_u32 s78, s6, s92
  buffer_load_dwordx4 v[160:163], v10, s[32:35], s78 offen sc1
  buffer_load_dwordx4 v[164:167], v11, s[32:35], s78 offen sc1
  s_add_u32 s78, s6, s93
  buffer_load_dwordx4 v[120:123], v10, s[32:35], s78 offen sc1
  buffer_load_dwordx4 v[124:127], v11, s[32:35], s78 offen sc1
  s_waitcnt vmcnt(14)
  s_branch L_cont_266
L_slow_269:
  s_mov_b32 s86, 65536
L_sp_271:
  s_sleep 1
  s_add_u32 s78, s10, s15
  buffer_load_dwordx4 v[96:99], v10, s[32:35], s78 offen sc1
  buffer_load_dwordx4 v[100:103], v11, s[32:35], s78 offen sc1
  s_waitcnt vmcnt(0)
  v_xor_b32 v96, v96, v14
  v_xor_b32 v98, v98, v15
  v_xor_b32 v100, v100, v14
  v_xor_b32 v102, v102, v15
  v_bitop3_b32 v2, v96, v98, v96 bitop3:0xf3
  v_bitop3_b32 v2, v100, v102, v2 bitop3:0xfb
  v_and_b32 v2, s3, v2
  v_cmp_ne_u32 vcc, 0, v2
  s_nop 1
  s_cmp_lg_u64 vcc, 0
  s_cbranch_scc0 L_sd_272
  s_sub_u32 s86, s86, 1
  s_cbranch_scc0 L_sp_271
L_sd_272:
  s_add_u32 s78, s11, s14
  buffer_load_dwordx4 v[144:147], v10, s[32:35], s78 offen sc1
  buffer_load_dwordx4 v[148:151], v11, s[32:35], s78 offen sc1
  s_add_u32 s78, s11, s15
  buffer_load_dwordx4 v[112:115], v10, s[32:35], s78 offen sc1
  buffer_load_dwordx4 v[116:119], v11, s[32:35], s78 offen sc1
  s_add_u32 s78, s6, s90
  buffer_load_dwordx4 v[152:155], v10, s[32:35], s78 offen sc1
  buffer_load_dwordx4 v[156:159], v11, s[32:35], s78 offen sc1
  s_add_u32 s78, s6, s91
  buffer_load_dwordx4 v[104:107], v10, s[32:35], s78 offen sc1
  buffer_load_dwordx4 v[108:111], v11, s[32:35], s78 offen sc1
  s_add_u32 s78, s6, s92
  buffer_load_dwordx4 v[160:163], v10, s[32:35], s78 offen sc1
  buffer_load_dwordx4 v[164:167], v11, s[32:35], s78 offen sc1
  s_add_u32 s78, s6, s93
  buffer_load_dwordx4 v[120:123], v10, s[32:35], s78 offen sc1
  buffer_load_dwordx4 v[124:127], v11, s[32:35], s78 offen sc1
  s_add_u32 s78, s7, s90
  buffer_load_dwordx4 v[168:171], v10, s[32:35], s78 offen sc1
  buffer_load_dwordx4 v[172:175], v11, s[32:35], s78 offen sc1
  s_waitcnt vmcnt(14)
  s_branch L_cont_270
L_slow_273:
  s_mov_b32 s86, 65536
L_sp_275:
  s_sleep 1
  s_add_u32 s78, s11, s14
  buffer_load_dwordx4 v[144:147], v10, s[32:35], s78 offen sc1
  buffer_load_dwordx4 v[148:151], v11, s[32:35], s78 offen sc1
  s_waitcnt vmcnt(0)
  v_xor_b32 v144, v144, v14
  v_xor_b32 v146, v146, v15
  v_xor_b32 v148, v148, v14
  v_xor_b32 v150, v150, v15
  v_bitop3_b32 v2, v144, v146, v144 bitop3:0xf3
  v_bitop3_b32 v2, v148, v150, v2 bitop3:0xfb
  v_and_b32 v2, s3, v2
  v_cmp_ne_u32 vcc, 0, v2
  s_nop 1
  s_cmp_lg_u64 vcc, 0
  s_cbranch_scc0 L_sd_276
  s_sub_u32 s86, s86, 1
  s_cbranch_scc0 L_sp_275
L_sd_276:
  s_add_u32 s78, s11, s15
  buffer_load_dwordx4 v[112:115], v10, s[32:35], s78 offen sc1
  buffer_load_dwordx4 v[116:119], v11, s[32:35], s78 offen sc1
  s_add_u32 s78, s6, s90
  buffer_load_dwordx4 v[152:155], v10, s[32:35], s78 offen sc1
  buffer_load_dwordx4 v[156:159], v11, s[32:35], s78 offen sc1
  s_add_u32 s78, s6, s91
  buffer_load_dwordx4 v[104:107], v10, s[32:35], s78 offen sc1
  buffer_load_dwordx4 v[108:111], v11, s[32:35], s78 offen sc1
  s_add_u32 s78, s6, s92
  buffer_load_dwordx4 v[160:163], v10, s[32:35], s78 offen sc1
  buffer_load_dwordx4 v[164:167], v11, s[32:35], s78 offen sc1
  s_add_u32 s78, s6, s93
  buffer_load_dwordx4 v[120:123], v10, s[32:35], s78 offen sc1
  buffer_load_dwordx4 v[124:127], v11, s[32:35], s78 offen sc1
  s_add_u32 s78, s7, s90
  buffer_load_dwordx4 v[168:171], v10, s[32:35], s78 offen sc1
  buffer_load_dwordx4 v[172:175], v11, s[32:35], s78 offen sc1
  s_add_u32 s78, s7, s91
  buffer_load_dwordx4 v[80:83], v10, s[32:35], s78 offen sc1
  buffer_load_dwordx4 v[84:87], v11, s[32:35], s78 offen sc1
  s_waitcnt vmcnt(14)
  s_branch L_cont_274
L_slow_277:
  s_mov_b32 s86, 65536
L_sp_279:
  s_sleep 1
  s_add_u32 s78, s11, s15
  buffer_load_dwordx4 v[112:115], v10, s[32:35], s78 offen sc1
  buffer_load_dwordx4 v[116:119], v11, s[32:35], s78 offen sc1
  s_waitcnt vmcnt(0)
  v_xor_b32 v112, v112, v14
  v_xor_b32 v114, v114, v15
  v_xor_b32 v116, v116, v14
  v_xor_b32 v118, v118, v15
  v_bitop3_b32 v2, v112, v114, v112 bitop3:0xf3
  v_bitop3_b32 v2, v116, v118, v2 bitop3:0xfb
  v_and_b32 v2, s3, v2
  v_cmp_ne_u32 vcc, 0, v2
  s_nop 1
  s_cmp_lg_u64 vcc, 0
  s_cbranch_scc0 L_sd_280
  s_sub_u32 s86, s86, 1
  s_cbranch_scc0 L_sp_279
L_sd_280:
  s_add_u32 s78, s6, s90
  buffer_load_dwordx4 v[152:155], v10, s[32:35], s78 offen sc1
  buffer_load_dwordx4 v[156:159], v11, s[32:35], s78 offen sc1
  s_add_u32 s78, s6, s91
  buffer_load_dwordx4 v[104:107], v10, s[32:35], s78 offen sc1
  buffer_load_dwordx4 v[108:111], v11, s[32:35], s78 offen sc1
  s_add_u32 s78, s6, s92
  buffer_load_dwordx4 v[160:163], v10, s[32:35], s78 offen sc1
  buffer_load_dwordx4 v[164:167], v11, s[32:35], s78 offen sc1
  s_add_u32 s78, s6, s93
  buffer_load_dwordx4 v[120:123], v10, s[32:35], s78 offen sc1
  buffer_load_dwordx4 v[124:127], v11, s[32:35], s78 offen sc1
  s_add_u32 s78, s7, s90
  buffer_load_dwordx4 v[168:171], v10, s[32:35], s78 offen sc1
  buffer_load_dwordx4 v[172:175], v11, s[32:35], s78 offen sc1
  s_add_u32 s78, s7, s91
  buffer_load_dwordx4 v[80:83], v10, s[32:35], s78 offen sc1
  buffer_load_dwordx4 v[84:87], v11, s[32:35], s78 offen sc1
  s_add_u32 s78, s7, s92
  buffer_load_dwordx4 v[176:179], v10, s[32:35], s78 offen sc1
  buffer_load_dwordx4 v[180:183], v11, s[32:35], s78 offen sc1
  s_waitcnt vmcnt(14)
  s_branch L_cont_278
L_slow_281:
  s_mov_b32 s86, 65536
L_sp_283:
  s_sleep 1
  s_add_u32 s78, s6, s90
  buffer_load_dwordx4 v[152:155], v10, s[32:35], s78 offen sc1
  buffer_load_dwordx4 v[156:159], v11, s[32:35], s78 offen sc1
  s_waitcnt vmcnt(0)
  v_xor_b32 v152, v152, v14
  v_xor_b32 v154, v154, v15
  v_xor_b32 v156, v156, v14
  v_xor_b32 v158, v158, v15
  v_bitop3_b32 v2, v152, v154, v152 bitop3:0xf3
  v_bitop3_b32 v2, v156, v158, v2 bitop3:0xfb
  v_and_b32 v2, s3, v2
  v_cmp_ne_u32 vcc, 0, v2
  s_nop 1
  s_cmp_lg_u64 vcc, 0
  s_cbranch_scc0 L_sd_284
  s_sub_u32 s86, s86, 1
  s_cbranch_scc0 L_sp_283
L_sd_284:
  s_add_u32 s78, s6, s91
  buffer_load_dwordx4 v[104:107], v10, s[32:35], s78 offen sc1
  buffer_load_dwordx4 v[108:111], v11, s[32:35], s78 offen sc1
  s_add_u32 s78, s6, s92
  buffer_load_dwordx4 v[160:163], v10, s[32:35], s78 offen sc1
  buffer_load_dwordx4 v[164:167], v11, s[32:35], s78 offen sc1
  s_add_u32 s78, s6, s93
  buffer_load_dwordx4 v[120:123], v10, s[32:35], s78 offen sc1
  buffer_load_dwordx4 v[124:127], v11, s[32:35], s78 offen sc1
  s_add_u32 s78, s7, s90
  buffer_load_dwordx4 v[168:171], v10, s[32:35], s78 offen sc1
  buffer_load_dwordx4 v[172:175], v11, s[32:35], s78 offen sc1
  s_add_u32 s78, s7, s91
  buffer_load_dwordx4 v[80:83], v10, s[32:35], s78 offen sc1
  buffer_load_dwordx4 v[84:87], v11, s[32:35], s78 offen sc1
  s_add_u32 s78, s7, s92
  buffer_load_dwordx4 v[176:179], v10, s[32:35], s78 offen sc1
  buffer_load_dwordx4 v[180:183], v11, s[32:35], s78 offen sc1
  s_add_u32 s78, s7, s93
  buffer_load_dwordx4 v[128:131], v10, s[32:35], s78 offen sc1
  buffer_load_dwordx4 v[132:135], v11, s[32:35], s78 offen sc1
  s_waitcnt vmcnt(14)
  s_branch L_cont_282
L_slow_285:
  s_mov_b32 s86, 65536
L_sp_287:
  s_sleep 1
  s_add_u32 s78, s6, s91
  buffer_load_dwordx4 v[104:107], v10, s[32:35], s78 offen sc1
  buffer_load_dwordx4 v[108:111], v11, s[32:35], s78 offen sc1
  s_waitcnt vmcnt(0)
  v_xor_b32 v104, v104, v14
  v_xor_b32 v106, v106, v15
  v_xor_b32 v108, v108, v14
  v_xor_b32 v110, v110, v15
  v_bitop3_b32 v2, v104, v106, v104 bitop3:0xf3
  v_bitop3_b32 v2, v108, v110, v2 bitop3:0xfb
  v_and_b32 v2, s3, v2
  v_cmp_ne_u32 vcc, 0, v2
  s_nop 1
  s_cmp_lg_u64 vcc, 0
  s_cbranch_scc0 L_sd_288
  s_sub_u32 s86, s86, 1
  s_cbranch_scc0 L_sp_287
L_sd_288:
  s_add_u32 s78, s6, s92
  buffer_load_dwordx4 v[160:163], v10, s[32:35], s78 offen sc1
  buffer_load_dwordx4 v[164:167], v11, s[32:35], s78 offen sc1
  s_add_u32 s78, s6, s93
  buffer_load_dwordx4 v[120:123], v10, s[32:35], s78 offen sc1
  buffer_load_dwordx4 v[124:127], v11, s[32:35], s78 offen sc1
  s_add_u32 s78, s7, s90
  buffer_load_dwordx4 v[168:171], v10, s[32:35], s78 offen sc1
  buffer_load_dwordx4 v[172:175], v11, s[32:35], s78 offen sc1
  s_add_u32 s78, s7, s91
  buffer_load_dwordx4 v[80:83], v10, s[32:35], s78 offen sc1
  buffer_load_dwordx4 v[84:87], v11, s[32:35], s78 offen sc1
  s_add_u32 s78, s7, s92
  buffer_load_dwordx4 v[176:179], v10, s[32:35], s78 offen sc1
  buffer_load_dwordx4 v[180:183], v11, s[32:35], s78 offen sc1
  s_add_u32 s78, s7, s93
  buffer_load_dwordx4 v[128:131], v10, s[32:35], s78 offen sc1
  buffer_load_dwordx4 v[132:135], v11, s[32:35], s78 offen sc1
  s_waitcnt vmcnt(12)
  s_branch L_cont_286
L_slow_289:
  s_mov_b32 s86, 65536
L_sp_291:
  s_sleep 1
  s_add_u32 s78, s6, s92
  buffer_load_dwordx4 v[160:163], v10, s[32:35], s78 offen sc1
  buffer_load_dwordx4 v[164:167], v11, s[32:35], s78 offen sc1
  s_waitcnt vmcnt(0)
  v_xor_b32 v160, v160, v14
  v_xor_b32 v162, v162, v15
  v_xor_b32 v164, v164, v14
  v_xor_b32 v166, v166, v15
  v_bitop3_b32 v2, v160, v162, v160 bitop3:0xf3
  v_bitop3_b32 v2, v164, v166, v2 bitop3:0xfb
  v_and_b32 v2, s3, v2
  v_cmp_ne_u32 vcc, 0, v2
  s_nop 1
  s_cmp_lg_u64 vcc, 0
  s_cbranch_scc0 L_sd_292
  s_sub_u32 s86, s86, 1
  s_cbranch_scc0 L_sp_291
L_sd_292:
  s_add_u32 s78, s6, s93
  buffer_load_dwordx4 v[120:123], v10, s[32:35], s78 offen sc1
  buffer_load_dwordx4 v[124:127], v11, s[32:35], s78 offen sc1
  s_add_u32 s78, s7, s90
  buffer_load_dwordx4 v[168:171], v10, s[32:35], s78 offen sc1
  buffer_load_dwordx4 v[172:175], v11, s[32:35], s78 offen sc1
  s_add_u32 s78, s7, s91
  buffer_load_dwordx4 v[80:83], v10, s[32:35], s78 offen sc1
  buffer_load_dwordx4 v[84:87], v11, s[32:35], s78 offen sc1
  s_add_u32 s78, s7, s92
  buffer_load_dwordx4 v[176:179], v10, s[32:35], s78 offen sc1
  buffer_load_dwordx4 v[180:183], v11, s[32:35], s78 offen sc1
  s_add_u32 s78, s7, s93
  buffer_load_dwordx4 v[128:131], v10, s[32:35], s78 offen sc1
  buffer_load_dwordx4 v[132:135], v11, s[32:35], s78 offen sc1
  s_waitcnt vmcnt(10)
  s_branch L_cont_290
L_slow_293:
  s_mov_b32 s86, 65536
L_sp_295:
  s_sleep 1
  s_add_u32 s78, s6, s93
  buffer_load_dwordx4 v[120:123], v10, s[32:35], s78 offen sc1
  buffer_load_dwordx4 v[124:127], v11, s[32:35], s78 offen sc1
  s_waitcnt vmcnt(0)
  v_xor_b32 v120, v120, v14
  v_xor_b32 v122, v122, v15
  v_xor_b32 v124, v124, v14
  v_xor_b32 v126, v126, v15
  v_bitop3_b32 v2, v120, v122, v120 bitop3:0xf3
  v_bitop3_b32 v2, v124, v126, v2 bitop3:0xfb
  v_and_b32 v2, s3, v2
  v_cmp_ne_u32 vcc, 0, v2
  s_nop 1
  s_cmp_lg_u64 vcc, 0
  s_cbranch_scc0 L_sd_296
  s_sub_u32 s86, s86, 1
  s_cbranch_scc0 L_sp_295
L_sd_296:
  s_add_u32 s78, s7, s90
  buffer_load_dwordx4 v[168:171], v10, s[32:35], s78 offen sc1
  buffer_load_dwordx4 v[172:175], v11, s[32:35], s78 offen sc1
  s_add_u32 s78, s7, s91
  buffer_load_dwordx4 v[80:83], v10, s[32:35], s78 offen sc1
  buffer_load_dwordx4 v[84:87], v11, s[32:35], s78 offen sc1
  s_add_u32 s78, s7, s92
  buffer_load_dwordx4 v[176:179], v10, s[32:35], s78 offen sc1
  buffer_load_dwordx4 v[180:183], v11, s[32:35], s78 offen sc1
  s_add_u32 s78, s7, s93
  buffer_load_dwordx4 v[128:131], v10, s[32:35], s78 offen sc1
  buffer_load_dwordx4 v[132:135], v11, s[32:35], s78 offen sc1
  buffer_load_dwordx4 v[136:139], v4, s[28:31], 0 offen
  buffer_load_dwordx4 v[140:143], v4, s[28:31], 0 offen offset:32
  s_waitcnt vmcnt(10)
  s_branch L_cont_294
L_slow_297:
  s_mov_b32 s86, 65536
L_sp_299:
  s_sleep 1
  s_add_u32 s78, s7, s90
  buffer_load_dwordx4 v[168:171], v10, s[32:35], s78 offen sc1
  buffer_load_dwordx4 v[172:175], v11, s[32:35], s78 offen sc1
  s_waitcnt vmcnt(0)
  v_xor_b32 v168, v168, v14
  v_xor_b32 v170, v170, v15
  v_xor_b32 v172, v172, v14
  v_xor_b32 v174, v174, v15
  v_bitop3_b32 v2, v168, v170, v168 bitop3:0xf3
  v_bitop3_b32 v2, v172, v174, v2 bitop3:0xfb
  v_and_b32 v2, s3, v2
  v_cmp_ne_u32 vcc, 0, v2
  s_nop 1
  s_cmp_lg_u64 vcc, 0
  s_cbranch_scc0 L_sd_300
  s_sub_u32 s86, s86, 1
  s_cbranch_scc0 L_sp_299
L_sd_300:
  s_add_u32 s78, s7, s91
  buffer_load_dwordx4 v[80:83], v10, s[32:35], s78 offen sc1
  buffer_load_dwordx4 v[84:87], v11, s[32:35], s78 offen sc1
  s_add_u32 s78, s7, s92
  buffer_load_dwordx4 v[176:179], v10, s[32:35], s78 offen sc1
  buffer_load_dwordx4 v[180:183], v11, s[32:35], s78 offen sc1
  s_add_u32 s78, s7, s93
  buffer_load_dwordx4 v[128:131], v10, s[32:35], s78 offen sc1
  buffer_load_dwordx4 v[132:135], v11, s[32:35], s78 offen sc1
  buffer_load_dwordx4 v[136:139], v4, s[28:31], 0 offen
  buffer_load_dwordx4 v[140:143], v4, s[28:31], 0 offen offset:32
  s_waitcnt vmcnt(8)
  s_branch L_cont_298
L_slow_301:
  s_mov_b32 s86, 65536
L_sp_303:
  s_sleep 1
  s_add_u32 s78, s7, s91
  buffer_load_dwordx4 v[80:83], v10, s[32:35], s78 offen sc1
  buffer_load_dwordx4 v[84:87], v11, s[32:35], s78 offen sc1
  s_waitcnt vmcnt(0)
  v_xor_b32 v80, v80, v14
  v_xor_b32 v82, v82, v15
  v_xor_b32 v84, v84, v14
  v_xor_b32 v86, v86, v15
  v_bitop3_b32 v2, v80, v82, v80 bitop3:0xf3
  v_bitop3_b32 v2, v84, v86, v2 bitop3:0xfb
  v_and_b32 v2, s3, v2
  v_cmp_ne_u32 vcc, 0, v2
  s_nop 1
  s_cmp_lg_u64 vcc, 0
  s_cbranch_scc0 L_sd_304
  s_sub_u32 s86, s86, 1
  s_cbranch_scc0 L_sp_303
L_sd_304:
  s_add_u32 s78, s7, s92
  buffer_load_dwordx4 v[176:179], v10, s[32:35], s78 offen sc1
  buffer_load_dwordx4 v[180:183], v11, s[32:35], s78 offen sc1
  s_add_u32 s78, s7, s93
  buffer_load_dwordx4 v[128:131], v10, s[32:35], s78 offen sc1
  buffer_load_dwordx4 v[132:135], v11, s[32:35], s78 offen sc1
  buffer_load_dwordx4 v[136:139], v4, s[28:31], 0 offen
  buffer_load_dwordx4 v[140:143], v4, s[28:31], 0 offen offset:32
  s_waitcnt vmcnt(6)
  s_branch L_cont_302
L_slow_305:
  s_mov_b32 s86, 65536
L_sp_307:
  s_sleep 1
  s_add_u32 s78, s7, s92
  buffer_load_dwordx4 v[176:179], v10, s[32:35], s78 offen sc1
  buffer_load_dwordx4 v[180:183], v11, s[32:35], s78 offen sc1
  s_waitcnt vmcnt(0)
  v_xor_b32 v176, v176, v14
  v_xor_b32 v178, v178, v15
  v_xor_b32 v180, v180, v14
  v_xor_b32 v182, v182, v15
  v_bitop3_b32 v2, v176, v178, v176 bitop3:0xf3
  v_bitop3_b32 v2, v180, v182, v2 bitop3:0xfb
  v_and_b32 v2, s3, v2
  v_cmp_ne_u32 vcc, 0, v2
  s_nop 1
  s_cmp_lg_u64 vcc, 0
  s_cbranch_scc0 L_sd_308
  s_sub_u32 s86, s86, 1
  s_cbranch_scc0 L_sp_307
L_sd_308:
  s_add_u32 s78, s7, s93
  buffer_load_dwordx4 v[128:131], v10, s[32:35], s78 offen sc1
  buffer_load_dwordx4 v[132:135], v11, s[32:35], s78 offen sc1
  buffer_load_dwordx4 v[136:139], v4, s[28:31], 0 offen
  buffer_load_dwordx4 v[140:143], v4, s[28:31], 0 offen offset:32
  s_waitcnt vmcnt(4)
  s_branch L_cont_306
L_slow_309:
  s_mov_b32 s86, 65536
L_sp_311:
  s_sleep 1
  s_add_u32 s78, s7, s93
  buffer_load_dwordx4 v[128:131], v10, s[32:35], s78 offen sc1
  buffer_load_dwordx4 v[132:135], v11, s[32:35], s78 offen sc1
  s_waitcnt vmcnt(0)
  v_xor_b32 v128, v128, v14
  v_xor_b32 v130, v130, v15
  v_xor_b32 v132, v132, v14
  v_xor_b32 v134, v134, v15
  v_bitop3_b32 v2, v128, v130, v128 bitop3:0xf3
  v_bitop3_b32 v2, v132, v134, v2 bitop3:0xfb
  v_and_b32 v2, s3, v2
  v_cmp_ne_u32 vcc, 0, v2
  s_nop 1
  s_cmp_lg_u64 vcc, 0
  s_cbranch_scc0 L_sd_312
  s_sub_u32 s86, s86, 1
  s_cbranch_scc0 L_sp_311
L_sd_312:
  buffer_load_dwordx4 v[136:139], v4, s[28:31], 0 offen
  buffer_load_dwordx4 v[140:143], v4, s[28:31], 0 offen offset:32
  s_waitcnt vmcnt(2)
  s_branch L_cont_310
L_end:
  s_endpgm
L_codeend:

.section .rodata,"a"
.p2align 6
.amdhsa_kernel parallel_sum__linear_kernel_hedgehog__glu_gated_glu__prompt_kernel
  .amdhsa_next_free_vgpr 256
  .amdhsa_next_free_sgpr 102
  .amdhsa_accum_offset 256
  .amdhsa_group_segment_fixed_size 0
  .amdhsa_kernarg_size 88
  .amdhsa_user_sgpr_count 2
  .amdhsa_user_sgpr_kernarg_segment_ptr 1
  .amdhsa_system_sgpr_workgroup_id_x 1
.end_amdhsa_kernel
```
